```python
import torch

def _softmax(x, axis=-1):
    return torch.softmax(x, dim=axis)

def _gelu(x):
    return torch.nn.functional.gelu(x, approximate='tanh')

def _silu(x):
    return torch.nn.functional.silu(x)

def _sigmoid(x):
    return torch.sigmoid(x)

def _layernorm(x, axis=-1, eps=1e-05):
    m = x.mean(dim=axis, keepdim=True)
    v = x.var(dim=axis, keepdim=True, unbiased=False)
    return (x - m) / torch.sqrt(v + eps)

def _scatter_add(tgt, idx, src, axis=0):
    return tgt.clone().index_add_(axis, idx, src)

def _segment_sum(src, seg, n):
    out = torch.zeros((n,) + src.shape[1:], dtype=src.dtype)
    return out.index_add_(0, seg, src)

def _pad(x, pw):
    flat = tuple((v for pair in reversed(pw) for v in pair))
    return torch.nn.functional.pad(x, flat)
kernel_name = 'interleave_layers__memory_aug_recurrent_mem_tr__mha_block__prompt'

def setup_inputs():

    _w = lambda a: (lambda t: t.to(torch.bfloat16) if t.is_floating_point() else t)(torch.as_tensor(a))

    def _A_setup():
        B, S, Dm = (1, 2048, 576)
        H, Dh = (32, 128)
        M, seg = (8, 32)
        seg = min(seg, S)
        S = S // seg * seg
        return {'x': _w((lambda *s: torch.randn(*s, dtype=torch.bfloat16) * 0.05)(B, S, Dm)), 'mem0': _w((lambda *s: torch.randn(*s, dtype=torch.bfloat16) * 0.2)(B, M, Dm)), 'Wq': _w((lambda *s: torch.randn(*s, dtype=torch.bfloat16) * 1.6)(Dm, H, Dh) * Dm ** (-0.5)), 'Wk': _w((lambda *s: torch.randn(*s, dtype=torch.bfloat16) * 1.6)(Dm, H, Dh) * Dm ** (-0.5)), 'Wv': _w((lambda *s: torch.randn(*s, dtype=torch.bfloat16) * 0.2)(Dm, H, Dh) * Dm ** (-0.5)), 'Wo': _w((lambda *s: torch.randn(*s, dtype=torch.bfloat16) * 0.2)(H, Dh, Dm) * (H * Dh) ** (-0.5)), 'seg_len': seg}
    _A_in = _A_setup()

    def _B_setup():
        B, S, D, H = (1, 2048, 576, 32)
        return {'x': _w((lambda *s: torch.randn(*s, dtype=torch.bfloat16) * 0.05)(B, S, D)), 'wqkv': _w((lambda *s: torch.randn(*s, dtype=torch.bfloat16) * 0.05)(D, 3 * D)), 'wo': _w((lambda *s: torch.randn(*s, dtype=torch.bfloat16) * 0.05)(D, D))}
    _B_in = _B_setup()
    return {'A_x': _A_in['x'], 'A_mem0': _A_in['mem0'], 'A_Wq': _A_in['Wq'], 'A_Wk': _A_in['Wk'], 'A_Wv': _A_in['Wv'], 'A_Wo': _A_in['Wo'], 'A_seg_len': _A_in['seg_len'], 'B_x': _B_in['x'], 'B_wqkv': _B_in['wqkv'], 'B_wo': _B_in['wo']}

def reference(A_x, A_mem0, A_Wq, A_Wk, A_Wv, A_Wo, A_seg_len, B_x, B_wqkv, B_wo):

    def _A_ref(x, mem0, Wq, Wk, Wv, Wo, seg_len):
        B, S, Dm = x.shape
        H, Dh = (Wq.shape[1], Wq.shape[2])
        M = mem0.shape[1]
        scale = Dh ** (-0.5)
        n_seg = S // seg_len
        L = M + seg_len
        idx = torch.arange(L)
        mask = (idx[:, None] < M) | (idx[:, None] >= idx[None, :])
        mem = mem0
        outs = []
        for s in range(n_seg):
            xs = x[:, s * seg_len:(s + 1) * seg_len, :].clone()
            h = torch.concatenate([mem, xs], axis=1)
            q = torch.einsum('btd,dhe->bhte', h, Wq)
            k = torch.einsum('btd,dhe->bhte', h, Wk)
            v = torch.einsum('btd,dhe->bhte', h, Wv)
            scores = torch.einsum('bhqe,bhke->bhqk', q, k) * scale
            scores = torch.where(mask[None, None], scores, -1000000000.0)
            p = _softmax(scores, axis=-1)
            o = torch.einsum('bhqk,bhke->bhqe', p, v)
            o = torch.einsum('bhte,hed->btd', o, Wo)
            mem = o[:, :M, :].clone()
            outs.append(o[:, M:, :])
        return torch.concatenate(outs, axis=1)

    def _B_ref(x, wqkv, wo):
        B, S, D = x.shape
        H = 32
        Dh = D // H
        qkv = (lambda x, *d: x.permute(*d))((x @ wqkv).reshape(B, S, 3, H, Dh), 2, 0, 3, 1, 4)
        q, k, v = (qkv[0], qkv[1], qkv[2])
        scores = torch.einsum('bhqd,bhkd->bhqk', q, k) * Dh ** (-0.5)
        p = _softmax(scores, axis=-1)
        o = torch.einsum('bhqk,bhkd->bhqd', p, v)
        return (lambda x, *d: x.permute(*d))(o, 0, 2, 1, 3).reshape(B, S, D) @ wo
    x = A_x
    x = x + _A_ref(_layernorm(x, axis=-1), A_mem0, A_Wq, A_Wk, A_Wv, A_Wo, A_seg_len)
    x = x + _B_ref(_layernorm(x, axis=-1), B_wqkv, B_wo)
    x = x + _A_ref(_layernorm(x, axis=-1), A_mem0, A_Wq, A_Wk, A_Wv, A_Wo, A_seg_len)
    x = x + _B_ref(_layernorm(x, axis=-1), B_wqkv, B_wo)
    return x
```

```asm
; @launch grid=(256,1,1) block=(256,1,1) lds=163840
.amdgcn_target "amdgcn-amd-amdhsa--gfx950"
.text
.globl interleave_layers__memory_aug_recurrent_mem_tr__mha_block__prompt_kernel
.p2align 8
.type interleave_layers__memory_aug_recurrent_mem_tr__mha_block__prompt_kernel,@function
interleave_layers__memory_aug_recurrent_mem_tr__mha_block__prompt_kernel:
s_cmp_lt_u32 s2,256
s_cbranch_scc1 k_go
k_end:
s_endpgm
k_go:
s_getreg_b32 s3,hwreg(HW_REG_XCC_ID,0,3)
s_lshl_b32 s3,s3,2
s_lshr_b32 s3,0x37260154,s3
s_and_b32 s3,s3,7
s_add_u32 s3,s3,1
v_lshlrev_b32 v2,4,v0
s_getpc_b64 s[16:17]
k_pc:
s_lshr_b32 s18,s2,3
s_lshl_b32 s18,s18,5
v_add_u32 v4,s18,v0
v_lshlrev_b32 v4,7,v4
v_cmp_gt_u32 vcc,32,v0
v_min_u32 v4,k_last-k_pc,v4
v_mov_b32 v7,s17
s_and_saveexec_b64 s[18:19],vcc
s_cbranch_execz k_pc2
v_add_co_u32 v6,vcc,s16,v4
s_nop 1
v_addc_co_u32 v7,vcc,0,v7,vcc
global_load_dword v20,v[6:7],off sc1
k_pc2:
s_mov_b64 exec,s[18:19]
s_load_dwordx8 s[64:71],s[0:1],0
s_load_dwordx4 s[72:75],s[0:1],32
s_load_dwordx4 s[92:95],s[0:1],64
s_load_dwordx2 s[96:97],s[0:1],80
s_load_dwordx4 s[4:7],s[0:1],88
v_lshrrev_b32 v1,6,v0
s_nop 0
v_readfirstlane_b32 s21,v1
v_and_b32_e64 v0,63,v0
s_waitcnt lgkmcnt(0)
s_mov_b32 s8,s6
s_mov_b32 s9,s7
s_mov_b32 s10,268435456
s_mov_b32 s11,0x20000
s_mov_b32 s23,0
s_mov_b32 s101,s2
s_lshr_b32 s60,s2,7
s_mul_i32 s60,s60,16777216
s_and_b32 s61,s2,127
s_lshl_b32 s62,s61,11
s_add_u32 s62,s62,s60
s_add_u32 s62,s62,6291456
s_lshl_b32 s61,s61,13
s_add_u32 s61,s61,s60
s_add_u32 s61,s61,8388608
s_add_u32 s60,s61,4096
v_lshrrev_b32 v3,1,v2
v_mov_b32 v4,-1
v_mov_b32 v5,-1
v_mov_b32 v6,-1
v_mov_b32 v7,-1
v_mov_b32 v8,0
v_mov_b32 v9,0
buffer_store_dwordx2 v[8:9],v3,s[8:11],s62 offen sc1
buffer_store_dwordx4 v[4:7],v2,s[8:11],s61 offen sc1
buffer_store_dwordx4 v[4:7],v2,s[8:11],s60 offen sc1
s_add_u32 s61,s61,12582912
v_lshlrev_b32_e64 v3,1,v2
s_mov_b32 exec_lo,0x11111111
s_mov_b32 exec_hi,0x11111111
buffer_store_dword v8,v3,s[8:11],s61 offen sc1
s_mov_b64 exec,-1
s_lshl_b32 s61,s2,11
s_add_u32 s61,s61,0
v_lshrrev_b32 v3,1,v2
buffer_store_dwordx2 v[4:5],v3,s[8:11],s61 offen sc1
s_lshl_b32 s61,s2,13
s_add_u32 s61,s61,2097152
s_add_u32 s60,s61,4096
buffer_store_dwordx4 v[4:7],v2,s[8:11],s61 offen sc1
buffer_store_dwordx4 v[4:7],v2,s[8:11],s60 offen sc1
s_sub_u32 s60,s3,1
s_and_b32 s60,s60,7
s_lshl_b32 s60,s60,5
s_lshr_b32 s24,s2,3
s_add_u32 s24,s24,s60
s_mov_b32 s19,0
s_waitcnt vmcnt(7)
s_mov_b32 s10,268435456
s_cmp_lt_u32 s24,32
s_cbranch_scc1 k_role
s_waitcnt vmcnt(0)
s_barrier
s_cmp_eq_u32 s21,0
s_cbranch_scc0 ann_1
v_mov_b32 v10,s2
v_mov_b32_e64 v11,s3
s_mov_b64 exec,1
global_store_byte v10,v11,s[4:5] sc1
s_mov_b64 exec,-1
ann_1:
k_role:
s_mov_b32 s101,s24
v_mbcnt_lo_u32_b32 v0,-1,0
v_mbcnt_hi_u32_b32 v0,-1,v0
s_barrier
s_cmp_lt_u32 s24,32
s_cbranch_scc1 chain
worker:
s_sub_u32 s24,255,s24
s_mov_b32 s38,0
s_add_u32 s101,s24,32
s_mov_b32 s12,s64
s_mov_b32 s13,s65
s_mov_b32 s14,2359296
s_mov_b32 s15,0x20000
s_mov_b32 s88,s6
s_mov_b32 s89,s7
s_mov_b32 s90,268435456
s_mov_b32 s91,0x20000
s_cmp_ge_u32 s24,128
s_cbranch_scc1 w_pipe
s_lshr_b32 s25,s24,2
s_and_b32 s22,s24,3
s_mov_b32 s76,s68
s_mov_b32 s77,s69
s_mov_b32 s78,4718592
s_mov_b32 s79,0x20000
s_mov_b32 s80,s70
s_mov_b32 s81,s71
s_mov_b32 s82,4718592
s_mov_b32 s83,0x20000
s_mov_b32 s84,s72
s_mov_b32 s85,s73
s_mov_b32 s86,4718592
s_mov_b32 s87,0x20000
s_lshl_b32 s61,s21,2
v_lshrrev_b32 v10,4,v0
v_and_b32 v11,15,v0
v_lshlrev_b32 v12,1,v10
v_xor_b32 v12,v12,v11
v_lshlrev_b32 v12,4,v12
v_bfe_u32 v11,v0,2,3
v_lshlrev_b32_e64 v11,1,v11
v_bfe_u32 v15,v0,1,1
v_add_u32 v15,s61,v15
v_xor_b32 v15,v15,v11
v_lshlrev_b32 v15,4,v15
v_and_b32 v11,1,v0
v_lshl_add_u32 v15,v11,3,v15
v_bfe_u32 v11,v0,2,2
v_lshl_add_u32 v10,v10,3,v11
v_lshl_add_u32 v14,v10,8,v15
v_xor_b32 v15,32,v14
v_lshrrev_b32 v10,4,v0
v_lshl_add_u32 v12,v10,13,v12
v_xor_b32 v13,0x80,v12
s_lshl_b32 s62,s25,8
s_lshl_b32 s61,s21,17
s_add_u32 s62,s62,s61
s_lshl_b32 s63,s21,12
s_barrier
s_add_u32 s60,s62,0
s_add_u32 m0,s63,40960
s_nop 0
buffer_load_dwordx4 v12,s[80:83],s60 offen lds
s_add_u32 s60,s62,32768
s_add_u32 m0,s63,41984
s_nop 0
buffer_load_dwordx4 v12,s[80:83],s60 offen lds
s_add_u32 s60,s62,65536
s_add_u32 m0,s63,43008
s_nop 0
buffer_load_dwordx4 v13,s[80:83],s60 offen lds
s_add_u32 s60,s62,98304
s_add_u32 m0,s63,44032
s_nop 0
buffer_load_dwordx4 v13,s[80:83],s60 offen lds
s_add_u32 s60,s62,524288
s_add_u32 m0,s63,106496
s_nop 0
buffer_load_dwordx4 v12,s[80:83],s60 offen lds
s_add_u32 s60,s62,557056
s_add_u32 m0,s63,107520
s_nop 0
buffer_load_dwordx4 v12,s[80:83],s60 offen lds
s_add_u32 s60,s62,589824
s_add_u32 m0,s63,108544
s_nop 0
buffer_load_dwordx4 v13,s[80:83],s60 offen lds
s_add_u32 s60,s62,622592
s_add_u32 m0,s63,109568
s_nop 0
buffer_load_dwordx4 v13,s[80:83],s60 offen lds
s_add_u32 s60,s62,1048576
s_add_u32 m0,s63,122880
s_nop 0
buffer_load_dwordx4 v12,s[80:83],s60 offen lds
s_add_u32 s60,s62,1081344
s_add_u32 m0,s63,123904
s_nop 0
buffer_load_dwordx4 v12,s[80:83],s60 offen lds
s_add_u32 s60,s62,1114112
s_add_u32 m0,s63,124928
s_nop 0
buffer_load_dwordx4 v13,s[80:83],s60 offen lds
s_add_u32 s60,s62,1146880
s_add_u32 m0,s63,125952
s_nop 0
buffer_load_dwordx4 v13,s[80:83],s60 offen lds
s_waitcnt vmcnt(8) lgkmcnt(0)
s_barrier
s_add_u32 s60,s62,1572864
s_add_u32 m0,s63,139264
s_nop 0
buffer_load_dwordx4 v12,s[80:83],s60 offen lds
s_add_u32 s60,s62,1605632
s_add_u32 m0,s63,140288
s_nop 0
buffer_load_dwordx4 v12,s[80:83],s60 offen lds
s_add_u32 s60,s62,1638400
s_add_u32 m0,s63,141312
s_nop 0
buffer_load_dwordx4 v13,s[80:83],s60 offen lds
s_add_u32 s60,s62,1671168
s_add_u32 m0,s63,142336
s_nop 0
buffer_load_dwordx4 v13,s[80:83],s60 offen lds
v_add_u32 v10,40960,v14
ds_read_b64_tr_b16 a[0:1],v10
ds_read_b64_tr_b16 a[2:3],v10 offset:1024
ds_read_b64_tr_b16 a[4:5],v10 offset:8192
ds_read_b64_tr_b16 a[6:7],v10 offset:9216
v_add_u32 v11,40960,v15
ds_read_b64_tr_b16 a[72:73],v11
ds_read_b64_tr_b16 a[74:75],v11 offset:1024
ds_read_b64_tr_b16 a[76:77],v11 offset:8192
ds_read_b64_tr_b16 a[78:79],v11 offset:9216
s_waitcnt vmcnt(8) lgkmcnt(0)
s_barrier
s_add_u32 s60,s62,2097152
s_add_u32 m0,s63,40960
s_nop 0
buffer_load_dwordx4 v12,s[80:83],s60 offen lds
s_add_u32 s60,s62,2129920
s_add_u32 m0,s63,41984
s_nop 0
buffer_load_dwordx4 v12,s[80:83],s60 offen lds
s_add_u32 s60,s62,2162688
s_add_u32 m0,s63,43008
s_nop 0
buffer_load_dwordx4 v13,s[80:83],s60 offen lds
s_add_u32 s60,s62,2195456
s_add_u32 m0,s63,44032
s_nop 0
buffer_load_dwordx4 v13,s[80:83],s60 offen lds
v_add_u32 v10,106496,v14
ds_read_b64_tr_b16 a[8:9],v10
ds_read_b64_tr_b16 a[10:11],v10 offset:1024
ds_read_b64_tr_b16 a[12:13],v10 offset:8192
ds_read_b64_tr_b16 a[14:15],v10 offset:9216
v_add_u32 v11,106496,v15
ds_read_b64_tr_b16 a[80:81],v11
ds_read_b64_tr_b16 a[82:83],v11 offset:1024
ds_read_b64_tr_b16 a[84:85],v11 offset:8192
ds_read_b64_tr_b16 a[86:87],v11 offset:9216
s_waitcnt vmcnt(8) lgkmcnt(0)
s_barrier
s_add_u32 s60,s62,2621440
s_add_u32 m0,s63,106496
s_nop 0
buffer_load_dwordx4 v12,s[80:83],s60 offen lds
s_add_u32 s60,s62,2654208
s_add_u32 m0,s63,107520
s_nop 0
buffer_load_dwordx4 v12,s[80:83],s60 offen lds
s_add_u32 s60,s62,2686976
s_add_u32 m0,s63,108544
s_nop 0
buffer_load_dwordx4 v13,s[80:83],s60 offen lds
s_add_u32 s60,s62,2719744
s_add_u32 m0,s63,109568
s_nop 0
buffer_load_dwordx4 v13,s[80:83],s60 offen lds
v_add_u32 v10,122880,v14
ds_read_b64_tr_b16 a[16:17],v10
ds_read_b64_tr_b16 a[18:19],v10 offset:1024
ds_read_b64_tr_b16 a[20:21],v10 offset:8192
ds_read_b64_tr_b16 a[22:23],v10 offset:9216
v_add_u32 v11,122880,v15
ds_read_b64_tr_b16 a[88:89],v11
ds_read_b64_tr_b16 a[90:91],v11 offset:1024
ds_read_b64_tr_b16 a[92:93],v11 offset:8192
ds_read_b64_tr_b16 a[94:95],v11 offset:9216
s_waitcnt vmcnt(8) lgkmcnt(0)
s_barrier
s_add_u32 s60,s62,3145728
s_add_u32 m0,s63,122880
s_nop 0
buffer_load_dwordx4 v12,s[80:83],s60 offen lds
s_add_u32 s60,s62,3178496
s_add_u32 m0,s63,123904
s_nop 0
buffer_load_dwordx4 v12,s[80:83],s60 offen lds
s_add_u32 s60,s62,3211264
s_add_u32 m0,s63,124928
s_nop 0
buffer_load_dwordx4 v13,s[80:83],s60 offen lds
s_add_u32 s60,s62,3244032
s_add_u32 m0,s63,125952
s_nop 0
buffer_load_dwordx4 v13,s[80:83],s60 offen lds
v_add_u32 v10,139264,v14
ds_read_b64_tr_b16 a[24:25],v10
ds_read_b64_tr_b16 a[26:27],v10 offset:1024
ds_read_b64_tr_b16 a[28:29],v10 offset:8192
ds_read_b64_tr_b16 a[30:31],v10 offset:9216
v_add_u32 v11,139264,v15
ds_read_b64_tr_b16 a[96:97],v11
ds_read_b64_tr_b16 a[98:99],v11 offset:1024
ds_read_b64_tr_b16 a[100:101],v11 offset:8192
ds_read_b64_tr_b16 a[102:103],v11 offset:9216
s_waitcnt vmcnt(8) lgkmcnt(0)
s_barrier
s_add_u32 s60,s62,3670016
s_add_u32 m0,s63,139264
s_nop 0
buffer_load_dwordx4 v12,s[80:83],s60 offen lds
s_add_u32 s60,s62,3702784
s_add_u32 m0,s63,140288
s_nop 0
buffer_load_dwordx4 v12,s[80:83],s60 offen lds
s_add_u32 s60,s62,3735552
s_add_u32 m0,s63,141312
s_nop 0
buffer_load_dwordx4 v13,s[80:83],s60 offen lds
s_add_u32 s60,s62,3768320
s_add_u32 m0,s63,142336
s_nop 0
buffer_load_dwordx4 v13,s[80:83],s60 offen lds
v_add_u32 v10,40960,v14
ds_read_b64_tr_b16 a[32:33],v10
ds_read_b64_tr_b16 a[34:35],v10 offset:1024
ds_read_b64_tr_b16 a[36:37],v10 offset:8192
ds_read_b64_tr_b16 a[38:39],v10 offset:9216
v_add_u32 v11,40960,v15
ds_read_b64_tr_b16 a[104:105],v11
ds_read_b64_tr_b16 a[106:107],v11 offset:1024
ds_read_b64_tr_b16 a[108:109],v11 offset:8192
ds_read_b64_tr_b16 a[110:111],v11 offset:9216
s_waitcnt vmcnt(8) lgkmcnt(0)
s_barrier
s_add_u32 s60,s62,4194304
s_add_u32 m0,s63,40960
s_nop 0
buffer_load_dwordx4 v12,s[80:83],s60 offen lds
s_add_u32 s60,s62,4227072
s_add_u32 m0,s63,41984
s_nop 0
buffer_load_dwordx4 v12,s[80:83],s60 offen lds
s_add_u32 s60,s62,4259840
s_add_u32 m0,s63,43008
s_nop 0
buffer_load_dwordx4 v13,s[80:83],s60 offen lds
s_add_u32 s60,s62,4292608
s_add_u32 m0,s63,44032
s_nop 0
buffer_load_dwordx4 v13,s[80:83],s60 offen lds
v_add_u32 v10,106496,v14
ds_read_b64_tr_b16 a[40:41],v10
ds_read_b64_tr_b16 a[42:43],v10 offset:1024
ds_read_b64_tr_b16 a[44:45],v10 offset:8192
ds_read_b64_tr_b16 a[46:47],v10 offset:9216
v_add_u32 v11,106496,v15
ds_read_b64_tr_b16 a[112:113],v11
ds_read_b64_tr_b16 a[114:115],v11 offset:1024
ds_read_b64_tr_b16 a[116:117],v11 offset:8192
ds_read_b64_tr_b16 a[118:119],v11 offset:9216
s_waitcnt vmcnt(8) lgkmcnt(0)
s_barrier
s_add_u32 s60,s62,0
s_add_u32 m0,s63,106496
s_nop 0
buffer_load_dwordx4 v12,s[84:87],s60 offen lds
s_add_u32 s60,s62,32768
s_add_u32 m0,s63,107520
s_nop 0
buffer_load_dwordx4 v12,s[84:87],s60 offen lds
s_add_u32 s60,s62,65536
s_add_u32 m0,s63,108544
s_nop 0
buffer_load_dwordx4 v13,s[84:87],s60 offen lds
s_add_u32 s60,s62,98304
s_add_u32 m0,s63,109568
s_nop 0
buffer_load_dwordx4 v13,s[84:87],s60 offen lds
v_add_u32 v10,122880,v14
ds_read_b64_tr_b16 a[48:49],v10
ds_read_b64_tr_b16 a[50:51],v10 offset:1024
ds_read_b64_tr_b16 a[52:53],v10 offset:8192
ds_read_b64_tr_b16 a[54:55],v10 offset:9216
v_add_u32 v11,122880,v15
ds_read_b64_tr_b16 a[120:121],v11
ds_read_b64_tr_b16 a[122:123],v11 offset:1024
ds_read_b64_tr_b16 a[124:125],v11 offset:8192
ds_read_b64_tr_b16 a[126:127],v11 offset:9216
s_waitcnt vmcnt(8) lgkmcnt(0)
s_barrier
s_add_u32 s60,s62,524288
s_add_u32 m0,s63,122880
s_nop 0
buffer_load_dwordx4 v12,s[84:87],s60 offen lds
s_add_u32 s60,s62,557056
s_add_u32 m0,s63,123904
s_nop 0
buffer_load_dwordx4 v12,s[84:87],s60 offen lds
s_add_u32 s60,s62,589824
s_add_u32 m0,s63,124928
s_nop 0
buffer_load_dwordx4 v13,s[84:87],s60 offen lds
s_add_u32 s60,s62,622592
s_add_u32 m0,s63,125952
s_nop 0
buffer_load_dwordx4 v13,s[84:87],s60 offen lds
v_add_u32 v10,139264,v14
ds_read_b64_tr_b16 a[56:57],v10
ds_read_b64_tr_b16 a[58:59],v10 offset:1024
ds_read_b64_tr_b16 a[60:61],v10 offset:8192
ds_read_b64_tr_b16 a[62:63],v10 offset:9216
v_add_u32 v11,139264,v15
ds_read_b64_tr_b16 a[128:129],v11
ds_read_b64_tr_b16 a[130:131],v11 offset:1024
ds_read_b64_tr_b16 a[132:133],v11 offset:8192
ds_read_b64_tr_b16 a[134:135],v11 offset:9216
s_waitcnt vmcnt(8) lgkmcnt(0)
s_barrier
s_add_u32 s60,s62,1048576
s_add_u32 m0,s63,139264
s_nop 0
buffer_load_dwordx4 v12,s[84:87],s60 offen lds
s_add_u32 s60,s62,1081344
s_add_u32 m0,s63,140288
s_nop 0
buffer_load_dwordx4 v12,s[84:87],s60 offen lds
s_add_u32 s60,s62,1114112
s_add_u32 m0,s63,141312
s_nop 0
buffer_load_dwordx4 v13,s[84:87],s60 offen lds
s_add_u32 s60,s62,1146880
s_add_u32 m0,s63,142336
s_nop 0
buffer_load_dwordx4 v13,s[84:87],s60 offen lds
v_add_u32 v10,40960,v14
ds_read_b64_tr_b16 a[64:65],v10
ds_read_b64_tr_b16 a[66:67],v10 offset:1024
ds_read_b64_tr_b16 a[68:69],v10 offset:8192
ds_read_b64_tr_b16 a[70:71],v10 offset:9216
v_add_u32 v11,40960,v15
ds_read_b64_tr_b16 a[136:137],v11
ds_read_b64_tr_b16 a[138:139],v11 offset:1024
ds_read_b64_tr_b16 a[140:141],v11 offset:8192
ds_read_b64_tr_b16 a[142:143],v11 offset:9216
s_waitcnt vmcnt(8) lgkmcnt(0)
s_barrier
s_add_u32 s60,s62,1572864
s_add_u32 m0,s63,40960
s_nop 0
buffer_load_dwordx4 v12,s[84:87],s60 offen lds
s_add_u32 s60,s62,1605632
s_add_u32 m0,s63,41984
s_nop 0
buffer_load_dwordx4 v12,s[84:87],s60 offen lds
s_add_u32 s60,s62,1638400
s_add_u32 m0,s63,43008
s_nop 0
buffer_load_dwordx4 v13,s[84:87],s60 offen lds
s_add_u32 s60,s62,1671168
s_add_u32 m0,s63,44032
s_nop 0
buffer_load_dwordx4 v13,s[84:87],s60 offen lds
v_add_u32 v10,106496,v14
ds_read_b64_tr_b16 a[144:145],v10
ds_read_b64_tr_b16 a[146:147],v10 offset:1024
ds_read_b64_tr_b16 a[148:149],v10 offset:8192
ds_read_b64_tr_b16 a[150:151],v10 offset:9216
v_add_u32 v11,106496,v15
ds_read_b64_tr_b16 a[216:217],v11
ds_read_b64_tr_b16 a[218:219],v11 offset:1024
ds_read_b64_tr_b16 a[220:221],v11 offset:8192
ds_read_b64_tr_b16 a[222:223],v11 offset:9216
s_waitcnt vmcnt(8) lgkmcnt(0)
s_barrier
s_add_u32 s60,s62,2097152
s_add_u32 m0,s63,106496
s_nop 0
buffer_load_dwordx4 v12,s[84:87],s60 offen lds
s_add_u32 s60,s62,2129920
s_add_u32 m0,s63,107520
s_nop 0
buffer_load_dwordx4 v12,s[84:87],s60 offen lds
s_add_u32 s60,s62,2162688
s_add_u32 m0,s63,108544
s_nop 0
buffer_load_dwordx4 v13,s[84:87],s60 offen lds
s_add_u32 s60,s62,2195456
s_add_u32 m0,s63,109568
s_nop 0
buffer_load_dwordx4 v13,s[84:87],s60 offen lds
v_add_u32 v10,122880,v14
ds_read_b64_tr_b16 a[152:153],v10
ds_read_b64_tr_b16 a[154:155],v10 offset:1024
ds_read_b64_tr_b16 a[156:157],v10 offset:8192
ds_read_b64_tr_b16 a[158:159],v10 offset:9216
v_add_u32 v11,122880,v15
ds_read_b64_tr_b16 a[224:225],v11
ds_read_b64_tr_b16 a[226:227],v11 offset:1024
ds_read_b64_tr_b16 a[228:229],v11 offset:8192
ds_read_b64_tr_b16 a[230:231],v11 offset:9216
s_waitcnt vmcnt(8) lgkmcnt(0)
s_barrier
s_add_u32 s60,s62,2621440
s_add_u32 m0,s63,122880
s_nop 0
buffer_load_dwordx4 v12,s[84:87],s60 offen lds
s_add_u32 s60,s62,2654208
s_add_u32 m0,s63,123904
s_nop 0
buffer_load_dwordx4 v12,s[84:87],s60 offen lds
s_add_u32 s60,s62,2686976
s_add_u32 m0,s63,124928
s_nop 0
buffer_load_dwordx4 v13,s[84:87],s60 offen lds
s_add_u32 s60,s62,2719744
s_add_u32 m0,s63,125952
s_nop 0
buffer_load_dwordx4 v13,s[84:87],s60 offen lds
v_add_u32 v10,139264,v14
ds_read_b64_tr_b16 a[160:161],v10
ds_read_b64_tr_b16 a[162:163],v10 offset:1024
ds_read_b64_tr_b16 a[164:165],v10 offset:8192
ds_read_b64_tr_b16 a[166:167],v10 offset:9216
v_add_u32 v11,139264,v15
ds_read_b64_tr_b16 a[232:233],v11
ds_read_b64_tr_b16 a[234:235],v11 offset:1024
ds_read_b64_tr_b16 a[236:237],v11 offset:8192
ds_read_b64_tr_b16 a[238:239],v11 offset:9216
s_waitcnt vmcnt(8) lgkmcnt(0)
s_barrier
s_add_u32 s60,s62,3145728
s_add_u32 m0,s63,139264
s_nop 0
buffer_load_dwordx4 v12,s[84:87],s60 offen lds
s_add_u32 s60,s62,3178496
s_add_u32 m0,s63,140288
s_nop 0
buffer_load_dwordx4 v12,s[84:87],s60 offen lds
s_add_u32 s60,s62,3211264
s_add_u32 m0,s63,141312
s_nop 0
buffer_load_dwordx4 v13,s[84:87],s60 offen lds
s_add_u32 s60,s62,3244032
s_add_u32 m0,s63,142336
s_nop 0
buffer_load_dwordx4 v13,s[84:87],s60 offen lds
v_add_u32 v10,40960,v14
ds_read_b64_tr_b16 a[168:169],v10
ds_read_b64_tr_b16 a[170:171],v10 offset:1024
ds_read_b64_tr_b16 a[172:173],v10 offset:8192
ds_read_b64_tr_b16 a[174:175],v10 offset:9216
v_add_u32 v11,40960,v15
ds_read_b64_tr_b16 a[240:241],v11
ds_read_b64_tr_b16 a[242:243],v11 offset:1024
ds_read_b64_tr_b16 a[244:245],v11 offset:8192
ds_read_b64_tr_b16 a[246:247],v11 offset:9216
s_waitcnt vmcnt(8) lgkmcnt(0)
s_barrier
s_add_u32 s60,s62,3670016
s_add_u32 m0,s63,40960
s_nop 0
buffer_load_dwordx4 v12,s[84:87],s60 offen lds
s_add_u32 s60,s62,3702784
s_add_u32 m0,s63,41984
s_nop 0
buffer_load_dwordx4 v12,s[84:87],s60 offen lds
s_add_u32 s60,s62,3735552
s_add_u32 m0,s63,43008
s_nop 0
buffer_load_dwordx4 v13,s[84:87],s60 offen lds
s_add_u32 s60,s62,3768320
s_add_u32 m0,s63,44032
s_nop 0
buffer_load_dwordx4 v13,s[84:87],s60 offen lds
v_add_u32 v10,106496,v14
ds_read_b64_tr_b16 a[176:177],v10
ds_read_b64_tr_b16 a[178:179],v10 offset:1024
ds_read_b64_tr_b16 a[180:181],v10 offset:8192
ds_read_b64_tr_b16 a[182:183],v10 offset:9216
v_add_u32 v11,106496,v15
ds_read_b64_tr_b16 a[248:249],v11
ds_read_b64_tr_b16 a[250:251],v11 offset:1024
ds_read_b64_tr_b16 a[252:253],v11 offset:8192
ds_read_b64_tr_b16 a[254:255],v11 offset:9216
s_waitcnt vmcnt(8) lgkmcnt(0)
s_barrier
s_add_u32 s60,s62,4194304
s_add_u32 m0,s63,106496
s_nop 0
buffer_load_dwordx4 v12,s[84:87],s60 offen lds
s_add_u32 s60,s62,4227072
s_add_u32 m0,s63,107520
s_nop 0
buffer_load_dwordx4 v12,s[84:87],s60 offen lds
s_add_u32 s60,s62,4259840
s_add_u32 m0,s63,108544
s_nop 0
buffer_load_dwordx4 v13,s[84:87],s60 offen lds
s_add_u32 s60,s62,4292608
s_add_u32 m0,s63,109568
s_nop 0
buffer_load_dwordx4 v13,s[84:87],s60 offen lds
v_add_u32 v10,122880,v14
ds_read_b64_tr_b16 a[184:185],v10
ds_read_b64_tr_b16 a[186:187],v10 offset:1024
ds_read_b64_tr_b16 a[188:189],v10 offset:8192
ds_read_b64_tr_b16 a[190:191],v10 offset:9216
v_add_u32 v11,122880,v15
ds_read_b64_tr_b16 v[80:81],v11
ds_read_b64_tr_b16 v[82:83],v11 offset:1024
ds_read_b64_tr_b16 v[84:85],v11 offset:8192
ds_read_b64_tr_b16 v[86:87],v11 offset:9216
s_waitcnt vmcnt(8) lgkmcnt(0)
s_barrier
v_add_u32 v10,139264,v14
ds_read_b64_tr_b16 a[192:193],v10
ds_read_b64_tr_b16 a[194:195],v10 offset:1024
ds_read_b64_tr_b16 a[196:197],v10 offset:8192
ds_read_b64_tr_b16 a[198:199],v10 offset:9216
v_add_u32 v11,139264,v15
ds_read_b64_tr_b16 v[88:89],v11
ds_read_b64_tr_b16 v[90:91],v11 offset:1024
ds_read_b64_tr_b16 v[92:93],v11 offset:8192
ds_read_b64_tr_b16 v[94:95],v11 offset:9216
s_waitcnt vmcnt(4) lgkmcnt(0)
s_barrier
v_add_u32 v10,40960,v14
ds_read_b64_tr_b16 a[200:201],v10
ds_read_b64_tr_b16 a[202:203],v10 offset:1024
ds_read_b64_tr_b16 a[204:205],v10 offset:8192
ds_read_b64_tr_b16 a[206:207],v10 offset:9216
v_add_u32 v11,40960,v15
ds_read_b64_tr_b16 v[96:97],v11
ds_read_b64_tr_b16 v[98:99],v11 offset:1024
ds_read_b64_tr_b16 v[100:101],v11 offset:8192
ds_read_b64_tr_b16 v[102:103],v11 offset:9216
s_waitcnt vmcnt(0) lgkmcnt(0)
s_barrier
v_add_u32 v10,106496,v14
ds_read_b64_tr_b16 a[208:209],v10
ds_read_b64_tr_b16 a[210:211],v10 offset:1024
ds_read_b64_tr_b16 a[212:213],v10 offset:8192
ds_read_b64_tr_b16 a[214:215],v10 offset:9216
v_add_u32 v11,106496,v15
ds_read_b64_tr_b16 v[104:105],v11
ds_read_b64_tr_b16 v[106:107],v11 offset:1024
ds_read_b64_tr_b16 v[108:109],v11 offset:8192
ds_read_b64_tr_b16 v[110:111],v11 offset:9216
s_waitcnt lgkmcnt(0)
s_barrier
s_cmp_lg_u32 s19,0
s_cbranch_scc1 ver_2
s_mov_b32 s19,1
v_mbcnt_lo_u32_b32 v18,-1,0
v_mbcnt_hi_u32_b32 v18,-1,v18
v_lshlrev_b32 v12,2,v18
s_mov_b32 s63,0
el_3:
global_load_dword v13,v12,s[4:5] sc1
s_add_u32 s63,s63,1
s_cmp_gt_u32 s63,4000000
s_cbranch_scc1 w_fail
s_waitcnt vmcnt(0)
el_3s:
v_bfe_u32 v14,v13,0,8
v_bfe_u32 v15,v13,8,8
v_bfe_u32 v16,v13,16,8
v_bfe_u32 v17,v13,24,8
v_min_u32 v13,v14,v15
v_min3_u32 v13,v13,v16,v17
v_cmp_eq_u32 vcc,0,v13
s_cbranch_vccnz el_3
s_mov_b32 s62,0
elw_4:
s_add_u32 s62,s62,1
s_mov_b32 s61,0
v_cmp_eq_u32 vcc,s62,v14
s_bcnt1_i32_b64 s60,vcc
s_add_u32 s61,s61,s60
v_cmp_eq_u32 vcc,s62,v15
s_bcnt1_i32_b64 s60,vcc
s_add_u32 s61,s61,s60
v_cmp_eq_u32 vcc,s62,v16
s_bcnt1_i32_b64 s60,vcc
s_add_u32 s61,s61,s60
v_cmp_eq_u32 vcc,s62,v17
s_bcnt1_i32_b64 s60,vcc
s_add_u32 s61,s61,s60
s_cmp_ge_u32 s62,16
s_cbranch_scc1 w_fail
s_cmp_lt_u32 s61,32
s_cbranch_scc1 elw_4
s_mov_b32 s61,0
s_mov_b32 s63,0
v_cmp_gt_u32 vcc,s3,v14
s_bcnt1_i32_b64 s60,vcc
s_add_u32 s63,s63,s60
v_add_u32 v13,0,v12
v_cmp_gt_u32 s[16:17],s2,v13
v_cmp_eq_u32 vcc,s3,v14
s_and_b64 vcc,vcc,s[16:17]
s_bcnt1_i32_b64 s60,vcc
s_add_u32 s61,s61,s60
v_cmp_gt_u32 vcc,s3,v15
s_bcnt1_i32_b64 s60,vcc
s_add_u32 s63,s63,s60
v_add_u32 v13,1,v12
v_cmp_gt_u32 s[16:17],s2,v13
v_cmp_eq_u32 vcc,s3,v15
s_and_b64 vcc,vcc,s[16:17]
s_bcnt1_i32_b64 s60,vcc
s_add_u32 s61,s61,s60
v_cmp_gt_u32 vcc,s3,v16
s_bcnt1_i32_b64 s60,vcc
s_add_u32 s63,s63,s60
v_add_u32_e64 v13,2,v12
v_cmp_gt_u32 s[16:17],s2,v13
v_cmp_eq_u32 vcc,s3,v16
s_and_b64 vcc,vcc,s[16:17]
s_bcnt1_i32_b64 s60,vcc
s_add_u32 s61,s61,s60
v_cmp_gt_u32 vcc,s3,v17
s_bcnt1_i32_b64 s60,vcc
s_add_u32 s63,s63,s60
v_add_u32 v13,3,v12
v_cmp_gt_u32 s[16:17],s2,v13
v_cmp_eq_u32 vcc,s3,v17
s_and_b64 vcc,vcc,s[16:17]
s_bcnt1_i32_b64 s60,vcc
s_add_u32 s61,s61,s60
s_add_u32 s18,s61,s63
s_cmp_gt_u32 s62,s3
s_cselect_b32 s60,32,0
s_add_u32 s18,s18,s60
s_cmp_lg_u32 s62,s3
s_cbranch_scc1 eld_5
s_cmp_lt_u32 s61,32
s_cselect_b32 s18,s61,s18
eld_5:
s_sub_u32 s60,255,s24
s_cmp_eq_u32 s60,s18
s_cbranch_scc1 ver_2
s_mov_b32 s24,s18
s_mov_b32 s10,268435456
s_waitcnt vmcnt(0) lgkmcnt(0)
s_branch k_role
ver_2:
g_layer:
s_mul_i32 s60,s23,16777216
s_add_u32 s8,s6,s60
s_addc_u32 s9,s7,0
s_mov_b32 s10,23068672
s_mov_b32 s26,s22
s_barrier
v_lshrrev_b32 v10,3,v0
v_and_b32 v11,7,v0
v_xor_b32 v11,v11,v10
s_lshl_b32 s60,s21,3
v_add_u32 v10,s60,v10
v_mul_u32_u24 v1,1152,v10
v_lshl_add_u32 v1,v11,4,v1
v_lshlrev_b32 v10,2,v10
v_add_u32 v9,37888,v10
s_mul_i32 s60,s21,9216
v_lshlrev_b32 v2,4,v0
v_add_u32 v2,s60,v2
v_lshrrev_b32 v10,4,v0
v_lshlrev_b32 v8,4,v10
v_add_u32 v8,37888,v8
v_and_b32 v11,7,v0
v_xor_b32 v10,v10,v11
v_lshlrev_b32 v10,4,v10
v_lshl_add_u32 v10,v11,7,v10
v_bfe_u32 v11,v0,3,1
v_mul_u32_u24 v11,9216,v11
v_add_u32 v4,v10,v11
v_xor_b32 v3,64,v4
v_and_b32 v10,15,v0
v_lshlrev_b32 v10,2,v10
v_add_u32 v7,37888,v10
s_mov_b32 s31,0
v_lshlrev_b32 v5,4,v0
v_lshrrev_b32 v10,2,v0
v_lshlrev_b32 v10,5,v10
v_and_b32 v11,1,v0
v_lshl_add_u32 v10,v11,4,v10
v_bfe_u32 v11,v0,1,1
v_lshl_add_u32 v6,v11,11,v10
s_cmp_eq_u32 s23,0
s_cbranch_scc0 g_cs1
v_mov_b32 v24,0x3f803f80
v_mov_b32 v25,0x3f803f80
v_mov_b32 v26,0x3f803f80
v_mov_b32 v27,0x3f803f80
s_nop 1
v_mfma_f32_16x16x32_bf16 v[28:31],v[24:27],a[0:3],0
v_mfma_f32_16x16x32_bf16 v[32:35],v[24:27],a[72:75],0
v_mfma_f32_16x16x32_bf16 v[36:39],v[24:27],a[144:147],0
v_mfma_f32_16x16x32_bf16 v[40:43],v[24:27],a[216:219],0
v_mfma_f32_16x16x32_bf16 v[28:31],v[24:27],a[4:7],v[28:31]
v_mfma_f32_16x16x32_bf16 v[32:35],v[24:27],a[76:79],v[32:35]
v_mfma_f32_16x16x32_bf16 v[36:39],v[24:27],a[148:151],v[36:39]
v_mfma_f32_16x16x32_bf16 v[40:43],v[24:27],a[220:223],v[40:43]
v_mfma_f32_16x16x32_bf16 v[28:31],v[24:27],a[8:11],v[28:31]
v_mfma_f32_16x16x32_bf16 v[32:35],v[24:27],a[80:83],v[32:35]
v_mfma_f32_16x16x32_bf16 v[36:39],v[24:27],a[152:155],v[36:39]
v_mfma_f32_16x16x32_bf16 v[40:43],v[24:27],a[224:227],v[40:43]
v_mfma_f32_16x16x32_bf16 v[28:31],v[24:27],a[12:15],v[28:31]
v_mfma_f32_16x16x32_bf16 v[32:35],v[24:27],a[84:87],v[32:35]
v_mfma_f32_16x16x32_bf16 v[36:39],v[24:27],a[156:159],v[36:39]
v_mfma_f32_16x16x32_bf16 v[40:43],v[24:27],a[228:231],v[40:43]
v_mfma_f32_16x16x32_bf16 v[28:31],v[24:27],a[16:19],v[28:31]
v_mfma_f32_16x16x32_bf16 v[32:35],v[24:27],a[88:91],v[32:35]
v_mfma_f32_16x16x32_bf16 v[36:39],v[24:27],a[160:163],v[36:39]
v_mfma_f32_16x16x32_bf16 v[40:43],v[24:27],a[232:235],v[40:43]
v_mfma_f32_16x16x32_bf16 v[28:31],v[24:27],a[20:23],v[28:31]
v_mfma_f32_16x16x32_bf16 v[32:35],v[24:27],a[92:95],v[32:35]
v_mfma_f32_16x16x32_bf16 v[36:39],v[24:27],a[164:167],v[36:39]
v_mfma_f32_16x16x32_bf16 v[40:43],v[24:27],a[236:239],v[40:43]
v_mfma_f32_16x16x32_bf16 v[28:31],v[24:27],a[24:27],v[28:31]
v_mfma_f32_16x16x32_bf16 v[32:35],v[24:27],a[96:99],v[32:35]
v_mfma_f32_16x16x32_bf16 v[36:39],v[24:27],a[168:171],v[36:39]
v_mfma_f32_16x16x32_bf16 v[40:43],v[24:27],a[240:243],v[40:43]
v_mfma_f32_16x16x32_bf16 v[28:31],v[24:27],a[28:31],v[28:31]
v_mfma_f32_16x16x32_bf16 v[32:35],v[24:27],a[100:103],v[32:35]
v_mfma_f32_16x16x32_bf16 v[36:39],v[24:27],a[172:175],v[36:39]
v_mfma_f32_16x16x32_bf16 v[40:43],v[24:27],a[244:247],v[40:43]
v_mfma_f32_16x16x32_bf16 v[28:31],v[24:27],a[32:35],v[28:31]
v_mfma_f32_16x16x32_bf16 v[32:35],v[24:27],a[104:107],v[32:35]
v_mfma_f32_16x16x32_bf16 v[36:39],v[24:27],a[176:179],v[36:39]
v_mfma_f32_16x16x32_bf16 v[40:43],v[24:27],a[248:251],v[40:43]
v_mfma_f32_16x16x32_bf16 v[28:31],v[24:27],a[36:39],v[28:31]
v_mfma_f32_16x16x32_bf16 v[32:35],v[24:27],a[108:111],v[32:35]
v_mfma_f32_16x16x32_bf16 v[36:39],v[24:27],a[180:183],v[36:39]
v_mfma_f32_16x16x32_bf16 v[40:43],v[24:27],a[252:255],v[40:43]
v_mfma_f32_16x16x32_bf16 v[28:31],v[24:27],a[40:43],v[28:31]
v_mfma_f32_16x16x32_bf16 v[32:35],v[24:27],a[112:115],v[32:35]
v_mfma_f32_16x16x32_bf16 v[36:39],v[24:27],a[184:187],v[36:39]
v_mfma_f32_16x16x32_bf16 v[40:43],v[24:27],v[80:83],v[40:43]
v_mfma_f32_16x16x32_bf16 v[28:31],v[24:27],a[44:47],v[28:31]
v_mfma_f32_16x16x32_bf16 v[32:35],v[24:27],a[116:119],v[32:35]
v_mfma_f32_16x16x32_bf16 v[36:39],v[24:27],a[188:191],v[36:39]
v_mfma_f32_16x16x32_bf16 v[40:43],v[24:27],v[84:87],v[40:43]
v_mfma_f32_16x16x32_bf16 v[28:31],v[24:27],a[48:51],v[28:31]
v_mfma_f32_16x16x32_bf16 v[32:35],v[24:27],a[120:123],v[32:35]
v_mfma_f32_16x16x32_bf16 v[36:39],v[24:27],a[192:195],v[36:39]
v_mfma_f32_16x16x32_bf16 v[40:43],v[24:27],v[88:91],v[40:43]
v_mfma_f32_16x16x32_bf16 v[28:31],v[24:27],a[52:55],v[28:31]
v_mfma_f32_16x16x32_bf16 v[32:35],v[24:27],a[124:127],v[32:35]
v_mfma_f32_16x16x32_bf16 v[36:39],v[24:27],a[196:199],v[36:39]
v_mfma_f32_16x16x32_bf16 v[40:43],v[24:27],v[92:95],v[40:43]
v_mfma_f32_16x16x32_bf16 v[28:31],v[24:27],a[56:59],v[28:31]
v_mfma_f32_16x16x32_bf16 v[32:35],v[24:27],a[128:131],v[32:35]
v_mfma_f32_16x16x32_bf16 v[36:39],v[24:27],a[200:203],v[36:39]
v_mfma_f32_16x16x32_bf16 v[40:43],v[24:27],v[96:99],v[40:43]
v_mfma_f32_16x16x32_bf16 v[28:31],v[24:27],a[60:63],v[28:31]
v_mfma_f32_16x16x32_bf16 v[32:35],v[24:27],a[132:135],v[32:35]
v_mfma_f32_16x16x32_bf16 v[36:39],v[24:27],a[204:207],v[36:39]
v_mfma_f32_16x16x32_bf16 v[40:43],v[24:27],v[100:103],v[40:43]
v_mfma_f32_16x16x32_bf16 v[28:31],v[24:27],a[64:67],v[28:31]
v_mfma_f32_16x16x32_bf16 v[32:35],v[24:27],a[136:139],v[32:35]
v_mfma_f32_16x16x32_bf16 v[36:39],v[24:27],a[208:211],v[36:39]
v_mfma_f32_16x16x32_bf16 v[40:43],v[24:27],v[104:107],v[40:43]
v_mfma_f32_16x16x32_bf16 v[28:31],v[24:27],a[68:71],v[28:31]
v_mfma_f32_16x16x32_bf16 v[32:35],v[24:27],a[140:143],v[32:35]
v_mfma_f32_16x16x32_bf16 v[36:39],v[24:27],a[212:215],v[36:39]
v_mfma_f32_16x16x32_bf16 v[40:43],v[24:27],v[108:111],v[40:43]
s_lshl_b32 s60,s21,9
v_add_u32 v10,s60,v7
ds_write_b32 v10,v28 offset:256
ds_write_b32 v10,v32 offset:320
ds_write_b32 v10,v36 offset:384
s_nop 2
ds_write_b32 v10,v40 offset:448
s_waitcnt lgkmcnt(0)
s_branch g_cs2
g_cs1:
s_lshl_b32 s60,s21,9
v_lshl_add_u32 v10,v0,2,s60
ds_write_b32 v10,v76 offset:38144
ds_write_b32 v10,v77 offset:38400
s_waitcnt lgkmcnt(0)
g_cs2:
s_cmp_eq_u32 s23,0
s_cbranch_scc1 nx_7
s_lshl_b32 s63,s26,12
s_add_u32 s63,s63,21757952
v_min_u32 v10,2,v0
v_lshlrev_b32 v10,7,v10
s_branch wf_8_0f
wf_8_0:
s_sleep 1
wf_8_0f:
buffer_load_dword v11,v10,s[8:11],s63 offen sc1
s_add_u32 s38,s38,1
s_cmp_gt_u32 s38,3000000
s_cbranch_scc1 w_fail
s_waitcnt vmcnt(0)
v_cmp_gt_u32 vcc,1,v11
s_cbranch_vccnz wf_8_0
nx_7:
s_mov_b32 s30,0x40000000
w_a1r:
s_mul_i32 s27,s26,36864
s_mul_i32 s61,s21,9216
s_add_u32 s61,s61,s31
s_add_u32 m0,s61,0
s_nop 0
buffer_load_dwordx4 v1,s[12:15],s27 offen sc1 lds
s_add_u32 m0,s61,896
s_nop 0
buffer_load_dwordx4 v1,s[12:15],s27 offen offset:128 sc1 lds
s_add_u32 m0,s61,1792
s_nop 0
buffer_load_dwordx4 v1,s[12:15],s27 offen offset:256 sc1 lds
s_add_u32 m0,s61,2688
s_nop 0
buffer_load_dwordx4 v1,s[12:15],s27 offen offset:384 sc1 lds
s_add_u32 m0,s61,3584
s_nop 0
buffer_load_dwordx4 v1,s[12:15],s27 offen offset:512 sc1 lds
s_add_u32 m0,s61,4480
s_nop 0
buffer_load_dwordx4 v1,s[12:15],s27 offen offset:640 sc1 lds
s_add_u32 m0,s61,5376
s_nop 0
buffer_load_dwordx4 v1,s[12:15],s27 offen offset:768 sc1 lds
s_add_u32 m0,s61,6272
s_nop 0
buffer_load_dwordx4 v1,s[12:15],s27 offen offset:896 sc1 lds
s_add_u32 m0,s61,7168
s_nop 0
buffer_load_dwordx4 v1,s[12:15],s27 offen offset:1024 sc1 lds
s_add_u32 s38,s38,64
s_cmp_gt_u32 s38,3000000
s_cbranch_scc1 w_fail
s_waitcnt vmcnt(0)
w_a1:
ds_read_b128 v[16:19],v2
ds_read_b128 v[20:23],v2 offset:1024
ds_read_b128 v[24:27],v2 offset:2048
ds_read_b128 v[28:31],v2 offset:3072
ds_read_b128 v[32:35],v2 offset:4096
ds_read_b128 v[36:39],v2 offset:5120
ds_read_b128 v[40:43],v2 offset:6144
ds_read_b128 v[44:47],v2 offset:7168
ds_read_b128 v[48:51],v2 offset:8192
v_mov_b32 v56,0x3f803f80
v_mov_b32 v52,0
v_mov_b32 v53,0
v_mov_b32 v54,0
v_mov_b32 v55,0
s_waitcnt lgkmcnt(8)
v_dot2c_f32_bf16 v52,v16,v56
v_dot2c_f32_bf16 v53,v16,v16
v_dot2c_f32_bf16 v54,v17,v56
v_dot2c_f32_bf16 v55,v17,v17
v_dot2c_f32_bf16 v52,v18,v56
v_dot2c_f32_bf16 v53,v18,v18
v_dot2c_f32_bf16 v54,v19,v56
v_dot2c_f32_bf16 v55,v19,v19
s_waitcnt lgkmcnt(7)
v_dot2c_f32_bf16 v52,v20,v56
v_dot2c_f32_bf16 v53,v20,v20
v_dot2c_f32_bf16 v54,v21,v56
v_dot2c_f32_bf16 v55,v21,v21
v_dot2c_f32_bf16 v52,v22,v56
v_dot2c_f32_bf16 v53,v22,v22
v_dot2c_f32_bf16 v54,v23,v56
v_dot2c_f32_bf16 v55,v23,v23
s_waitcnt lgkmcnt(6)
v_dot2c_f32_bf16 v52,v24,v56
v_dot2c_f32_bf16 v53,v24,v24
v_dot2c_f32_bf16 v54,v25,v56
v_dot2c_f32_bf16 v55,v25,v25
v_dot2c_f32_bf16 v52,v26,v56
v_dot2c_f32_bf16 v53,v26,v26
v_dot2c_f32_bf16 v54,v27,v56
v_dot2c_f32_bf16 v55,v27,v27
s_waitcnt lgkmcnt(5)
v_dot2c_f32_bf16 v52,v28,v56
v_dot2c_f32_bf16 v53,v28,v28
v_dot2c_f32_bf16 v54,v29,v56
v_dot2c_f32_bf16 v55,v29,v29
v_dot2c_f32_bf16 v52,v30,v56
v_dot2c_f32_bf16 v53,v30,v30
v_dot2c_f32_bf16 v54,v31,v56
v_dot2c_f32_bf16 v55,v31,v31
s_waitcnt lgkmcnt(4)
v_dot2c_f32_bf16 v52,v32,v56
v_dot2c_f32_bf16 v53,v32,v32
v_dot2c_f32_bf16 v54,v33,v56
v_dot2c_f32_bf16 v55,v33,v33
v_dot2c_f32_bf16 v52,v34,v56
v_dot2c_f32_bf16 v53,v34,v34
v_dot2c_f32_bf16 v54,v35,v56
v_dot2c_f32_bf16 v55,v35,v35
s_waitcnt lgkmcnt(3)
v_dot2c_f32_bf16 v52,v36,v56
v_dot2c_f32_bf16 v53,v36,v36
v_dot2c_f32_bf16 v54,v37,v56
v_dot2c_f32_bf16 v55,v37,v37
v_dot2c_f32_bf16 v52,v38,v56
v_dot2c_f32_bf16 v53,v38,v38
v_dot2c_f32_bf16 v54,v39,v56
v_dot2c_f32_bf16 v55,v39,v39
s_waitcnt lgkmcnt(2)
v_dot2c_f32_bf16 v52,v40,v56
v_dot2c_f32_bf16 v53,v40,v40
v_dot2c_f32_bf16 v54,v41,v56
v_dot2c_f32_bf16 v55,v41,v41
v_dot2c_f32_bf16 v52,v42,v56
v_dot2c_f32_bf16 v53,v42,v42
v_dot2c_f32_bf16 v54,v43,v56
v_dot2c_f32_bf16 v55,v43,v43
s_waitcnt lgkmcnt(1)
v_dot2c_f32_bf16 v52,v44,v56
v_dot2c_f32_bf16 v53,v44,v44
v_dot2c_f32_bf16 v54,v45,v56
v_dot2c_f32_bf16 v55,v45,v45
v_dot2c_f32_bf16 v52,v46,v56
v_dot2c_f32_bf16 v53,v46,v46
v_dot2c_f32_bf16 v54,v47,v56
v_dot2c_f32_bf16 v55,v47,v47
s_waitcnt lgkmcnt(0)
v_dot2c_f32_bf16 v52,v48,v56
v_dot2c_f32_bf16 v53,v48,v48
v_dot2c_f32_bf16 v54,v49,v56
v_dot2c_f32_bf16 v55,v49,v49
v_dot2c_f32_bf16 v52,v50,v56
v_dot2c_f32_bf16 v53,v50,v50
v_dot2c_f32_bf16 v54,v51,v56
v_dot2c_f32_bf16 v55,v51,v51
s_nop 2
v_add_f32 v52,v52,v54
v_add_f32_e64 v53,v53,v55
v_cmp_u_f32 vcc,v52,v52
v_add_f32_dpp v52,v52,v52 quad_perm:[1,0,3,2] row_mask:0xf bank_mask:0xf
v_add_f32_dpp v53,v53,v53 quad_perm:[1,0,3,2] row_mask:0xf bank_mask:0xf
s_nop 0
v_add_f32_dpp v52,v52,v52 quad_perm:[2,3,0,1] row_mask:0xf bank_mask:0xf
v_add_f32_dpp v53,v53,v53 quad_perm:[2,3,0,1] row_mask:0xf bank_mask:0xf
s_nop 0
v_add_f32_dpp v52,v52,v52 row_half_mirror row_mask:0xf bank_mask:0xf
v_add_f32_dpp v53,v53,v53 row_half_mirror row_mask:0xf bank_mask:0xf
s_cbranch_vccnz w_a1r
v_mul_f32 v52,0xbae38e39,v52
v_mul_f32 v54,v52,v52
v_mul_f32 v53,0x3ae38e39,v53
v_sub_f32 v53,v53,v54
v_max_f32 v53,0,v53
v_add_f32 v53,0x3727c5ac,v53
v_rsq_f32 v53,v53
s_nop 0
v_mul_f32_e64 v54,v52,v53
ds_write2_b32 v9,v53,v54 offset0:0 offset1:32
s_mul_i32 s60,s25,65
s_add_u32 s60,s60,s26
s_lshl_b32 s28,s60,14
s_add_u32 s28,s28,41943040
s_lshl_b32 s29,s60,13
s_add_u32 s29,s29,76546048
s_xor_b32 s31,s31,65536
v_xor_b32 v2,65536,v2
s_waitcnt lgkmcnt(0)
s_barrier
ds_read2_b32 v[12:13],v7 offset0:0 offset1:16
ds_read2_b32 v[14:15],v7 offset0:32 offset1:48
s_add_u32 s62,s26,4
s_min_u32 s62,s62,63
s_cmp_ge_u32 s26,32
s_cbranch_scc1 nx_10
s_cmp_lt_u32 s26,28
s_cbranch_scc1 nx_10o
s_cmp_eq_u32 s23,0
s_cbranch_scc1 nx_10
s_mov_b32 s63,21757952
v_min_u32 v10,63,v0
v_lshlrev_b32 v10,12,v10
s_branch wf_11_0f
wf_11_0:
s_sleep 1
wf_11_0f:
buffer_load_dword v11,v10,s[8:11],s63 offen sc1
s_add_u32 s38,s38,1
s_cmp_gt_u32 s38,3000000
s_cbranch_scc1 w_fail
s_waitcnt vmcnt(0)
v_cmp_gt_u32 vcc,1,v11
s_cbranch_vccnz wf_11_0
s_add_u32 s63,s63,128
v_min_u32 v10,63,v0
v_lshlrev_b32_e64 v10,12,v10
s_branch wf_13_0f
wf_13_0:
s_sleep 1
wf_13_0f:
buffer_load_dword v11,v10,s[8:11],s63 offen sc1
s_add_u32 s38,s38,1
s_cmp_gt_u32 s38,3000000
s_cbranch_scc1 w_fail
s_waitcnt vmcnt(0)
v_cmp_gt_u32 vcc,1,v11
s_cbranch_vccnz wf_13_0
s_add_u32 s63,s63,128
v_min_u32 v10,63,v0
v_lshlrev_b32_e64 v10,12,v10
s_branch wf_15_0f
wf_15_0:
s_sleep 1
wf_15_0f:
buffer_load_dword v11,v10,s[8:11],s63 offen sc1
s_add_u32 s38,s38,1
s_cmp_gt_u32 s38,3000000
s_cbranch_scc1 w_fail
s_waitcnt vmcnt(0)
v_cmp_gt_u32 vcc,1,v11
s_cbranch_vccnz wf_15_0
s_add_u32 s63,s63,128
s_branch nx_10
nx_10o:
s_cmp_lt_u32 s26,4
s_cselect_b32 s62,4096,s62
s_cbranch_scc1 nx_10
s_cmp_eq_u32 s23,0
s_cbranch_scc1 nx_17
s_lshl_b32 s63,s62,12
s_add_u32 s63,s63,21757952
v_min_u32 v10,2,v0
v_lshlrev_b32 v10,7,v10
s_branch wf_18_0f
wf_18_0:
s_sleep 1
wf_18_0f:
buffer_load_dword v11,v10,s[8:11],s63 offen sc1
s_add_u32 s38,s38,1
s_cmp_gt_u32 s38,3000000
s_cbranch_scc1 w_fail
s_waitcnt vmcnt(0)
v_cmp_gt_u32 vcc,1,v11
s_cbranch_vccnz wf_18_0
nx_17:
nx_10:
s_mul_i32 s27,s62,36864
s_mul_i32 s61,s21,9216
s_add_u32 s61,s61,s31
ds_read_b128 v[64:67],v4
ds_read_b128 v[68:71],v4 offset:18432
ds_read_b128 v[72:75],v3
ds_read_b128 v[76:79],v3 offset:18432
s_waitcnt lgkmcnt(2)
v_mfma_f32_16x16x32_bf16 v[16:19],a[0:3],v[64:67],0
ds_read_b128 v[48:51],v4 offset:1024
v_mfma_f32_16x16x32_bf16 v[20:23],a[0:3],v[68:71],0
ds_read_b128 v[52:55],v4 offset:19456
v_mfma_f32_16x16x32_bf16 v[24:27],a[72:75],v[64:67],0
v_mfma_f32_16x16x32_bf16 v[28:31],a[72:75],v[68:71],0
s_add_u32 m0,s61,0
s_nop 0
buffer_load_dwordx4 v1,s[12:15],s27 offen sc1 lds
v_mfma_f32_16x16x32_bf16 v[32:35],v[64:67],a[144:147],0
v_mfma_f32_16x16x32_bf16 v[36:39],v[68:71],a[144:147],0
v_mfma_f32_16x16x32_bf16 v[40:43],v[64:67],a[216:219],0
v_mfma_f32_16x16x32_bf16 v[44:47],v[68:71],a[216:219],0
s_waitcnt lgkmcnt(2)
v_mfma_f32_16x16x32_bf16 v[16:19],a[4:7],v[72:75],v[16:19]
ds_read_b128 v[64:67],v3 offset:1024
v_mfma_f32_16x16x32_bf16 v[20:23],a[4:7],v[76:79],v[20:23]
ds_read_b128 v[68:71],v3 offset:19456
v_mfma_f32_16x16x32_bf16 v[24:27],a[76:79],v[72:75],v[24:27]
v_mfma_f32_16x16x32_bf16 v[28:31],a[76:79],v[76:79],v[28:31]
s_add_u32 m0,s61,896
s_nop 0
buffer_load_dwordx4 v1,s[12:15],s27 offen offset:128 sc1 lds
v_mfma_f32_16x16x32_bf16 v[32:35],v[72:75],a[148:151],v[32:35]
v_mfma_f32_16x16x32_bf16 v[36:39],v[76:79],a[148:151],v[36:39]
v_mfma_f32_16x16x32_bf16 v[40:43],v[72:75],a[220:223],v[40:43]
v_mfma_f32_16x16x32_bf16 v[44:47],v[76:79],a[220:223],v[44:47]
s_waitcnt lgkmcnt(2)
v_mfma_f32_16x16x32_bf16 v[16:19],a[8:11],v[48:51],v[16:19]
ds_read_b128 v[72:75],v4 offset:2048
v_mfma_f32_16x16x32_bf16 v[20:23],a[8:11],v[52:55],v[20:23]
ds_read_b128 v[76:79],v4 offset:20480
v_mfma_f32_16x16x32_bf16 v[24:27],a[80:83],v[48:51],v[24:27]
v_mfma_f32_16x16x32_bf16 v[28:31],a[80:83],v[52:55],v[28:31]
s_add_u32 m0,s61,1792
s_nop 0
buffer_load_dwordx4 v1,s[12:15],s27 offen offset:256 sc1 lds
v_mfma_f32_16x16x32_bf16 v[32:35],v[48:51],a[152:155],v[32:35]
v_mfma_f32_16x16x32_bf16 v[36:39],v[52:55],a[152:155],v[36:39]
v_mfma_f32_16x16x32_bf16 v[40:43],v[48:51],a[224:227],v[40:43]
v_mfma_f32_16x16x32_bf16 v[44:47],v[52:55],a[224:227],v[44:47]
s_waitcnt lgkmcnt(2)
v_mfma_f32_16x16x32_bf16 v[16:19],a[12:15],v[64:67],v[16:19]
ds_read_b128 v[48:51],v3 offset:2048
v_mfma_f32_16x16x32_bf16 v[20:23],a[12:15],v[68:71],v[20:23]
ds_read_b128 v[52:55],v3 offset:20480
v_mfma_f32_16x16x32_bf16 v[24:27],a[84:87],v[64:67],v[24:27]
v_mfma_f32_16x16x32_bf16 v[28:31],a[84:87],v[68:71],v[28:31]
s_add_u32 m0,s61,2688
s_nop 0
buffer_load_dwordx4 v1,s[12:15],s27 offen offset:384 sc1 lds
v_mfma_f32_16x16x32_bf16 v[32:35],v[64:67],a[156:159],v[32:35]
v_mfma_f32_16x16x32_bf16 v[36:39],v[68:71],a[156:159],v[36:39]
v_mfma_f32_16x16x32_bf16 v[40:43],v[64:67],a[228:231],v[40:43]
v_mfma_f32_16x16x32_bf16 v[44:47],v[68:71],a[228:231],v[44:47]
s_waitcnt lgkmcnt(2)
v_mfma_f32_16x16x32_bf16 v[16:19],a[16:19],v[72:75],v[16:19]
ds_read_b128 v[64:67],v4 offset:3072
v_mfma_f32_16x16x32_bf16 v[20:23],a[16:19],v[76:79],v[20:23]
ds_read_b128 v[68:71],v4 offset:21504
v_mfma_f32_16x16x32_bf16 v[24:27],a[88:91],v[72:75],v[24:27]
v_mfma_f32_16x16x32_bf16 v[28:31],a[88:91],v[76:79],v[28:31]
s_add_u32 m0,s61,3584
s_nop 0
buffer_load_dwordx4 v1,s[12:15],s27 offen offset:512 sc1 lds
v_mfma_f32_16x16x32_bf16 v[32:35],v[72:75],a[160:163],v[32:35]
v_mfma_f32_16x16x32_bf16 v[36:39],v[76:79],a[160:163],v[36:39]
v_mfma_f32_16x16x32_bf16 v[40:43],v[72:75],a[232:235],v[40:43]
v_mfma_f32_16x16x32_bf16 v[44:47],v[76:79],a[232:235],v[44:47]
s_waitcnt lgkmcnt(2)
v_mfma_f32_16x16x32_bf16 v[16:19],a[20:23],v[48:51],v[16:19]
ds_read_b128 v[72:75],v3 offset:3072
v_mfma_f32_16x16x32_bf16 v[20:23],a[20:23],v[52:55],v[20:23]
ds_read_b128 v[76:79],v3 offset:21504
v_mfma_f32_16x16x32_bf16 v[24:27],a[92:95],v[48:51],v[24:27]
v_mfma_f32_16x16x32_bf16 v[28:31],a[92:95],v[52:55],v[28:31]
s_add_u32 m0,s61,4480
s_nop 0
buffer_load_dwordx4 v1,s[12:15],s27 offen offset:640 sc1 lds
v_mfma_f32_16x16x32_bf16 v[32:35],v[48:51],a[164:167],v[32:35]
v_mfma_f32_16x16x32_bf16 v[36:39],v[52:55],a[164:167],v[36:39]
v_mfma_f32_16x16x32_bf16 v[40:43],v[48:51],a[236:239],v[40:43]
v_mfma_f32_16x16x32_bf16 v[44:47],v[52:55],a[236:239],v[44:47]
s_waitcnt lgkmcnt(2)
v_mfma_f32_16x16x32_bf16 v[16:19],a[24:27],v[64:67],v[16:19]
ds_read_b128 v[48:51],v4 offset:4096
v_mfma_f32_16x16x32_bf16 v[20:23],a[24:27],v[68:71],v[20:23]
ds_read_b128 v[52:55],v4 offset:22528
v_mfma_f32_16x16x32_bf16 v[24:27],a[96:99],v[64:67],v[24:27]
v_mfma_f32_16x16x32_bf16 v[28:31],a[96:99],v[68:71],v[28:31]
s_add_u32 m0,s61,5376
s_nop 0
buffer_load_dwordx4 v1,s[12:15],s27 offen offset:768 sc1 lds
v_mfma_f32_16x16x32_bf16 v[32:35],v[64:67],a[168:171],v[32:35]
v_mfma_f32_16x16x32_bf16 v[36:39],v[68:71],a[168:171],v[36:39]
v_mfma_f32_16x16x32_bf16 v[40:43],v[64:67],a[240:243],v[40:43]
v_mfma_f32_16x16x32_bf16 v[44:47],v[68:71],a[240:243],v[44:47]
s_waitcnt lgkmcnt(2)
v_mfma_f32_16x16x32_bf16 v[16:19],a[28:31],v[72:75],v[16:19]
ds_read_b128 v[64:67],v3 offset:4096
v_mfma_f32_16x16x32_bf16 v[20:23],a[28:31],v[76:79],v[20:23]
ds_read_b128 v[68:71],v3 offset:22528
v_mfma_f32_16x16x32_bf16 v[24:27],a[100:103],v[72:75],v[24:27]
v_mfma_f32_16x16x32_bf16 v[28:31],a[100:103],v[76:79],v[28:31]
s_add_u32 m0,s61,6272
s_nop 0
buffer_load_dwordx4 v1,s[12:15],s27 offen offset:896 sc1 lds
v_mfma_f32_16x16x32_bf16 v[32:35],v[72:75],a[172:175],v[32:35]
v_mfma_f32_16x16x32_bf16 v[36:39],v[76:79],a[172:175],v[36:39]
v_mfma_f32_16x16x32_bf16 v[40:43],v[72:75],a[244:247],v[40:43]
v_mfma_f32_16x16x32_bf16 v[44:47],v[76:79],a[244:247],v[44:47]
s_waitcnt lgkmcnt(2)
v_mfma_f32_16x16x32_bf16 v[16:19],a[32:35],v[48:51],v[16:19]
ds_read_b128 v[72:75],v4 offset:5120
v_mfma_f32_16x16x32_bf16 v[20:23],a[32:35],v[52:55],v[20:23]
ds_read_b128 v[76:79],v4 offset:23552
v_mfma_f32_16x16x32_bf16 v[24:27],a[104:107],v[48:51],v[24:27]
v_mfma_f32_16x16x32_bf16 v[28:31],a[104:107],v[52:55],v[28:31]
s_add_u32 m0,s61,7168
s_nop 0
buffer_load_dwordx4 v1,s[12:15],s27 offen offset:1024 sc1 lds
v_mfma_f32_16x16x32_bf16 v[32:35],v[48:51],a[176:179],v[32:35]
v_mfma_f32_16x16x32_bf16 v[36:39],v[52:55],a[176:179],v[36:39]
v_mfma_f32_16x16x32_bf16 v[40:43],v[48:51],a[248:251],v[40:43]
v_mfma_f32_16x16x32_bf16 v[44:47],v[52:55],a[248:251],v[44:47]
s_waitcnt lgkmcnt(2)
v_mfma_f32_16x16x32_bf16 v[16:19],a[36:39],v[64:67],v[16:19]
ds_read_b128 v[48:51],v3 offset:5120
v_mfma_f32_16x16x32_bf16 v[20:23],a[36:39],v[68:71],v[20:23]
ds_read_b128 v[52:55],v3 offset:23552
v_mfma_f32_16x16x32_bf16 v[24:27],a[108:111],v[64:67],v[24:27]
v_mfma_f32_16x16x32_bf16 v[28:31],a[108:111],v[68:71],v[28:31]
v_mfma_f32_16x16x32_bf16 v[32:35],v[64:67],a[180:183],v[32:35]
v_mfma_f32_16x16x32_bf16 v[36:39],v[68:71],a[180:183],v[36:39]
v_mfma_f32_16x16x32_bf16 v[40:43],v[64:67],a[252:255],v[40:43]
v_mfma_f32_16x16x32_bf16 v[44:47],v[68:71],a[252:255],v[44:47]
s_waitcnt lgkmcnt(2)
v_mfma_f32_16x16x32_bf16 v[16:19],a[40:43],v[72:75],v[16:19]
ds_read_b128 v[64:67],v4 offset:6144
v_mfma_f32_16x16x32_bf16 v[20:23],a[40:43],v[76:79],v[20:23]
ds_read_b128 v[68:71],v4 offset:24576
v_mfma_f32_16x16x32_bf16 v[24:27],a[112:115],v[72:75],v[24:27]
v_mfma_f32_16x16x32_bf16 v[28:31],a[112:115],v[76:79],v[28:31]
v_mfma_f32_16x16x32_bf16 v[32:35],v[72:75],a[184:187],v[32:35]
v_mfma_f32_16x16x32_bf16 v[36:39],v[76:79],a[184:187],v[36:39]
v_mfma_f32_16x16x32_bf16 v[40:43],v[72:75],v[80:83],v[40:43]
v_mfma_f32_16x16x32_bf16 v[44:47],v[76:79],v[80:83],v[44:47]
s_waitcnt lgkmcnt(2)
v_mfma_f32_16x16x32_bf16 v[16:19],a[44:47],v[48:51],v[16:19]
ds_read_b128 v[72:75],v3 offset:6144
v_mfma_f32_16x16x32_bf16 v[20:23],a[44:47],v[52:55],v[20:23]
ds_read_b128 v[76:79],v3 offset:24576
v_mfma_f32_16x16x32_bf16 v[24:27],a[116:119],v[48:51],v[24:27]
v_mfma_f32_16x16x32_bf16 v[28:31],a[116:119],v[52:55],v[28:31]
v_mfma_f32_16x16x32_bf16 v[32:35],v[48:51],a[188:191],v[32:35]
v_mfma_f32_16x16x32_bf16 v[36:39],v[52:55],a[188:191],v[36:39]
v_mfma_f32_16x16x32_bf16 v[40:43],v[48:51],v[84:87],v[40:43]
v_mfma_f32_16x16x32_bf16 v[44:47],v[52:55],v[84:87],v[44:47]
s_waitcnt lgkmcnt(2)
v_mfma_f32_16x16x32_bf16 v[16:19],a[48:51],v[64:67],v[16:19]
ds_read_b128 v[48:51],v4 offset:7168
v_mfma_f32_16x16x32_bf16 v[20:23],a[48:51],v[68:71],v[20:23]
ds_read_b128 v[52:55],v4 offset:25600
v_mfma_f32_16x16x32_bf16 v[24:27],a[120:123],v[64:67],v[24:27]
v_mfma_f32_16x16x32_bf16 v[28:31],a[120:123],v[68:71],v[28:31]
v_mfma_f32_16x16x32_bf16 v[32:35],v[64:67],a[192:195],v[32:35]
v_mfma_f32_16x16x32_bf16 v[36:39],v[68:71],a[192:195],v[36:39]
v_mfma_f32_16x16x32_bf16 v[40:43],v[64:67],v[88:91],v[40:43]
v_mfma_f32_16x16x32_bf16 v[44:47],v[68:71],v[88:91],v[44:47]
s_waitcnt vmcnt(9)
s_barrier
s_cmp_lg_u32 s21,0
s_cbranch_scc1 sg_20
v_mov_b32 v10,0
v_mov_b32 v11,2
s_mov_b64 exec,1
buffer_store_dword v11,v10,s[8:11],s30 offen sc1
s_mov_b64 exec,-1
sg_20:
s_waitcnt lgkmcnt(2)
v_mfma_f32_16x16x32_bf16 v[16:19],a[52:55],v[72:75],v[16:19]
ds_read_b128 v[64:67],v3 offset:7168
v_mfma_f32_16x16x32_bf16 v[20:23],a[52:55],v[76:79],v[20:23]
ds_read_b128 v[68:71],v3 offset:25600
v_mfma_f32_16x16x32_bf16 v[24:27],a[124:127],v[72:75],v[24:27]
v_mfma_f32_16x16x32_bf16 v[28:31],a[124:127],v[76:79],v[28:31]
v_mfma_f32_16x16x32_bf16 v[32:35],v[72:75],a[196:199],v[32:35]
v_mfma_f32_16x16x32_bf16 v[36:39],v[76:79],a[196:199],v[36:39]
v_mfma_f32_16x16x32_bf16 v[40:43],v[72:75],v[92:95],v[40:43]
v_mfma_f32_16x16x32_bf16 v[44:47],v[76:79],v[92:95],v[44:47]
s_waitcnt lgkmcnt(2)
v_mfma_f32_16x16x32_bf16 v[16:19],a[56:59],v[48:51],v[16:19]
ds_read_b128 v[72:75],v4 offset:8192
v_mfma_f32_16x16x32_bf16 v[20:23],a[56:59],v[52:55],v[20:23]
ds_read_b128 v[76:79],v4 offset:26624
v_mfma_f32_16x16x32_bf16 v[24:27],a[128:131],v[48:51],v[24:27]
v_mfma_f32_16x16x32_bf16 v[28:31],a[128:131],v[52:55],v[28:31]
v_mfma_f32_16x16x32_bf16 v[32:35],v[48:51],a[200:203],v[32:35]
v_mfma_f32_16x16x32_bf16 v[36:39],v[52:55],a[200:203],v[36:39]
v_mfma_f32_16x16x32_bf16 v[40:43],v[48:51],v[96:99],v[40:43]
v_mfma_f32_16x16x32_bf16 v[44:47],v[52:55],v[96:99],v[44:47]
s_waitcnt lgkmcnt(2)
v_mfma_f32_16x16x32_bf16 v[16:19],a[60:63],v[64:67],v[16:19]
ds_read_b128 v[48:51],v3 offset:8192
v_mfma_f32_16x16x32_bf16 v[20:23],a[60:63],v[68:71],v[20:23]
ds_read_b128 v[52:55],v3 offset:26624
v_mfma_f32_16x16x32_bf16 v[24:27],a[132:135],v[64:67],v[24:27]
v_mfma_f32_16x16x32_bf16 v[28:31],a[132:135],v[68:71],v[28:31]
v_mfma_f32_16x16x32_bf16 v[32:35],v[64:67],a[204:207],v[32:35]
v_mfma_f32_16x16x32_bf16 v[36:39],v[68:71],a[204:207],v[36:39]
v_mfma_f32_16x16x32_bf16 v[40:43],v[64:67],v[100:103],v[40:43]
v_mfma_f32_16x16x32_bf16 v[44:47],v[68:71],v[100:103],v[44:47]
s_waitcnt lgkmcnt(2)
v_mfma_f32_16x16x32_bf16 v[16:19],a[64:67],v[72:75],v[16:19]
v_mfma_f32_16x16x32_bf16 v[20:23],a[64:67],v[76:79],v[20:23]
v_mfma_f32_16x16x32_bf16 v[24:27],a[136:139],v[72:75],v[24:27]
v_mfma_f32_16x16x32_bf16 v[28:31],a[136:139],v[76:79],v[28:31]
v_mfma_f32_16x16x32_bf16 v[32:35],v[72:75],a[208:211],v[32:35]
v_mfma_f32_16x16x32_bf16 v[36:39],v[76:79],a[208:211],v[36:39]
v_mfma_f32_16x16x32_bf16 v[40:43],v[72:75],v[104:107],v[40:43]
v_mfma_f32_16x16x32_bf16 v[44:47],v[76:79],v[104:107],v[44:47]
s_waitcnt lgkmcnt(0)
v_mfma_f32_16x16x32_bf16 v[16:19],a[68:71],v[48:51],v[16:19]
v_mfma_f32_16x16x32_bf16 v[20:23],a[68:71],v[52:55],v[20:23]
v_mfma_f32_16x16x32_bf16 v[24:27],a[140:143],v[48:51],v[24:27]
v_mfma_f32_16x16x32_bf16 v[28:31],a[140:143],v[52:55],v[28:31]
v_mfma_f32_16x16x32_bf16 v[32:35],v[48:51],a[212:215],v[32:35]
v_mfma_f32_16x16x32_bf16 v[36:39],v[52:55],a[212:215],v[36:39]
v_mfma_f32_16x16x32_bf16 v[40:43],v[48:51],v[108:111],v[40:43]
v_mfma_f32_16x16x32_bf16 v[44:47],v[52:55],v[108:111],v[44:47]
s_lshl_b32 s60,s21,9
v_add_u32 v10,s60,v8
v_add_u32_e64 v11,s60,v7
ds_read_b128 v[56:59],v10 offset:256
ds_read_b128 v[60:63],v10 offset:320
ds_read_b128 v[64:67],v8
ds_read_b128 v[68:71],v8 offset:128
ds_read_b128 v[72:75],v8 offset:64
ds_read_b128 v[76:79],v8 offset:192
ds_read2_b32 v[48:49],v11 offset0:96 offset1:112
s_add_u32 s60,s60,s28
s_add_u32 s61,s60,4096
s_lshl_b32 s62,s21,11
s_add_u32 s62,s62,s28
s_add_u32 s62,s62,8192
s_waitcnt lgkmcnt(5)
v_pk_mul_f32 v[16:17],v[16:17],v[12:13] op_sel:[0,0] op_sel_hi:[1,0]
v_pk_mul_f32 v[18:19],v[18:19],v[12:13] op_sel:[0,0] op_sel_hi:[1,0]
v_pk_fma_f32 v[16:17],v[56:57],v[14:15],v[16:17] op_sel:[0,0,0] op_sel_hi:[1,0,1]
v_pk_fma_f32 v[18:19],v[58:59],v[14:15],v[18:19] op_sel:[0,0,0] op_sel_hi:[1,0,1]
v_pk_mul_f32 v[24:25],v[24:25],v[12:13] op_sel:[0,0] op_sel_hi:[1,0]
v_pk_mul_f32 v[26:27],v[26:27],v[12:13] op_sel:[0,0] op_sel_hi:[1,0]
v_pk_fma_f32 v[24:25],v[60:61],v[14:15],v[24:25] op_sel:[0,0,0] op_sel_hi:[1,0,1]
v_pk_fma_f32 v[26:27],v[62:63],v[14:15],v[26:27] op_sel:[0,0,0] op_sel_hi:[1,0,1]
v_cvt_pk_bf16_f32 v16,v16,v17
v_cvt_pk_bf16_f32 v17,v18,v19
v_cvt_pk_bf16_f32 v18,v24,v25
v_cvt_pk_bf16_f32 v19,v26,v27
buffer_store_dwordx4 v[16:19],v6,s[88:91],s60 offen sc1
v_pk_mul_f32 v[20:21],v[20:21],v[12:13] op_sel:[0,1] op_sel_hi:[1,1]
v_pk_mul_f32 v[22:23],v[22:23],v[12:13] op_sel:[0,1] op_sel_hi:[1,1]
v_pk_fma_f32 v[20:21],v[56:57],v[14:15],v[20:21] op_sel:[0,1,0] op_sel_hi:[1,1,1]
v_pk_fma_f32 v[22:23],v[58:59],v[14:15],v[22:23] op_sel:[0,1,0] op_sel_hi:[1,1,1]
v_pk_mul_f32 v[28:29],v[28:29],v[12:13] op_sel:[0,1] op_sel_hi:[1,1]
v_pk_mul_f32 v[30:31],v[30:31],v[12:13] op_sel:[0,1] op_sel_hi:[1,1]
v_pk_fma_f32 v[28:29],v[60:61],v[14:15],v[28:29] op_sel:[0,1,0] op_sel_hi:[1,1,1]
v_pk_fma_f32 v[30:31],v[62:63],v[14:15],v[30:31] op_sel:[0,1,0] op_sel_hi:[1,1,1]
v_cvt_pk_bf16_f32 v20,v20,v21
v_cvt_pk_bf16_f32 v21,v22,v23
v_cvt_pk_bf16_f32 v22,v28,v29
v_cvt_pk_bf16_f32 v23,v30,v31
buffer_store_dwordx4 v[20:23],v6,s[88:91],s61 offen sc1
s_waitcnt lgkmcnt(0)
v_pk_mul_f32 v[32:33],v[32:33],v[64:65]
v_pk_mul_f32 v[34:35],v[34:35],v[66:67]
v_pk_fma_f32 v[32:33],v[68:69],v[48:49],v[32:33] op_sel:[0,0,0] op_sel_hi:[1,0,1]
v_pk_fma_f32 v[34:35],v[70:71],v[48:49],v[34:35] op_sel:[0,0,0] op_sel_hi:[1,0,1]
v_pk_mul_f32 v[36:37],v[36:37],v[72:73]
v_pk_mul_f32 v[38:39],v[38:39],v[74:75]
v_pk_fma_f32 v[36:37],v[76:77],v[48:49],v[36:37] op_sel:[0,0,0] op_sel_hi:[1,0,1]
v_pk_fma_f32 v[38:39],v[78:79],v[48:49],v[38:39] op_sel:[0,0,0] op_sel_hi:[1,0,1]
v_cvt_pk_bf16_f32 v32,v32,v33
v_cvt_pk_bf16_f32 v33,v34,v35
v_cvt_pk_bf16_f32 v34,v36,v37
v_cvt_pk_bf16_f32 v35,v38,v39
buffer_store_dwordx4 v[32:35],v5,s[88:91],s62 offen sc1
v_pk_mul_f32 v[40:41],v[40:41],v[64:65]
v_pk_mul_f32 v[42:43],v[42:43],v[66:67]
v_pk_fma_f32 v[40:41],v[68:69],v[48:49],v[40:41] op_sel:[0,1,0] op_sel_hi:[1,1,1]
v_pk_fma_f32 v[42:43],v[70:71],v[48:49],v[42:43] op_sel:[0,1,0] op_sel_hi:[1,1,1]
v_pk_mul_f32 v[44:45],v[44:45],v[72:73]
v_pk_mul_f32 v[46:47],v[46:47],v[74:75]
v_pk_fma_f32 v[44:45],v[76:77],v[48:49],v[44:45] op_sel:[0,1,0] op_sel_hi:[1,1,1]
v_pk_fma_f32 v[46:47],v[78:79],v[48:49],v[46:47] op_sel:[0,1,0] op_sel_hi:[1,1,1]
v_cvt_pk_bf16_f32 v40,v40,v41
v_cvt_pk_bf16_f32 v41,v42,v43
v_cvt_pk_bf16_f32 v42,v44,v45
v_cvt_pk_bf16_f32 v43,v46,v47
buffer_store_dwordx4 v[40:43],v5,s[88:91],s62 offen offset:1024 sc1
s_cmp_ge_u32 s26,4
s_cbranch_scc1 a1_hasq
s_mov_b32 s76,s68
s_mov_b32 s77,s69
s_mov_b32 s78,4718592
s_mov_b32 s79,0x20000
s_mov_b32 s80,s70
s_mov_b32 s81,s71
s_mov_b32 s82,4718592
s_mov_b32 s83,0x20000
s_mov_b32 s84,s72
s_mov_b32 s85,s73
s_mov_b32 s86,4718592
s_mov_b32 s87,0x20000
s_lshl_b32 s61,s21,2
v_lshrrev_b32 v10,4,v0
v_and_b32 v11,15,v0
v_lshlrev_b32 v12,1,v10
v_xor_b32 v12,v12,v11
v_lshlrev_b32 v12,4,v12
v_bfe_u32 v11,v0,2,3
v_lshlrev_b32 v11,1,v11
v_bfe_u32 v15,v0,1,1
v_add_u32 v15,s61,v15
v_xor_b32 v15,v15,v11
v_lshlrev_b32 v15,4,v15
v_and_b32 v11,1,v0
v_lshl_add_u32 v15,v11,3,v15
v_bfe_u32 v11,v0,2,2
v_lshl_add_u32 v10,v10,3,v11
v_lshl_add_u32 v14,v10,8,v15
v_xor_b32 v15,32,v14
v_lshrrev_b32 v10,4,v0
v_lshl_add_u32 v12,v10,13,v12
v_xor_b32 v13,0x80,v12
s_lshl_b32 s62,s25,8
s_lshl_b32 s61,s21,17
s_add_u32 s62,s62,s61
s_lshl_b32 s63,s21,12
s_barrier
s_add_u32 s60,s62,0
s_add_u32 m0,s63,40960
s_nop 0
buffer_load_dwordx4 v12,s[76:79],s60 offen lds
s_add_u32 s60,s62,32768
s_add_u32 m0,s63,41984
s_nop 0
buffer_load_dwordx4 v12,s[76:79],s60 offen lds
s_add_u32 s60,s62,65536
s_add_u32 m0,s63,43008
s_nop 0
buffer_load_dwordx4 v13,s[76:79],s60 offen lds
s_add_u32 s60,s62,98304
s_add_u32 m0,s63,44032
s_nop 0
buffer_load_dwordx4 v13,s[76:79],s60 offen lds
s_add_u32 s60,s62,524288
s_add_u32 m0,s63,106496
s_nop 0
buffer_load_dwordx4 v12,s[76:79],s60 offen lds
s_add_u32 s60,s62,557056
s_add_u32 m0,s63,107520
s_nop 0
buffer_load_dwordx4 v12,s[76:79],s60 offen lds
s_add_u32 s60,s62,589824
s_add_u32 m0,s63,108544
s_nop 0
buffer_load_dwordx4 v13,s[76:79],s60 offen lds
s_add_u32 s60,s62,622592
s_add_u32 m0,s63,109568
s_nop 0
buffer_load_dwordx4 v13,s[76:79],s60 offen lds
s_add_u32 s60,s62,1048576
s_add_u32 m0,s63,122880
s_nop 0
buffer_load_dwordx4 v12,s[76:79],s60 offen lds
s_add_u32 s60,s62,1081344
s_add_u32 m0,s63,123904
s_nop 0
buffer_load_dwordx4 v12,s[76:79],s60 offen lds
s_add_u32 s60,s62,1114112
s_add_u32 m0,s63,124928
s_nop 0
buffer_load_dwordx4 v13,s[76:79],s60 offen lds
s_add_u32 s60,s62,1146880
s_add_u32 m0,s63,125952
s_nop 0
buffer_load_dwordx4 v13,s[76:79],s60 offen lds
s_waitcnt vmcnt(12)
s_barrier
s_lshl_b32 s30,s25,6
s_add_u32 s30,s30,s26
s_lshl_b32 s30,s30,4
s_add_u32 s30,s30,6422528
s_cmp_lg_u32 s21,0
s_cbranch_scc1 sg_21
v_mov_b32 v16,0
v_mov_b32 v17,1
s_mov_b64 exec,1
buffer_store_dword v17,v16,s[8:11],s30 offen sc1
s_mov_b64 exec,-1
sg_21:
s_waitcnt vmcnt(8) lgkmcnt(0)
s_barrier
s_add_u32 s60,s62,1572864
s_add_u32 m0,s63,139264
s_nop 0
buffer_load_dwordx4 v12,s[76:79],s60 offen lds
s_add_u32 s60,s62,1605632
s_add_u32 m0,s63,140288
s_nop 0
buffer_load_dwordx4 v12,s[76:79],s60 offen lds
s_add_u32 s60,s62,1638400
s_add_u32 m0,s63,141312
s_nop 0
buffer_load_dwordx4 v13,s[76:79],s60 offen lds
s_add_u32 s60,s62,1671168
s_add_u32 m0,s63,142336
s_nop 0
buffer_load_dwordx4 v13,s[76:79],s60 offen lds
v_add_u32 v10,40960,v14
ds_read_b64_tr_b16 v[112:113],v10
ds_read_b64_tr_b16 v[114:115],v10 offset:1024
ds_read_b64_tr_b16 v[116:117],v10 offset:8192
ds_read_b64_tr_b16 v[118:119],v10 offset:9216
v_add_u32 v11,40960,v15
ds_read_b64_tr_b16 v[184:185],v11
ds_read_b64_tr_b16 v[186:187],v11 offset:1024
ds_read_b64_tr_b16 v[188:189],v11 offset:8192
ds_read_b64_tr_b16 v[190:191],v11 offset:9216
s_waitcnt vmcnt(8) lgkmcnt(0)
s_barrier
s_add_u32 s60,s62,2097152
s_add_u32 m0,s63,40960
s_nop 0
buffer_load_dwordx4 v12,s[76:79],s60 offen lds
s_add_u32 s60,s62,2129920
s_add_u32 m0,s63,41984
s_nop 0
buffer_load_dwordx4 v12,s[76:79],s60 offen lds
s_add_u32 s60,s62,2162688
s_add_u32 m0,s63,43008
s_nop 0
buffer_load_dwordx4 v13,s[76:79],s60 offen lds
s_add_u32 s60,s62,2195456
s_add_u32 m0,s63,44032
s_nop 0
buffer_load_dwordx4 v13,s[76:79],s60 offen lds
v_add_u32 v10,106496,v14
ds_read_b64_tr_b16 v[120:121],v10
ds_read_b64_tr_b16 v[122:123],v10 offset:1024
ds_read_b64_tr_b16 v[124:125],v10 offset:8192
ds_read_b64_tr_b16 v[126:127],v10 offset:9216
v_add_u32 v11,106496,v15
ds_read_b64_tr_b16 v[192:193],v11
ds_read_b64_tr_b16 v[194:195],v11 offset:1024
ds_read_b64_tr_b16 v[196:197],v11 offset:8192
ds_read_b64_tr_b16 v[198:199],v11 offset:9216
s_waitcnt vmcnt(8) lgkmcnt(0)
s_barrier
s_add_u32 s60,s62,2621440
s_add_u32 m0,s63,106496
s_nop 0
buffer_load_dwordx4 v12,s[76:79],s60 offen lds
s_add_u32 s60,s62,2654208
s_add_u32 m0,s63,107520
s_nop 0
buffer_load_dwordx4 v12,s[76:79],s60 offen lds
s_add_u32 s60,s62,2686976
s_add_u32 m0,s63,108544
s_nop 0
buffer_load_dwordx4 v13,s[76:79],s60 offen lds
s_add_u32 s60,s62,2719744
s_add_u32 m0,s63,109568
s_nop 0
buffer_load_dwordx4 v13,s[76:79],s60 offen lds
v_add_u32 v10,122880,v14
ds_read_b64_tr_b16 v[128:129],v10
ds_read_b64_tr_b16 v[130:131],v10 offset:1024
ds_read_b64_tr_b16 v[132:133],v10 offset:8192
ds_read_b64_tr_b16 v[134:135],v10 offset:9216
v_add_u32 v11,122880,v15
ds_read_b64_tr_b16 v[200:201],v11
ds_read_b64_tr_b16 v[202:203],v11 offset:1024
ds_read_b64_tr_b16 v[204:205],v11 offset:8192
ds_read_b64_tr_b16 v[206:207],v11 offset:9216
s_waitcnt vmcnt(8) lgkmcnt(0)
s_barrier
s_add_u32 s60,s62,3145728
s_add_u32 m0,s63,122880
s_nop 0
buffer_load_dwordx4 v12,s[76:79],s60 offen lds
s_add_u32 s60,s62,3178496
s_add_u32 m0,s63,123904
s_nop 0
buffer_load_dwordx4 v12,s[76:79],s60 offen lds
s_add_u32 s60,s62,3211264
s_add_u32 m0,s63,124928
s_nop 0
buffer_load_dwordx4 v13,s[76:79],s60 offen lds
s_add_u32 s60,s62,3244032
s_add_u32 m0,s63,125952
s_nop 0
buffer_load_dwordx4 v13,s[76:79],s60 offen lds
v_add_u32 v10,139264,v14
ds_read_b64_tr_b16 v[136:137],v10
ds_read_b64_tr_b16 v[138:139],v10 offset:1024
ds_read_b64_tr_b16 v[140:141],v10 offset:8192
ds_read_b64_tr_b16 v[142:143],v10 offset:9216
v_add_u32 v11,139264,v15
ds_read_b64_tr_b16 v[208:209],v11
ds_read_b64_tr_b16 v[210:211],v11 offset:1024
ds_read_b64_tr_b16 v[212:213],v11 offset:8192
ds_read_b64_tr_b16 v[214:215],v11 offset:9216
s_waitcnt vmcnt(8) lgkmcnt(0)
s_barrier
s_add_u32 s60,s62,3670016
s_add_u32 m0,s63,139264
s_nop 0
buffer_load_dwordx4 v12,s[76:79],s60 offen lds
s_add_u32 s60,s62,3702784
s_add_u32 m0,s63,140288
s_nop 0
buffer_load_dwordx4 v12,s[76:79],s60 offen lds
s_add_u32 s60,s62,3735552
s_add_u32 m0,s63,141312
s_nop 0
buffer_load_dwordx4 v13,s[76:79],s60 offen lds
s_add_u32 s60,s62,3768320
s_add_u32 m0,s63,142336
s_nop 0
buffer_load_dwordx4 v13,s[76:79],s60 offen lds
v_add_u32 v10,40960,v14
ds_read_b64_tr_b16 v[144:145],v10
ds_read_b64_tr_b16 v[146:147],v10 offset:1024
ds_read_b64_tr_b16 v[148:149],v10 offset:8192
ds_read_b64_tr_b16 v[150:151],v10 offset:9216
v_add_u32 v11,40960,v15
ds_read_b64_tr_b16 v[216:217],v11
ds_read_b64_tr_b16 v[218:219],v11 offset:1024
ds_read_b64_tr_b16 v[220:221],v11 offset:8192
ds_read_b64_tr_b16 v[222:223],v11 offset:9216
s_waitcnt vmcnt(8) lgkmcnt(0)
s_barrier
s_add_u32 s60,s62,4194304
s_add_u32 m0,s63,40960
s_nop 0
buffer_load_dwordx4 v12,s[76:79],s60 offen lds
s_add_u32 s60,s62,4227072
s_add_u32 m0,s63,41984
s_nop 0
buffer_load_dwordx4 v12,s[76:79],s60 offen lds
s_add_u32 s60,s62,4259840
s_add_u32 m0,s63,43008
s_nop 0
buffer_load_dwordx4 v13,s[76:79],s60 offen lds
s_add_u32 s60,s62,4292608
s_add_u32 m0,s63,44032
s_nop 0
buffer_load_dwordx4 v13,s[76:79],s60 offen lds
v_add_u32 v10,106496,v14
ds_read_b64_tr_b16 v[152:153],v10
ds_read_b64_tr_b16 v[154:155],v10 offset:1024
ds_read_b64_tr_b16 v[156:157],v10 offset:8192
ds_read_b64_tr_b16 v[158:159],v10 offset:9216
v_add_u32 v11,106496,v15
ds_read_b64_tr_b16 v[224:225],v11
ds_read_b64_tr_b16 v[226:227],v11 offset:1024
ds_read_b64_tr_b16 v[228:229],v11 offset:8192
ds_read_b64_tr_b16 v[230:231],v11 offset:9216
s_waitcnt vmcnt(8) lgkmcnt(0)
s_barrier
v_add_u32 v10,122880,v14
ds_read_b64_tr_b16 v[160:161],v10
ds_read_b64_tr_b16 v[162:163],v10 offset:1024
ds_read_b64_tr_b16 v[164:165],v10 offset:8192
ds_read_b64_tr_b16 v[166:167],v10 offset:9216
v_add_u32 v11,122880,v15
ds_read_b64_tr_b16 v[232:233],v11
ds_read_b64_tr_b16 v[234:235],v11 offset:1024
ds_read_b64_tr_b16 v[236:237],v11 offset:8192
ds_read_b64_tr_b16 v[238:239],v11 offset:9216
s_waitcnt vmcnt(4) lgkmcnt(0)
s_barrier
v_add_u32 v10,139264,v14
ds_read_b64_tr_b16 v[168:169],v10
ds_read_b64_tr_b16 v[170:171],v10 offset:1024
ds_read_b64_tr_b16 v[172:173],v10 offset:8192
ds_read_b64_tr_b16 v[174:175],v10 offset:9216
v_add_u32 v11,139264,v15
ds_read_b64_tr_b16 v[240:241],v11
ds_read_b64_tr_b16 v[242:243],v11 offset:1024
ds_read_b64_tr_b16 v[244:245],v11 offset:8192
ds_read_b64_tr_b16 v[246:247],v11 offset:9216
s_waitcnt vmcnt(0) lgkmcnt(0)
s_barrier
v_add_u32 v10,40960,v14
ds_read_b64_tr_b16 v[176:177],v10
ds_read_b64_tr_b16 v[178:179],v10 offset:1024
ds_read_b64_tr_b16 v[180:181],v10 offset:8192
ds_read_b64_tr_b16 v[182:183],v10 offset:9216
v_add_u32 v11,40960,v15
ds_read_b64_tr_b16 v[248:249],v11
ds_read_b64_tr_b16 v[250:251],v11 offset:1024
ds_read_b64_tr_b16 v[252:253],v11 offset:8192
ds_read_b64_tr_b16 v[254:255],v11 offset:9216
s_waitcnt lgkmcnt(0)
s_barrier
s_add_u32 s62,s26,4
s_cmp_eq_u32 s23,0
s_cbranch_scc1 nx_22
s_lshl_b32 s63,s62,12
s_add_u32 s63,s63,21757952
v_min_u32 v10,2,v0
v_lshlrev_b32 v10,7,v10
s_branch wf_23_0f
wf_23_0:
s_sleep 1
wf_23_0f:
buffer_load_dword v11,v10,s[8:11],s63 offen sc1
s_add_u32 s38,s38,1
s_cmp_gt_u32 s38,3000000
s_cbranch_scc1 w_fail
s_waitcnt vmcnt(0)
v_cmp_gt_u32 vcc,1,v11
s_cbranch_vccnz wf_23_0
nx_22:
s_mul_i32 s27,s62,36864
s_mul_i32 s61,s21,9216
s_add_u32 s61,s61,s31
s_add_u32 m0,s61,0
s_nop 0
buffer_load_dwordx4 v1,s[12:15],s27 offen sc1 lds
s_add_u32 m0,s61,896
s_nop 0
buffer_load_dwordx4 v1,s[12:15],s27 offen offset:128 sc1 lds
s_add_u32 m0,s61,1792
s_nop 0
buffer_load_dwordx4 v1,s[12:15],s27 offen offset:256 sc1 lds
s_add_u32 m0,s61,2688
s_nop 0
buffer_load_dwordx4 v1,s[12:15],s27 offen offset:384 sc1 lds
s_add_u32 m0,s61,3584
s_nop 0
buffer_load_dwordx4 v1,s[12:15],s27 offen offset:512 sc1 lds
s_add_u32 m0,s61,4480
s_nop 0
buffer_load_dwordx4 v1,s[12:15],s27 offen offset:640 sc1 lds
s_add_u32 m0,s61,5376
s_nop 0
buffer_load_dwordx4 v1,s[12:15],s27 offen offset:768 sc1 lds
s_add_u32 m0,s61,6272
s_nop 0
buffer_load_dwordx4 v1,s[12:15],s27 offen offset:896 sc1 lds
s_add_u32 m0,s61,7168
s_nop 0
buffer_load_dwordx4 v1,s[12:15],s27 offen offset:1024 sc1 lds
s_cmp_eq_u32 s23,0
s_cbranch_scc0 g_cs3
v_mov_b32 v24,0x3f803f80
v_mov_b32 v25,0x3f803f80
v_mov_b32 v26,0x3f803f80
v_mov_b32 v27,0x3f803f80
s_nop 1
v_mfma_f32_16x16x32_bf16 v[28:31],v[24:27],v[112:115],0
v_mfma_f32_16x16x32_bf16 v[32:35],v[24:27],v[184:187],0
v_mfma_f32_16x16x32_bf16 v[28:31],v[24:27],v[116:119],v[28:31]
v_mfma_f32_16x16x32_bf16 v[32:35],v[24:27],v[188:191],v[32:35]
v_mfma_f32_16x16x32_bf16 v[28:31],v[24:27],v[120:123],v[28:31]
v_mfma_f32_16x16x32_bf16 v[32:35],v[24:27],v[192:195],v[32:35]
v_mfma_f32_16x16x32_bf16 v[28:31],v[24:27],v[124:127],v[28:31]
v_mfma_f32_16x16x32_bf16 v[32:35],v[24:27],v[196:199],v[32:35]
v_mfma_f32_16x16x32_bf16 v[28:31],v[24:27],v[128:131],v[28:31]
v_mfma_f32_16x16x32_bf16 v[32:35],v[24:27],v[200:203],v[32:35]
v_mfma_f32_16x16x32_bf16 v[28:31],v[24:27],v[132:135],v[28:31]
v_mfma_f32_16x16x32_bf16 v[32:35],v[24:27],v[204:207],v[32:35]
v_mfma_f32_16x16x32_bf16 v[28:31],v[24:27],v[136:139],v[28:31]
v_mfma_f32_16x16x32_bf16 v[32:35],v[24:27],v[208:211],v[32:35]
v_mfma_f32_16x16x32_bf16 v[28:31],v[24:27],v[140:143],v[28:31]
v_mfma_f32_16x16x32_bf16 v[32:35],v[24:27],v[212:215],v[32:35]
v_mfma_f32_16x16x32_bf16 v[28:31],v[24:27],v[144:147],v[28:31]
v_mfma_f32_16x16x32_bf16 v[32:35],v[24:27],v[216:219],v[32:35]
v_mfma_f32_16x16x32_bf16 v[28:31],v[24:27],v[148:151],v[28:31]
v_mfma_f32_16x16x32_bf16 v[32:35],v[24:27],v[220:223],v[32:35]
v_mfma_f32_16x16x32_bf16 v[28:31],v[24:27],v[152:155],v[28:31]
v_mfma_f32_16x16x32_bf16 v[32:35],v[24:27],v[224:227],v[32:35]
v_mfma_f32_16x16x32_bf16 v[28:31],v[24:27],v[156:159],v[28:31]
v_mfma_f32_16x16x32_bf16 v[32:35],v[24:27],v[228:231],v[32:35]
v_mfma_f32_16x16x32_bf16 v[28:31],v[24:27],v[160:163],v[28:31]
v_mfma_f32_16x16x32_bf16 v[32:35],v[24:27],v[232:235],v[32:35]
v_mfma_f32_16x16x32_bf16 v[28:31],v[24:27],v[164:167],v[28:31]
v_mfma_f32_16x16x32_bf16 v[32:35],v[24:27],v[236:239],v[32:35]
v_mfma_f32_16x16x32_bf16 v[28:31],v[24:27],v[168:171],v[28:31]
v_mfma_f32_16x16x32_bf16 v[32:35],v[24:27],v[240:243],v[32:35]
v_mfma_f32_16x16x32_bf16 v[28:31],v[24:27],v[172:175],v[28:31]
v_mfma_f32_16x16x32_bf16 v[32:35],v[24:27],v[244:247],v[32:35]
v_mfma_f32_16x16x32_bf16 v[28:31],v[24:27],v[176:179],v[28:31]
v_mfma_f32_16x16x32_bf16 v[32:35],v[24:27],v[248:251],v[32:35]
v_mfma_f32_16x16x32_bf16 v[28:31],v[24:27],v[180:183],v[28:31]
v_mfma_f32_16x16x32_bf16 v[32:35],v[24:27],v[252:255],v[32:35]
s_lshl_b32 s60,s21,9
v_add_u32 v10,s60,v7
s_nop 1
ds_write_b32 v10,v28 offset:512
s_nop 2
ds_write_b32 v10,v32 offset:576
s_waitcnt lgkmcnt(0)
g_cs3:
ds_read2_b32 v[12:13],v7 offset0:0 offset1:16
ds_read2_b32 v[14:15],v7 offset0:32 offset1:48
a1_hasq:
ds_read_b128 v[64:67],v4
ds_read_b128 v[68:71],v4 offset:18432
ds_read_b128 v[72:75],v3
ds_read_b128 v[76:79],v3 offset:18432
s_waitcnt lgkmcnt(2)
v_mfma_f32_16x16x32_bf16 v[48:51],v[112:115],v[64:67],0
ds_read_b128 v[24:27],v4 offset:1024
v_mfma_f32_16x16x32_bf16 v[52:55],v[112:115],v[68:71],0
ds_read_b128 v[28:31],v4 offset:19456
v_mfma_f32_16x16x32_bf16 v[56:59],v[184:187],v[64:67],0
v_mfma_f32_16x16x32_bf16 v[60:63],v[184:187],v[68:71],0
s_waitcnt lgkmcnt(2)
v_mfma_f32_16x16x32_bf16 v[48:51],v[116:119],v[72:75],v[48:51]
ds_read_b128 v[64:67],v3 offset:1024
v_mfma_f32_16x16x32_bf16 v[52:55],v[116:119],v[76:79],v[52:55]
ds_read_b128 v[68:71],v3 offset:19456
v_mfma_f32_16x16x32_bf16 v[56:59],v[188:191],v[72:75],v[56:59]
v_mfma_f32_16x16x32_bf16 v[60:63],v[188:191],v[76:79],v[60:63]
s_waitcnt lgkmcnt(2)
v_mfma_f32_16x16x32_bf16 v[48:51],v[120:123],v[24:27],v[48:51]
ds_read_b128 v[72:75],v4 offset:2048
v_mfma_f32_16x16x32_bf16 v[52:55],v[120:123],v[28:31],v[52:55]
ds_read_b128 v[76:79],v4 offset:20480
v_mfma_f32_16x16x32_bf16 v[56:59],v[192:195],v[24:27],v[56:59]
v_mfma_f32_16x16x32_bf16 v[60:63],v[192:195],v[28:31],v[60:63]
s_waitcnt lgkmcnt(2)
v_mfma_f32_16x16x32_bf16 v[48:51],v[124:127],v[64:67],v[48:51]
ds_read_b128 v[24:27],v3 offset:2048
v_mfma_f32_16x16x32_bf16 v[52:55],v[124:127],v[68:71],v[52:55]
ds_read_b128 v[28:31],v3 offset:20480
v_mfma_f32_16x16x32_bf16 v[56:59],v[196:199],v[64:67],v[56:59]
v_mfma_f32_16x16x32_bf16 v[60:63],v[196:199],v[68:71],v[60:63]
s_waitcnt lgkmcnt(2)
v_mfma_f32_16x16x32_bf16 v[48:51],v[128:131],v[72:75],v[48:51]
ds_read_b128 v[64:67],v4 offset:3072
v_mfma_f32_16x16x32_bf16 v[52:55],v[128:131],v[76:79],v[52:55]
ds_read_b128 v[68:71],v4 offset:21504
v_mfma_f32_16x16x32_bf16 v[56:59],v[200:203],v[72:75],v[56:59]
v_mfma_f32_16x16x32_bf16 v[60:63],v[200:203],v[76:79],v[60:63]
s_waitcnt lgkmcnt(2)
v_mfma_f32_16x16x32_bf16 v[48:51],v[132:135],v[24:27],v[48:51]
ds_read_b128 v[72:75],v3 offset:3072
v_mfma_f32_16x16x32_bf16 v[52:55],v[132:135],v[28:31],v[52:55]
ds_read_b128 v[76:79],v3 offset:21504
v_mfma_f32_16x16x32_bf16 v[56:59],v[204:207],v[24:27],v[56:59]
v_mfma_f32_16x16x32_bf16 v[60:63],v[204:207],v[28:31],v[60:63]
s_waitcnt lgkmcnt(2)
v_mfma_f32_16x16x32_bf16 v[48:51],v[136:139],v[64:67],v[48:51]
ds_read_b128 v[24:27],v4 offset:4096
v_mfma_f32_16x16x32_bf16 v[52:55],v[136:139],v[68:71],v[52:55]
ds_read_b128 v[28:31],v4 offset:22528
v_mfma_f32_16x16x32_bf16 v[56:59],v[208:211],v[64:67],v[56:59]
v_mfma_f32_16x16x32_bf16 v[60:63],v[208:211],v[68:71],v[60:63]
s_waitcnt lgkmcnt(2)
v_mfma_f32_16x16x32_bf16 v[48:51],v[140:143],v[72:75],v[48:51]
ds_read_b128 v[64:67],v3 offset:4096
v_mfma_f32_16x16x32_bf16 v[52:55],v[140:143],v[76:79],v[52:55]
ds_read_b128 v[68:71],v3 offset:22528
v_mfma_f32_16x16x32_bf16 v[56:59],v[212:215],v[72:75],v[56:59]
v_mfma_f32_16x16x32_bf16 v[60:63],v[212:215],v[76:79],v[60:63]
s_waitcnt lgkmcnt(2)
v_mfma_f32_16x16x32_bf16 v[48:51],v[144:147],v[24:27],v[48:51]
ds_read_b128 v[72:75],v4 offset:5120
v_mfma_f32_16x16x32_bf16 v[52:55],v[144:147],v[28:31],v[52:55]
ds_read_b128 v[76:79],v4 offset:23552
v_mfma_f32_16x16x32_bf16 v[56:59],v[216:219],v[24:27],v[56:59]
v_mfma_f32_16x16x32_bf16 v[60:63],v[216:219],v[28:31],v[60:63]
s_waitcnt lgkmcnt(2)
v_mfma_f32_16x16x32_bf16 v[48:51],v[148:151],v[64:67],v[48:51]
ds_read_b128 v[24:27],v3 offset:5120
v_mfma_f32_16x16x32_bf16 v[52:55],v[148:151],v[68:71],v[52:55]
ds_read_b128 v[28:31],v3 offset:23552
v_mfma_f32_16x16x32_bf16 v[56:59],v[220:223],v[64:67],v[56:59]
v_mfma_f32_16x16x32_bf16 v[60:63],v[220:223],v[68:71],v[60:63]
s_waitcnt lgkmcnt(2)
v_mfma_f32_16x16x32_bf16 v[48:51],v[152:155],v[72:75],v[48:51]
ds_read_b128 v[64:67],v4 offset:6144
v_mfma_f32_16x16x32_bf16 v[52:55],v[152:155],v[76:79],v[52:55]
ds_read_b128 v[68:71],v4 offset:24576
v_mfma_f32_16x16x32_bf16 v[56:59],v[224:227],v[72:75],v[56:59]
v_mfma_f32_16x16x32_bf16 v[60:63],v[224:227],v[76:79],v[60:63]
s_lshl_b32 s30,s25,6
s_add_u32 s30,s30,s26
s_lshl_b32 s30,s30,4
s_add_u32 s30,s30,6422528
s_waitcnt vmcnt(0)
s_barrier
s_cmp_lg_u32 s21,0
s_cbranch_scc1 sg_25
v_mov_b32 v10,0
v_mov_b32 v11,1
s_mov_b64 exec,1
buffer_store_dword v11,v10,s[8:11],s30 offen sc1
s_mov_b64 exec,-1
sg_25:
s_waitcnt lgkmcnt(2)
v_mfma_f32_16x16x32_bf16 v[48:51],v[156:159],v[24:27],v[48:51]
ds_read_b128 v[72:75],v3 offset:6144
v_mfma_f32_16x16x32_bf16 v[52:55],v[156:159],v[28:31],v[52:55]
ds_read_b128 v[76:79],v3 offset:24576
v_mfma_f32_16x16x32_bf16 v[56:59],v[228:231],v[24:27],v[56:59]
v_mfma_f32_16x16x32_bf16 v[60:63],v[228:231],v[28:31],v[60:63]
s_waitcnt lgkmcnt(2)
v_mfma_f32_16x16x32_bf16 v[48:51],v[160:163],v[64:67],v[48:51]
ds_read_b128 v[24:27],v4 offset:7168
v_mfma_f32_16x16x32_bf16 v[52:55],v[160:163],v[68:71],v[52:55]
ds_read_b128 v[28:31],v4 offset:25600
v_mfma_f32_16x16x32_bf16 v[56:59],v[232:235],v[64:67],v[56:59]
v_mfma_f32_16x16x32_bf16 v[60:63],v[232:235],v[68:71],v[60:63]
s_waitcnt lgkmcnt(2)
v_mfma_f32_16x16x32_bf16 v[48:51],v[164:167],v[72:75],v[48:51]
ds_read_b128 v[64:67],v3 offset:7168
v_mfma_f32_16x16x32_bf16 v[52:55],v[164:167],v[76:79],v[52:55]
ds_read_b128 v[68:71],v3 offset:25600
v_mfma_f32_16x16x32_bf16 v[56:59],v[236:239],v[72:75],v[56:59]
v_mfma_f32_16x16x32_bf16 v[60:63],v[236:239],v[76:79],v[60:63]
s_waitcnt lgkmcnt(2)
v_mfma_f32_16x16x32_bf16 v[48:51],v[168:171],v[24:27],v[48:51]
ds_read_b128 v[72:75],v4 offset:8192
v_mfma_f32_16x16x32_bf16 v[52:55],v[168:171],v[28:31],v[52:55]
ds_read_b128 v[76:79],v4 offset:26624
v_mfma_f32_16x16x32_bf16 v[56:59],v[240:243],v[24:27],v[56:59]
v_mfma_f32_16x16x32_bf16 v[60:63],v[240:243],v[28:31],v[60:63]
s_waitcnt lgkmcnt(2)
v_mfma_f32_16x16x32_bf16 v[48:51],v[172:175],v[64:67],v[48:51]
ds_read_b128 v[24:27],v3 offset:8192
v_mfma_f32_16x16x32_bf16 v[52:55],v[172:175],v[68:71],v[52:55]
ds_read_b128 v[28:31],v3 offset:26624
v_mfma_f32_16x16x32_bf16 v[56:59],v[244:247],v[64:67],v[56:59]
v_mfma_f32_16x16x32_bf16 v[60:63],v[244:247],v[68:71],v[60:63]
s_waitcnt lgkmcnt(2)
v_mfma_f32_16x16x32_bf16 v[48:51],v[176:179],v[72:75],v[48:51]
v_mfma_f32_16x16x32_bf16 v[52:55],v[176:179],v[76:79],v[52:55]
v_mfma_f32_16x16x32_bf16 v[56:59],v[248:251],v[72:75],v[56:59]
v_mfma_f32_16x16x32_bf16 v[60:63],v[248:251],v[76:79],v[60:63]
s_waitcnt lgkmcnt(0)
v_mfma_f32_16x16x32_bf16 v[48:51],v[180:183],v[24:27],v[48:51]
v_mfma_f32_16x16x32_bf16 v[52:55],v[180:183],v[28:31],v[52:55]
v_mfma_f32_16x16x32_bf16 v[56:59],v[252:255],v[24:27],v[56:59]
v_mfma_f32_16x16x32_bf16 v[60:63],v[252:255],v[28:31],v[60:63]
s_lshl_b32 s60,s21,9
v_add_u32 v10,s60,v8
ds_read_b128 v[64:67],v10 offset:512
ds_read_b128 v[68:71],v10 offset:576
s_lshl_b32 s60,s21,10
s_add_u32 s60,s60,s29
s_add_u32 s61,s60,4096
v_xor_b32 v4,65536,v4
v_xor_b32 v3,65536,v3
s_waitcnt lgkmcnt(0)
v_pk_mul_f32 v[48:49],v[48:49],v[12:13] op_sel:[0,0] op_sel_hi:[1,0]
v_pk_mul_f32 v[50:51],v[50:51],v[12:13] op_sel:[0,0] op_sel_hi:[1,0]
v_pk_fma_f32 v[48:49],v[64:65],v[14:15],v[48:49] op_sel:[0,0,0] op_sel_hi:[1,0,1]
v_pk_fma_f32 v[50:51],v[66:67],v[14:15],v[50:51] op_sel:[0,0,0] op_sel_hi:[1,0,1]
v_pk_mul_f32 v[56:57],v[56:57],v[12:13] op_sel:[0,0] op_sel_hi:[1,0]
v_pk_mul_f32 v[58:59],v[58:59],v[12:13] op_sel:[0,0] op_sel_hi:[1,0]
v_pk_fma_f32 v[56:57],v[68:69],v[14:15],v[56:57] op_sel:[0,0,0] op_sel_hi:[1,0,1]
v_pk_fma_f32 v[58:59],v[70:71],v[14:15],v[58:59] op_sel:[0,0,0] op_sel_hi:[1,0,1]
v_cvt_pk_bf16_f32 v48,v48,v49
v_cvt_pk_bf16_f32 v49,v50,v51
v_cvt_pk_bf16_f32 v50,v56,v57
v_cvt_pk_bf16_f32 v51,v58,v59
buffer_store_dwordx4 v[48:51],v5,s[88:91],s60 offen sc1
v_pk_mul_f32 v[52:53],v[52:53],v[12:13] op_sel:[0,1] op_sel_hi:[1,1]
v_pk_mul_f32 v[54:55],v[54:55],v[12:13] op_sel:[0,1] op_sel_hi:[1,1]
v_pk_fma_f32 v[52:53],v[64:65],v[14:15],v[52:53] op_sel:[0,1,0] op_sel_hi:[1,1,1]
v_pk_fma_f32 v[54:55],v[66:67],v[14:15],v[54:55] op_sel:[0,1,0] op_sel_hi:[1,1,1]
v_pk_mul_f32 v[60:61],v[60:61],v[12:13] op_sel:[0,1] op_sel_hi:[1,1]
v_pk_mul_f32 v[62:63],v[62:63],v[12:13] op_sel:[0,1] op_sel_hi:[1,1]
v_pk_fma_f32 v[60:61],v[68:69],v[14:15],v[60:61] op_sel:[0,1,0] op_sel_hi:[1,1,1]
v_pk_fma_f32 v[62:63],v[70:71],v[14:15],v[62:63] op_sel:[0,1,0] op_sel_hi:[1,1,1]
v_cvt_pk_bf16_f32 v52,v52,v53
v_cvt_pk_bf16_f32 v53,v54,v55
v_cvt_pk_bf16_f32 v54,v60,v61
v_cvt_pk_bf16_f32 v55,v62,v63
buffer_store_dwordx4 v[52:55],v5,s[88:91],s61 offen sc1
s_add_u32 s26,s26,4
s_cmp_lt_u32 s26,64
s_cbranch_scc1 w_a1
s_waitcnt vmcnt(0)
s_barrier
s_cmp_lg_u32 s21,0
s_cbranch_scc1 sg_26
v_mov_b32 v10,0
v_mov_b32 v11,2
s_mov_b64 exec,1
buffer_store_dword v11,v10,s[8:11],s30 offen sc1
s_mov_b64 exec,-1
sg_26:
s_lshl_b32 s60,s21,9
v_lshl_add_u32 v10,v0,2,s60
ds_read_b32 v76,v10 offset:38144
ds_read_b32 v77,v10 offset:38400
s_waitcnt lgkmcnt(0)
s_cmp_eq_u32 s23,0
s_cbranch_scc1 g_att
s_cmp_ge_u32 s22,2
s_cbranch_scc1 g_att
s_lshr_b32 s61,s24,1
s_add_u32 s61,s61,s22
s_add_u32 s61,s61,128
s_mul_i32 s26,s61,43691
s_lshr_b32 s26,s26,17
s_mul_i32 s60,s26,3
s_sub_u32 s25,s61,s60
s_sub_u32 s60,63,s26
s_cmp_eq_u32 s23,0
s_cselect_b32 s26,s26,s60
s_mov_b32 s76,s94
s_mov_b32 s77,s95
s_mov_b32 s78,663552
s_mov_b32 s79,0x20000
s_lshl_b32 s63,s21,14
s_add_u32 s63,s63,81920
v_lshrrev_b32 v10,4,v0
v_bfe_u32 v11,v0,2,2
v_lshl_add_u32 v10,v10,3,v11
v_lshlrev_b32 v10,6,v10
v_and_b32 v11,3,v0
v_lshl_add_u32 v10,v11,3,v10
v_add_u32_e64 v3,s63,v10
v_bfe_u32 v10,v0,2,2
v_bfe_u32 v11,v0,4,1
v_lshl_add_u32 v10,v11,3,v10
v_lshrrev_b32_e64 v11,5,v0
v_lshl_add_u32 v10,v11,2,v10
v_mul_u32_u24 v10,1152,v10
v_and_b32 v11,3,v0
v_lshlrev_b32 v11,4,v11
v_add_u32_e64 v4,v11,v10
v_bfe_u32 v12,v0,1,1
v_mul_u32_u24 v12,82944,v12
v_and_b32 v13,1,v0
v_lshl_add_u32 v12,v13,4,v12
v_add_u32 v5,v10,v12
v_lshrrev_b32 v12,3,v0
v_mul_u32_u24 v12,18,v12
v_bfe_u32 v13,v0,2,1
v_add_u32 v12,v12,v13
v_mul_u32_u24 v12,1152,v12
v_add_u32 v6,v11,v12
s_lshl_b32 s62,s25,2
s_add_u32 s62,s62,s21
s_mul_i32 s62,s62,96
s_add_u32 s60,s62,0
s_add_u32 m0,s63,0
s_nop 0
buffer_load_dwordx4 v4,s[76:79],s60 offen lds
s_add_u32 s60,s62,20736
s_add_u32 m0,s63,1024
s_nop 0
buffer_load_dwordx4 v4,s[76:79],s60 offen lds
s_add_u32 s60,s62,41472
s_add_u32 m0,s63,2048
s_nop 0
buffer_load_dwordx4 v4,s[76:79],s60 offen lds
s_add_u32 s60,s62,62208
s_add_u32 m0,s63,3072
s_nop 0
buffer_load_dwordx4 v4,s[76:79],s60 offen lds
s_add_u32 s60,s62,82944
s_add_u32 m0,s63,4096
s_nop 0
buffer_load_dwordx4 v4,s[76:79],s60 offen lds
s_add_u32 s60,s62,103680
s_add_u32 m0,s63,5120
s_nop 0
buffer_load_dwordx4 v4,s[76:79],s60 offen lds
s_add_u32 s60,s62,124416
s_add_u32 m0,s63,6144
s_nop 0
buffer_load_dwordx4 v4,s[76:79],s60 offen lds
s_add_u32 s60,s62,145152
s_add_u32 m0,s63,7168
s_nop 0
buffer_load_dwordx4 v4,s[76:79],s60 offen lds
s_add_u32 s60,s62,165888
s_add_u32 m0,s63,8192
s_nop 0
buffer_load_dwordx4 v4,s[76:79],s60 offen lds
s_add_u32 s60,s62,186624
s_add_u32 m0,s63,9216
s_nop 0
buffer_load_dwordx4 v4,s[76:79],s60 offen lds
s_add_u32 s60,s62,207360
s_add_u32 m0,s63,10240
s_nop 0
buffer_load_dwordx4 v4,s[76:79],s60 offen lds
s_add_u32 s60,s62,228096
s_add_u32 m0,s63,11264
s_nop 0
buffer_load_dwordx4 v4,s[76:79],s60 offen lds
s_waitcnt lgkmcnt(0)
s_add_u32 s60,s62,248832
s_add_u32 m0,s63,12288
s_nop 0
buffer_load_dwordx4 v4,s[76:79],s60 offen lds
s_add_u32 s60,s62,269568
s_add_u32 m0,s63,13312
s_nop 0
buffer_load_dwordx4 v4,s[76:79],s60 offen lds
s_add_u32 s60,s62,290304
s_add_u32 m0,s63,14336
s_nop 0
buffer_load_dwordx4 v4,s[76:79],s60 offen lds
s_add_u32 s60,s62,311040
s_add_u32 m0,s63,15360
s_nop 0
buffer_load_dwordx4 v4,s[76:79],s60 offen lds
s_waitcnt vmcnt(12)
ds_read_b64_tr_b16 a[0:1],v3
ds_read_b64_tr_b16 a[2:3],v3 offset:256
ds_read_b64_tr_b16 a[4:5],v3 offset:2048
ds_read_b64_tr_b16 a[6:7],v3 offset:2304
ds_read_b64_tr_b16 a[72:73],v3 offset:32
ds_read_b64_tr_b16 a[74:75],v3 offset:288
ds_read_b64_tr_b16 a[76:77],v3 offset:2080
ds_read_b64_tr_b16 a[78:79],v3 offset:2336
s_waitcnt lgkmcnt(0)
s_add_u32 s60,s62,331776
s_add_u32 m0,s63,0
s_nop 0
buffer_load_dwordx4 v4,s[76:79],s60 offen lds
s_add_u32 s60,s62,352512
s_add_u32 m0,s63,1024
s_nop 0
buffer_load_dwordx4 v4,s[76:79],s60 offen lds
s_add_u32 s60,s62,373248
s_add_u32 m0,s63,2048
s_nop 0
buffer_load_dwordx4 v4,s[76:79],s60 offen lds
s_add_u32 s60,s62,393984
s_add_u32 m0,s63,3072
s_nop 0
buffer_load_dwordx4 v4,s[76:79],s60 offen lds
s_waitcnt vmcnt(12)
ds_read_b64_tr_b16 a[8:9],v3 offset:4096
ds_read_b64_tr_b16 a[10:11],v3 offset:4352
ds_read_b64_tr_b16 a[12:13],v3 offset:6144
ds_read_b64_tr_b16 a[14:15],v3 offset:6400
ds_read_b64_tr_b16 a[80:81],v3 offset:4128
ds_read_b64_tr_b16 a[82:83],v3 offset:4384
ds_read_b64_tr_b16 a[84:85],v3 offset:6176
ds_read_b64_tr_b16 a[86:87],v3 offset:6432
s_waitcnt lgkmcnt(0)
s_add_u32 s60,s62,414720
s_add_u32 m0,s63,4096
s_nop 0
buffer_load_dwordx4 v4,s[76:79],s60 offen lds
s_add_u32 s60,s62,435456
s_add_u32 m0,s63,5120
s_nop 0
buffer_load_dwordx4 v4,s[76:79],s60 offen lds
s_add_u32 s60,s62,456192
s_add_u32 m0,s63,6144
s_nop 0
buffer_load_dwordx4 v4,s[76:79],s60 offen lds
s_add_u32 s60,s62,476928
s_add_u32 m0,s63,7168
s_nop 0
buffer_load_dwordx4 v4,s[76:79],s60 offen lds
s_waitcnt vmcnt(12)
ds_read_b64_tr_b16 a[16:17],v3 offset:8192
ds_read_b64_tr_b16 a[18:19],v3 offset:8448
ds_read_b64_tr_b16 a[20:21],v3 offset:10240
ds_read_b64_tr_b16 a[22:23],v3 offset:10496
ds_read_b64_tr_b16 a[88:89],v3 offset:8224
ds_read_b64_tr_b16 a[90:91],v3 offset:8480
ds_read_b64_tr_b16 a[92:93],v3 offset:10272
ds_read_b64_tr_b16 a[94:95],v3 offset:10528
s_waitcnt lgkmcnt(0)
s_add_u32 s60,s62,497664
s_add_u32 m0,s63,8192
s_nop 0
buffer_load_dwordx4 v4,s[76:79],s60 offen lds
s_add_u32 s60,s62,518400
s_add_u32 m0,s63,9216
s_nop 0
buffer_load_dwordx4 v4,s[76:79],s60 offen lds
s_add_u32 s60,s62,539136
s_add_u32 m0,s63,10240
s_nop 0
buffer_load_dwordx4 v4,s[76:79],s60 offen lds
s_add_u32 s60,s62,559872
s_add_u32 m0,s63,11264
s_nop 0
buffer_load_dwordx4 v4,s[76:79],s60 offen lds
s_waitcnt vmcnt(12)
ds_read_b64_tr_b16 a[24:25],v3 offset:12288
ds_read_b64_tr_b16 a[26:27],v3 offset:12544
ds_read_b64_tr_b16 a[28:29],v3 offset:14336
ds_read_b64_tr_b16 a[30:31],v3 offset:14592
ds_read_b64_tr_b16 a[96:97],v3 offset:12320
ds_read_b64_tr_b16 a[98:99],v3 offset:12576
ds_read_b64_tr_b16 a[100:101],v3 offset:14368
ds_read_b64_tr_b16 a[102:103],v3 offset:14624
s_waitcnt lgkmcnt(0)
s_add_u32 s60,s62,580608
s_add_u32 m0,s63,12288
s_nop 0
buffer_load_dwordx4 v4,s[76:79],s60 offen lds
s_add_u32 s60,s62,601344
s_add_u32 m0,s63,13312
s_nop 0
buffer_load_dwordx4 v4,s[76:79],s60 offen lds
s_add_u32 s60,s62,622080
s_add_u32 m0,s63,14336
s_nop 0
buffer_load_dwordx4 v4,s[76:79],s60 offen lds
s_add_u32 s60,s62,642816
s_add_u32 m0,s63,15360
s_nop 0
buffer_load_dwordx4 v4,s[76:79],s60 offen lds
s_waitcnt vmcnt(12)
ds_read_b64_tr_b16 a[32:33],v3
ds_read_b64_tr_b16 a[34:35],v3 offset:256
ds_read_b64_tr_b16 a[36:37],v3 offset:2048
ds_read_b64_tr_b16 a[38:39],v3 offset:2304
ds_read_b64_tr_b16 a[104:105],v3 offset:32
ds_read_b64_tr_b16 a[106:107],v3 offset:288
ds_read_b64_tr_b16 a[108:109],v3 offset:2080
ds_read_b64_tr_b16 a[110:111],v3 offset:2336
s_waitcnt lgkmcnt(0)
s_add_u32 s60,s62,64
s_add_u32 m0,s63,0
s_nop 0
buffer_load_dwordx4 v5,s[76:79],s60 offen lds
s_add_u32 s60,s62,20800
s_add_u32 m0,s63,1024
s_nop 0
buffer_load_dwordx4 v5,s[76:79],s60 offen lds
s_add_u32 s60,s62,41536
s_add_u32 m0,s63,2048
s_nop 0
buffer_load_dwordx4 v5,s[76:79],s60 offen lds
s_add_u32 s60,s62,62272
s_add_u32 m0,s63,3072
s_nop 0
buffer_load_dwordx4 v5,s[76:79],s60 offen lds
s_waitcnt vmcnt(12)
ds_read_b64_tr_b16 a[40:41],v3 offset:4096
ds_read_b64_tr_b16 a[42:43],v3 offset:4352
ds_read_b64_tr_b16 a[44:45],v3 offset:6144
ds_read_b64_tr_b16 a[46:47],v3 offset:6400
ds_read_b64_tr_b16 a[112:113],v3 offset:4128
ds_read_b64_tr_b16 a[114:115],v3 offset:4384
ds_read_b64_tr_b16 a[116:117],v3 offset:6176
ds_read_b64_tr_b16 a[118:119],v3 offset:6432
s_waitcnt lgkmcnt(0)
s_add_u32 s60,s62,165952
s_add_u32 m0,s63,4096
s_nop 0
buffer_load_dwordx4 v5,s[76:79],s60 offen lds
s_add_u32 s60,s62,186688
s_add_u32 m0,s63,5120
s_nop 0
buffer_load_dwordx4 v5,s[76:79],s60 offen lds
s_add_u32 s60,s62,207424
s_add_u32 m0,s63,6144
s_nop 0
buffer_load_dwordx4 v5,s[76:79],s60 offen lds
s_add_u32 s60,s62,228160
s_add_u32 m0,s63,7168
s_nop 0
buffer_load_dwordx4 v5,s[76:79],s60 offen lds
s_waitcnt vmcnt(12)
ds_read_b64_tr_b16 a[48:49],v3 offset:8192
ds_read_b64_tr_b16 a[50:51],v3 offset:8448
ds_read_b64_tr_b16 a[52:53],v3 offset:10240
ds_read_b64_tr_b16 a[54:55],v3 offset:10496
ds_read_b64_tr_b16 a[120:121],v3 offset:8224
ds_read_b64_tr_b16 a[122:123],v3 offset:8480
ds_read_b64_tr_b16 a[124:125],v3 offset:10272
ds_read_b64_tr_b16 a[126:127],v3 offset:10528
s_waitcnt lgkmcnt(0)
s_add_u32 s60,s62,331840
s_add_u32 m0,s63,8192
s_nop 0
buffer_load_dwordx4 v5,s[76:79],s60 offen lds
s_add_u32 s60,s62,352576
s_add_u32 m0,s63,9216
s_nop 0
buffer_load_dwordx4 v5,s[76:79],s60 offen lds
s_add_u32 s60,s62,373312
s_add_u32 m0,s63,10240
s_nop 0
buffer_load_dwordx4 v5,s[76:79],s60 offen lds
s_add_u32 s60,s62,394048
s_add_u32 m0,s63,11264
s_nop 0
buffer_load_dwordx4 v5,s[76:79],s60 offen lds
s_waitcnt vmcnt(12)
ds_read_b64_tr_b16 a[56:57],v3 offset:12288
ds_read_b64_tr_b16 a[58:59],v3 offset:12544
ds_read_b64_tr_b16 a[60:61],v3 offset:14336
ds_read_b64_tr_b16 a[62:63],v3 offset:14592
ds_read_b64_tr_b16 a[128:129],v3 offset:12320
ds_read_b64_tr_b16 a[130:131],v3 offset:12576
ds_read_b64_tr_b16 a[132:133],v3 offset:14368
ds_read_b64_tr_b16 a[134:135],v3 offset:14624
s_waitcnt lgkmcnt(0)
s_add_u32 s60,s62,497728
s_add_u32 m0,s63,12288
s_nop 0
buffer_load_dwordx4 v5,s[76:79],s60 offen lds
s_add_u32 s60,s62,518464
s_add_u32 m0,s63,13312
s_nop 0
buffer_load_dwordx4 v5,s[76:79],s60 offen lds
s_add_u32 s60,s62,539200
s_add_u32 m0,s63,14336
s_nop 0
buffer_load_dwordx4 v5,s[76:79],s60 offen lds
s_add_u32 s60,s62,559936
s_add_u32 m0,s63,15360
s_nop 0
buffer_load_dwordx4 v5,s[76:79],s60 offen lds
s_waitcnt vmcnt(12)
ds_read_b64_tr_b16 a[144:145],v3
ds_read_b64_tr_b16 a[146:147],v3 offset:256
ds_read_b64_tr_b16 a[148:149],v3 offset:2048
ds_read_b64_tr_b16 a[150:151],v3 offset:2304
ds_read_b64_tr_b16 a[152:153],v3 offset:32
ds_read_b64_tr_b16 a[154:155],v3 offset:288
ds_read_b64_tr_b16 a[156:157],v3 offset:2080
ds_read_b64_tr_b16 a[158:159],v3 offset:2336
s_waitcnt lgkmcnt(0)
s_add_u32 s60,s62,18432
s_add_u32 m0,s63,0
s_nop 0
buffer_load_dwordx4 v6,s[76:79],s60 offen lds
s_add_u32 s60,s62,184320
s_add_u32 m0,s63,1024
s_nop 0
buffer_load_dwordx4 v6,s[76:79],s60 offen lds
s_add_u32 s60,s62,350208
s_add_u32 m0,s63,2048
s_nop 0
buffer_load_dwordx4 v6,s[76:79],s60 offen lds
s_add_u32 s60,s62,516096
s_add_u32 m0,s63,3072
s_nop 0
buffer_load_dwordx4 v6,s[76:79],s60 offen lds
s_waitcnt vmcnt(12)
ds_read_b64_tr_b16 a[160:161],v3 offset:4096
ds_read_b64_tr_b16 a[162:163],v3 offset:4352
ds_read_b64_tr_b16 a[164:165],v3 offset:6144
ds_read_b64_tr_b16 a[166:167],v3 offset:6400
ds_read_b64_tr_b16 a[168:169],v3 offset:4128
ds_read_b64_tr_b16 a[170:171],v3 offset:4384
ds_read_b64_tr_b16 a[172:173],v3 offset:6176
ds_read_b64_tr_b16 a[174:175],v3 offset:6432
s_waitcnt lgkmcnt(0)
s_add_u32 s60,s62,18496
s_add_u32 m0,s63,4096
s_nop 0
buffer_load_dwordx4 v6,s[76:79],s60 offen lds
s_add_u32 s60,s62,184384
s_add_u32 m0,s63,5120
s_nop 0
buffer_load_dwordx4 v6,s[76:79],s60 offen lds
s_add_u32 s60,s62,350272
s_add_u32 m0,s63,6144
s_nop 0
buffer_load_dwordx4 v6,s[76:79],s60 offen lds
s_add_u32 s60,s62,516160
s_add_u32 m0,s63,7168
s_nop 0
buffer_load_dwordx4 v6,s[76:79],s60 offen lds
s_waitcnt vmcnt(12)
ds_read_b64_tr_b16 a[176:177],v3 offset:8192
ds_read_b64_tr_b16 a[178:179],v3 offset:8448
ds_read_b64_tr_b16 a[180:181],v3 offset:10240
ds_read_b64_tr_b16 a[182:183],v3 offset:10496
ds_read_b64_tr_b16 a[184:185],v3 offset:8224
ds_read_b64_tr_b16 a[186:187],v3 offset:8480
ds_read_b64_tr_b16 a[188:189],v3 offset:10272
ds_read_b64_tr_b16 a[190:191],v3 offset:10528
s_waitcnt vmcnt(8)
ds_read_b64_tr_b16 a[192:193],v3 offset:12288
ds_read_b64_tr_b16 a[194:195],v3 offset:12544
ds_read_b64_tr_b16 a[196:197],v3 offset:14336
ds_read_b64_tr_b16 a[198:199],v3 offset:14592
ds_read_b64_tr_b16 a[200:201],v3 offset:12320
ds_read_b64_tr_b16 a[202:203],v3 offset:12576
ds_read_b64_tr_b16 a[204:205],v3 offset:14368
ds_read_b64_tr_b16 a[206:207],v3 offset:14624
s_waitcnt vmcnt(4)
ds_read_b64_tr_b16 a[64:65],v3
ds_read_b64_tr_b16 a[66:67],v3 offset:256
ds_read_b64_tr_b16 a[68:69],v3 offset:2048
ds_read_b64_tr_b16 a[70:71],v3 offset:2304
ds_read_b64_tr_b16 a[136:137],v3 offset:32
ds_read_b64_tr_b16 a[138:139],v3 offset:288
ds_read_b64_tr_b16 a[140:141],v3 offset:2080
ds_read_b64_tr_b16 a[142:143],v3 offset:2336
s_waitcnt vmcnt(0)
ds_read_b64_tr_b16 a[208:209],v3 offset:4096
ds_read_b64_tr_b16 a[210:211],v3 offset:4352
ds_read_b64_tr_b16 a[212:213],v3 offset:6144
ds_read_b64_tr_b16 a[214:215],v3 offset:6400
s_waitcnt lgkmcnt(0)
g_att:
s_lshr_b32 s25,s24,2
s_mov_b32 s26,s22
v_lshlrev_b32 v1,4,v0
v_and_b32 v10,31,v0
v_lshrrev_b32 v11,5,v0
v_lshlrev_b32 v12,4,v11
v_lshl_add_u32 v2,v10,5,v12
v_lshlrev_b32 v3,3,v10
v_lshl_add_u32 v6,v10,6,v12
v_lshlrev_b32 v7,2,v10
v_and_b32_e64 v13,7,v10
v_bfe_u32 v14,v10,3,1
v_lshl_add_u32 v13,v14,4,v13
v_lshrrev_b32 v14,4,v10
v_lshl_add_u32 v13,v14,3,v13
v_lshl_add_u32 v4,v13,5,v12
v_lshlrev_b32 v13,3,v13
v_lshl_add_u32 v5,v11,30,v13
s_mul_i32 s60,s21,3072
v_add_u32_e64 v8,s60,v1
s_mov_b32 s40,0x3ffff
s_mov_b32 s41,0x3ffff
s_lshl_b32 s60,s25,16
s_add_u32 s30,s60,14680064
s_lshr_b32 s60,s25,1
s_lshl_b32 s60,s60,14
s_and_b32 s61,s25,1
s_lshl_b32 s61,s61,2
s_add_u32 s60,s60,s61
s_add_u32 s31,s60,6815744
s_mov_b32 s34,562036736
v_mov_b32 v228,0
v_mov_b32 v229,0
v_mov_b32_e64 v231,0
v_mov_b32 v232,0x3f803f80
v_mov_b32 v233,0x3f803f80
v_mov_b32 v234,0x3f803f80
v_mov_b32 v235,0x3f803f80
v_mov_b32 v236,0x3f803f80
v_mov_b32 v237,0x3f803f80
v_mov_b32 v238,0x3f803f80
v_mov_b32 v239,0x3f803f80
v_mov_b32 v244,0
v_mov_b32 v245,0
v_mov_b32_e64 v247,0
v_mov_b32 v248,0x3f803f80
v_mov_b32 v249,0x3f803f80
v_mov_b32 v250,0x3f803f80
v_mov_b32 v251,0x3f803f80
v_mov_b32 v252,0x3f803f80
v_mov_b32 v253,0x3f803f80
v_mov_b32 v254,0x3f803f80
v_mov_b32 v255,0x3f803f80
v_lshrrev_b32 v11,5,v0
v_and_b32 v10,31,v0
v_and_b32 v13,0xff,v5
v_lshl_add_u32 v3,v11,30,v3
v_lshlrev_b32 v14,2,v10
v_min_u32 v10,18,v10
v_mul_u32_u24 v11,304,v11
v_lshl_add_u32 v15,v10,4,v11
v_mul_u32_u24 v10,3450,v0
v_lshrrev_b32 v10,16,v10
v_mul_u32_u24 v11,19,v10
v_sub_u32_e64 v11,v0,v11
v_cmp_ne_u32 s[52:53],18,v11
v_lshlrev_b32 v10,4,v10
v_lshl_add_u32 v9,v11,6,v10
v_lshlrev_b32 v10,6,v0
v_add_u32 v12,496,v10
s_lshr_b32 s60,s25,2
s_lshl_b32 s60,s60,8
s_add_u32 s47,s60,6307840
s_mov_b32 s48,6309888
s_mul_i32 s60,s25,18
s_add_u32 s61,s60,17
s_lshr_b32 s60,s60,6
s_lshr_b32 s61,s61,6
s_lshl_b32 s60,s60,8
s_lshl_b32 s61,s61,8
s_add_u32 s49,s60,6307840
s_add_u32 s50,s61,6307840
s_mov_b32 s42,0
s_mov_b32 s45,0
s_mov_b32 s46,0
s_mov_b32 s51,0
s_mov_b32 s44,s26
v_mul_u32_u24 v10,2368,v0
s_mul_i32 s60,s21,304
v_add_u32 v10,s60,v10
s_barrier
ds_write_b128 v10,v[232:235] offset:1440
v_mov_b32 v176,-1
v_mov_b32 v177,-1
v_mov_b32 v178,-1
v_mov_b32 v179,-1
s_lshl_b32 s33,s21,2
s_add_u32 s33,s33,s26
s_add_u32 s33,s33,0
s_lshl_b32 s60,s33,10
s_add_u32 s60,s60,s30
s_add_u32 s60,s60,4194304
s_lshl_b32 s61,s25,6
s_add_u32 s61,s61,s33
s_lshl_b32 s61,s61,7
s_add_u32 s61,s61,7077888
buffer_store_dwordx4 v[176:179],v2,s[8:11],s60 offen sc1
s_mov_b64 exec,0xffffffff
buffer_store_dword v176,v7,s[8:11],s61 offen sc1
s_mov_b64 exec,-1
s_lshl_b32 s33,s21,2
s_add_u32 s33,s33,s26
s_add_u32 s33,s33,16
s_lshl_b32 s60,s33,10
s_add_u32 s60,s60,s30
s_add_u32 s60,s60,4194304
s_lshl_b32 s61,s25,6
s_add_u32 s61,s61,s33
s_lshl_b32 s61,s61,7
s_add_u32 s61,s61,7077888
buffer_store_dwordx4 v[176:179],v2,s[8:11],s60 offen sc1
s_mov_b64 exec,0xffffffff
buffer_store_dword v176,v7,s[8:11],s61 offen sc1
s_mov_b64 exec,-1
s_lshl_b32 s33,s21,2
s_add_u32 s33,s33,s26
s_add_u32 s33,s33,32
s_lshl_b32 s60,s33,10
s_add_u32 s60,s60,s30
s_add_u32 s60,s60,4194304
s_lshl_b32 s61,s25,6
s_add_u32 s61,s61,s33
s_lshl_b32 s61,s61,7
s_add_u32 s61,s61,7077888
buffer_store_dwordx4 v[176:179],v2,s[8:11],s60 offen sc1
s_mov_b64 exec,0xffffffff
buffer_store_dword v176,v7,s[8:11],s61 offen sc1
s_mov_b64 exec,-1
s_lshl_b32 s33,s21,2
s_add_u32 s33,s33,s26
s_add_u32 s33,s33,48
s_lshl_b32 s60,s33,10
s_add_u32 s60,s60,s30
s_add_u32 s60,s60,4194304
s_lshl_b32 s61,s25,6
s_add_u32 s61,s61,s33
s_lshl_b32 s61,s61,7
s_add_u32 s61,s61,7077888
buffer_store_dwordx4 v[176:179],v2,s[8:11],s60 offen sc1
s_mov_b64 exec,0xffffffff
buffer_store_dword v176,v7,s[8:11],s61 offen sc1
s_mov_b64 exec,-1
bp_loop:
s_cmp_lg_u32 s21,0
s_cbranch_scc1 bp_got
v_lshlrev_b32 v10,2,v0
s_branch bp_pf
bp_poll:
s_sleep 2
bp_pf:
buffer_load_dword v20,v10,s[8:11],s47 offen sc1
buffer_load_dword v21,v10,s[8:11],s48 offen sc1
buffer_load_dword v22,v10,s[8:11],s49 offen sc1
buffer_load_dword v23,v10,s[8:11],s50 offen sc1
s_add_u32 s38,s38,1
s_cmp_gt_u32 s38,3000000
s_cbranch_scc1 w_fail
s_waitcnt vmcnt(0)
v_min_u32 v20,v20,v21
v_min3_u32 v20,v20,v22,v23
v_cmp_ne_u32 vcc,0,v20
s_nop 0
s_ff0_i32_b64 s43,vcc
s_min_u32 s43,s43,64
s_and_b32 s43,s43,-2
s_cmp_le_u32 s43,s42
s_cbranch_scc1 bp_poll
v_mov_b32 v10,160768
v_mov_b32 v11,s43
ds_write_b32 v10,v11
bp_got:
s_waitcnt lgkmcnt(0)
s_barrier
v_mov_b32 v10,160768
ds_read_b32 v11,v10
s_waitcnt lgkmcnt(0)
v_readfirstlane_b32 s43,v11
s_min_u32 s43,s43,64
bp_restage:
s_add_u32 s33,s42,s21
bp_stage:
s_cmp_ge_u32 s33,s43
s_cbranch_scc1 bp_staged
s_lshl_b32 s60,s33,10
s_add_u32 s27,s30,s60
s_add_u32 s27,s27,2097152
s_lshl_b32 s60,s33,8
s_add_u32 s28,s31,s60
s_add_u32 s28,s28,1048576
s_mul_i32 s60,s33,36864
s_mul_i32 s61,s25,1152
s_add_u32 s60,s60,s61
s_add_u32 s29,s60,12058624
s_mul_i32 s62,s33,2368
s_mov_b32 m0,s62
s_add_u32 s33,s33,4
buffer_load_dwordx4 v4,s[8:11],s27 offen sc1 lds
s_add_u32 m0,s62,1152
s_mov_b64 exec,s[52:53]
buffer_load_dwordx4 v9,s[8:11],s29 offen sc1 lds
s_add_u32 m0,s62,2176
s_mov_b64 exec,0x7ff
buffer_load_dwordx4 v12,s[8:11],s29 offen sc1 lds
s_add_u32 m0,s62,1024
s_mov_b64 exec,0xffffffff
buffer_load_dword v13,s[8:11],s28 offen sc1 lds
s_mov_b64 exec,-1
s_waitcnt vmcnt(40)
s_branch bp_stage
bp_staged:
s_cmp_ge_u32 s44,s43
s_cbranch_scc1 bp_noq
s_lshl_b32 s60,s44,10
s_add_u32 s60,s60,s30
s_lshl_b32 s61,s44,8
s_add_u32 s61,s61,s31
buffer_load_dwordx4 v[56:59],v2,s[8:11],s60 offen sc1
buffer_load_dword v60,v3,s[8:11],s61 offen sc1
v_mov_b32 v61,0
bp_noq:
s_cmp_lt_u32 s43,61
s_cbranch_scc1 bp_nochk
s_waitcnt vmcnt(0)
s_add_u32 s38,s38,64
s_cmp_gt_u32 s38,3000000
s_cbranch_scc1 w_fail
s_cmp_ge_u32 s44,s43
s_cbranch_scc1 bp_chk2
v_max3_u32 v10,v56,v57,v58
v_max3_u32 v10,v10,v59,v60
v_cmp_eq_u32 vcc,-1,v10
s_cbranch_vccnz bp_restage
bp_chk2:
s_sub_u32 s61,s33,4
s_cmp_lt_i32 s61,s42
s_cbranch_scc1 bp_nochk
s_mul_i32 s60,s61,2368
v_add_u32 v16,s60,v1
v_add_u32 v17,s60,v14
v_add_u32_e64 v18,s60,v15
ds_read_b128 v[192:195],v16
ds_read_b128 v[196:199],v18 offset:1152
ds_read_b128 v[200:203],v18 offset:1760
ds_read_b32 v204,v17 offset:1024
s_waitcnt lgkmcnt(0)
v_max3_u32 v204,v204,v192,v193
v_max3_u32 v204,v204,v194,v195
v_max3_u32 v204,v204,v196,v197
v_max3_u32 v204,v204,v198,v199
v_max3_u32 v204,v204,v200,v201
v_max3_u32 v204,v204,v202,v203
v_cmp_eq_u32 vcc,-1,v204
s_cbranch_vccnz bp_restage
bp_nochk:
s_mul_i32 s60,s42,2368
v_add_u32 v16,s60,v1
v_add_u32 v17,s60,v14
v_add_u32 v18,s60,v15
s_sub_u32 s32,s43,s42
s_sub_u32 s32,s32,1
s_mov_b32 s42,s43
s_waitcnt vmcnt(0)
s_barrier
s_cmp_eq_u32 s45,1
s_cbranch_scc1 bp_t1_1
s_cmp_eq_u32 s45,2
s_cbranch_scc1 bp_t1_2
s_cmp_eq_u32 s45,3
s_cbranch_scc1 bp_t1_3
s_cmp_eq_u32 s45,4
s_cbranch_scc1 bp_t1_4
bp_t1d:
s_cmp_lt_u32 s42,64
s_cbranch_scc0 bp_fin
s_lshl_b32 s60,s23,6
s_add_u32 s60,s60,60
s_cmp_ge_u32 s44,s60
s_cbranch_scc1 bp_loop
bp_t2:
s_cmp_ge_u32 s44,s42
s_cbranch_scc1 bp_next
v_mov_b32 v176,0
v_mov_b32 v177,0
v_mov_b32 v178,0
v_mov_b32 v179,0
v_mov_b32 v180,0
v_mov_b32 v181,0
v_mov_b32 v182,0
v_mov_b32 v183,0
v_mov_b32 v184,0
v_mov_b32 v185,0
v_mov_b32 v186,0
v_mov_b32 v187,0
s_mul_i32 s60,s21,2368
v_add_u32 v16,s60,v1
v_add_u32 v17,s60,v14
v_add_u32 v18,s60,v15
s_sub_u32 s61,s21,s46
s_sub_u32 s61,s61,1
s_and_b32 s63,s61,3
s_mul_i32 s61,s63,3072
s_add_u32 s61,s61,151552
v_add_u32 v19,s61,v1
s_sub_u32 s32,s42,s21
s_sub_u32 s32,s32,1
s_ashr_i32 s32,s32,2
s_cmp_ge_i32 s32,0
s_cbranch_scc1 bp_cu
bp_merge:
s_cmp_eq_u32 s63,3
s_barrier
s_cbranch_scc1 bp_own
s_nop 7
ds_write_b128 v19,v[176:179]
ds_write_b128 v19,v[180:183] offset:1024
ds_write_b128 v19,v[184:187] offset:2048
s_waitcnt lgkmcnt(0)
s_barrier
s_branch bp_merged
bp_own:
s_add_u32 s62,s45,1
s_cmp_eq_u32 s42,64
s_cselect_b32 s62,s62,s45
s_cmp_eq_u32 s45,s62
s_cbranch_scc1 st_27
s_lshl_b32 s63,s21,2
s_add_u32 s63,s63,s22
s_lshl_b32 s63,s63,5
s_add_u32 s63,s63,s25
s_lshl_b32 s63,s63,7
s_add_u32 s63,s63,21495808
v_lshlrev_b32 v10,16,v0
v_mov_b32 v11,1
s_bfm_b64 exec,s62,0
buffer_store_dword v11,v10,s[8:11],s63 offen sc1
s_mov_b64 exec,-1
st_27:
v_add_u32 v10,151552,v1
s_barrier
ds_read_b128 v[192:195],v10
ds_read_b128 v[196:199],v10 offset:1024
ds_read_b128 v[200:203],v10 offset:2048
ds_read_b128 v[204:207],v10 offset:3072
ds_read_b128 v[208:211],v10 offset:4096
ds_read_b128 v[212:215],v10 offset:5120
ds_read_b128 v[64:67],v10 offset:6144
ds_read_b128 v[68:71],v10 offset:7168
ds_read_b128 v[72:75],v10 offset:8192
s_waitcnt lgkmcnt(6)
v_add_f32 v176,v176,v192
v_add_f32 v177,v177,v193
v_add_f32 v178,v178,v194
v_add_f32 v179,v179,v195
v_add_f32 v180,v180,v196
v_add_f32 v181,v181,v197
v_add_f32 v182,v182,v198
v_add_f32 v183,v183,v199
v_add_f32 v184,v184,v200
v_add_f32 v185,v185,v201
v_add_f32 v186,v186,v202
s_waitcnt lgkmcnt(0)
v_add_f32 v204,v204,v64
v_add_f32 v205,v205,v65
v_add_f32 v206,v206,v66
v_add_f32 v207,v207,v67
v_add_f32 v208,v208,v68
v_add_f32 v209,v209,v69
v_add_f32 v210,v210,v70
v_add_f32 v211,v211,v71
v_add_f32 v212,v212,v72
v_add_f32 v213,v213,v73
v_add_f32 v214,v214,v74
s_cmp_eq_u32 s45,1
s_cbranch_scc1 bp_keep1
s_cmp_eq_u32 s45,2
s_cbranch_scc1 bp_keep2
s_cmp_eq_u32 s45,3
s_cbranch_scc1 bp_keep3
bp_keep0:
v_add_f32 v112,v176,v204
v_add_f32 v113,v177,v205
v_add_f32 v114,v178,v206
v_add_f32 v115,v179,v207
v_add_f32 v116,v180,v208
v_add_f32 v117,v181,v209
v_add_f32 v118,v182,v210
v_add_f32 v119,v183,v211
v_add_f32 v120,v184,v212
v_add_f32 v121,v185,v213
v_add_f32 v122,v186,v214
v_mov_b32 v32,v56
v_mov_b32 v33,v57
v_mov_b32 v34,v58
v_mov_b32 v35,v59
v_mov_b32 v36,v60
v_mov_b32 v37,v61
s_branch bp_kept
bp_keep1:
v_add_f32 v128,v176,v204
v_add_f32 v129,v177,v205
v_add_f32 v130,v178,v206
v_add_f32 v131,v179,v207
v_add_f32 v132,v180,v208
v_add_f32 v133,v181,v209
v_add_f32 v134,v182,v210
v_add_f32 v135,v183,v211
v_add_f32 v136,v184,v212
v_add_f32 v137,v185,v213
v_add_f32 v138,v186,v214
v_mov_b32 v38,v56
v_mov_b32 v39,v57
v_mov_b32 v40,v58
v_mov_b32 v41,v59
v_mov_b32 v42,v60
v_mov_b32 v43,v61
s_branch bp_kept
bp_keep2:
v_add_f32 v144,v176,v204
v_add_f32 v145,v177,v205
v_add_f32 v146,v178,v206
v_add_f32 v147,v179,v207
v_add_f32 v148,v180,v208
v_add_f32 v149,v181,v209
v_add_f32 v150,v182,v210
v_add_f32 v151,v183,v211
v_add_f32 v152,v184,v212
v_add_f32 v153,v185,v213
v_add_f32 v154,v186,v214
v_mov_b32 v44,v56
v_mov_b32 v45,v57
v_mov_b32 v46,v58
v_mov_b32 v47,v59
v_mov_b32 v48,v60
v_mov_b32 v49,v61
s_branch bp_kept
bp_keep3:
v_add_f32 v160,v176,v204
v_add_f32 v161,v177,v205
v_add_f32 v162,v178,v206
v_add_f32 v163,v179,v207
v_add_f32 v164,v180,v208
v_add_f32 v165,v181,v209
v_add_f32 v166,v182,v210
v_add_f32 v167,v183,v211
v_add_f32 v168,v184,v212
v_add_f32 v169,v185,v213
v_add_f32 v170,v186,v214
v_mov_b32 v50,v56
v_mov_b32 v51,v57
v_mov_b32 v52,v58
v_mov_b32 v53,v59
v_mov_b32 v54,v60
v_mov_b32 v55,v61
bp_kept:
s_add_u32 s45,s45,1
bp_merged:
s_add_u32 s46,s46,1
s_add_u32 s44,s44,4
s_cmp_ge_u32 s44,s42
s_cbranch_scc1 bp_next
bp_req:
s_lshl_b32 s60,s44,10
s_add_u32 s60,s60,s30
s_lshl_b32 s61,s44,8
s_add_u32 s61,s61,s31
buffer_load_dwordx4 v[56:59],v2,s[8:11],s60 offen sc1
buffer_load_dword v60,v3,s[8:11],s61 offen sc1
v_mov_b32 v61,0
s_add_u32 s38,s38,64
s_cmp_gt_u32 s38,3000000
s_cbranch_scc1 w_fail
s_waitcnt vmcnt(0)
v_max3_u32 v10,v56,v57,v58
v_max3_u32 v10,v10,v59,v60
v_cmp_eq_u32 vcc,-1,v10
s_cbranch_vccnz bp_req
s_branch bp_t2
bp_next:
s_cmp_lt_u32 s42,64
s_cbranch_scc1 bp_loop
s_branch bp_fin
bp_t1_1:
ds_read_b128 v[224:227],v16
ds_read_b32 v230,v17 offset:1024
ds_read_b128 v[240:243],v16 offset:2368
ds_read_b32 v246,v17 offset:3392
ds_read_b128 v[232:235],v18 offset:1152
ds_read_b128 v[236:239],v18 offset:1760
v_mov_b32 v28,0
v_mov_b32 v252,0
v_mov_b32 v29,0
v_mov_b32 v253,0
v_mov_b32 v30,0
v_mov_b32 v254,0
v_mov_b32 v31,0
v_mov_b32 v255,0
s_waitcnt lgkmcnt(4)
v_mfma_f32_32x32x16_bf16 v[192:207],v[224:227],v[32:35],0
v_mfma_f32_32x32x16_bf16 v[192:207],v[228:231],v[34:37],v[192:207]
s_waitcnt lgkmcnt(0)
s_nop 10
bp_t1_1_l:
v_mfma_f32_32x32x16_bf16 v[208:223],v[240:243],v[32:35],0
s_waitcnt lgkmcnt(0)
v_exp_f32 v192,v192
v_exp_f32 v193,v193
v_exp_f32 v194,v194
v_exp_f32_e64 v195,v195
v_cvt_pk_bf16_f32 v24,v192,v193
v_cvt_pk_bf16_f32 v25,v194,v195
v_mfma_f32_32x32x16_bf16 v[208:223],v[244:247],v[34:37],v[208:223]
s_sub_u32 s32,s32,1
v_exp_f32 v196,v196
v_exp_f32 v197,v197
v_exp_f32 v198,v198
v_exp_f32_e64 v199,v199
v_cvt_pk_bf16_f32 v26,v196,v197
v_cvt_pk_bf16_f32 v27,v198,v199
v_mfma_f32_32x32x16_bf16 v[112:127],v[252:255],v[28:31],v[112:127]
ds_read_b128 v[224:227],v16 offset:4736
ds_read_b32 v230,v17 offset:5760
ds_read_b128 v[248:251],v18 offset:3520
ds_read_b128 v[252:255],v18 offset:4128
v_exp_f32 v200,v200
v_exp_f32 v201,v201
v_exp_f32 v202,v202
v_exp_f32 v203,v203
v_cvt_pk_bf16_f32 v28,v200,v201
v_cvt_pk_bf16_f32 v29,v202,v203
v_mfma_f32_32x32x16_bf16 v[112:127],v[232:235],v[24:27],v[112:127]
s_cbranch_scc1 bp_t1_1_x0
v_exp_f32 v204,v204
v_exp_f32 v205,v205
v_exp_f32 v206,v206
v_exp_f32_e64 v207,v207
v_cvt_pk_bf16_f32 v30,v204,v205
v_cvt_pk_bf16_f32 v31,v206,v207
s_waitcnt lgkmcnt(2)
v_mfma_f32_32x32x16_bf16 v[192:207],v[224:227],v[32:35],0
s_waitcnt lgkmcnt(0)
v_exp_f32 v208,v208
v_exp_f32 v209,v209
v_exp_f32 v210,v210
v_exp_f32 v211,v211
v_cvt_pk_bf16_f32 v24,v208,v209
v_cvt_pk_bf16_f32 v25,v210,v211
v_mfma_f32_32x32x16_bf16 v[192:207],v[228:231],v[34:37],v[192:207]
s_sub_u32 s32,s32,1
v_exp_f32 v212,v212
v_exp_f32 v213,v213
v_exp_f32 v214,v214
v_exp_f32_e64 v215,v215
v_cvt_pk_bf16_f32 v26,v212,v213
v_cvt_pk_bf16_f32 v27,v214,v215
v_mfma_f32_32x32x16_bf16 v[112:127],v[236:239],v[28:31],v[112:127]
ds_read_b128 v[240:243],v16 offset:7104
ds_read_b32 v246,v17 offset:8128
ds_read_b128 v[232:235],v18 offset:5888
ds_read_b128 v[236:239],v18 offset:6496
v_exp_f32 v216,v216
v_exp_f32 v217,v217
v_exp_f32 v218,v218
v_exp_f32 v219,v219
v_cvt_pk_bf16_f32 v28,v216,v217
v_cvt_pk_bf16_f32 v29,v218,v219
v_mfma_f32_32x32x16_bf16 v[112:127],v[248:251],v[24:27],v[112:127]
s_cbranch_scc1 bp_t1_1_x1
v_exp_f32 v220,v220
v_exp_f32 v221,v221
v_exp_f32 v222,v222
v_exp_f32_e64 v223,v223
v_cvt_pk_bf16_f32 v30,v220,v221
v_cvt_pk_bf16_f32 v31,v222,v223
s_waitcnt lgkmcnt(2)
v_mfma_f32_32x32x16_bf16 v[208:223],v[240:243],v[32:35],0
s_waitcnt lgkmcnt(0)
v_exp_f32 v192,v192
v_exp_f32 v193,v193
v_exp_f32 v194,v194
v_exp_f32 v195,v195
v_cvt_pk_bf16_f32 v24,v192,v193
v_cvt_pk_bf16_f32 v25,v194,v195
v_mfma_f32_32x32x16_bf16 v[208:223],v[244:247],v[34:37],v[208:223]
s_sub_u32 s32,s32,1
v_exp_f32 v196,v196
v_exp_f32 v197,v197
v_exp_f32 v198,v198
v_exp_f32_e64 v199,v199
v_cvt_pk_bf16_f32 v26,v196,v197
v_cvt_pk_bf16_f32 v27,v198,v199
v_mfma_f32_32x32x16_bf16 v[112:127],v[252:255],v[28:31],v[112:127]
ds_read_b128 v[224:227],v16 offset:9472
ds_read_b32 v230,v17 offset:10496
ds_read_b128 v[248:251],v18 offset:8256
ds_read_b128 v[252:255],v18 offset:8864
v_exp_f32 v200,v200
v_exp_f32 v201,v201
v_exp_f32 v202,v202
v_exp_f32 v203,v203
v_cvt_pk_bf16_f32 v28,v200,v201
v_cvt_pk_bf16_f32 v29,v202,v203
v_mfma_f32_32x32x16_bf16 v[112:127],v[232:235],v[24:27],v[112:127]
s_cbranch_scc1 bp_t1_1_x0
v_exp_f32 v204,v204
v_exp_f32 v205,v205
v_exp_f32 v206,v206
v_exp_f32 v207,v207
v_cvt_pk_bf16_f32 v30,v204,v205
v_cvt_pk_bf16_f32 v31,v206,v207
s_waitcnt lgkmcnt(2)
v_mfma_f32_32x32x16_bf16 v[192:207],v[224:227],v[32:35],0
s_waitcnt lgkmcnt(0)
v_exp_f32 v208,v208
v_exp_f32 v209,v209
v_exp_f32 v210,v210
v_exp_f32_e64 v211,v211
v_cvt_pk_bf16_f32 v24,v208,v209
v_cvt_pk_bf16_f32 v25,v210,v211
v_mfma_f32_32x32x16_bf16 v[192:207],v[228:231],v[34:37],v[192:207]
s_sub_u32 s32,s32,1
v_exp_f32 v212,v212
v_exp_f32 v213,v213
v_exp_f32 v214,v214
v_exp_f32_e64 v215,v215
v_cvt_pk_bf16_f32 v26,v212,v213
v_cvt_pk_bf16_f32 v27,v214,v215
v_mfma_f32_32x32x16_bf16 v[112:127],v[236:239],v[28:31],v[112:127]
ds_read_b128 v[240:243],v16 offset:11840
ds_read_b32 v246,v17 offset:12864
ds_read_b128 v[232:235],v18 offset:10624
ds_read_b128 v[236:239],v18 offset:11232
v_exp_f32 v216,v216
v_exp_f32 v217,v217
v_exp_f32 v218,v218
v_exp_f32 v219,v219
v_cvt_pk_bf16_f32 v28,v216,v217
v_cvt_pk_bf16_f32 v29,v218,v219
v_mfma_f32_32x32x16_bf16 v[112:127],v[248:251],v[24:27],v[112:127]
s_cbranch_scc1 bp_t1_1_x1
v_exp_f32 v220,v220
v_exp_f32 v221,v221
v_exp_f32 v222,v222
v_exp_f32_e64 v223,v223
v_cvt_pk_bf16_f32 v30,v220,v221
v_cvt_pk_bf16_f32 v31,v222,v223
v_add_u32 v16,9472,v16
v_add_u32 v17,9472,v17
v_add_u32 v18,9472,v18
s_waitcnt lgkmcnt(2)
s_branch bp_t1_1_l
bp_t1_1_x0:
v_exp_f32 v204,v204
v_exp_f32 v205,v205
v_exp_f32 v206,v206
v_exp_f32 v207,v207
v_cvt_pk_bf16_f32 v30,v204,v205
v_cvt_pk_bf16_f32 v31,v206,v207
s_waitcnt lgkmcnt(0)
s_nop 0
v_mfma_f32_32x32x16_bf16 v[112:127],v[236:239],v[28:31],v[112:127]
s_branch bp_t1d
bp_t1_1_x1:
v_exp_f32 v220,v220
v_exp_f32 v221,v221
v_exp_f32 v222,v222
v_exp_f32_e64 v223,v223
v_cvt_pk_bf16_f32 v30,v220,v221
v_cvt_pk_bf16_f32 v31,v222,v223
s_waitcnt lgkmcnt(0)
s_nop 0
v_mfma_f32_32x32x16_bf16 v[112:127],v[252:255],v[28:31],v[112:127]
s_branch bp_t1d
bp_t1_2:
ds_read_b128 v[224:227],v16
ds_read_b32 v230,v17 offset:1024
ds_read_b128 v[240:243],v16 offset:2368
ds_read_b32 v246,v17 offset:3392
ds_read_b128 v[232:235],v18 offset:1152
ds_read_b128 v[236:239],v18 offset:1760
v_mov_b32 v28,0
v_mov_b32 v252,0
v_mov_b32 v29,0
v_mov_b32 v253,0
v_mov_b32 v30,0
v_mov_b32 v254,0
v_mov_b32 v31,0
v_mov_b32 v255,0
s_waitcnt lgkmcnt(4)
v_mfma_f32_32x32x16_bf16 v[192:207],v[224:227],v[32:35],0
v_mfma_f32_32x32x16_bf16 v[192:207],v[228:231],v[34:37],v[192:207]
s_waitcnt lgkmcnt(0)
s_nop 10
bp_t1_2_l:
v_mfma_f32_32x32x16_bf16 v[208:223],v[224:227],v[38:41],0
s_waitcnt lgkmcnt(0)
v_exp_f32 v192,v192
v_exp_f32 v193,v193
v_exp_f32 v194,v194
v_exp_f32_e64 v195,v195
v_cvt_pk_bf16_f32 v24,v192,v193
v_cvt_pk_bf16_f32 v25,v194,v195
v_mfma_f32_32x32x16_bf16 v[208:223],v[228:231],v[40:43],v[208:223]
v_exp_f32 v196,v196
v_exp_f32 v197,v197
v_exp_f32 v198,v198
v_exp_f32 v199,v199
v_cvt_pk_bf16_f32 v26,v196,v197
v_cvt_pk_bf16_f32 v27,v198,v199
v_mfma_f32_32x32x16_bf16 v[128:143],v[252:255],v[28:31],v[128:143]
v_exp_f32 v200,v200
v_exp_f32 v201,v201
v_exp_f32 v202,v202
v_exp_f32 v203,v203
v_cvt_pk_bf16_f32 v28,v200,v201
v_cvt_pk_bf16_f32 v29,v202,v203
v_mfma_f32_32x32x16_bf16 v[112:127],v[232:235],v[24:27],v[112:127]
v_exp_f32 v204,v204
v_exp_f32 v205,v205
v_exp_f32 v206,v206
v_exp_f32 v207,v207
v_cvt_pk_bf16_f32 v30,v204,v205
v_cvt_pk_bf16_f32 v31,v206,v207
v_mfma_f32_32x32x16_bf16 v[192:207],v[240:243],v[32:35],0
v_exp_f32 v208,v208
v_exp_f32 v209,v209
v_exp_f32 v210,v210
v_exp_f32 v211,v211
v_cvt_pk_bf16_f32 v24,v208,v209
v_cvt_pk_bf16_f32 v25,v210,v211
v_mfma_f32_32x32x16_bf16 v[192:207],v[244:247],v[34:37],v[192:207]
s_sub_u32 s32,s32,1
v_exp_f32 v212,v212
v_exp_f32 v213,v213
v_exp_f32 v214,v214
v_exp_f32_e64 v215,v215
v_cvt_pk_bf16_f32 v26,v212,v213
v_cvt_pk_bf16_f32 v27,v214,v215
v_mfma_f32_32x32x16_bf16 v[112:127],v[236:239],v[28:31],v[112:127]
ds_read_b128 v[224:227],v16 offset:4736
ds_read_b32 v230,v17 offset:5760
ds_read_b128 v[248:251],v18 offset:3520
ds_read_b128 v[252:255],v18 offset:4128
v_exp_f32 v216,v216
v_exp_f32 v217,v217
v_exp_f32 v218,v218
v_exp_f32 v219,v219
v_cvt_pk_bf16_f32 v28,v216,v217
v_cvt_pk_bf16_f32 v29,v218,v219
v_mfma_f32_32x32x16_bf16 v[128:143],v[232:235],v[24:27],v[128:143]
s_cbranch_scc1 bp_t1_2_x0
v_exp_f32 v220,v220
v_exp_f32 v221,v221
v_exp_f32 v222,v222
v_exp_f32_e64 v223,v223
v_cvt_pk_bf16_f32 v30,v220,v221
v_cvt_pk_bf16_f32 v31,v222,v223
v_mfma_f32_32x32x16_bf16 v[208:223],v[240:243],v[38:41],0
s_waitcnt lgkmcnt(0)
v_exp_f32 v192,v192
v_exp_f32 v193,v193
v_exp_f32 v194,v194
v_exp_f32 v195,v195
v_cvt_pk_bf16_f32 v24,v192,v193
v_cvt_pk_bf16_f32 v25,v194,v195
v_mfma_f32_32x32x16_bf16 v[208:223],v[244:247],v[40:43],v[208:223]
v_exp_f32 v196,v196
v_exp_f32 v197,v197
v_exp_f32 v198,v198
v_exp_f32_e64 v199,v199
v_cvt_pk_bf16_f32 v26,v196,v197
v_cvt_pk_bf16_f32 v27,v198,v199
v_mfma_f32_32x32x16_bf16 v[128:143],v[236:239],v[28:31],v[128:143]
v_exp_f32 v200,v200
v_exp_f32 v201,v201
v_exp_f32 v202,v202
v_exp_f32 v203,v203
v_cvt_pk_bf16_f32 v28,v200,v201
v_cvt_pk_bf16_f32 v29,v202,v203
v_mfma_f32_32x32x16_bf16 v[112:127],v[248:251],v[24:27],v[112:127]
v_exp_f32 v204,v204
v_exp_f32 v205,v205
v_exp_f32 v206,v206
v_exp_f32 v207,v207
v_cvt_pk_bf16_f32 v30,v204,v205
v_cvt_pk_bf16_f32 v31,v206,v207
v_mfma_f32_32x32x16_bf16 v[192:207],v[224:227],v[32:35],0
v_exp_f32 v208,v208
v_exp_f32 v209,v209
v_exp_f32 v210,v210
v_exp_f32 v211,v211
v_cvt_pk_bf16_f32 v24,v208,v209
v_cvt_pk_bf16_f32 v25,v210,v211
v_mfma_f32_32x32x16_bf16 v[192:207],v[228:231],v[34:37],v[192:207]
s_sub_u32 s32,s32,1
v_exp_f32 v212,v212
v_exp_f32 v213,v213
v_exp_f32 v214,v214
v_exp_f32_e64 v215,v215
v_cvt_pk_bf16_f32 v26,v212,v213
v_cvt_pk_bf16_f32 v27,v214,v215
v_mfma_f32_32x32x16_bf16 v[112:127],v[252:255],v[28:31],v[112:127]
ds_read_b128 v[240:243],v16 offset:7104
ds_read_b32 v246,v17 offset:8128
ds_read_b128 v[232:235],v18 offset:5888
ds_read_b128 v[236:239],v18 offset:6496
v_exp_f32 v216,v216
v_exp_f32 v217,v217
v_exp_f32 v218,v218
v_exp_f32 v219,v219
v_cvt_pk_bf16_f32 v28,v216,v217
v_cvt_pk_bf16_f32 v29,v218,v219
v_mfma_f32_32x32x16_bf16 v[128:143],v[248:251],v[24:27],v[128:143]
s_cbranch_scc1 bp_t1_2_x1
v_exp_f32 v220,v220
v_exp_f32 v221,v221
v_exp_f32 v222,v222
v_exp_f32_e64 v223,v223
v_cvt_pk_bf16_f32 v30,v220,v221
v_cvt_pk_bf16_f32 v31,v222,v223
v_add_u32 v16,4736,v16
v_add_u32 v17,4736,v17
v_add_u32 v18,4736,v18
s_branch bp_t1_2_l
bp_t1_2_x0:
v_exp_f32 v220,v220
v_exp_f32 v221,v221
v_exp_f32 v222,v222
v_exp_f32 v223,v223
v_cvt_pk_bf16_f32 v30,v220,v221
v_cvt_pk_bf16_f32 v31,v222,v223
s_waitcnt lgkmcnt(0)
s_nop 0
v_mfma_f32_32x32x16_bf16 v[128:143],v[236:239],v[28:31],v[128:143]
s_branch bp_t1d
bp_t1_2_x1:
v_exp_f32 v220,v220
v_exp_f32 v221,v221
v_exp_f32 v222,v222
v_exp_f32 v223,v223
v_cvt_pk_bf16_f32 v30,v220,v221
v_cvt_pk_bf16_f32 v31,v222,v223
s_waitcnt lgkmcnt(0)
s_nop 0
v_mfma_f32_32x32x16_bf16 v[128:143],v[252:255],v[28:31],v[128:143]
s_branch bp_t1d
bp_t1_3:
ds_read_b128 v[224:227],v16
ds_read_b32 v230,v17 offset:1024
ds_read_b128 v[240:243],v16 offset:2368
ds_read_b32 v246,v17 offset:3392
ds_read_b128 v[232:235],v18 offset:1152
ds_read_b128 v[236:239],v18 offset:1760
v_mov_b32 v28,0
v_mov_b32 v252,0
v_mov_b32 v29,0
v_mov_b32 v253,0
v_mov_b32 v30,0
v_mov_b32 v254,0
v_mov_b32 v31,0
v_mov_b32 v255,0
s_waitcnt lgkmcnt(4)
v_mfma_f32_32x32x16_bf16 v[192:207],v[224:227],v[32:35],0
v_mfma_f32_32x32x16_bf16 v[192:207],v[228:231],v[34:37],v[192:207]
s_waitcnt lgkmcnt(0)
s_nop 10
bp_t1_3_l:
v_mfma_f32_32x32x16_bf16 v[208:223],v[224:227],v[38:41],0
s_waitcnt lgkmcnt(0)
v_exp_f32 v192,v192
v_exp_f32 v193,v193
v_exp_f32 v194,v194
v_exp_f32_e64 v195,v195
v_cvt_pk_bf16_f32 v24,v192,v193
v_cvt_pk_bf16_f32 v25,v194,v195
v_mfma_f32_32x32x16_bf16 v[208:223],v[228:231],v[40:43],v[208:223]
v_exp_f32 v196,v196
v_exp_f32 v197,v197
v_exp_f32 v198,v198
v_exp_f32 v199,v199
v_cvt_pk_bf16_f32 v26,v196,v197
v_cvt_pk_bf16_f32 v27,v198,v199
v_mfma_f32_32x32x16_bf16 v[144:159],v[252:255],v[28:31],v[144:159]
v_exp_f32 v200,v200
v_exp_f32 v201,v201
v_exp_f32 v202,v202
v_exp_f32 v203,v203
v_cvt_pk_bf16_f32 v28,v200,v201
v_cvt_pk_bf16_f32 v29,v202,v203
v_mfma_f32_32x32x16_bf16 v[112:127],v[232:235],v[24:27],v[112:127]
v_exp_f32 v204,v204
v_exp_f32 v205,v205
v_exp_f32 v206,v206
v_exp_f32 v207,v207
v_cvt_pk_bf16_f32 v30,v204,v205
v_cvt_pk_bf16_f32 v31,v206,v207
v_mfma_f32_32x32x16_bf16 v[192:207],v[224:227],v[44:47],0
v_exp_f32 v208,v208
v_exp_f32 v209,v209
v_exp_f32 v210,v210
v_exp_f32 v211,v211
v_cvt_pk_bf16_f32 v24,v208,v209
v_cvt_pk_bf16_f32 v25,v210,v211
v_mfma_f32_32x32x16_bf16 v[192:207],v[228:231],v[46:49],v[192:207]
v_exp_f32 v212,v212
v_exp_f32 v213,v213
v_exp_f32 v214,v214
v_exp_f32 v215,v215
v_cvt_pk_bf16_f32 v26,v212,v213
v_cvt_pk_bf16_f32 v27,v214,v215
v_mfma_f32_32x32x16_bf16 v[112:127],v[236:239],v[28:31],v[112:127]
v_exp_f32 v216,v216
v_exp_f32 v217,v217
v_exp_f32 v218,v218
v_exp_f32 v219,v219
v_cvt_pk_bf16_f32 v28,v216,v217
v_cvt_pk_bf16_f32 v29,v218,v219
v_mfma_f32_32x32x16_bf16 v[128:143],v[232:235],v[24:27],v[128:143]
v_exp_f32 v220,v220
v_exp_f32 v221,v221
v_exp_f32 v222,v222
v_exp_f32 v223,v223
v_cvt_pk_bf16_f32 v30,v220,v221
v_cvt_pk_bf16_f32 v31,v222,v223
v_mfma_f32_32x32x16_bf16 v[208:223],v[240:243],v[32:35],0
v_exp_f32 v192,v192
v_exp_f32 v193,v193
v_exp_f32 v194,v194
v_exp_f32 v195,v195
v_cvt_pk_bf16_f32 v24,v192,v193
v_cvt_pk_bf16_f32 v25,v194,v195
v_mfma_f32_32x32x16_bf16 v[208:223],v[244:247],v[34:37],v[208:223]
s_sub_u32 s32,s32,1
v_exp_f32 v196,v196
v_exp_f32 v197,v197
v_exp_f32 v198,v198
v_exp_f32_e64 v199,v199
v_cvt_pk_bf16_f32 v26,v196,v197
v_cvt_pk_bf16_f32 v27,v198,v199
v_mfma_f32_32x32x16_bf16 v[128:143],v[236:239],v[28:31],v[128:143]
ds_read_b128 v[224:227],v16 offset:4736
ds_read_b32 v230,v17 offset:5760
ds_read_b128 v[248:251],v18 offset:3520
ds_read_b128 v[252:255],v18 offset:4128
v_exp_f32 v200,v200
v_exp_f32 v201,v201
v_exp_f32 v202,v202
v_exp_f32 v203,v203
v_cvt_pk_bf16_f32 v28,v200,v201
v_cvt_pk_bf16_f32 v29,v202,v203
v_mfma_f32_32x32x16_bf16 v[144:159],v[232:235],v[24:27],v[144:159]
s_cbranch_scc1 bp_t1_3_x0
v_exp_f32 v204,v204
v_exp_f32 v205,v205
v_exp_f32 v206,v206
v_exp_f32_e64 v207,v207
v_cvt_pk_bf16_f32 v30,v204,v205
v_cvt_pk_bf16_f32 v31,v206,v207
v_mfma_f32_32x32x16_bf16 v[192:207],v[240:243],v[38:41],0
s_waitcnt lgkmcnt(0)
v_exp_f32 v208,v208
v_exp_f32 v209,v209
v_exp_f32 v210,v210
v_exp_f32 v211,v211
v_cvt_pk_bf16_f32 v24,v208,v209
v_cvt_pk_bf16_f32 v25,v210,v211
v_mfma_f32_32x32x16_bf16 v[192:207],v[244:247],v[40:43],v[192:207]
v_exp_f32 v212,v212
v_exp_f32 v213,v213
v_exp_f32 v214,v214
v_exp_f32_e64 v215,v215
v_cvt_pk_bf16_f32 v26,v212,v213
v_cvt_pk_bf16_f32 v27,v214,v215
v_mfma_f32_32x32x16_bf16 v[144:159],v[236:239],v[28:31],v[144:159]
v_exp_f32 v216,v216
v_exp_f32 v217,v217
v_exp_f32 v218,v218
v_exp_f32 v219,v219
v_cvt_pk_bf16_f32 v28,v216,v217
v_cvt_pk_bf16_f32 v29,v218,v219
v_mfma_f32_32x32x16_bf16 v[112:127],v[248:251],v[24:27],v[112:127]
v_exp_f32 v220,v220
v_exp_f32 v221,v221
v_exp_f32 v222,v222
v_exp_f32 v223,v223
v_cvt_pk_bf16_f32 v30,v220,v221
v_cvt_pk_bf16_f32 v31,v222,v223
v_mfma_f32_32x32x16_bf16 v[208:223],v[240:243],v[44:47],0
v_exp_f32 v192,v192
v_exp_f32 v193,v193
v_exp_f32 v194,v194
v_exp_f32 v195,v195
v_cvt_pk_bf16_f32 v24,v192,v193
v_cvt_pk_bf16_f32 v25,v194,v195
v_mfma_f32_32x32x16_bf16 v[208:223],v[244:247],v[46:49],v[208:223]
v_exp_f32 v196,v196
v_exp_f32 v197,v197
v_exp_f32 v198,v198
v_exp_f32 v199,v199
v_cvt_pk_bf16_f32 v26,v196,v197
v_cvt_pk_bf16_f32 v27,v198,v199
v_mfma_f32_32x32x16_bf16 v[112:127],v[252:255],v[28:31],v[112:127]
v_exp_f32 v200,v200
v_exp_f32 v201,v201
v_exp_f32 v202,v202
v_exp_f32 v203,v203
v_cvt_pk_bf16_f32 v28,v200,v201
v_cvt_pk_bf16_f32 v29,v202,v203
v_mfma_f32_32x32x16_bf16 v[128:143],v[248:251],v[24:27],v[128:143]
v_exp_f32 v204,v204
v_exp_f32 v205,v205
v_exp_f32 v206,v206
v_exp_f32 v207,v207
v_cvt_pk_bf16_f32 v30,v204,v205
v_cvt_pk_bf16_f32 v31,v206,v207
v_mfma_f32_32x32x16_bf16 v[192:207],v[224:227],v[32:35],0
v_exp_f32 v208,v208
v_exp_f32 v209,v209
v_exp_f32 v210,v210
v_exp_f32 v211,v211
v_cvt_pk_bf16_f32 v24,v208,v209
v_cvt_pk_bf16_f32 v25,v210,v211
v_mfma_f32_32x32x16_bf16 v[192:207],v[228:231],v[34:37],v[192:207]
s_sub_u32 s32,s32,1
v_exp_f32 v212,v212
v_exp_f32 v213,v213
v_exp_f32 v214,v214
v_exp_f32_e64 v215,v215
v_cvt_pk_bf16_f32 v26,v212,v213
v_cvt_pk_bf16_f32 v27,v214,v215
v_mfma_f32_32x32x16_bf16 v[128:143],v[252:255],v[28:31],v[128:143]
ds_read_b128 v[240:243],v16 offset:7104
ds_read_b32 v246,v17 offset:8128
ds_read_b128 v[232:235],v18 offset:5888
ds_read_b128 v[236:239],v18 offset:6496
v_exp_f32 v216,v216
v_exp_f32 v217,v217
v_exp_f32 v218,v218
v_exp_f32 v219,v219
v_cvt_pk_bf16_f32 v28,v216,v217
v_cvt_pk_bf16_f32 v29,v218,v219
v_mfma_f32_32x32x16_bf16 v[144:159],v[248:251],v[24:27],v[144:159]
s_cbranch_scc1 bp_t1_3_x1
v_exp_f32 v220,v220
v_exp_f32 v221,v221
v_exp_f32 v222,v222
v_exp_f32_e64 v223,v223
v_cvt_pk_bf16_f32 v30,v220,v221
v_cvt_pk_bf16_f32 v31,v222,v223
v_add_u32 v16,4736,v16
v_add_u32 v17,4736,v17
v_add_u32 v18,4736,v18
s_branch bp_t1_3_l
bp_t1_3_x0:
v_exp_f32 v204,v204
v_exp_f32 v205,v205
v_exp_f32 v206,v206
v_exp_f32 v207,v207
v_cvt_pk_bf16_f32 v30,v204,v205
v_cvt_pk_bf16_f32 v31,v206,v207
s_waitcnt lgkmcnt(0)
s_nop 0
v_mfma_f32_32x32x16_bf16 v[144:159],v[236:239],v[28:31],v[144:159]
s_branch bp_t1d
bp_t1_3_x1:
v_exp_f32 v220,v220
v_exp_f32 v221,v221
v_exp_f32 v222,v222
v_exp_f32 v223,v223
v_cvt_pk_bf16_f32 v30,v220,v221
v_cvt_pk_bf16_f32 v31,v222,v223
s_waitcnt lgkmcnt(0)
s_nop 0
v_mfma_f32_32x32x16_bf16 v[144:159],v[252:255],v[28:31],v[144:159]
s_branch bp_t1d
bp_t1_4:
ds_read_b128 v[224:227],v16
ds_read_b32 v230,v17 offset:1024
ds_read_b128 v[240:243],v16 offset:2368
ds_read_b32 v246,v17 offset:3392
ds_read_b128 v[232:235],v18 offset:1152
ds_read_b128 v[236:239],v18 offset:1760
v_mov_b32 v28,0
v_mov_b32 v252,0
v_mov_b32 v29,0
v_mov_b32 v253,0
v_mov_b32 v30,0
v_mov_b32 v254,0
v_mov_b32 v31,0
v_mov_b32 v255,0
s_waitcnt lgkmcnt(4)
v_mfma_f32_32x32x16_bf16 v[192:207],v[224:227],v[32:35],0
v_mfma_f32_32x32x16_bf16 v[192:207],v[228:231],v[34:37],v[192:207]
s_waitcnt lgkmcnt(0)
s_nop 10
bp_t1_4_l:
v_mfma_f32_32x32x16_bf16 v[208:223],v[224:227],v[38:41],0
s_waitcnt lgkmcnt(0)
v_exp_f32 v192,v192
v_exp_f32 v193,v193
v_exp_f32 v194,v194
v_exp_f32_e64 v195,v195
v_cvt_pk_bf16_f32 v24,v192,v193
v_cvt_pk_bf16_f32 v25,v194,v195
v_mfma_f32_32x32x16_bf16 v[208:223],v[228:231],v[40:43],v[208:223]
v_exp_f32 v196,v196
v_exp_f32 v197,v197
v_exp_f32 v198,v198
v_exp_f32 v199,v199
v_cvt_pk_bf16_f32 v26,v196,v197
v_cvt_pk_bf16_f32 v27,v198,v199
v_mfma_f32_32x32x16_bf16 v[160:175],v[252:255],v[28:31],v[160:175]
v_exp_f32 v200,v200
v_exp_f32 v201,v201
v_exp_f32 v202,v202
v_exp_f32 v203,v203
v_cvt_pk_bf16_f32 v28,v200,v201
v_cvt_pk_bf16_f32 v29,v202,v203
v_mfma_f32_32x32x16_bf16 v[112:127],v[232:235],v[24:27],v[112:127]
v_exp_f32 v204,v204
v_exp_f32 v205,v205
v_exp_f32 v206,v206
v_exp_f32 v207,v207
v_cvt_pk_bf16_f32 v30,v204,v205
v_cvt_pk_bf16_f32 v31,v206,v207
v_mfma_f32_32x32x16_bf16 v[192:207],v[224:227],v[44:47],0
v_exp_f32 v208,v208
v_exp_f32 v209,v209
v_exp_f32 v210,v210
v_exp_f32 v211,v211
v_cvt_pk_bf16_f32 v24,v208,v209
v_cvt_pk_bf16_f32 v25,v210,v211
v_mfma_f32_32x32x16_bf16 v[192:207],v[228:231],v[46:49],v[192:207]
v_exp_f32 v212,v212
v_exp_f32 v213,v213
v_exp_f32 v214,v214
v_exp_f32 v215,v215
v_cvt_pk_bf16_f32 v26,v212,v213
v_cvt_pk_bf16_f32 v27,v214,v215
v_mfma_f32_32x32x16_bf16 v[112:127],v[236:239],v[28:31],v[112:127]
v_exp_f32 v216,v216
v_exp_f32 v217,v217
v_exp_f32 v218,v218
v_exp_f32 v219,v219
v_cvt_pk_bf16_f32 v28,v216,v217
v_cvt_pk_bf16_f32 v29,v218,v219
v_mfma_f32_32x32x16_bf16 v[128:143],v[232:235],v[24:27],v[128:143]
v_exp_f32 v220,v220
v_exp_f32 v221,v221
v_exp_f32 v222,v222
v_exp_f32 v223,v223
v_cvt_pk_bf16_f32 v30,v220,v221
v_cvt_pk_bf16_f32 v31,v222,v223
v_mfma_f32_32x32x16_bf16 v[208:223],v[224:227],v[50:53],0
v_exp_f32 v192,v192
v_exp_f32 v193,v193
v_exp_f32 v194,v194
v_exp_f32 v195,v195
v_cvt_pk_bf16_f32 v24,v192,v193
v_cvt_pk_bf16_f32 v25,v194,v195
v_mfma_f32_32x32x16_bf16 v[208:223],v[228:231],v[52:55],v[208:223]
v_exp_f32 v196,v196
v_exp_f32 v197,v197
v_exp_f32 v198,v198
v_exp_f32 v199,v199
v_cvt_pk_bf16_f32 v26,v196,v197
v_cvt_pk_bf16_f32 v27,v198,v199
v_mfma_f32_32x32x16_bf16 v[128:143],v[236:239],v[28:31],v[128:143]
v_exp_f32 v200,v200
v_exp_f32 v201,v201
v_exp_f32 v202,v202
v_exp_f32 v203,v203
v_cvt_pk_bf16_f32 v28,v200,v201
v_cvt_pk_bf16_f32 v29,v202,v203
v_mfma_f32_32x32x16_bf16 v[144:159],v[232:235],v[24:27],v[144:159]
v_exp_f32 v204,v204
v_exp_f32 v205,v205
v_exp_f32 v206,v206
v_exp_f32 v207,v207
v_cvt_pk_bf16_f32 v30,v204,v205
v_cvt_pk_bf16_f32 v31,v206,v207
v_mfma_f32_32x32x16_bf16 v[192:207],v[240:243],v[32:35],0
v_exp_f32 v208,v208
v_exp_f32 v209,v209
v_exp_f32 v210,v210
v_exp_f32 v211,v211
v_cvt_pk_bf16_f32 v24,v208,v209
v_cvt_pk_bf16_f32 v25,v210,v211
v_mfma_f32_32x32x16_bf16 v[192:207],v[244:247],v[34:37],v[192:207]
s_sub_u32 s32,s32,1
v_exp_f32 v212,v212
v_exp_f32 v213,v213
v_exp_f32 v214,v214
v_exp_f32_e64 v215,v215
v_cvt_pk_bf16_f32 v26,v212,v213
v_cvt_pk_bf16_f32 v27,v214,v215
v_mfma_f32_32x32x16_bf16 v[144:159],v[236:239],v[28:31],v[144:159]
ds_read_b128 v[224:227],v16 offset:4736
ds_read_b32 v230,v17 offset:5760
ds_read_b128 v[248:251],v18 offset:3520
ds_read_b128 v[252:255],v18 offset:4128
v_exp_f32 v216,v216
v_exp_f32 v217,v217
v_exp_f32 v218,v218
v_exp_f32 v219,v219
v_cvt_pk_bf16_f32 v28,v216,v217
v_cvt_pk_bf16_f32 v29,v218,v219
v_mfma_f32_32x32x16_bf16 v[160:175],v[232:235],v[24:27],v[160:175]
s_cbranch_scc1 bp_t1_4_x0
v_exp_f32 v220,v220
v_exp_f32 v221,v221
v_exp_f32 v222,v222
v_exp_f32_e64 v223,v223
v_cvt_pk_bf16_f32 v30,v220,v221
v_cvt_pk_bf16_f32 v31,v222,v223
v_mfma_f32_32x32x16_bf16 v[208:223],v[240:243],v[38:41],0
s_waitcnt lgkmcnt(0)
v_exp_f32 v192,v192
v_exp_f32 v193,v193
v_exp_f32 v194,v194
v_exp_f32 v195,v195
v_cvt_pk_bf16_f32 v24,v192,v193
v_cvt_pk_bf16_f32 v25,v194,v195
v_mfma_f32_32x32x16_bf16 v[208:223],v[244:247],v[40:43],v[208:223]
v_exp_f32 v196,v196
v_exp_f32 v197,v197
v_exp_f32 v198,v198
v_exp_f32_e64 v199,v199
v_cvt_pk_bf16_f32 v26,v196,v197
v_cvt_pk_bf16_f32 v27,v198,v199
v_mfma_f32_32x32x16_bf16 v[160:175],v[236:239],v[28:31],v[160:175]
v_exp_f32 v200,v200
v_exp_f32 v201,v201
v_exp_f32 v202,v202
v_exp_f32 v203,v203
v_cvt_pk_bf16_f32 v28,v200,v201
v_cvt_pk_bf16_f32 v29,v202,v203
v_mfma_f32_32x32x16_bf16 v[112:127],v[248:251],v[24:27],v[112:127]
v_exp_f32 v204,v204
v_exp_f32 v205,v205
v_exp_f32 v206,v206
v_exp_f32 v207,v207
v_cvt_pk_bf16_f32 v30,v204,v205
v_cvt_pk_bf16_f32 v31,v206,v207
v_mfma_f32_32x32x16_bf16 v[192:207],v[240:243],v[44:47],0
v_exp_f32 v208,v208
v_exp_f32 v209,v209
v_exp_f32 v210,v210
v_exp_f32 v211,v211
v_cvt_pk_bf16_f32 v24,v208,v209
v_cvt_pk_bf16_f32 v25,v210,v211
v_mfma_f32_32x32x16_bf16 v[192:207],v[244:247],v[46:49],v[192:207]
v_exp_f32 v212,v212
v_exp_f32 v213,v213
v_exp_f32 v214,v214
v_exp_f32 v215,v215
v_cvt_pk_bf16_f32 v26,v212,v213
v_cvt_pk_bf16_f32 v27,v214,v215
v_mfma_f32_32x32x16_bf16 v[112:127],v[252:255],v[28:31],v[112:127]
v_exp_f32 v216,v216
v_exp_f32 v217,v217
v_exp_f32 v218,v218
v_exp_f32 v219,v219
v_cvt_pk_bf16_f32 v28,v216,v217
v_cvt_pk_bf16_f32 v29,v218,v219
v_mfma_f32_32x32x16_bf16 v[128:143],v[248:251],v[24:27],v[128:143]
v_exp_f32 v220,v220
v_exp_f32 v221,v221
v_exp_f32 v222,v222
v_exp_f32 v223,v223
v_cvt_pk_bf16_f32 v30,v220,v221
v_cvt_pk_bf16_f32 v31,v222,v223
v_mfma_f32_32x32x16_bf16 v[208:223],v[240:243],v[50:53],0
v_exp_f32 v192,v192
v_exp_f32 v193,v193
v_exp_f32 v194,v194
v_exp_f32 v195,v195
v_cvt_pk_bf16_f32 v24,v192,v193
v_cvt_pk_bf16_f32 v25,v194,v195
v_mfma_f32_32x32x16_bf16 v[208:223],v[244:247],v[52:55],v[208:223]
v_exp_f32 v196,v196
v_exp_f32 v197,v197
v_exp_f32 v198,v198
v_exp_f32 v199,v199
v_cvt_pk_bf16_f32 v26,v196,v197
v_cvt_pk_bf16_f32 v27,v198,v199
v_mfma_f32_32x32x16_bf16 v[128:143],v[252:255],v[28:31],v[128:143]
v_exp_f32 v200,v200
v_exp_f32 v201,v201
v_exp_f32 v202,v202
v_exp_f32 v203,v203
v_cvt_pk_bf16_f32 v28,v200,v201
v_cvt_pk_bf16_f32 v29,v202,v203
v_mfma_f32_32x32x16_bf16 v[144:159],v[248:251],v[24:27],v[144:159]
v_exp_f32 v204,v204
v_exp_f32 v205,v205
v_exp_f32 v206,v206
v_exp_f32 v207,v207
v_cvt_pk_bf16_f32 v30,v204,v205
v_cvt_pk_bf16_f32 v31,v206,v207
v_mfma_f32_32x32x16_bf16 v[192:207],v[224:227],v[32:35],0
v_exp_f32 v208,v208
v_exp_f32 v209,v209
v_exp_f32 v210,v210
v_exp_f32 v211,v211
v_cvt_pk_bf16_f32 v24,v208,v209
v_cvt_pk_bf16_f32 v25,v210,v211
v_mfma_f32_32x32x16_bf16 v[192:207],v[228:231],v[34:37],v[192:207]
s_sub_u32 s32,s32,1
v_exp_f32 v212,v212
v_exp_f32 v213,v213
v_exp_f32 v214,v214
v_exp_f32_e64 v215,v215
v_cvt_pk_bf16_f32 v26,v212,v213
v_cvt_pk_bf16_f32 v27,v214,v215
v_mfma_f32_32x32x16_bf16 v[144:159],v[252:255],v[28:31],v[144:159]
ds_read_b128 v[240:243],v16 offset:7104
ds_read_b32 v246,v17 offset:8128
ds_read_b128 v[232:235],v18 offset:5888
ds_read_b128 v[236:239],v18 offset:6496
v_exp_f32 v216,v216
v_exp_f32 v217,v217
v_exp_f32 v218,v218
v_exp_f32 v219,v219
v_cvt_pk_bf16_f32 v28,v216,v217
v_cvt_pk_bf16_f32 v29,v218,v219
v_mfma_f32_32x32x16_bf16 v[160:175],v[248:251],v[24:27],v[160:175]
s_cbranch_scc1 bp_t1_4_x1
v_exp_f32 v220,v220
v_exp_f32 v221,v221
v_exp_f32 v222,v222
v_exp_f32_e64 v223,v223
v_cvt_pk_bf16_f32 v30,v220,v221
v_cvt_pk_bf16_f32 v31,v222,v223
v_add_u32 v16,4736,v16
v_add_u32 v17,4736,v17
v_add_u32 v18,4736,v18
s_branch bp_t1_4_l
bp_t1_4_x0:
v_exp_f32 v220,v220
v_exp_f32 v221,v221
v_exp_f32 v222,v222
v_exp_f32 v223,v223
v_cvt_pk_bf16_f32 v30,v220,v221
v_cvt_pk_bf16_f32 v31,v222,v223
s_waitcnt lgkmcnt(0)
s_nop 0
v_mfma_f32_32x32x16_bf16 v[160:175],v[236:239],v[28:31],v[160:175]
s_branch bp_t1d
bp_t1_4_x1:
v_exp_f32 v220,v220
v_exp_f32 v221,v221
v_exp_f32 v222,v222
v_exp_f32 v223,v223
v_cvt_pk_bf16_f32 v30,v220,v221
v_cvt_pk_bf16_f32 v31,v222,v223
s_waitcnt lgkmcnt(0)
s_nop 0
v_mfma_f32_32x32x16_bf16 v[160:175],v[252:255],v[28:31],v[160:175]
s_branch bp_t1d
bp_cu:
ds_read_b128 v[224:227],v16
ds_read_b32 v230,v17 offset:1024
ds_read_b128 v[240:243],v16 offset:9472
ds_read_b32 v246,v17 offset:10496
ds_read_b128 v[232:235],v18 offset:1152
ds_read_b128 v[236:239],v18 offset:1760
v_mov_b32 v28,0
v_mov_b32 v252,0
v_mov_b32 v29,0
v_mov_b32 v253,0
v_mov_b32 v30,0
v_mov_b32 v254,0
v_mov_b32 v31,0
v_mov_b32 v255,0
s_waitcnt lgkmcnt(4)
v_mfma_f32_32x32x16_bf16 v[192:207],v[224:227],v[56:59],0
v_mfma_f32_32x32x16_bf16 v[192:207],v[228:231],v[58:61],v[192:207]
s_waitcnt lgkmcnt(0)
s_nop 10
bp_cu_l:
v_mfma_f32_32x32x16_bf16 v[208:223],v[240:243],v[56:59],0
s_waitcnt lgkmcnt(0)
v_exp_f32 v192,v192
v_exp_f32 v193,v193
v_exp_f32 v194,v194
v_exp_f32_e64 v195,v195
v_cvt_pk_bf16_f32 v24,v192,v193
v_cvt_pk_bf16_f32 v25,v194,v195
v_mfma_f32_32x32x16_bf16 v[208:223],v[244:247],v[58:61],v[208:223]
s_sub_u32 s32,s32,1
v_exp_f32 v196,v196
v_exp_f32 v197,v197
v_exp_f32 v198,v198
v_exp_f32_e64 v199,v199
v_cvt_pk_bf16_f32 v26,v196,v197
v_cvt_pk_bf16_f32 v27,v198,v199
v_mfma_f32_32x32x16_bf16 v[176:191],v[252:255],v[28:31],v[176:191]
ds_read_b128 v[224:227],v16 offset:18944
ds_read_b32 v230,v17 offset:19968
ds_read_b128 v[248:251],v18 offset:10624
ds_read_b128 v[252:255],v18 offset:11232
v_exp_f32 v200,v200
v_exp_f32 v201,v201
v_exp_f32 v202,v202
v_exp_f32 v203,v203
v_cvt_pk_bf16_f32 v28,v200,v201
v_cvt_pk_bf16_f32 v29,v202,v203
v_mfma_f32_32x32x16_bf16 v[176:191],v[232:235],v[24:27],v[176:191]
s_cbranch_scc1 bp_cu_x0
v_exp_f32 v204,v204
v_exp_f32 v205,v205
v_exp_f32 v206,v206
v_exp_f32_e64 v207,v207
v_cvt_pk_bf16_f32 v30,v204,v205
v_cvt_pk_bf16_f32 v31,v206,v207
s_waitcnt lgkmcnt(2)
v_mfma_f32_32x32x16_bf16 v[192:207],v[224:227],v[56:59],0
s_waitcnt lgkmcnt(0)
v_exp_f32 v208,v208
v_exp_f32 v209,v209
v_exp_f32 v210,v210
v_exp_f32 v211,v211
v_cvt_pk_bf16_f32 v24,v208,v209
v_cvt_pk_bf16_f32 v25,v210,v211
v_mfma_f32_32x32x16_bf16 v[192:207],v[228:231],v[58:61],v[192:207]
s_sub_u32 s32,s32,1
v_exp_f32 v212,v212
v_exp_f32 v213,v213
v_exp_f32 v214,v214
v_exp_f32_e64 v215,v215
v_cvt_pk_bf16_f32 v26,v212,v213
v_cvt_pk_bf16_f32 v27,v214,v215
v_mfma_f32_32x32x16_bf16 v[176:191],v[236:239],v[28:31],v[176:191]
ds_read_b128 v[240:243],v16 offset:28416
ds_read_b32 v246,v17 offset:29440
ds_read_b128 v[232:235],v18 offset:20096
ds_read_b128 v[236:239],v18 offset:20704
v_exp_f32 v216,v216
v_exp_f32 v217,v217
v_exp_f32 v218,v218
v_exp_f32 v219,v219
v_cvt_pk_bf16_f32 v28,v216,v217
v_cvt_pk_bf16_f32 v29,v218,v219
v_mfma_f32_32x32x16_bf16 v[176:191],v[248:251],v[24:27],v[176:191]
s_cbranch_scc1 bp_cu_x1
v_exp_f32 v220,v220
v_exp_f32 v221,v221
v_exp_f32 v222,v222
v_exp_f32 v223,v223
v_cvt_pk_bf16_f32 v30,v220,v221
v_cvt_pk_bf16_f32 v31,v222,v223
s_waitcnt lgkmcnt(2)
v_mfma_f32_32x32x16_bf16 v[208:223],v[240:243],v[56:59],0
s_waitcnt lgkmcnt(0)
v_exp_f32 v192,v192
v_exp_f32 v193,v193
v_exp_f32 v194,v194
v_exp_f32_e64 v195,v195
v_cvt_pk_bf16_f32 v24,v192,v193
v_cvt_pk_bf16_f32 v25,v194,v195
v_mfma_f32_32x32x16_bf16 v[208:223],v[244:247],v[58:61],v[208:223]
s_sub_u32 s32,s32,1
v_exp_f32 v196,v196
v_exp_f32 v197,v197
v_exp_f32 v198,v198
v_exp_f32_e64 v199,v199
v_cvt_pk_bf16_f32 v26,v196,v197
v_cvt_pk_bf16_f32 v27,v198,v199
v_mfma_f32_32x32x16_bf16 v[176:191],v[252:255],v[28:31],v[176:191]
ds_read_b128 v[224:227],v16 offset:37888
ds_read_b32 v230,v17 offset:38912
ds_read_b128 v[248:251],v18 offset:29568
ds_read_b128 v[252:255],v18 offset:30176
v_exp_f32 v200,v200
v_exp_f32 v201,v201
v_exp_f32 v202,v202
v_exp_f32 v203,v203
v_cvt_pk_bf16_f32 v28,v200,v201
v_cvt_pk_bf16_f32 v29,v202,v203
v_mfma_f32_32x32x16_bf16 v[176:191],v[232:235],v[24:27],v[176:191]
s_cbranch_scc1 bp_cu_x0
v_exp_f32 v204,v204
v_exp_f32 v205,v205
v_exp_f32 v206,v206
v_exp_f32 v207,v207
v_cvt_pk_bf16_f32 v30,v204,v205
v_cvt_pk_bf16_f32 v31,v206,v207
s_waitcnt lgkmcnt(2)
v_mfma_f32_32x32x16_bf16 v[192:207],v[224:227],v[56:59],0
s_waitcnt lgkmcnt(0)
v_exp_f32 v208,v208
v_exp_f32 v209,v209
v_exp_f32 v210,v210
v_exp_f32_e64 v211,v211
v_cvt_pk_bf16_f32 v24,v208,v209
v_cvt_pk_bf16_f32 v25,v210,v211
v_mfma_f32_32x32x16_bf16 v[192:207],v[228:231],v[58:61],v[192:207]
s_sub_u32 s32,s32,1
v_exp_f32 v212,v212
v_exp_f32 v213,v213
v_exp_f32 v214,v214
v_exp_f32_e64 v215,v215
v_cvt_pk_bf16_f32 v26,v212,v213
v_cvt_pk_bf16_f32 v27,v214,v215
v_mfma_f32_32x32x16_bf16 v[176:191],v[236:239],v[28:31],v[176:191]
ds_read_b128 v[240:243],v16 offset:47360
ds_read_b32 v246,v17 offset:48384
ds_read_b128 v[232:235],v18 offset:39040
ds_read_b128 v[236:239],v18 offset:39648
v_exp_f32 v216,v216
v_exp_f32 v217,v217
v_exp_f32 v218,v218
v_exp_f32 v219,v219
v_cvt_pk_bf16_f32 v28,v216,v217
v_cvt_pk_bf16_f32 v29,v218,v219
v_mfma_f32_32x32x16_bf16 v[176:191],v[248:251],v[24:27],v[176:191]
s_cbranch_scc1 bp_cu_x1
v_exp_f32 v220,v220
v_exp_f32 v221,v221
v_exp_f32 v222,v222
v_exp_f32_e64 v223,v223
v_cvt_pk_bf16_f32 v30,v220,v221
v_cvt_pk_bf16_f32 v31,v222,v223
v_add_u32 v16,37888,v16
v_add_u32 v17,37888,v17
v_add_u32 v18,37888,v18
s_waitcnt lgkmcnt(2)
s_branch bp_cu_l
bp_cu_x0:
v_exp_f32 v204,v204
v_exp_f32 v205,v205
v_exp_f32 v206,v206
v_exp_f32 v207,v207
v_cvt_pk_bf16_f32 v30,v204,v205
v_cvt_pk_bf16_f32 v31,v206,v207
s_waitcnt lgkmcnt(0)
s_nop 0
v_mfma_f32_32x32x16_bf16 v[176:191],v[236:239],v[28:31],v[176:191]
s_branch bp_merge
bp_cu_x1:
v_exp_f32 v220,v220
v_exp_f32 v221,v221
v_exp_f32 v222,v222
v_exp_f32_e64 v223,v223
v_cvt_pk_bf16_f32 v30,v220,v221
v_cvt_pk_bf16_f32 v31,v222,v223
s_waitcnt lgkmcnt(0)
s_nop 0
v_mfma_f32_32x32x16_bf16 v[176:191],v[252:255],v[28:31],v[176:191]
s_branch bp_merge
bp_fin:
s_mov_b32 s35,s51
s_cmp_eq_u32 s35,s45
s_cbranch_scc1 st_28
s_lshl_b32 s63,s21,2
s_add_u32 s63,s63,s22
s_lshl_b32 s63,s63,5
s_add_u32 s63,s63,s25
s_lshl_b32 s63,s63,7
s_add_u32 s63,s63,21495808
v_lshlrev_b32 v10,16,v0
v_mov_b32 v11,1
s_bfm_b64 exec,s45,0
buffer_store_dword v11,v10,s[8:11],s63 offen sc1
s_mov_b64 exec,-1
st_28:
s_cmp_eq_u32 s51,1
s_cbranch_scc1 bp_f1
s_cmp_eq_u32 s51,2
s_cbranch_scc1 bp_f2
s_cmp_eq_u32 s51,3
s_cbranch_scc1 bp_f3
s_cmp_eq_u32 s51,4
s_cbranch_scc1 bp_f4
bp_f0:
s_cmp_le_u32 s45,0
s_cbranch_scc1 bp_f4
v_subrev_u32 v123,s34,v122
v_cmp_lt_u32 vcc,0x3c000000,v123
s_lshl_b32 s33,s21,2
s_add_u32 s33,s33,s26
s_add_u32 s33,s33,0
s_cbranch_vccnz bp_slow
bp_norm0:
v_rcp_f32_e64 v122,v122
s_lshl_b32 s60,s33,10
s_add_u32 s60,s60,s30
s_add_u32 s60,s60,4194304
v_pk_mul_f32 v[112:113],v[112:113],v[122:123] op_sel_hi:[1,0]
v_pk_mul_f32 v[114:115],v[114:115],v[122:123] op_sel_hi:[1,0]
v_pk_mul_f32 v[116:117],v[116:117],v[122:123] op_sel_hi:[1,0]
v_pk_mul_f32 v[118:119],v[118:119],v[122:123] op_sel_hi:[1,0]
v_pk_mul_f32 v[120:121],v[120:121],v[122:123] op_sel_hi:[1,0]
s_lshl_b32 s61,s25,6
s_add_u32 s61,s61,s33
s_lshl_b32 s61,s61,7
s_add_u32 s61,s61,7077888
v_cvt_pk_bf16_f32 v112,v112,v113
v_cvt_pk_bf16_f32 v113,v114,v115
v_cvt_pk_bf16_f32 v114,v116,v117
v_cvt_pk_bf16_f32 v115,v118,v119
v_cvt_pk_bf16_f32 v116,v120,v121
buffer_store_dwordx4 v[112:115],v2,s[8:11],s60 offen sc1
s_mov_b64 exec,0xffffffff
buffer_store_dword v116,v7,s[8:11],s61 offen sc1
s_mov_b64 exec,-1
s_mov_b32 s51,1
bp_f1:
s_cmp_le_u32 s45,1
s_cbranch_scc1 bp_f4
s_nop 1
v_subrev_u32 v139,s34,v138
v_cmp_lt_u32 vcc,0x3c000000,v139
s_lshl_b32 s33,s21,2
s_add_u32 s33,s33,s26
s_add_u32 s33,s33,16
s_cbranch_vccnz bp_slow
bp_norm1:
v_rcp_f32 v138,v138
s_lshl_b32 s60,s33,10
s_add_u32 s60,s60,s30
s_add_u32 s60,s60,4194304
v_pk_mul_f32 v[128:129],v[128:129],v[138:139] op_sel_hi:[1,0]
v_pk_mul_f32 v[130:131],v[130:131],v[138:139] op_sel_hi:[1,0]
v_pk_mul_f32 v[132:133],v[132:133],v[138:139] op_sel_hi:[1,0]
v_pk_mul_f32 v[134:135],v[134:135],v[138:139] op_sel_hi:[1,0]
v_pk_mul_f32 v[136:137],v[136:137],v[138:139] op_sel_hi:[1,0]
s_lshl_b32 s61,s25,6
s_add_u32 s61,s61,s33
s_lshl_b32 s61,s61,7
s_add_u32 s61,s61,7077888
v_cvt_pk_bf16_f32 v128,v128,v129
v_cvt_pk_bf16_f32 v129,v130,v131
v_cvt_pk_bf16_f32 v130,v132,v133
v_cvt_pk_bf16_f32 v131,v134,v135
v_cvt_pk_bf16_f32 v132,v136,v137
buffer_store_dwordx4 v[128:131],v2,s[8:11],s60 offen sc1
s_mov_b64 exec,0xffffffff
buffer_store_dword v132,v7,s[8:11],s61 offen sc1
s_mov_b64 exec,-1
s_mov_b32 s51,2
bp_f2:
s_cmp_le_u32 s45,2
s_cbranch_scc1 bp_f4
v_subrev_u32 v155,s34,v154
v_cmp_lt_u32 vcc,0x3c000000,v155
s_lshl_b32 s33,s21,2
s_add_u32 s33,s33,s26
s_add_u32 s33,s33,32
s_cbranch_vccnz bp_slow
bp_norm2:
v_rcp_f32_e64 v154,v154
s_lshl_b32 s60,s33,10
s_add_u32 s60,s60,s30
s_add_u32 s60,s60,4194304
v_pk_mul_f32 v[144:145],v[144:145],v[154:155] op_sel_hi:[1,0]
v_pk_mul_f32 v[146:147],v[146:147],v[154:155] op_sel_hi:[1,0]
v_pk_mul_f32 v[148:149],v[148:149],v[154:155] op_sel_hi:[1,0]
v_pk_mul_f32 v[150:151],v[150:151],v[154:155] op_sel_hi:[1,0]
v_pk_mul_f32 v[152:153],v[152:153],v[154:155] op_sel_hi:[1,0]
s_lshl_b32 s61,s25,6
s_add_u32 s61,s61,s33
s_lshl_b32 s61,s61,7
s_add_u32 s61,s61,7077888
v_cvt_pk_bf16_f32 v144,v144,v145
v_cvt_pk_bf16_f32 v145,v146,v147
v_cvt_pk_bf16_f32 v146,v148,v149
v_cvt_pk_bf16_f32 v147,v150,v151
v_cvt_pk_bf16_f32 v148,v152,v153
buffer_store_dwordx4 v[144:147],v2,s[8:11],s60 offen sc1
s_mov_b64 exec,0xffffffff
buffer_store_dword v148,v7,s[8:11],s61 offen sc1
s_mov_b64 exec,-1
s_mov_b32 s51,3
bp_f3:
s_cmp_le_u32 s45,3
s_cbranch_scc1 bp_f4
v_subrev_u32 v171,s34,v170
v_cmp_lt_u32 vcc,0x3c000000,v171
s_lshl_b32 s33,s21,2
s_add_u32 s33,s33,s26
s_add_u32 s33,s33,48
s_cbranch_vccnz bp_slow
bp_norm3:
v_rcp_f32_e64 v170,v170
s_lshl_b32 s60,s33,10
s_add_u32 s60,s60,s30
s_add_u32 s60,s60,4194304
v_pk_mul_f32 v[160:161],v[160:161],v[170:171] op_sel_hi:[1,0]
v_pk_mul_f32 v[162:163],v[162:163],v[170:171] op_sel_hi:[1,0]
v_pk_mul_f32 v[164:165],v[164:165],v[170:171] op_sel_hi:[1,0]
v_pk_mul_f32 v[166:167],v[166:167],v[170:171] op_sel_hi:[1,0]
v_pk_mul_f32 v[168:169],v[168:169],v[170:171] op_sel_hi:[1,0]
s_lshl_b32 s61,s25,6
s_add_u32 s61,s61,s33
s_lshl_b32 s61,s61,7
s_add_u32 s61,s61,7077888
v_cvt_pk_bf16_f32 v160,v160,v161
v_cvt_pk_bf16_f32 v161,v162,v163
v_cvt_pk_bf16_f32 v162,v164,v165
v_cvt_pk_bf16_f32 v163,v166,v167
v_cvt_pk_bf16_f32 v164,v168,v169
buffer_store_dwordx4 v[160:163],v2,s[8:11],s60 offen sc1
s_mov_b64 exec,0xffffffff
buffer_store_dword v164,v7,s[8:11],s61 offen sc1
s_mov_b64 exec,-1
s_mov_b32 s51,4
bp_f4:
s_cmp_lt_u32 s44,64
s_cbranch_scc1 bp_t2
s_branch bp_done
bp_slow:
s_lshl_b32 s60,s33,10
s_add_u32 s60,s60,s30
s_lshl_b32 s61,s33,8
s_add_u32 s61,s61,s31
buffer_load_dwordx4 v[66:69],v2,s[8:11],s60 offen sc1
buffer_load_dword v70,v3,s[8:11],s61 offen sc1
v_mov_b32 v71,0
s_mul_i32 s60,0,2368
v_add_u32 v16,s60,v1
v_add_u32 v17,s60,v14
v_add_u32 v18,s60,v15
v_mov_b32 v64,0xff800000
s_mov_b32 s62,0
s_waitcnt vmcnt(0)
bp_p1:
ds_read_b128 v[224:227],v16
ds_read_b32 v230,v17 offset:1024
ds_read_b128 v[232:235],v18 offset:1152
ds_read_b128 v[236:239],v18 offset:1760
v_add_u32 v16,2368,v16
v_add_u32 v17,2368,v17
v_add_u32 v18,2368,v18
s_waitcnt lgkmcnt(0)
v_mfma_f32_32x32x16_bf16 v[192:207],v[224:227],v[66:69],0
v_mfma_f32_32x32x16_bf16 v[192:207],v[228:231],v[68:71],v[192:207]
s_nop 11
v_max3_f32 v64,v64,v192,v193
v_max3_f32 v64,v64,v194,v195
v_max3_f32 v64,v64,v196,v197
v_max3_f32 v64,v64,v198,v199
v_max3_f32 v64,v64,v200,v201
v_max3_f32 v64,v64,v202,v203
v_max3_f32 v64,v64,v204,v205
v_max3_f32 v64,v64,v206,v207
s_add_u32 s62,s62,1
s_cmp_lt_u32 s62,64
s_cbranch_scc1 bp_p1
v_mov_b32 v65,v64
s_nop 1
v_permlane32_swap_b32 v64,v65
v_max_f32 v64,v64,v65
v_sub_f32 v208,0,v64
v_mov_b32 v176,0
v_sub_f32 v209,0,v64
v_mov_b32 v177,0
v_sub_f32 v210,0,v64
v_mov_b32 v178,0
v_sub_f32 v211,0,v64
v_mov_b32 v179,0
v_sub_f32 v212,0,v64
v_mov_b32 v180,0
v_sub_f32 v213,0,v64
v_mov_b32 v181,0
v_sub_f32 v214,0,v64
v_mov_b32 v182,0
v_sub_f32 v215,0,v64
v_mov_b32 v183,0
v_sub_f32 v216,0,v64
v_mov_b32 v184,0
v_sub_f32 v217,0,v64
v_mov_b32 v185,0
v_sub_f32 v218,0,v64
v_mov_b32 v186,0
v_sub_f32 v219,0,v64
v_mov_b32 v187,0
v_sub_f32 v220,0,v64
v_mov_b32 v188,0
v_sub_f32 v221,0,v64
v_mov_b32 v189,0
v_sub_f32 v222,0,v64
v_mov_b32 v190,0
v_sub_f32 v223,0,v64
v_mov_b32_e64 v191,0
s_mul_i32 s60,0,2368
v_add_u32 v16,s60,v1
v_add_u32 v17,s60,v14
v_add_u32 v18,s60,v15
s_mov_b32 s62,0
bp_p2:
ds_read_b128 v[224:227],v16
ds_read_b32 v230,v17 offset:1024
ds_read_b128 v[232:235],v18 offset:1152
ds_read_b128 v[236:239],v18 offset:1760
v_add_u32 v16,2368,v16
v_add_u32 v17,2368,v17
v_add_u32 v18,2368,v18
s_waitcnt lgkmcnt(0)
v_mfma_f32_32x32x16_bf16 v[192:207],v[224:227],v[66:69],v[208:223]
v_mfma_f32_32x32x16_bf16 v[192:207],v[228:231],v[68:71],v[192:207]
s_nop 11
v_exp_f32 v192,v192
v_exp_f32 v193,v193
v_exp_f32 v194,v194
v_exp_f32 v195,v195
v_cvt_pk_bf16_f32 v24,v192,v193
v_cvt_pk_bf16_f32 v25,v194,v195
v_exp_f32 v196,v196
v_exp_f32 v197,v197
v_exp_f32 v198,v198
v_exp_f32 v199,v199
v_cvt_pk_bf16_f32 v26,v196,v197
v_cvt_pk_bf16_f32 v27,v198,v199
v_exp_f32 v200,v200
v_exp_f32 v201,v201
v_exp_f32 v202,v202
v_exp_f32 v203,v203
v_cvt_pk_bf16_f32 v28,v200,v201
v_cvt_pk_bf16_f32 v29,v202,v203
v_exp_f32 v204,v204
v_exp_f32 v205,v205
v_exp_f32 v206,v206
v_exp_f32 v207,v207
v_cvt_pk_bf16_f32 v30,v204,v205
v_cvt_pk_bf16_f32 v31,v206,v207
v_mfma_f32_32x32x16_bf16 v[176:191],v[232:235],v[24:27],v[176:191]
v_mfma_f32_32x32x16_bf16 v[176:191],v[236:239],v[28:31],v[176:191]
s_add_u32 s62,s62,1
s_cmp_lt_u32 s62,64
s_cbranch_scc1 bp_p2
s_cmp_lg_u32 s51,0
s_cbranch_scc1 bp_sl1
s_nop 6
v_mov_b32 v112,v176
v_mov_b32 v113,v177
v_mov_b32 v114,v178
v_mov_b32 v115,v179
v_mov_b32 v116,v180
v_mov_b32 v117,v181
v_mov_b32 v118,v182
v_mov_b32 v119,v183
v_mov_b32 v120,v184
v_mov_b32 v121,v185
v_mov_b32 v122,v186
s_branch bp_norm0
bp_sl1:
s_cmp_lg_u32 s51,1
s_cbranch_scc1 bp_sl2
s_nop 4
v_mov_b32 v128,v176
v_mov_b32 v129,v177
v_mov_b32 v130,v178
v_mov_b32 v131,v179
v_mov_b32 v132,v180
v_mov_b32 v133,v181
v_mov_b32 v134,v182
v_mov_b32 v135,v183
v_mov_b32 v136,v184
v_mov_b32 v137,v185
v_mov_b32 v138,v186
s_branch bp_norm1
bp_sl2:
s_cmp_lg_u32 s51,2
s_cbranch_scc1 bp_sl3
s_nop 2
v_mov_b32 v144,v176
v_mov_b32 v145,v177
v_mov_b32 v146,v178
v_mov_b32 v147,v179
v_mov_b32 v148,v180
v_mov_b32 v149,v181
v_mov_b32 v150,v182
v_mov_b32 v151,v183
v_mov_b32 v152,v184
v_mov_b32 v153,v185
v_mov_b32 v154,v186
s_branch bp_norm2
bp_sl3:
s_nop 2
v_mov_b32 v160,v176
v_mov_b32 v161,v177
v_mov_b32 v162,v178
v_mov_b32 v163,v179
v_mov_b32 v164,v180
v_mov_b32 v165,v181
v_mov_b32 v166,v182
v_mov_b32 v167,v183
v_mov_b32 v168,v184
v_mov_b32 v169,v185
v_mov_b32 v170,v186
s_branch bp_norm3
bp_done:
s_cmp_eq_u32 s23,0
s_cbranch_scc1 g_next
s_cmp_ge_u32 s22,2
s_cbranch_scc1 g_next
s_lshr_b32 s61,s24,1
s_add_u32 s61,s61,s22
s_add_u32 s61,s61,128
s_mul_i32 s26,s61,43691
s_lshr_b32 s26,s26,17
s_mul_i32 s60,s26,3
s_sub_u32 s25,s61,s60
s_sub_u32 s60,63,s26
s_cmp_eq_u32 s23,0
s_cselect_b32 s26,s26,s60
s_branch w_bw0
g_next:
s_add_u32 s12,s6,39321600
s_addc_u32 s13,s7,0
s_mov_b32 s14,2359296
s_mov_b32 s15,0x20000
s_add_u32 s23,s23,1
s_cmp_lt_u32 s23,2
s_cbranch_scc1 g_layer
s_branch w_fail
w_pipe:
s_sub_u32 s60,s24,128
s_lshr_b32 s62,s60,5
s_and_b32 s61,s60,31
s_mul_i32 s39,s61,58255
s_lshr_b32 s39,s39,19
s_mul_i32 s60,s39,9
s_sub_u32 s37,s61,s60
s_cmp_eq_u32 s62,2
s_cselect_b32 s60,27,18
s_cmp_lt_u32 s61,s60
s_cbranch_scc1 p_layer
s_mul_i32 s25,s62,14
s_add_u32 s25,s25,s61
s_sub_u32 s25,s25,s60
s_min_u32 s25,s25,31
v_lshrrev_b32 v10,3,v0
v_and_b32 v11,7,v0
v_xor_b32 v11,v11,v10
s_lshl_b32 s60,s21,3
v_add_u32_e64 v10,s60,v10
v_mul_u32_u24 v1,1152,v10
v_lshl_add_u32 v1,v11,4,v1
v_lshlrev_b32 v10,2,v10
v_add_u32 v9,37888,v10
s_mul_i32 s60,s21,9216
v_lshlrev_b32 v2,4,v0
v_add_u32 v2,s60,v2
v_lshrrev_b32 v10,4,v0
v_lshlrev_b32 v8,4,v10
v_add_u32 v8,37888,v8
v_and_b32 v11,7,v0
v_xor_b32 v10,v10,v11
v_lshlrev_b32 v10,4,v10
v_lshl_add_u32 v10,v11,7,v10
v_bfe_u32 v11,v0,3,1
v_mul_u32_u24 v11,9216,v11
v_add_u32 v4,v10,v11
v_xor_b32 v3,64,v4
v_and_b32 v10,15,v0
v_lshlrev_b32 v10,2,v10
v_add_u32 v7,37888,v10
s_mov_b32 s31,0
v_lshlrev_b32 v5,4,v0
v_lshrrev_b32 v10,2,v0
v_lshlrev_b32 v10,5,v10
v_and_b32 v11,1,v0
v_lshl_add_u32 v10,v11,4,v10
v_bfe_u32 v11,v0,1,1
v_lshl_add_u32 v6,v11,11,v10
s_mov_b32 s76,s68
s_mov_b32 s77,s69
s_mov_b32 s78,4718592
s_mov_b32 s79,0x20000
s_mov_b32 s80,s70
s_mov_b32 s81,s71
s_mov_b32 s82,4718592
s_mov_b32 s83,0x20000
s_mov_b32 s84,s72
s_mov_b32 s85,s73
s_mov_b32 s86,4718592
s_mov_b32 s87,0x20000
s_lshl_b32 s61,s21,2
v_lshrrev_b32 v10,4,v0
v_and_b32 v11,15,v0
v_lshlrev_b32 v12,1,v10
v_xor_b32 v12,v12,v11
v_lshlrev_b32_e64 v12,4,v12
v_bfe_u32 v11,v0,2,3
v_lshlrev_b32 v11,1,v11
v_bfe_u32 v15,v0,1,1
v_add_u32 v15,s61,v15
v_xor_b32 v15,v15,v11
v_lshlrev_b32 v15,4,v15
v_and_b32_e64 v11,1,v0
v_lshl_add_u32 v15,v11,3,v15
v_bfe_u32 v11,v0,2,2
v_lshl_add_u32 v10,v10,3,v11
v_lshl_add_u32 v14,v10,8,v15
v_xor_b32 v15,32,v14
v_lshrrev_b32 v10,4,v0
v_lshl_add_u32 v12,v10,13,v12
v_xor_b32 v13,0x80,v12
s_lshl_b32 s62,s25,8
s_lshl_b32 s61,s21,17
s_add_u32 s62,s62,s61
s_lshl_b32 s63,s21,12
s_barrier
s_add_u32 s60,s62,0
s_add_u32 m0,s63,40960
s_nop 0
buffer_load_dwordx4 v12,s[80:83],s60 offen lds
s_add_u32 s60,s62,32768
s_add_u32 m0,s63,41984
s_nop 0
buffer_load_dwordx4 v12,s[80:83],s60 offen lds
s_add_u32 s60,s62,65536
s_add_u32 m0,s63,43008
s_nop 0
buffer_load_dwordx4 v13,s[80:83],s60 offen lds
s_add_u32 s60,s62,98304
s_add_u32 m0,s63,44032
s_nop 0
buffer_load_dwordx4 v13,s[80:83],s60 offen lds
s_add_u32 s60,s62,524288
s_add_u32 m0,s63,106496
s_nop 0
buffer_load_dwordx4 v12,s[80:83],s60 offen lds
s_add_u32 s60,s62,557056
s_add_u32 m0,s63,107520
s_nop 0
buffer_load_dwordx4 v12,s[80:83],s60 offen lds
s_add_u32 s60,s62,589824
s_add_u32 m0,s63,108544
s_nop 0
buffer_load_dwordx4 v13,s[80:83],s60 offen lds
s_add_u32 s60,s62,622592
s_add_u32 m0,s63,109568
s_nop 0
buffer_load_dwordx4 v13,s[80:83],s60 offen lds
s_add_u32 s60,s62,1048576
s_add_u32 m0,s63,122880
s_nop 0
buffer_load_dwordx4 v12,s[80:83],s60 offen lds
s_add_u32 s60,s62,1081344
s_add_u32 m0,s63,123904
s_nop 0
buffer_load_dwordx4 v12,s[80:83],s60 offen lds
s_add_u32 s60,s62,1114112
s_add_u32 m0,s63,124928
s_nop 0
buffer_load_dwordx4 v13,s[80:83],s60 offen lds
s_add_u32 s60,s62,1146880
s_add_u32 m0,s63,125952
s_nop 0
buffer_load_dwordx4 v13,s[80:83],s60 offen lds
s_waitcnt vmcnt(8) lgkmcnt(0)
s_barrier
s_add_u32 s60,s62,1572864
s_add_u32 m0,s63,139264
s_nop 0
buffer_load_dwordx4 v12,s[80:83],s60 offen lds
s_add_u32 s60,s62,1605632
s_add_u32 m0,s63,140288
s_nop 0
buffer_load_dwordx4 v12,s[80:83],s60 offen lds
s_add_u32 s60,s62,1638400
s_add_u32 m0,s63,141312
s_nop 0
buffer_load_dwordx4 v13,s[80:83],s60 offen lds
s_add_u32 s60,s62,1671168
s_add_u32 m0,s63,142336
s_nop 0
buffer_load_dwordx4 v13,s[80:83],s60 offen lds
v_add_u32 v10,40960,v14
ds_read_b64_tr_b16 a[0:1],v10
ds_read_b64_tr_b16 a[2:3],v10 offset:1024
ds_read_b64_tr_b16 a[4:5],v10 offset:8192
ds_read_b64_tr_b16 a[6:7],v10 offset:9216
v_add_u32 v11,40960,v15
ds_read_b64_tr_b16 a[72:73],v11
ds_read_b64_tr_b16 a[74:75],v11 offset:1024
ds_read_b64_tr_b16 a[76:77],v11 offset:8192
ds_read_b64_tr_b16 a[78:79],v11 offset:9216
s_waitcnt vmcnt(8) lgkmcnt(0)
s_barrier
s_add_u32 s60,s62,2097152
s_add_u32 m0,s63,40960
s_nop 0
buffer_load_dwordx4 v12,s[80:83],s60 offen lds
s_add_u32 s60,s62,2129920
s_add_u32 m0,s63,41984
s_nop 0
buffer_load_dwordx4 v12,s[80:83],s60 offen lds
s_add_u32 s60,s62,2162688
s_add_u32 m0,s63,43008
s_nop 0
buffer_load_dwordx4 v13,s[80:83],s60 offen lds
s_add_u32 s60,s62,2195456
s_add_u32 m0,s63,44032
s_nop 0
buffer_load_dwordx4 v13,s[80:83],s60 offen lds
v_add_u32 v10,106496,v14
ds_read_b64_tr_b16 a[8:9],v10
ds_read_b64_tr_b16 a[10:11],v10 offset:1024
ds_read_b64_tr_b16 a[12:13],v10 offset:8192
ds_read_b64_tr_b16 a[14:15],v10 offset:9216
v_add_u32 v11,106496,v15
ds_read_b64_tr_b16 a[80:81],v11
ds_read_b64_tr_b16 a[82:83],v11 offset:1024
ds_read_b64_tr_b16 a[84:85],v11 offset:8192
ds_read_b64_tr_b16 a[86:87],v11 offset:9216
s_waitcnt vmcnt(8) lgkmcnt(0)
s_barrier
s_add_u32 s60,s62,2621440
s_add_u32 m0,s63,106496
s_nop 0
buffer_load_dwordx4 v12,s[80:83],s60 offen lds
s_add_u32 s60,s62,2654208
s_add_u32 m0,s63,107520
s_nop 0
buffer_load_dwordx4 v12,s[80:83],s60 offen lds
s_add_u32 s60,s62,2686976
s_add_u32 m0,s63,108544
s_nop 0
buffer_load_dwordx4 v13,s[80:83],s60 offen lds
s_add_u32 s60,s62,2719744
s_add_u32 m0,s63,109568
s_nop 0
buffer_load_dwordx4 v13,s[80:83],s60 offen lds
v_add_u32 v10,122880,v14
ds_read_b64_tr_b16 a[16:17],v10
ds_read_b64_tr_b16 a[18:19],v10 offset:1024
ds_read_b64_tr_b16 a[20:21],v10 offset:8192
ds_read_b64_tr_b16 a[22:23],v10 offset:9216
v_add_u32 v11,122880,v15
ds_read_b64_tr_b16 a[88:89],v11
ds_read_b64_tr_b16 a[90:91],v11 offset:1024
ds_read_b64_tr_b16 a[92:93],v11 offset:8192
ds_read_b64_tr_b16 a[94:95],v11 offset:9216
s_waitcnt vmcnt(8) lgkmcnt(0)
s_barrier
s_add_u32 s60,s62,3145728
s_add_u32 m0,s63,122880
s_nop 0
buffer_load_dwordx4 v12,s[80:83],s60 offen lds
s_add_u32 s60,s62,3178496
s_add_u32 m0,s63,123904
s_nop 0
buffer_load_dwordx4 v12,s[80:83],s60 offen lds
s_add_u32 s60,s62,3211264
s_add_u32 m0,s63,124928
s_nop 0
buffer_load_dwordx4 v13,s[80:83],s60 offen lds
s_add_u32 s60,s62,3244032
s_add_u32 m0,s63,125952
s_nop 0
buffer_load_dwordx4 v13,s[80:83],s60 offen lds
v_add_u32 v10,139264,v14
ds_read_b64_tr_b16 a[24:25],v10
ds_read_b64_tr_b16 a[26:27],v10 offset:1024
ds_read_b64_tr_b16 a[28:29],v10 offset:8192
ds_read_b64_tr_b16 a[30:31],v10 offset:9216
v_add_u32 v11,139264,v15
ds_read_b64_tr_b16 a[96:97],v11
ds_read_b64_tr_b16 a[98:99],v11 offset:1024
ds_read_b64_tr_b16 a[100:101],v11 offset:8192
ds_read_b64_tr_b16 a[102:103],v11 offset:9216
s_waitcnt vmcnt(8) lgkmcnt(0)
s_barrier
s_add_u32 s60,s62,3670016
s_add_u32 m0,s63,139264
s_nop 0
buffer_load_dwordx4 v12,s[80:83],s60 offen lds
s_add_u32 s60,s62,3702784
s_add_u32 m0,s63,140288
s_nop 0
buffer_load_dwordx4 v12,s[80:83],s60 offen lds
s_add_u32 s60,s62,3735552
s_add_u32 m0,s63,141312
s_nop 0
buffer_load_dwordx4 v13,s[80:83],s60 offen lds
s_add_u32 s60,s62,3768320
s_add_u32 m0,s63,142336
s_nop 0
buffer_load_dwordx4 v13,s[80:83],s60 offen lds
v_add_u32 v10,40960,v14
ds_read_b64_tr_b16 a[32:33],v10
ds_read_b64_tr_b16 a[34:35],v10 offset:1024
ds_read_b64_tr_b16 a[36:37],v10 offset:8192
ds_read_b64_tr_b16 a[38:39],v10 offset:9216
v_add_u32 v11,40960,v15
ds_read_b64_tr_b16 a[104:105],v11
ds_read_b64_tr_b16 a[106:107],v11 offset:1024
ds_read_b64_tr_b16 a[108:109],v11 offset:8192
ds_read_b64_tr_b16 a[110:111],v11 offset:9216
s_waitcnt vmcnt(8) lgkmcnt(0)
s_barrier
s_add_u32 s60,s62,4194304
s_add_u32 m0,s63,40960
s_nop 0
buffer_load_dwordx4 v12,s[80:83],s60 offen lds
s_add_u32 s60,s62,4227072
s_add_u32 m0,s63,41984
s_nop 0
buffer_load_dwordx4 v12,s[80:83],s60 offen lds
s_add_u32 s60,s62,4259840
s_add_u32 m0,s63,43008
s_nop 0
buffer_load_dwordx4 v13,s[80:83],s60 offen lds
s_add_u32 s60,s62,4292608
s_add_u32 m0,s63,44032
s_nop 0
buffer_load_dwordx4 v13,s[80:83],s60 offen lds
v_add_u32 v10,106496,v14
ds_read_b64_tr_b16 a[40:41],v10
ds_read_b64_tr_b16 a[42:43],v10 offset:1024
ds_read_b64_tr_b16 a[44:45],v10 offset:8192
ds_read_b64_tr_b16 a[46:47],v10 offset:9216
v_add_u32 v11,106496,v15
ds_read_b64_tr_b16 a[112:113],v11
ds_read_b64_tr_b16 a[114:115],v11 offset:1024
ds_read_b64_tr_b16 a[116:117],v11 offset:8192
ds_read_b64_tr_b16 a[118:119],v11 offset:9216
s_waitcnt vmcnt(8) lgkmcnt(0)
s_barrier
s_add_u32 s60,s62,0
s_add_u32 m0,s63,106496
s_nop 0
buffer_load_dwordx4 v12,s[84:87],s60 offen lds
s_add_u32 s60,s62,32768
s_add_u32 m0,s63,107520
s_nop 0
buffer_load_dwordx4 v12,s[84:87],s60 offen lds
s_add_u32 s60,s62,65536
s_add_u32 m0,s63,108544
s_nop 0
buffer_load_dwordx4 v13,s[84:87],s60 offen lds
s_add_u32 s60,s62,98304
s_add_u32 m0,s63,109568
s_nop 0
buffer_load_dwordx4 v13,s[84:87],s60 offen lds
v_add_u32 v10,122880,v14
ds_read_b64_tr_b16 a[48:49],v10
ds_read_b64_tr_b16 a[50:51],v10 offset:1024
ds_read_b64_tr_b16 a[52:53],v10 offset:8192
ds_read_b64_tr_b16 a[54:55],v10 offset:9216
v_add_u32 v11,122880,v15
ds_read_b64_tr_b16 a[120:121],v11
ds_read_b64_tr_b16 a[122:123],v11 offset:1024
ds_read_b64_tr_b16 a[124:125],v11 offset:8192
ds_read_b64_tr_b16 a[126:127],v11 offset:9216
s_waitcnt vmcnt(8) lgkmcnt(0)
s_barrier
s_add_u32 s60,s62,524288
s_add_u32 m0,s63,122880
s_nop 0
buffer_load_dwordx4 v12,s[84:87],s60 offen lds
s_add_u32 s60,s62,557056
s_add_u32 m0,s63,123904
s_nop 0
buffer_load_dwordx4 v12,s[84:87],s60 offen lds
s_add_u32 s60,s62,589824
s_add_u32 m0,s63,124928
s_nop 0
buffer_load_dwordx4 v13,s[84:87],s60 offen lds
s_add_u32 s60,s62,622592
s_add_u32 m0,s63,125952
s_nop 0
buffer_load_dwordx4 v13,s[84:87],s60 offen lds
v_add_u32 v10,139264,v14
ds_read_b64_tr_b16 a[56:57],v10
ds_read_b64_tr_b16 a[58:59],v10 offset:1024
ds_read_b64_tr_b16 a[60:61],v10 offset:8192
ds_read_b64_tr_b16 a[62:63],v10 offset:9216
v_add_u32 v11,139264,v15
ds_read_b64_tr_b16 a[128:129],v11
ds_read_b64_tr_b16 a[130:131],v11 offset:1024
ds_read_b64_tr_b16 a[132:133],v11 offset:8192
ds_read_b64_tr_b16 a[134:135],v11 offset:9216
s_waitcnt vmcnt(8) lgkmcnt(0)
s_barrier
s_add_u32 s60,s62,1048576
s_add_u32 m0,s63,139264
s_nop 0
buffer_load_dwordx4 v12,s[84:87],s60 offen lds
s_add_u32 s60,s62,1081344
s_add_u32 m0,s63,140288
s_nop 0
buffer_load_dwordx4 v12,s[84:87],s60 offen lds
s_add_u32 s60,s62,1114112
s_add_u32 m0,s63,141312
s_nop 0
buffer_load_dwordx4 v13,s[84:87],s60 offen lds
s_add_u32 s60,s62,1146880
s_add_u32 m0,s63,142336
s_nop 0
buffer_load_dwordx4 v13,s[84:87],s60 offen lds
v_add_u32 v10,40960,v14
ds_read_b64_tr_b16 a[64:65],v10
ds_read_b64_tr_b16 a[66:67],v10 offset:1024
ds_read_b64_tr_b16 a[68:69],v10 offset:8192
ds_read_b64_tr_b16 a[70:71],v10 offset:9216
v_add_u32 v11,40960,v15
ds_read_b64_tr_b16 a[136:137],v11
ds_read_b64_tr_b16 a[138:139],v11 offset:1024
ds_read_b64_tr_b16 a[140:141],v11 offset:8192
ds_read_b64_tr_b16 a[142:143],v11 offset:9216
s_waitcnt vmcnt(8) lgkmcnt(0)
s_barrier
s_add_u32 s60,s62,1572864
s_add_u32 m0,s63,40960
s_nop 0
buffer_load_dwordx4 v12,s[84:87],s60 offen lds
s_add_u32 s60,s62,1605632
s_add_u32 m0,s63,41984
s_nop 0
buffer_load_dwordx4 v12,s[84:87],s60 offen lds
s_add_u32 s60,s62,1638400
s_add_u32 m0,s63,43008
s_nop 0
buffer_load_dwordx4 v13,s[84:87],s60 offen lds
s_add_u32 s60,s62,1671168
s_add_u32 m0,s63,44032
s_nop 0
buffer_load_dwordx4 v13,s[84:87],s60 offen lds
v_add_u32 v10,106496,v14
ds_read_b64_tr_b16 a[144:145],v10
ds_read_b64_tr_b16 a[146:147],v10 offset:1024
ds_read_b64_tr_b16 a[148:149],v10 offset:8192
ds_read_b64_tr_b16 a[150:151],v10 offset:9216
v_add_u32 v11,106496,v15
ds_read_b64_tr_b16 a[216:217],v11
ds_read_b64_tr_b16 a[218:219],v11 offset:1024
ds_read_b64_tr_b16 a[220:221],v11 offset:8192
ds_read_b64_tr_b16 a[222:223],v11 offset:9216
s_waitcnt vmcnt(8) lgkmcnt(0)
s_barrier
s_add_u32 s60,s62,2097152
s_add_u32 m0,s63,106496
s_nop 0
buffer_load_dwordx4 v12,s[84:87],s60 offen lds
s_add_u32 s60,s62,2129920
s_add_u32 m0,s63,107520
s_nop 0
buffer_load_dwordx4 v12,s[84:87],s60 offen lds
s_add_u32 s60,s62,2162688
s_add_u32 m0,s63,108544
s_nop 0
buffer_load_dwordx4 v13,s[84:87],s60 offen lds
s_add_u32 s60,s62,2195456
s_add_u32 m0,s63,109568
s_nop 0
buffer_load_dwordx4 v13,s[84:87],s60 offen lds
v_add_u32 v10,122880,v14
ds_read_b64_tr_b16 a[152:153],v10
ds_read_b64_tr_b16 a[154:155],v10 offset:1024
ds_read_b64_tr_b16 a[156:157],v10 offset:8192
ds_read_b64_tr_b16 a[158:159],v10 offset:9216
v_add_u32 v11,122880,v15
ds_read_b64_tr_b16 a[224:225],v11
ds_read_b64_tr_b16 a[226:227],v11 offset:1024
ds_read_b64_tr_b16 a[228:229],v11 offset:8192
ds_read_b64_tr_b16 a[230:231],v11 offset:9216
s_waitcnt vmcnt(8) lgkmcnt(0)
s_barrier
s_add_u32 s60,s62,2621440
s_add_u32 m0,s63,122880
s_nop 0
buffer_load_dwordx4 v12,s[84:87],s60 offen lds
s_add_u32 s60,s62,2654208
s_add_u32 m0,s63,123904
s_nop 0
buffer_load_dwordx4 v12,s[84:87],s60 offen lds
s_add_u32 s60,s62,2686976
s_add_u32 m0,s63,124928
s_nop 0
buffer_load_dwordx4 v13,s[84:87],s60 offen lds
s_add_u32 s60,s62,2719744
s_add_u32 m0,s63,125952
s_nop 0
buffer_load_dwordx4 v13,s[84:87],s60 offen lds
v_add_u32 v10,139264,v14
ds_read_b64_tr_b16 a[160:161],v10
ds_read_b64_tr_b16 a[162:163],v10 offset:1024
ds_read_b64_tr_b16 a[164:165],v10 offset:8192
ds_read_b64_tr_b16 a[166:167],v10 offset:9216
v_add_u32 v11,139264,v15
ds_read_b64_tr_b16 a[232:233],v11
ds_read_b64_tr_b16 a[234:235],v11 offset:1024
ds_read_b64_tr_b16 a[236:237],v11 offset:8192
ds_read_b64_tr_b16 a[238:239],v11 offset:9216
s_waitcnt vmcnt(8) lgkmcnt(0)
s_barrier
s_add_u32 s60,s62,3145728
s_add_u32 m0,s63,139264
s_nop 0
buffer_load_dwordx4 v12,s[84:87],s60 offen lds
s_add_u32 s60,s62,3178496
s_add_u32 m0,s63,140288
s_nop 0
buffer_load_dwordx4 v12,s[84:87],s60 offen lds
s_add_u32 s60,s62,3211264
s_add_u32 m0,s63,141312
s_nop 0
buffer_load_dwordx4 v13,s[84:87],s60 offen lds
s_add_u32 s60,s62,3244032
s_add_u32 m0,s63,142336
s_nop 0
buffer_load_dwordx4 v13,s[84:87],s60 offen lds
v_add_u32 v10,40960,v14
ds_read_b64_tr_b16 a[168:169],v10
ds_read_b64_tr_b16 a[170:171],v10 offset:1024
ds_read_b64_tr_b16 a[172:173],v10 offset:8192
ds_read_b64_tr_b16 a[174:175],v10 offset:9216
v_add_u32 v11,40960,v15
ds_read_b64_tr_b16 a[240:241],v11
ds_read_b64_tr_b16 a[242:243],v11 offset:1024
ds_read_b64_tr_b16 a[244:245],v11 offset:8192
ds_read_b64_tr_b16 a[246:247],v11 offset:9216
s_waitcnt vmcnt(8) lgkmcnt(0)
s_barrier
s_add_u32 s60,s62,3670016
s_add_u32 m0,s63,40960
s_nop 0
buffer_load_dwordx4 v12,s[84:87],s60 offen lds
s_add_u32 s60,s62,3702784
s_add_u32 m0,s63,41984
s_nop 0
buffer_load_dwordx4 v12,s[84:87],s60 offen lds
s_add_u32 s60,s62,3735552
s_add_u32 m0,s63,43008
s_nop 0
buffer_load_dwordx4 v13,s[84:87],s60 offen lds
s_add_u32 s60,s62,3768320
s_add_u32 m0,s63,44032
s_nop 0
buffer_load_dwordx4 v13,s[84:87],s60 offen lds
v_add_u32 v10,106496,v14
ds_read_b64_tr_b16 a[176:177],v10
ds_read_b64_tr_b16 a[178:179],v10 offset:1024
ds_read_b64_tr_b16 a[180:181],v10 offset:8192
ds_read_b64_tr_b16 a[182:183],v10 offset:9216
v_add_u32 v11,106496,v15
ds_read_b64_tr_b16 a[248:249],v11
ds_read_b64_tr_b16 a[250:251],v11 offset:1024
ds_read_b64_tr_b16 a[252:253],v11 offset:8192
ds_read_b64_tr_b16 a[254:255],v11 offset:9216
s_waitcnt vmcnt(8) lgkmcnt(0)
s_barrier
s_add_u32 s60,s62,4194304
s_add_u32 m0,s63,106496
s_nop 0
buffer_load_dwordx4 v12,s[84:87],s60 offen lds
s_add_u32 s60,s62,4227072
s_add_u32 m0,s63,107520
s_nop 0
buffer_load_dwordx4 v12,s[84:87],s60 offen lds
s_add_u32 s60,s62,4259840
s_add_u32 m0,s63,108544
s_nop 0
buffer_load_dwordx4 v13,s[84:87],s60 offen lds
s_add_u32 s60,s62,4292608
s_add_u32 m0,s63,109568
s_nop 0
buffer_load_dwordx4 v13,s[84:87],s60 offen lds
v_add_u32 v10,122880,v14
ds_read_b64_tr_b16 a[184:185],v10
ds_read_b64_tr_b16 a[186:187],v10 offset:1024
ds_read_b64_tr_b16 a[188:189],v10 offset:8192
ds_read_b64_tr_b16 a[190:191],v10 offset:9216
v_add_u32 v11,122880,v15
ds_read_b64_tr_b16 v[80:81],v11
ds_read_b64_tr_b16 v[82:83],v11 offset:1024
ds_read_b64_tr_b16 v[84:85],v11 offset:8192
ds_read_b64_tr_b16 v[86:87],v11 offset:9216
s_waitcnt vmcnt(8) lgkmcnt(0)
s_barrier
v_add_u32 v10,139264,v14
ds_read_b64_tr_b16 a[192:193],v10
ds_read_b64_tr_b16 a[194:195],v10 offset:1024
ds_read_b64_tr_b16 a[196:197],v10 offset:8192
ds_read_b64_tr_b16 a[198:199],v10 offset:9216
v_add_u32 v11,139264,v15
ds_read_b64_tr_b16 v[88:89],v11
ds_read_b64_tr_b16 v[90:91],v11 offset:1024
ds_read_b64_tr_b16 v[92:93],v11 offset:8192
ds_read_b64_tr_b16 v[94:95],v11 offset:9216
s_waitcnt vmcnt(4) lgkmcnt(0)
s_barrier
v_add_u32 v10,40960,v14
ds_read_b64_tr_b16 a[200:201],v10
ds_read_b64_tr_b16 a[202:203],v10 offset:1024
ds_read_b64_tr_b16 a[204:205],v10 offset:8192
ds_read_b64_tr_b16 a[206:207],v10 offset:9216
v_add_u32 v11,40960,v15
ds_read_b64_tr_b16 v[96:97],v11
ds_read_b64_tr_b16 v[98:99],v11 offset:1024
ds_read_b64_tr_b16 v[100:101],v11 offset:8192
ds_read_b64_tr_b16 v[102:103],v11 offset:9216
s_waitcnt vmcnt(0) lgkmcnt(0)
s_barrier
v_add_u32 v10,106496,v14
ds_read_b64_tr_b16 a[208:209],v10
ds_read_b64_tr_b16 a[210:211],v10 offset:1024
ds_read_b64_tr_b16 a[212:213],v10 offset:8192
ds_read_b64_tr_b16 a[214:215],v10 offset:9216
v_add_u32 v11,106496,v15
ds_read_b64_tr_b16 v[104:105],v11
ds_read_b64_tr_b16 v[106:107],v11 offset:1024
ds_read_b64_tr_b16 v[108:109],v11 offset:8192
ds_read_b64_tr_b16 v[110:111],v11 offset:9216
s_waitcnt lgkmcnt(0)
s_barrier
s_cmp_lg_u32 s19,0
s_cbranch_scc1 ver_29
s_mov_b32 s19,1
v_mbcnt_lo_u32_b32 v18,-1,0
v_mbcnt_hi_u32_b32 v18,-1,v18
v_lshlrev_b32 v12,2,v18
s_mov_b32 s63,0
el_30:
global_load_dword v13,v12,s[4:5] sc1
s_add_u32 s63,s63,1
s_cmp_gt_u32 s63,4000000
s_cbranch_scc1 w_fail
s_waitcnt vmcnt(0)
el_30s:
v_bfe_u32 v14,v13,0,8
v_bfe_u32 v15,v13,8,8
v_bfe_u32 v16,v13,16,8
v_bfe_u32 v17,v13,24,8
v_min_u32 v13,v14,v15
v_min3_u32 v13,v13,v16,v17
v_cmp_eq_u32 vcc,0,v13
s_cbranch_vccnz el_30
s_mov_b32 s62,0
elw_31:
s_add_u32 s62,s62,1
s_mov_b32 s61,0
v_cmp_eq_u32 vcc,s62,v14
s_bcnt1_i32_b64 s60,vcc
s_add_u32 s61,s61,s60
v_cmp_eq_u32 vcc,s62,v15
s_bcnt1_i32_b64 s60,vcc
s_add_u32 s61,s61,s60
v_cmp_eq_u32 vcc,s62,v16
s_bcnt1_i32_b64 s60,vcc
s_add_u32 s61,s61,s60
v_cmp_eq_u32 vcc,s62,v17
s_bcnt1_i32_b64 s60,vcc
s_add_u32 s61,s61,s60
s_cmp_ge_u32 s62,16
s_cbranch_scc1 w_fail
s_cmp_lt_u32 s61,32
s_cbranch_scc1 elw_31
s_mov_b32 s61,0
s_mov_b32 s63,0
v_cmp_gt_u32 vcc,s3,v14
s_bcnt1_i32_b64 s60,vcc
s_add_u32 s63,s63,s60
v_add_u32_e64 v13,0,v12
v_cmp_gt_u32 s[16:17],s2,v13
v_cmp_eq_u32 vcc,s3,v14
s_and_b64 vcc,vcc,s[16:17]
s_bcnt1_i32_b64 s60,vcc
s_add_u32 s61,s61,s60
v_cmp_gt_u32 vcc,s3,v15
s_bcnt1_i32_b64 s60,vcc
s_add_u32 s63,s63,s60
v_add_u32 v13,1,v12
v_cmp_gt_u32 s[16:17],s2,v13
v_cmp_eq_u32 vcc,s3,v15
s_and_b64 vcc,vcc,s[16:17]
s_bcnt1_i32_b64 s60,vcc
s_add_u32 s61,s61,s60
v_cmp_gt_u32 vcc,s3,v16
s_bcnt1_i32_b64 s60,vcc
s_add_u32 s63,s63,s60
v_add_u32 v13,2,v12
v_cmp_gt_u32 s[16:17],s2,v13
v_cmp_eq_u32 vcc,s3,v16
s_and_b64 vcc,vcc,s[16:17]
s_bcnt1_i32_b64 s60,vcc
s_add_u32 s61,s61,s60
v_cmp_gt_u32 vcc,s3,v17
s_bcnt1_i32_b64 s60,vcc
s_add_u32 s63,s63,s60
v_add_u32 v13,3,v12
v_cmp_gt_u32 s[16:17],s2,v13
v_cmp_eq_u32 vcc,s3,v17
s_and_b64 vcc,vcc,s[16:17]
s_bcnt1_i32_b64 s60,vcc
s_add_u32 s61,s61,s60
s_add_u32 s18,s61,s63
s_cmp_gt_u32 s62,s3
s_cselect_b32 s60,32,0
s_add_u32 s18,s18,s60
s_cmp_lg_u32 s62,s3
s_cbranch_scc1 eld_32
s_cmp_lt_u32 s61,32
s_cselect_b32 s18,s61,s18
eld_32:
s_sub_u32 s60,255,s24
s_cmp_eq_u32 s60,s18
s_cbranch_scc1 ver_29
s_mov_b32 s24,s18
s_mov_b32 s10,268435456
s_waitcnt vmcnt(0) lgkmcnt(0)
s_branch k_role
ver_29:
s_cmp_lg_u32 s24,223
s_cbranch_scc1 a2_go
s_mov_b32 s23,1
s_mul_i32 s60,s23,16777216
s_add_u32 s8,s6,s60
s_addc_u32 s9,s7,0
s_mov_b32 s10,23068672
s_mov_b32 s61,63
s_branch w_bwo
a2_go:
v_and_b32 v10,15,v0
v_lshrrev_b32 v11,4,v0
v_and_b32 v12,13,v10
v_lshlrev_b32 v12,4,v12
v_bfe_u32 v13,v10,1,1
v_lshrrev_b32 v14,1,v11
v_lshl_add_u32 v12,v14,10,v12
v_and_b32 v14,1,v11
v_lshl_add_u32 v15,v14,8,v12
v_lshl_add_u32 v15,v13,3,v15
s_lshl_b32 s60,s21,11
v_add_u32 v2,s60,v15
v_lshl_add_u32 v14,v14,1,v13
v_lshl_add_u32 v14,v14,8,v12
s_and_b32 s60,s21,1
s_lshl_b32 s61,s60,5
v_add_u32 v3,s61,v14
s_lshl_b32 s61,s60,11
v_add_u32 v9,s61,v5
s_lshl_b32 s33,s21,10
v_add_u32 v4,s33,v5
v_lshlrev_b32_e64 v11,2,v11
s_mov_b32 s32,1040356334
s_mov_b32 s34,0x05040100
s_mov_b32 s35,0x07060302
s_cmp_ge_u32 s21,2
s_cselect_b64 s[48:49],-1,0
v_add_u32_e64 v12,0,v11
v_cmp_le_u32 s[40:41],v12,v10
v_add_u32 v12,1,v11
v_cmp_le_u32 s[42:43],v12,v10
v_add_u32 v12,2,v11
v_cmp_le_u32 s[44:45],v12,v10
v_add_u32_e64 v12,3,v11
v_cmp_le_u32 s[46:47],v12,v10
v_mov_b32 v12,0x3f803f80
v_mov_b32 v13,0x3f803f80
v_mov_b32 v14,0x3f803f80
v_mov_b32 v15,0x3f803f80
a2_layer:
s_mul_i32 s60,s23,16777216
s_add_u32 s8,s6,s60
s_addc_u32 s9,s7,0
s_mov_b32 s10,23068672
s_mov_b32 s26,0
s_lshl_b32 s27,s25,10
s_add_u32 s27,s27,6422528
v_mov_b32 v8,0x20000000
v_mov_b32 v7,0
v_cmp_lt_u32 vcc,1,v7
s_lshr_b32 s63,s21,1
s_add_u32 s63,s63,s26
s_cmp_ge_u32 s63,64
s_cbranch_scc1 a2r_34
s_bitcmp1_b64 vcc,s63
s_cbranch_scc1 a2r_34
s_lshr_b32 s63,s21,1
s_add_u32 s63,s63,s26
s_lshl_b32 s63,s63,4
s_add_u32 s63,s63,s27
v_min_u32 v10,0,v0
v_lshlrev_b32 v10,2,v10
s_branch wf_35_0f
wf_35_0:
s_sleep 4
wf_35_0f:
buffer_load_dword v11,v10,s[8:11],s63 offen sc1
s_add_u32 s38,s38,1
s_cmp_gt_u32 s38,3000000
s_cbranch_scc1 w_fail
s_waitcnt vmcnt(0)
v_cmp_gt_u32 vcc,2,v11
s_cbranch_vccnz wf_35_0
a2r_34:
s_lshr_b32 s60,s21,1
s_add_u32 s62,s60,58
s_lshl_b32 s60,s62,6
s_add_u32 s60,s60,s25
s_lshl_b32 s60,s60,1
s_and_b32 s61,s21,1
s_add_u32 s60,s60,s61
s_lshl_b32 s31,s60,11
s_add_u32 s31,s31,94371840
s_cmp_lt_u32 s62,64
s_cselect_b32 s31,s31,1073741824
s_add_u32 s36,s31,131072
v_mov_b32 v40,-1
v_mov_b32 v41,-1
v_mov_b32 v42,-1
v_mov_b32_e64 v43,-1
buffer_store_dwordx4 v[40:43],v5,s[88:91],s31 offen sc1
buffer_store_dwordx4 v[40:43],v5,s[88:91],s31 offen offset:1024 sc1
buffer_store_dwordx4 v[40:43],v5,s[88:91],s36 offen sc1
buffer_store_dwordx4 v[40:43],v5,s[88:91],s36 offen offset:1024 sc1
s_lshr_b32 s60,s21,1
s_add_u32 s62,s60,60
s_lshl_b32 s60,s62,6
s_add_u32 s60,s60,s25
s_lshl_b32 s60,s60,1
s_and_b32 s61,s21,1
s_add_u32 s60,s60,s61
s_lshl_b32 s31,s60,11
s_add_u32 s31,s31,94371840
s_cmp_lt_u32 s62,64
s_cselect_b32 s31,s31,1073741824
s_add_u32 s36,s31,131072
v_mov_b32 v40,-1
v_mov_b32 v41,-1
v_mov_b32 v42,-1
v_mov_b32 v43,-1
buffer_store_dwordx4 v[40:43],v5,s[88:91],s31 offen sc1
buffer_store_dwordx4 v[40:43],v5,s[88:91],s31 offen offset:1024 sc1
buffer_store_dwordx4 v[40:43],v5,s[88:91],s36 offen sc1
buffer_store_dwordx4 v[40:43],v5,s[88:91],s36 offen offset:1024 sc1
s_lshr_b32 s60,s21,1
s_add_u32 s62,s60,62
s_lshl_b32 s60,s62,6
s_add_u32 s60,s60,s25
s_lshl_b32 s60,s60,1
s_and_b32 s61,s21,1
s_add_u32 s60,s60,s61
s_lshl_b32 s31,s60,11
s_add_u32 s31,s31,94371840
s_cmp_lt_u32 s62,64
s_cselect_b32 s31,s31,1073741824
s_add_u32 s36,s31,131072
v_mov_b32 v40,-1
v_mov_b32 v41,-1
v_mov_b32 v42,-1
v_mov_b32 v43,-1
buffer_store_dwordx4 v[40:43],v5,s[88:91],s31 offen sc1
buffer_store_dwordx4 v[40:43],v5,s[88:91],s31 offen offset:1024 sc1
buffer_store_dwordx4 v[40:43],v5,s[88:91],s36 offen sc1
buffer_store_dwordx4 v[40:43],v5,s[88:91],s36 offen offset:1024 sc1
s_lshr_b32 s61,s21,1
s_add_u32 s61,s61,s26
s_mul_i32 s60,s25,65
s_add_u32 s60,s60,s61
s_lshl_b32 s28,s60,14
s_add_u32 s28,s28,41943040
s_lshl_b32 s29,s60,13
s_add_u32 s29,s29,76546048
s_cmp_lt_u32 s61,64
s_cselect_b32 s28,s28,1073741824
s_cselect_b32 s29,s29,1073741824
s_add_u32 s53,s29,4096
s_add_u32 s51,s28,4096
s_and_b32 s62,s21,1
s_lshl_b32 s62,s62,12
s_add_u32 s62,s62,s28
s_add_u32 s52,s62,8192
buffer_load_dwordx4 v[144:147],v6,s[88:91],s28 offen sc1
buffer_load_dwordx4 v[148:151],v6,s[88:91],s28 offen offset:512 sc1
buffer_load_dwordx4 v[152:155],v6,s[88:91],s28 offen offset:1024 sc1
buffer_load_dwordx4 v[156:159],v6,s[88:91],s28 offen offset:1536 sc1
buffer_load_dwordx4 v[160:163],v6,s[88:91],s51 offen sc1
buffer_load_dwordx4 v[164:167],v6,s[88:91],s51 offen offset:512 sc1
buffer_load_dwordx4 v[168:171],v6,s[88:91],s51 offen offset:1024 sc1
buffer_load_dwordx4 v[172:175],v6,s[88:91],s51 offen offset:1536 sc1
buffer_load_dwordx4 v[176:179],v5,s[88:91],s52 offen sc1
buffer_load_dwordx4 v[180:183],v5,s[88:91],s52 offen offset:1024 sc1
buffer_load_dwordx4 v[184:187],v5,s[88:91],s52 offen offset:2048 sc1
buffer_load_dwordx4 v[188:191],v5,s[88:91],s52 offen offset:3072 sc1
buffer_load_dwordx4 v[112:115],v5,s[88:91],s29 offen sc1
buffer_load_dwordx4 v[116:119],v5,s[88:91],s29 offen offset:1024 sc1
buffer_load_dwordx4 v[120:123],v5,s[88:91],s29 offen offset:2048 sc1
buffer_load_dwordx4 v[124:127],v5,s[88:91],s29 offen offset:3072 sc1
buffer_load_dwordx4 v[128:131],v5,s[88:91],s53 offen sc1
buffer_load_dwordx4 v[132:135],v5,s[88:91],s53 offen offset:1024 sc1
buffer_load_dwordx4 v[136:139],v5,s[88:91],s53 offen offset:2048 sc1
buffer_load_dwordx4 v[140:143],v5,s[88:91],s53 offen offset:3072 sc1
s_waitcnt vmcnt(0)
w_a2:
s_lshl_b32 s30,s26,14
s_add_u32 s30,s30,8388608
s_add_u32 s62,s30,16384
s_cmp_lt_u32 s26,64
s_cselect_b32 s60,s30,1073741824
s_cmp_eq_u32 s26,63
s_cselect_b32 s62,1073741824,s62
s_bitcmp1_b32 s21,0
s_cselect_b32 s36,s62,s60
s_add_u32 s36,s36,8192
s_add_u32 s60,s60,s33
s_add_u32 s62,s62,s33
s_add_u32 s61,s60,4096
s_add_u32 s63,s62,4096
buffer_load_dwordx4 v[232:235],v5,s[8:11],s60 offen sc1
buffer_load_dwordx4 v[236:239],v5,s[8:11],s61 offen sc1
buffer_load_dwordx4 v[240:243],v5,s[8:11],s62 offen sc1
buffer_load_dwordx4 v[244:247],v5,s[8:11],s63 offen sc1
buffer_load_dwordx4 v[248:251],v5,s[8:11],s36 offen sc1
buffer_load_dword v7,v5,s[8:11],s27 offen sc1
v_mov_b32 v228,0xf149f2ca
s_waitcnt vmcnt(10)
v_mfma_f32_16x16x32_bf16 v[208:211],v[144:147],v[112:115],0
v_mfma_f32_16x16x32_bf16 v[208:211],v[148:151],v[116:119],v[208:211]
v_mfma_f32_16x16x32_bf16 v[208:211],v[152:155],v[120:123],v[208:211]
v_mfma_f32_16x16x32_bf16 v[208:211],v[156:159],v[124:127],v[208:211]
v_mfma_f32_16x16x32_bf16 v[212:215],v[144:147],v[128:131],0
v_mfma_f32_16x16x32_bf16 v[212:215],v[148:151],v[132:135],v[212:215]
v_mfma_f32_16x16x32_bf16 v[212:215],v[152:155],v[136:139],v[212:215]
v_mfma_f32_16x16x32_bf16 v[212:215],v[156:159],v[140:143],v[212:215]
v_mfma_f32_16x16x32_bf16 v[216:219],v[160:163],v[128:131],0
v_mfma_f32_16x16x32_bf16 v[216:219],v[164:167],v[132:135],v[216:219]
v_mfma_f32_16x16x32_bf16 v[216:219],v[168:171],v[136:139],v[216:219]
v_mfma_f32_16x16x32_bf16 v[216:219],v[172:175],v[140:143],v[216:219]
v_cndmask_b32 v208,v228,v208,s[40:41]
v_cndmask_b32 v209,v228,v209,s[42:43]
v_cndmask_b32 v210,v228,v210,s[44:45]
v_cndmask_b32 v211,v228,v211,s[46:47]
s_nop 2
v_cndmask_b32 v216,v228,v216,s[40:41]
v_cndmask_b32 v217,v228,v217,s[42:43]
v_cndmask_b32 v218,v228,v218,s[44:45]
v_cndmask_b32 v219,v228,v219,s[46:47]
s_waitcnt vmcnt(6)
s_barrier
s_sub_u32 s50,s26,2
v_add_u32 v10,s50,v0
v_cmp_gt_u32 vcc,64,v10
v_lshlrev_b32 v10,12,v10
v_mov_b32 v11,1
s_lshl_b32 s50,s25,7
s_add_u32 s50,s50,20971520
s_cmp_eq_u32 s21,0
s_cselect_b32 s50,s50,1073741824
v_cndmask_b32 v10,v8,v10,vcc
s_mov_b64 exec,3
buffer_store_dword v11,v10,s[8:11],s50 offen sc1
s_mov_b64 exec,-1
s_waitcnt vmcnt(1)
s_branch a2poll_37c
a2poll_37:
s_sleep 1
buffer_load_dwordx4 v[232:235],v5,s[8:11],s60 offen sc1
buffer_load_dwordx4 v[236:239],v5,s[8:11],s61 offen sc1
buffer_load_dwordx4 v[240:243],v5,s[8:11],s62 offen sc1
buffer_load_dwordx4 v[244:247],v5,s[8:11],s63 offen sc1
buffer_load_dwordx4 v[248:251],v5,s[8:11],s36 offen sc1
s_add_u32 s38,s38,1
s_cmp_gt_u32 s38,3000000
s_cbranch_scc1 w_fail
s_waitcnt vmcnt(0)
a2poll_37c:
v_max3_u32 v228,v232,v236,v240
v_max3_u32 v228,v228,v244,v248
v_cmp_eq_u32 vcc,-1,v228
s_cbranch_vccnz a2poll_37
v_perm_b32 v72,v233,v232,s34
v_perm_b32 v73,v235,v234,s34
v_perm_b32 v74,v233,v232,s35
v_perm_b32 v75,v235,v234,s35
ds_write_b64 v2,v[72:73]
ds_write_b64 v2,v[74:75] offset:512
v_perm_b32 v76,v237,v236,s34
v_perm_b32 v77,v239,v238,s34
v_perm_b32 v78,v237,v236,s35
v_perm_b32 v79,v239,v238,s35
ds_write_b64 v2,v[76:77] offset:8192
ds_write_b64 v2,v[78:79] offset:8704
v_perm_b32 v72,v241,v240,s34
v_perm_b32 v73,v243,v242,s34
v_perm_b32 v74,v241,v240,s35
v_perm_b32 v75,v243,v242,s35
ds_write_b64 v2,v[72:73] offset:32
ds_write_b64 v2,v[74:75] offset:544
v_perm_b32 v76,v245,v244,s34
v_perm_b32 v77,v247,v246,s34
v_perm_b32 v78,v245,v244,s35
v_perm_b32 v79,v247,v246,s35
ds_write_b64 v2,v[76:77] offset:8224
ds_write_b64 v2,v[78:79] offset:8736
ds_write_b128 v3,v[248:251] offset:16384
s_add_u32 s50,s26,2
v_cmp_lt_u32 vcc,1,v7
s_lshr_b32 s63,s21,1
s_add_u32 s63,s63,s50
s_cmp_ge_u32 s63,64
s_cbranch_scc1 a2r_38
s_bitcmp1_b64 vcc,s63
s_cbranch_scc1 a2r_38
s_lshr_b32 s63,s21,1
s_add_u32 s63,s63,s50
s_lshl_b32 s63,s63,4
s_add_u32 s63,s63,s27
v_min_u32 v10,0,v0
v_lshlrev_b32 v10,2,v10
s_branch wf_39_0f
wf_39_0:
s_sleep 4
wf_39_0f:
buffer_load_dword v11,v10,s[8:11],s63 offen sc1
s_add_u32 s38,s38,1
s_cmp_gt_u32 s38,3000000
s_cbranch_scc1 w_fail
s_waitcnt vmcnt(0)
v_cmp_gt_u32 vcc,2,v11
s_cbranch_vccnz wf_39_0
a2r_38:
s_lshr_b32 s61,s21,1
s_add_u32 s61,s61,s50
s_mul_i32 s60,s25,65
s_add_u32 s60,s60,s61
s_lshl_b32 s28,s60,14
s_add_u32 s28,s28,41943040
s_lshl_b32 s29,s60,13
s_add_u32 s29,s29,76546048
s_cmp_lt_u32 s61,64
s_cselect_b32 s28,s28,1073741824
s_cselect_b32 s29,s29,1073741824
s_add_u32 s53,s29,4096
s_add_u32 s51,s28,4096
s_and_b32 s62,s21,1
s_lshl_b32 s62,s62,12
s_add_u32 s62,s62,s28
s_add_u32 s52,s62,8192
s_waitcnt lgkmcnt(0)
s_barrier
ds_read_b128 v[32:35],v5
ds_read_b128 v[36:39],v5 offset:1024
s_waitcnt lgkmcnt(1)
v_mfma_f32_16x16x32_bf16 v[16:19],a[0:3],v[32:35],0
ds_read_b128 v[40:43],v5 offset:2048
v_mfma_f32_16x16x32_bf16 v[20:23],a[72:75],v[32:35],0
v_mfma_f32_16x16x32_bf16 v[24:27],v[32:35],a[144:147],0
buffer_load_dwordx4 v[144:147],v6,s[88:91],s28 offen sc1
v_mfma_f32_16x16x32_bf16 v[28:31],v[32:35],a[216:219],0
s_waitcnt lgkmcnt(1)
v_mfma_f32_16x16x32_bf16 v[16:19],a[4:7],v[36:39],v[16:19]
ds_read_b128 v[32:35],v5 offset:3072
v_mfma_f32_16x16x32_bf16 v[20:23],a[76:79],v[36:39],v[20:23]
v_mfma_f32_16x16x32_bf16 v[24:27],v[36:39],a[148:151],v[24:27]
buffer_load_dwordx4 v[148:151],v6,s[88:91],s28 offen offset:512 sc1
v_mfma_f32_16x16x32_bf16 v[28:31],v[36:39],a[220:223],v[28:31]
s_waitcnt lgkmcnt(1)
v_mfma_f32_16x16x32_bf16 v[16:19],a[8:11],v[40:43],v[16:19]
ds_read_b128 v[36:39],v5 offset:4096
v_mfma_f32_16x16x32_bf16 v[20:23],a[80:83],v[40:43],v[20:23]
v_mfma_f32_16x16x32_bf16 v[24:27],v[40:43],a[152:155],v[24:27]
v_mfma_f32_16x16x32_bf16 v[28:31],v[40:43],a[224:227],v[28:31]
s_waitcnt lgkmcnt(1)
v_mfma_f32_16x16x32_bf16 v[16:19],a[12:15],v[32:35],v[16:19]
ds_read_b128 v[40:43],v5 offset:5120
v_mfma_f32_16x16x32_bf16 v[20:23],a[84:87],v[32:35],v[20:23]
v_mfma_f32_16x16x32_bf16 v[24:27],v[32:35],a[156:159],v[24:27]
buffer_load_dwordx4 v[152:155],v6,s[88:91],s28 offen offset:1024 sc1
v_mfma_f32_16x16x32_bf16 v[28:31],v[32:35],a[228:231],v[28:31]
s_waitcnt lgkmcnt(1)
v_mfma_f32_16x16x32_bf16 v[16:19],a[16:19],v[36:39],v[16:19]
ds_read_b128 v[32:35],v5 offset:6144
v_mfma_f32_16x16x32_bf16 v[20:23],a[88:91],v[36:39],v[20:23]
v_mfma_f32_16x16x32_bf16 v[24:27],v[36:39],a[160:163],v[24:27]
buffer_load_dwordx4 v[156:159],v6,s[88:91],s28 offen offset:1536 sc1
v_mfma_f32_16x16x32_bf16 v[28:31],v[36:39],a[232:235],v[28:31]
s_waitcnt lgkmcnt(1)
v_mfma_f32_16x16x32_bf16 v[16:19],a[20:23],v[40:43],v[16:19]
ds_read_b128 v[36:39],v5 offset:7168
v_mfma_f32_16x16x32_bf16 v[20:23],a[92:95],v[40:43],v[20:23]
v_mfma_f32_16x16x32_bf16 v[24:27],v[40:43],a[164:167],v[24:27]
v_mfma_f32_16x16x32_bf16 v[28:31],v[40:43],a[236:239],v[28:31]
s_waitcnt lgkmcnt(1)
v_mfma_f32_16x16x32_bf16 v[16:19],a[24:27],v[32:35],v[16:19]
ds_read_b128 v[40:43],v5 offset:8192
v_mfma_f32_16x16x32_bf16 v[20:23],a[96:99],v[32:35],v[20:23]
v_mfma_f32_16x16x32_bf16 v[24:27],v[32:35],a[168:171],v[24:27]
buffer_load_dwordx4 v[160:163],v6,s[88:91],s51 offen sc1
v_mfma_f32_16x16x32_bf16 v[28:31],v[32:35],a[240:243],v[28:31]
s_waitcnt lgkmcnt(1)
v_mfma_f32_16x16x32_bf16 v[16:19],a[28:31],v[36:39],v[16:19]
ds_read_b128 v[32:35],v5 offset:9216
v_mfma_f32_16x16x32_bf16 v[20:23],a[100:103],v[36:39],v[20:23]
v_mfma_f32_16x16x32_bf16 v[24:27],v[36:39],a[172:175],v[24:27]
buffer_load_dwordx4 v[164:167],v6,s[88:91],s51 offen offset:512 sc1
v_mfma_f32_16x16x32_bf16 v[28:31],v[36:39],a[244:247],v[28:31]
s_waitcnt lgkmcnt(1)
v_mfma_f32_16x16x32_bf16 v[16:19],a[32:35],v[40:43],v[16:19]
ds_read_b128 v[36:39],v5 offset:10240
v_mfma_f32_16x16x32_bf16 v[20:23],a[104:107],v[40:43],v[20:23]
v_mfma_f32_16x16x32_bf16 v[24:27],v[40:43],a[176:179],v[24:27]
v_mfma_f32_16x16x32_bf16 v[28:31],v[40:43],a[248:251],v[28:31]
s_waitcnt lgkmcnt(1)
v_mfma_f32_16x16x32_bf16 v[16:19],a[36:39],v[32:35],v[16:19]
ds_read_b128 v[40:43],v5 offset:11264
v_mfma_f32_16x16x32_bf16 v[20:23],a[108:111],v[32:35],v[20:23]
v_mfma_f32_16x16x32_bf16 v[24:27],v[32:35],a[180:183],v[24:27]
buffer_load_dwordx4 v[168:171],v6,s[88:91],s51 offen offset:1024 sc1
v_mfma_f32_16x16x32_bf16 v[28:31],v[32:35],a[252:255],v[28:31]
s_waitcnt lgkmcnt(1)
v_mfma_f32_16x16x32_bf16 v[16:19],a[40:43],v[36:39],v[16:19]
ds_read_b128 v[32:35],v5 offset:12288
v_mfma_f32_16x16x32_bf16 v[20:23],a[112:115],v[36:39],v[20:23]
v_mfma_f32_16x16x32_bf16 v[24:27],v[36:39],a[184:187],v[24:27]
buffer_load_dwordx4 v[172:175],v6,s[88:91],s51 offen offset:1536 sc1
v_mfma_f32_16x16x32_bf16 v[28:31],v[36:39],v[80:83],v[28:31]
s_waitcnt lgkmcnt(1)
v_mfma_f32_16x16x32_bf16 v[16:19],a[44:47],v[40:43],v[16:19]
ds_read_b128 v[36:39],v5 offset:13312
v_mfma_f32_16x16x32_bf16 v[20:23],a[116:119],v[40:43],v[20:23]
v_mfma_f32_16x16x32_bf16 v[24:27],v[40:43],a[188:191],v[24:27]
v_mfma_f32_16x16x32_bf16 v[28:31],v[40:43],v[84:87],v[28:31]
s_waitcnt lgkmcnt(1)
v_mfma_f32_16x16x32_bf16 v[16:19],a[48:51],v[32:35],v[16:19]
ds_read_b128 v[40:43],v5 offset:14336
v_mfma_f32_16x16x32_bf16 v[20:23],a[120:123],v[32:35],v[20:23]
v_mfma_f32_16x16x32_bf16 v[24:27],v[32:35],a[192:195],v[24:27]
buffer_load_dwordx4 v[192:195],v5,s[88:91],s52 offen sc1
v_mfma_f32_16x16x32_bf16 v[28:31],v[32:35],v[88:91],v[28:31]
s_waitcnt lgkmcnt(1)
v_mfma_f32_16x16x32_bf16 v[16:19],a[52:55],v[36:39],v[16:19]
ds_read_b128 v[32:35],v5 offset:15360
v_mfma_f32_16x16x32_bf16 v[20:23],a[124:127],v[36:39],v[20:23]
v_mfma_f32_16x16x32_bf16 v[24:27],v[36:39],a[196:199],v[24:27]
buffer_load_dwordx4 v[196:199],v5,s[88:91],s52 offen offset:1024 sc1
v_mfma_f32_16x16x32_bf16 v[28:31],v[36:39],v[92:95],v[28:31]
s_waitcnt lgkmcnt(1)
v_mfma_f32_16x16x32_bf16 v[16:19],a[56:59],v[40:43],v[16:19]
ds_read_b128 v[36:39],v5 offset:16384
v_mfma_f32_16x16x32_bf16 v[20:23],a[128:131],v[40:43],v[20:23]
v_mfma_f32_16x16x32_bf16 v[24:27],v[40:43],a[200:203],v[24:27]
v_mfma_f32_16x16x32_bf16 v[28:31],v[40:43],v[96:99],v[28:31]
s_waitcnt lgkmcnt(1)
v_mfma_f32_16x16x32_bf16 v[16:19],a[60:63],v[32:35],v[16:19]
ds_read_b128 v[40:43],v5 offset:17408
v_mfma_f32_16x16x32_bf16 v[20:23],a[132:135],v[32:35],v[20:23]
v_mfma_f32_16x16x32_bf16 v[24:27],v[32:35],a[204:207],v[24:27]
buffer_load_dwordx4 v[200:203],v5,s[88:91],s52 offen offset:2048 sc1
v_mfma_f32_16x16x32_bf16 v[28:31],v[32:35],v[100:103],v[28:31]
s_waitcnt lgkmcnt(1)
v_mfma_f32_16x16x32_bf16 v[16:19],a[64:67],v[36:39],v[16:19]
v_mfma_f32_16x16x32_bf16 v[20:23],a[136:139],v[36:39],v[20:23]
v_mfma_f32_16x16x32_bf16 v[24:27],v[36:39],a[208:211],v[24:27]
buffer_load_dwordx4 v[204:207],v5,s[88:91],s52 offen offset:3072 sc1
v_mfma_f32_16x16x32_bf16 v[28:31],v[36:39],v[104:107],v[28:31]
s_waitcnt lgkmcnt(0)
v_mfma_f32_16x16x32_bf16 v[16:19],a[68:71],v[40:43],v[16:19]
v_mfma_f32_16x16x32_bf16 v[20:23],a[140:143],v[40:43],v[20:23]
v_mfma_f32_16x16x32_bf16 v[24:27],v[40:43],a[212:215],v[24:27]
v_mfma_f32_16x16x32_bf16 v[28:31],v[40:43],v[108:111],v[28:31]
v_cvt_pk_bf16_f32 v16,v16,v17
v_cvt_pk_bf16_f32 v17,v18,v19
v_cvt_pk_bf16_f32 v18,v20,v21
v_cvt_pk_bf16_f32 v19,v22,v23
ds_write_b128 v4,v[16:19] offset:18432
v_cvt_pk_bf16_f32 v24,v24,v25
v_cvt_pk_bf16_f32 v25,v26,v27
v_cvt_pk_bf16_f32 v26,v28,v29
v_cvt_pk_bf16_f32 v27,v30,v31
ds_write_b128 v4,v[24:27] offset:22528
v_mov_b32 v234,0
v_mov_b32 v235,0
s_waitcnt lgkmcnt(0)
s_barrier
ds_read_b128 v[16:19],v5 offset:18432
ds_read_b128 v[20:23],v5 offset:19456
ds_read_b128 v[24:27],v5 offset:20480
ds_read_b128 v[28:31],v5 offset:21504
ds_read_b128 v[32:35],v9 offset:22528
ds_read_b128 v[36:39],v9 offset:23552
s_waitcnt lgkmcnt(5)
v_mfma_f32_16x16x32_bf16 v[220:223],v[16:19],v[112:115],0
v_mfma_f32_16x16x32_bf16 v[224:227],v[16:19],v[128:131],0
s_waitcnt lgkmcnt(4)
v_mfma_f32_16x16x32_bf16 v[220:223],v[20:23],v[116:119],v[220:223]
v_mfma_f32_16x16x32_bf16 v[224:227],v[20:23],v[132:135],v[224:227]
s_waitcnt lgkmcnt(3)
v_mfma_f32_16x16x32_bf16 v[220:223],v[24:27],v[120:123],v[220:223]
v_mfma_f32_16x16x32_bf16 v[224:227],v[24:27],v[136:139],v[224:227]
s_waitcnt lgkmcnt(2)
v_mfma_f32_16x16x32_bf16 v[220:223],v[28:31],v[124:127],v[220:223]
v_mfma_f32_16x16x32_bf16 v[224:227],v[28:31],v[140:143],v[224:227]
s_lshr_b32 s60,s21,1
s_add_u32 s62,s60,s26
s_lshl_b32 s60,s62,6
s_add_u32 s60,s60,s25
s_lshl_b32 s60,s60,1
s_and_b32 s61,s21,1
s_add_u32 s60,s60,s61
s_lshl_b32 s31,s60,11
s_add_u32 s31,s31,94371840
s_cmp_lt_u32 s62,64
s_cselect_b32 s31,s31,1073741824
buffer_load_dwordx4 v[112:115],v5,s[88:91],s29 offen sc1
v_cndmask_b32 v220,v220,v222,s[48:49]
v_cndmask_b32 v221,v221,v223,s[48:49]
v_cndmask_b32 v224,v224,v226,s[48:49]
v_cndmask_b32 v225,v225,v227,s[48:49]
v_max_f32_e64 v228,v208,v209
v_max3_f32 v228,v228,v210,v211
v_max3_f32 v228,v228,v220,v221
v_max_f32_e64 v230,v212,v213
v_max3_f32 v230,v230,v214,v215
v_max3_f32 v230,v230,v216,v217
v_max3_f32 v230,v230,v218,v219
v_max3_f32 v230,v230,v224,v225
v_mov_b32 v229,v228
v_mov_b32 v231,v230
buffer_load_dwordx4 v[116:119],v5,s[88:91],s29 offen offset:1024 sc1
v_permlane16_swap_b32 v228,v229
v_permlane16_swap_b32 v230,v231
v_max_f32 v228,v228,v229
v_max_f32 v230,v230,v231
v_mov_b32 v229,v228
v_mov_b32 v231,v230
buffer_load_dwordx4 v[120:123],v5,s[88:91],s29 offen offset:2048 sc1
v_permlane32_swap_b32 v228,v229
v_permlane32_swap_b32 v230,v231
v_max_f32 v228,v228,v229
v_max_f32 v230,v230,v231
v_mul_f32_e64 v228,s32,v228
v_fma_f32 v208,v208,s32,-v228
v_fma_f32 v209,v209,s32,-v228
v_fma_f32 v210,v210,s32,-v228
v_fma_f32 v211,v211,s32,-v228
v_fma_f32 v220,v220,s32,-v228
v_fma_f32 v221,v221,s32,-v228
v_exp_f32 v208,v208
v_exp_f32 v209,v209
v_exp_f32 v210,v210
v_exp_f32 v211,v211
v_exp_f32 v220,v220
v_exp_f32 v221,v221
v_cvt_pk_bf16_f32 v232,v208,v209
v_cvt_pk_bf16_f32 v233,v210,v211
v_cvt_pk_bf16_f32 v228,v220,v221
v_cndmask_b32 v240,v228,0,s[48:49]
v_cndmask_b32 v241,0,v228,s[48:49]
s_add_u32 s36,s31,131072
s_waitcnt lgkmcnt(0)
v_mfma_f32_16x16x32_bf16 v[244:247],v[12:15],v[232:235],0
buffer_load_dwordx4 v[124:127],v5,s[88:91],s29 offen offset:3072 sc1
v_mul_f32 v230,s32,v230
v_fma_f32 v212,v212,s32,-v230
v_fma_f32 v213,v213,s32,-v230
v_mfma_f32_16x16x32_bf16 v[40:43],v[176:179],v[232:235],0
v_fma_f32 v214,v214,s32,-v230
v_fma_f32 v215,v215,s32,-v230
v_fma_f32 v216,v216,s32,-v230
v_mfma_f32_16x16x32_bf16 v[44:47],v[180:183],v[232:235],0
buffer_load_dwordx4 v[128:131],v5,s[88:91],s53 offen sc1
v_fma_f32 v217,v217,s32,-v230
v_fma_f32 v218,v218,s32,-v230
v_fma_f32 v219,v219,s32,-v230
v_mfma_f32_16x16x32_bf16 v[48:51],v[184:187],v[232:235],0
v_fma_f32 v224,v224,s32,-v230
v_fma_f32 v225,v225,s32,-v230
v_exp_f32_e64 v212,v212
v_mfma_f32_16x16x32_bf16 v[52:55],v[188:191],v[232:235],0
buffer_load_dwordx4 v[132:135],v5,s[88:91],s53 offen offset:1024 sc1
v_exp_f32 v213,v213
v_exp_f32 v214,v214
v_exp_f32_e64 v215,v215
v_mfma_f32_16x16x16_bf16 v[244:247],v[12:13],v[240:241],v[244:247]
v_exp_f32 v216,v216
v_exp_f32 v217,v217
v_exp_f32_e64 v218,v218
v_mfma_f32_16x16x16_bf16 v[40:43],v[32:33],v[240:241],v[40:43]
buffer_load_dwordx4 v[136:139],v5,s[88:91],s53 offen offset:2048 sc1
v_exp_f32 v219,v219
v_exp_f32 v224,v224
v_exp_f32_e64 v225,v225
v_mfma_f32_16x16x16_bf16 v[44:47],v[34:35],v[240:241],v[44:47]
v_cvt_pk_bf16_f32 v236,v212,v213
v_cvt_pk_bf16_f32 v237,v214,v215
v_cvt_pk_bf16_f32 v238,v216,v217
v_mfma_f32_16x16x16_bf16 v[48:51],v[36:37],v[240:241],v[48:51]
buffer_load_dwordx4 v[140:143],v5,s[88:91],s53 offen offset:3072 sc1
v_cvt_pk_bf16_f32 v239,v218,v219
v_cvt_pk_bf16_f32 v230,v224,v225
v_cndmask_b32 v242,v230,0,s[48:49]
v_mfma_f32_16x16x16_bf16 v[52:55],v[38:39],v[240:241],v[52:55]
v_cndmask_b32 v243,0,v230,s[48:49]
s_cmp_lt_u32 s26,58
s_cbranch_scc1 oe_41
s_sub_u32 s50,s26,0
v_add_u32 v10,s50,v0
v_cmp_gt_u32 vcc,64,v10
v_lshlrev_b32 v10,12,v10
v_mov_b32 v11,1
s_lshl_b32 s50,s25,7
s_add_u32 s50,s50,20971520
s_cmp_eq_u32 s21,0
s_cselect_b32 s50,s50,1073741824
v_cndmask_b32 v10,v8,v10,vcc
s_mov_b64 exec,3
buffer_store_dword v11,v10,s[8:11],s50 offen sc1
s_mov_b64 exec,-1
oe_41:
v_mfma_f32_16x16x32_bf16 v[248:251],v[12:15],v[236:239],0
v_rcp_f32 v228,v244
s_nop 0
v_mul_f32 v40,v40,v228
v_mul_f32 v41,v41,v228
v_mfma_f32_16x16x32_bf16 v[56:59],v[176:179],v[236:239],0
v_mul_f32 v42,v42,v228
v_mul_f32 v43,v43,v228
v_mul_f32 v44,v44,v228
v_mfma_f32_16x16x32_bf16 v[60:63],v[180:183],v[236:239],0
v_mul_f32 v45,v45,v228
v_mul_f32 v46,v46,v228
v_mul_f32_e64 v47,v47,v228
v_mfma_f32_16x16x32_bf16 v[64:67],v[184:187],v[236:239],0
v_cvt_pk_bf16_f32 v40,v40,v41
v_cvt_pk_bf16_f32 v41,v42,v43
v_cvt_pk_bf16_f32 v42,v44,v45
v_mfma_f32_16x16x32_bf16 v[68:71],v[188:191],v[236:239],0
v_cvt_pk_bf16_f32 v43,v46,v47
buffer_store_dwordx4 v[40:43],v5,s[88:91],s31 offen sc1
v_mul_f32 v48,v48,v228
v_mfma_f32_16x16x16_bf16 v[248:251],v[12:13],v[242:243],v[248:251]
v_mul_f32 v49,v49,v228
v_mul_f32 v50,v50,v228
v_mul_f32 v51,v51,v228
v_mfma_f32_16x16x16_bf16 v[56:59],v[32:33],v[242:243],v[56:59]
v_mul_f32 v52,v52,v228
v_mul_f32 v53,v53,v228
v_mul_f32_e64 v54,v54,v228
v_mfma_f32_16x16x16_bf16 v[60:63],v[34:35],v[242:243],v[60:63]
v_mul_f32_e64 v55,v55,v228
v_cvt_pk_bf16_f32 v48,v48,v49
v_cvt_pk_bf16_f32 v49,v50,v51
v_mfma_f32_16x16x16_bf16 v[64:67],v[36:37],v[242:243],v[64:67]
v_cvt_pk_bf16_f32 v50,v52,v53
v_cvt_pk_bf16_f32 v51,v54,v55
buffer_store_dwordx4 v[48:51],v5,s[88:91],s31 offen offset:1024 sc1
v_mfma_f32_16x16x16_bf16 v[68:71],v[38:39],v[242:243],v[68:71]
v_rcp_f32 v228,v248
s_nop 0
v_mul_f32 v56,v56,v228
v_mul_f32 v57,v57,v228
v_mul_f32 v58,v58,v228
v_mul_f32 v59,v59,v228
v_mul_f32 v60,v60,v228
v_mul_f32 v61,v61,v228
v_mul_f32 v62,v62,v228
v_mul_f32 v63,v63,v228
v_cvt_pk_bf16_f32 v56,v56,v57
v_cvt_pk_bf16_f32 v57,v58,v59
v_cvt_pk_bf16_f32 v58,v60,v61
v_cvt_pk_bf16_f32 v59,v62,v63
buffer_store_dwordx4 v[56:59],v5,s[88:91],s36 offen sc1
v_mul_f32 v64,v64,v228
v_mul_f32 v65,v65,v228
v_mul_f32 v66,v66,v228
v_mul_f32 v67,v67,v228
v_mul_f32 v68,v68,v228
v_mul_f32 v69,v69,v228
v_mul_f32 v70,v70,v228
v_mul_f32 v71,v71,v228
v_cvt_pk_bf16_f32 v64,v64,v65
v_cvt_pk_bf16_f32 v65,v66,v67
v_cvt_pk_bf16_f32 v66,v68,v69
v_cvt_pk_bf16_f32 v67,v70,v71
buffer_store_dwordx4 v[64:67],v5,s[88:91],s36 offen offset:1024 sc1
s_add_u32 s26,s26,2
s_lshl_b32 s30,s26,14
s_add_u32 s30,s30,8388608
s_add_u32 s62,s30,16384
s_cmp_lt_u32 s26,64
s_cselect_b32 s60,s30,1073741824
s_cmp_eq_u32 s26,63
s_cselect_b32 s62,1073741824,s62
s_bitcmp1_b32 s21,0
s_cselect_b32 s36,s62,s60
s_add_u32 s36,s36,8192
s_add_u32 s60,s60,s33
s_add_u32 s62,s62,s33
s_add_u32 s61,s60,4096
s_add_u32 s63,s62,4096
buffer_load_dwordx4 v[232:235],v5,s[8:11],s60 offen sc1
buffer_load_dwordx4 v[236:239],v5,s[8:11],s61 offen sc1
buffer_load_dwordx4 v[240:243],v5,s[8:11],s62 offen sc1
buffer_load_dwordx4 v[244:247],v5,s[8:11],s63 offen sc1
buffer_load_dwordx4 v[248:251],v5,s[8:11],s36 offen sc1
buffer_load_dword v7,v5,s[8:11],s27 offen sc1
v_mov_b32 v228,0xf149f2ca
s_waitcnt vmcnt(10)
v_mfma_f32_16x16x32_bf16 v[208:211],v[144:147],v[112:115],0
v_mfma_f32_16x16x32_bf16 v[208:211],v[148:151],v[116:119],v[208:211]
v_mfma_f32_16x16x32_bf16 v[208:211],v[152:155],v[120:123],v[208:211]
v_mfma_f32_16x16x32_bf16 v[208:211],v[156:159],v[124:127],v[208:211]
v_mfma_f32_16x16x32_bf16 v[212:215],v[144:147],v[128:131],0
v_mfma_f32_16x16x32_bf16 v[212:215],v[148:151],v[132:135],v[212:215]
v_mfma_f32_16x16x32_bf16 v[212:215],v[152:155],v[136:139],v[212:215]
v_mfma_f32_16x16x32_bf16 v[212:215],v[156:159],v[140:143],v[212:215]
v_mfma_f32_16x16x32_bf16 v[216:219],v[160:163],v[128:131],0
v_mfma_f32_16x16x32_bf16 v[216:219],v[164:167],v[132:135],v[216:219]
v_mfma_f32_16x16x32_bf16 v[216:219],v[168:171],v[136:139],v[216:219]
v_mfma_f32_16x16x32_bf16 v[216:219],v[172:175],v[140:143],v[216:219]
v_cndmask_b32 v208,v228,v208,s[40:41]
v_cndmask_b32 v209,v228,v209,s[42:43]
v_cndmask_b32 v210,v228,v210,s[44:45]
v_cndmask_b32 v211,v228,v211,s[46:47]
s_nop 2
v_cndmask_b32 v216,v228,v216,s[40:41]
v_cndmask_b32 v217,v228,v217,s[42:43]
v_cndmask_b32 v218,v228,v218,s[44:45]
v_cndmask_b32 v219,v228,v219,s[46:47]
s_waitcnt vmcnt(6)
s_barrier
s_sub_u32 s50,s26,2
v_add_u32 v10,s50,v0
v_cmp_gt_u32 vcc,64,v10
v_lshlrev_b32 v10,12,v10
v_mov_b32 v11,1
s_lshl_b32 s50,s25,7
s_add_u32 s50,s50,20971520
s_cmp_eq_u32 s21,0
s_cselect_b32 s50,s50,1073741824
v_cndmask_b32 v10,v8,v10,vcc
s_mov_b64 exec,3
buffer_store_dword v11,v10,s[8:11],s50 offen sc1
s_mov_b64 exec,-1
s_waitcnt vmcnt(1)
s_branch a2poll_42c
a2poll_42:
s_sleep 1
buffer_load_dwordx4 v[232:235],v5,s[8:11],s60 offen sc1
buffer_load_dwordx4 v[236:239],v5,s[8:11],s61 offen sc1
buffer_load_dwordx4 v[240:243],v5,s[8:11],s62 offen sc1
buffer_load_dwordx4 v[244:247],v5,s[8:11],s63 offen sc1
buffer_load_dwordx4 v[248:251],v5,s[8:11],s36 offen sc1
s_add_u32 s38,s38,1
s_cmp_gt_u32 s38,3000000
s_cbranch_scc1 w_fail
s_waitcnt vmcnt(0)
a2poll_42c:
v_max3_u32 v228,v232,v236,v240
v_max3_u32 v228,v228,v244,v248
v_cmp_eq_u32_e64 vcc,-1,v228
s_cbranch_vccnz a2poll_42
v_perm_b32 v72,v233,v232,s34
v_perm_b32 v73,v235,v234,s34
v_perm_b32 v74,v233,v232,s35
v_perm_b32 v75,v235,v234,s35
ds_write_b64 v2,v[72:73]
ds_write_b64 v2,v[74:75] offset:512
v_perm_b32 v76,v237,v236,s34
v_perm_b32 v77,v239,v238,s34
v_perm_b32 v78,v237,v236,s35
v_perm_b32 v79,v239,v238,s35
ds_write_b64 v2,v[76:77] offset:8192
ds_write_b64 v2,v[78:79] offset:8704
v_perm_b32 v72,v241,v240,s34
v_perm_b32 v73,v243,v242,s34
v_perm_b32 v74,v241,v240,s35
v_perm_b32 v75,v243,v242,s35
ds_write_b64 v2,v[72:73] offset:32
ds_write_b64 v2,v[74:75] offset:544
v_perm_b32 v76,v245,v244,s34
v_perm_b32 v77,v247,v246,s34
v_perm_b32 v78,v245,v244,s35
v_perm_b32 v79,v247,v246,s35
ds_write_b64 v2,v[76:77] offset:8224
ds_write_b64 v2,v[78:79] offset:8736
ds_write_b128 v3,v[248:251] offset:16384
s_add_u32 s50,s26,2
v_cmp_lt_u32 vcc,1,v7
s_lshr_b32 s63,s21,1
s_add_u32 s63,s63,s50
s_cmp_ge_u32 s63,64
s_cbranch_scc1 a2r_43
s_bitcmp1_b64 vcc,s63
s_cbranch_scc1 a2r_43
s_lshr_b32 s63,s21,1
s_add_u32 s63,s63,s50
s_lshl_b32 s63,s63,4
s_add_u32 s63,s63,s27
v_min_u32 v10,0,v0
v_lshlrev_b32 v10,2,v10
s_branch wf_44_0f
wf_44_0:
s_sleep 4
wf_44_0f:
buffer_load_dword v11,v10,s[8:11],s63 offen sc1
s_add_u32 s38,s38,1
s_cmp_gt_u32 s38,3000000
s_cbranch_scc1 w_fail
s_waitcnt vmcnt(0)
v_cmp_gt_u32 vcc,2,v11
s_cbranch_vccnz wf_44_0
a2r_43:
s_lshr_b32 s61,s21,1
s_add_u32 s61,s61,s50
s_mul_i32 s60,s25,65
s_add_u32 s60,s60,s61
s_lshl_b32 s28,s60,14
s_add_u32 s28,s28,41943040
s_lshl_b32 s29,s60,13
s_add_u32 s29,s29,76546048
s_cmp_lt_u32 s61,64
s_cselect_b32 s28,s28,1073741824
s_cselect_b32 s29,s29,1073741824
s_add_u32 s53,s29,4096
s_add_u32 s51,s28,4096
s_and_b32 s62,s21,1
s_lshl_b32 s62,s62,12
s_add_u32 s62,s62,s28
s_add_u32 s52,s62,8192
s_waitcnt lgkmcnt(0)
s_barrier
ds_read_b128 v[32:35],v5
ds_read_b128 v[36:39],v5 offset:1024
s_waitcnt lgkmcnt(1)
v_mfma_f32_16x16x32_bf16 v[16:19],a[0:3],v[32:35],0
ds_read_b128 v[40:43],v5 offset:2048
v_mfma_f32_16x16x32_bf16 v[20:23],a[72:75],v[32:35],0
v_mfma_f32_16x16x32_bf16 v[24:27],v[32:35],a[144:147],0
buffer_load_dwordx4 v[144:147],v6,s[88:91],s28 offen sc1
v_mfma_f32_16x16x32_bf16 v[28:31],v[32:35],a[216:219],0
s_waitcnt lgkmcnt(1)
v_mfma_f32_16x16x32_bf16 v[16:19],a[4:7],v[36:39],v[16:19]
ds_read_b128 v[32:35],v5 offset:3072
v_mfma_f32_16x16x32_bf16 v[20:23],a[76:79],v[36:39],v[20:23]
v_mfma_f32_16x16x32_bf16 v[24:27],v[36:39],a[148:151],v[24:27]
buffer_load_dwordx4 v[148:151],v6,s[88:91],s28 offen offset:512 sc1
v_mfma_f32_16x16x32_bf16 v[28:31],v[36:39],a[220:223],v[28:31]
s_waitcnt lgkmcnt(1)
v_mfma_f32_16x16x32_bf16 v[16:19],a[8:11],v[40:43],v[16:19]
ds_read_b128 v[36:39],v5 offset:4096
v_mfma_f32_16x16x32_bf16 v[20:23],a[80:83],v[40:43],v[20:23]
v_mfma_f32_16x16x32_bf16 v[24:27],v[40:43],a[152:155],v[24:27]
v_mfma_f32_16x16x32_bf16 v[28:31],v[40:43],a[224:227],v[28:31]
s_waitcnt lgkmcnt(1)
v_mfma_f32_16x16x32_bf16 v[16:19],a[12:15],v[32:35],v[16:19]
ds_read_b128 v[40:43],v5 offset:5120
v_mfma_f32_16x16x32_bf16 v[20:23],a[84:87],v[32:35],v[20:23]
v_mfma_f32_16x16x32_bf16 v[24:27],v[32:35],a[156:159],v[24:27]
buffer_load_dwordx4 v[152:155],v6,s[88:91],s28 offen offset:1024 sc1
v_mfma_f32_16x16x32_bf16 v[28:31],v[32:35],a[228:231],v[28:31]
s_waitcnt lgkmcnt(1)
v_mfma_f32_16x16x32_bf16 v[16:19],a[16:19],v[36:39],v[16:19]
ds_read_b128 v[32:35],v5 offset:6144
v_mfma_f32_16x16x32_bf16 v[20:23],a[88:91],v[36:39],v[20:23]
v_mfma_f32_16x16x32_bf16 v[24:27],v[36:39],a[160:163],v[24:27]
buffer_load_dwordx4 v[156:159],v6,s[88:91],s28 offen offset:1536 sc1
v_mfma_f32_16x16x32_bf16 v[28:31],v[36:39],a[232:235],v[28:31]
s_waitcnt lgkmcnt(1)
v_mfma_f32_16x16x32_bf16 v[16:19],a[20:23],v[40:43],v[16:19]
ds_read_b128 v[36:39],v5 offset:7168
v_mfma_f32_16x16x32_bf16 v[20:23],a[92:95],v[40:43],v[20:23]
v_mfma_f32_16x16x32_bf16 v[24:27],v[40:43],a[164:167],v[24:27]
v_mfma_f32_16x16x32_bf16 v[28:31],v[40:43],a[236:239],v[28:31]
s_waitcnt lgkmcnt(1)
v_mfma_f32_16x16x32_bf16 v[16:19],a[24:27],v[32:35],v[16:19]
ds_read_b128 v[40:43],v5 offset:8192
v_mfma_f32_16x16x32_bf16 v[20:23],a[96:99],v[32:35],v[20:23]
v_mfma_f32_16x16x32_bf16 v[24:27],v[32:35],a[168:171],v[24:27]
buffer_load_dwordx4 v[160:163],v6,s[88:91],s51 offen sc1
v_mfma_f32_16x16x32_bf16 v[28:31],v[32:35],a[240:243],v[28:31]
s_waitcnt lgkmcnt(1)
v_mfma_f32_16x16x32_bf16 v[16:19],a[28:31],v[36:39],v[16:19]
ds_read_b128 v[32:35],v5 offset:9216
v_mfma_f32_16x16x32_bf16 v[20:23],a[100:103],v[36:39],v[20:23]
v_mfma_f32_16x16x32_bf16 v[24:27],v[36:39],a[172:175],v[24:27]
buffer_load_dwordx4 v[164:167],v6,s[88:91],s51 offen offset:512 sc1
v_mfma_f32_16x16x32_bf16 v[28:31],v[36:39],a[244:247],v[28:31]
s_waitcnt lgkmcnt(1)
v_mfma_f32_16x16x32_bf16 v[16:19],a[32:35],v[40:43],v[16:19]
ds_read_b128 v[36:39],v5 offset:10240
v_mfma_f32_16x16x32_bf16 v[20:23],a[104:107],v[40:43],v[20:23]
v_mfma_f32_16x16x32_bf16 v[24:27],v[40:43],a[176:179],v[24:27]
v_mfma_f32_16x16x32_bf16 v[28:31],v[40:43],a[248:251],v[28:31]
s_waitcnt lgkmcnt(1)
v_mfma_f32_16x16x32_bf16 v[16:19],a[36:39],v[32:35],v[16:19]
ds_read_b128 v[40:43],v5 offset:11264
v_mfma_f32_16x16x32_bf16 v[20:23],a[108:111],v[32:35],v[20:23]
v_mfma_f32_16x16x32_bf16 v[24:27],v[32:35],a[180:183],v[24:27]
buffer_load_dwordx4 v[168:171],v6,s[88:91],s51 offen offset:1024 sc1
v_mfma_f32_16x16x32_bf16 v[28:31],v[32:35],a[252:255],v[28:31]
s_waitcnt lgkmcnt(1)
v_mfma_f32_16x16x32_bf16 v[16:19],a[40:43],v[36:39],v[16:19]
ds_read_b128 v[32:35],v5 offset:12288
v_mfma_f32_16x16x32_bf16 v[20:23],a[112:115],v[36:39],v[20:23]
v_mfma_f32_16x16x32_bf16 v[24:27],v[36:39],a[184:187],v[24:27]
buffer_load_dwordx4 v[172:175],v6,s[88:91],s51 offen offset:1536 sc1
v_mfma_f32_16x16x32_bf16 v[28:31],v[36:39],v[80:83],v[28:31]
s_waitcnt lgkmcnt(1)
v_mfma_f32_16x16x32_bf16 v[16:19],a[44:47],v[40:43],v[16:19]
ds_read_b128 v[36:39],v5 offset:13312
v_mfma_f32_16x16x32_bf16 v[20:23],a[116:119],v[40:43],v[20:23]
v_mfma_f32_16x16x32_bf16 v[24:27],v[40:43],a[188:191],v[24:27]
v_mfma_f32_16x16x32_bf16 v[28:31],v[40:43],v[84:87],v[28:31]
s_waitcnt lgkmcnt(1)
v_mfma_f32_16x16x32_bf16 v[16:19],a[48:51],v[32:35],v[16:19]
ds_read_b128 v[40:43],v5 offset:14336
v_mfma_f32_16x16x32_bf16 v[20:23],a[120:123],v[32:35],v[20:23]
v_mfma_f32_16x16x32_bf16 v[24:27],v[32:35],a[192:195],v[24:27]
buffer_load_dwordx4 v[176:179],v5,s[88:91],s52 offen sc1
v_mfma_f32_16x16x32_bf16 v[28:31],v[32:35],v[88:91],v[28:31]
s_waitcnt lgkmcnt(1)
v_mfma_f32_16x16x32_bf16 v[16:19],a[52:55],v[36:39],v[16:19]
ds_read_b128 v[32:35],v5 offset:15360
v_mfma_f32_16x16x32_bf16 v[20:23],a[124:127],v[36:39],v[20:23]
v_mfma_f32_16x16x32_bf16 v[24:27],v[36:39],a[196:199],v[24:27]
buffer_load_dwordx4 v[180:183],v5,s[88:91],s52 offen offset:1024 sc1
v_mfma_f32_16x16x32_bf16 v[28:31],v[36:39],v[92:95],v[28:31]
s_waitcnt lgkmcnt(1)
v_mfma_f32_16x16x32_bf16 v[16:19],a[56:59],v[40:43],v[16:19]
ds_read_b128 v[36:39],v5 offset:16384
v_mfma_f32_16x16x32_bf16 v[20:23],a[128:131],v[40:43],v[20:23]
v_mfma_f32_16x16x32_bf16 v[24:27],v[40:43],a[200:203],v[24:27]
v_mfma_f32_16x16x32_bf16 v[28:31],v[40:43],v[96:99],v[28:31]
s_waitcnt lgkmcnt(1)
v_mfma_f32_16x16x32_bf16 v[16:19],a[60:63],v[32:35],v[16:19]
ds_read_b128 v[40:43],v5 offset:17408
v_mfma_f32_16x16x32_bf16 v[20:23],a[132:135],v[32:35],v[20:23]
v_mfma_f32_16x16x32_bf16 v[24:27],v[32:35],a[204:207],v[24:27]
buffer_load_dwordx4 v[184:187],v5,s[88:91],s52 offen offset:2048 sc1
v_mfma_f32_16x16x32_bf16 v[28:31],v[32:35],v[100:103],v[28:31]
s_waitcnt lgkmcnt(1)
v_mfma_f32_16x16x32_bf16 v[16:19],a[64:67],v[36:39],v[16:19]
v_mfma_f32_16x16x32_bf16 v[20:23],a[136:139],v[36:39],v[20:23]
v_mfma_f32_16x16x32_bf16 v[24:27],v[36:39],a[208:211],v[24:27]
buffer_load_dwordx4 v[188:191],v5,s[88:91],s52 offen offset:3072 sc1
v_mfma_f32_16x16x32_bf16 v[28:31],v[36:39],v[104:107],v[28:31]
s_waitcnt lgkmcnt(0)
v_mfma_f32_16x16x32_bf16 v[16:19],a[68:71],v[40:43],v[16:19]
v_mfma_f32_16x16x32_bf16 v[20:23],a[140:143],v[40:43],v[20:23]
v_mfma_f32_16x16x32_bf16 v[24:27],v[40:43],a[212:215],v[24:27]
v_mfma_f32_16x16x32_bf16 v[28:31],v[40:43],v[108:111],v[28:31]
v_cvt_pk_bf16_f32 v16,v16,v17
v_cvt_pk_bf16_f32 v17,v18,v19
v_cvt_pk_bf16_f32 v18,v20,v21
v_cvt_pk_bf16_f32 v19,v22,v23
ds_write_b128 v4,v[16:19] offset:18432
v_cvt_pk_bf16_f32 v24,v24,v25
v_cvt_pk_bf16_f32 v25,v26,v27
v_cvt_pk_bf16_f32 v26,v28,v29
v_cvt_pk_bf16_f32 v27,v30,v31
ds_write_b128 v4,v[24:27] offset:22528
v_mov_b32 v234,0
v_mov_b32 v235,0
s_waitcnt lgkmcnt(0)
s_barrier
ds_read_b128 v[16:19],v5 offset:18432
ds_read_b128 v[20:23],v5 offset:19456
ds_read_b128 v[24:27],v5 offset:20480
ds_read_b128 v[28:31],v5 offset:21504
ds_read_b128 v[32:35],v9 offset:22528
ds_read_b128 v[36:39],v9 offset:23552
s_waitcnt lgkmcnt(5)
v_mfma_f32_16x16x32_bf16 v[220:223],v[16:19],v[112:115],0
v_mfma_f32_16x16x32_bf16 v[224:227],v[16:19],v[128:131],0
s_waitcnt lgkmcnt(4)
v_mfma_f32_16x16x32_bf16 v[220:223],v[20:23],v[116:119],v[220:223]
v_mfma_f32_16x16x32_bf16 v[224:227],v[20:23],v[132:135],v[224:227]
s_waitcnt lgkmcnt(3)
v_mfma_f32_16x16x32_bf16 v[220:223],v[24:27],v[120:123],v[220:223]
v_mfma_f32_16x16x32_bf16 v[224:227],v[24:27],v[136:139],v[224:227]
s_waitcnt lgkmcnt(2)
v_mfma_f32_16x16x32_bf16 v[220:223],v[28:31],v[124:127],v[220:223]
v_mfma_f32_16x16x32_bf16 v[224:227],v[28:31],v[140:143],v[224:227]
s_lshr_b32 s60,s21,1
s_add_u32 s62,s60,s26
s_lshl_b32 s60,s62,6
s_add_u32 s60,s60,s25
s_lshl_b32 s60,s60,1
s_and_b32 s61,s21,1
s_add_u32 s60,s60,s61
s_lshl_b32 s31,s60,11
s_add_u32 s31,s31,94371840
s_cmp_lt_u32 s62,64
s_cselect_b32 s31,s31,1073741824
buffer_load_dwordx4 v[112:115],v5,s[88:91],s29 offen sc1
v_cndmask_b32 v220,v220,v222,s[48:49]
v_cndmask_b32 v221,v221,v223,s[48:49]
v_cndmask_b32 v224,v224,v226,s[48:49]
v_cndmask_b32 v225,v225,v227,s[48:49]
v_max_f32_e64 v228,v208,v209
v_max3_f32 v228,v228,v210,v211
v_max3_f32 v228,v228,v220,v221
v_max_f32_e64 v230,v212,v213
v_max3_f32 v230,v230,v214,v215
v_max3_f32 v230,v230,v216,v217
v_max3_f32 v230,v230,v218,v219
v_max3_f32 v230,v230,v224,v225
v_mov_b32 v229,v228
v_mov_b32 v231,v230
buffer_load_dwordx4 v[116:119],v5,s[88:91],s29 offen offset:1024 sc1
v_permlane16_swap_b32 v228,v229
v_permlane16_swap_b32 v230,v231
v_max_f32 v228,v228,v229
v_max_f32 v230,v230,v231
v_mov_b32 v229,v228
v_mov_b32 v231,v230
buffer_load_dwordx4 v[120:123],v5,s[88:91],s29 offen offset:2048 sc1
v_permlane32_swap_b32 v228,v229
v_permlane32_swap_b32 v230,v231
v_max_f32 v228,v228,v229
v_max_f32 v230,v230,v231
v_mul_f32_e64 v228,s32,v228
v_fma_f32 v208,v208,s32,-v228
v_fma_f32 v209,v209,s32,-v228
v_fma_f32 v210,v210,s32,-v228
v_fma_f32 v211,v211,s32,-v228
v_fma_f32 v220,v220,s32,-v228
v_fma_f32 v221,v221,s32,-v228
v_exp_f32 v208,v208
v_exp_f32 v209,v209
v_exp_f32 v210,v210
v_exp_f32 v211,v211
v_exp_f32 v220,v220
v_exp_f32 v221,v221
v_cvt_pk_bf16_f32 v232,v208,v209
v_cvt_pk_bf16_f32 v233,v210,v211
v_cvt_pk_bf16_f32 v228,v220,v221
v_cndmask_b32 v240,v228,0,s[48:49]
v_cndmask_b32 v241,0,v228,s[48:49]
s_add_u32 s36,s31,131072
s_waitcnt lgkmcnt(0)
v_mfma_f32_16x16x32_bf16 v[244:247],v[12:15],v[232:235],0
buffer_load_dwordx4 v[124:127],v5,s[88:91],s29 offen offset:3072 sc1
v_mul_f32 v230,s32,v230
v_fma_f32 v212,v212,s32,-v230
v_fma_f32 v213,v213,s32,-v230
v_mfma_f32_16x16x32_bf16 v[40:43],v[192:195],v[232:235],0
v_fma_f32 v214,v214,s32,-v230
v_fma_f32 v215,v215,s32,-v230
v_fma_f32 v216,v216,s32,-v230
v_mfma_f32_16x16x32_bf16 v[44:47],v[196:199],v[232:235],0
buffer_load_dwordx4 v[128:131],v5,s[88:91],s53 offen sc1
v_fma_f32 v217,v217,s32,-v230
v_fma_f32 v218,v218,s32,-v230
v_fma_f32 v219,v219,s32,-v230
v_mfma_f32_16x16x32_bf16 v[48:51],v[200:203],v[232:235],0
v_fma_f32 v224,v224,s32,-v230
v_fma_f32 v225,v225,s32,-v230
v_exp_f32 v212,v212
v_mfma_f32_16x16x32_bf16 v[52:55],v[204:207],v[232:235],0
buffer_load_dwordx4 v[132:135],v5,s[88:91],s53 offen offset:1024 sc1
v_exp_f32 v213,v213
v_exp_f32 v214,v214
v_exp_f32 v215,v215
v_mfma_f32_16x16x16_bf16 v[244:247],v[12:13],v[240:241],v[244:247]
v_exp_f32 v216,v216
v_exp_f32 v217,v217
v_exp_f32_e64 v218,v218
v_mfma_f32_16x16x16_bf16 v[40:43],v[32:33],v[240:241],v[40:43]
buffer_load_dwordx4 v[136:139],v5,s[88:91],s53 offen offset:2048 sc1
v_exp_f32 v219,v219
v_exp_f32 v224,v224
v_exp_f32_e64 v225,v225
v_mfma_f32_16x16x16_bf16 v[44:47],v[34:35],v[240:241],v[44:47]
v_cvt_pk_bf16_f32 v236,v212,v213
v_cvt_pk_bf16_f32 v237,v214,v215
v_cvt_pk_bf16_f32 v238,v216,v217
v_mfma_f32_16x16x16_bf16 v[48:51],v[36:37],v[240:241],v[48:51]
buffer_load_dwordx4 v[140:143],v5,s[88:91],s53 offen offset:3072 sc1
v_cvt_pk_bf16_f32 v239,v218,v219
v_cvt_pk_bf16_f32 v230,v224,v225
v_cndmask_b32 v242,v230,0,s[48:49]
v_mfma_f32_16x16x16_bf16 v[52:55],v[38:39],v[240:241],v[52:55]
v_cndmask_b32 v243,0,v230,s[48:49]
s_cmp_lt_u32 s26,58
s_cbranch_scc1 oe_46
s_sub_u32 s50,s26,0
v_add_u32 v10,s50,v0
v_cmp_gt_u32 vcc,64,v10
v_lshlrev_b32 v10,12,v10
v_mov_b32 v11,1
s_lshl_b32 s50,s25,7
s_add_u32 s50,s50,20971520
s_cmp_eq_u32 s21,0
s_cselect_b32 s50,s50,1073741824
v_cndmask_b32 v10,v8,v10,vcc
s_mov_b64 exec,3
buffer_store_dword v11,v10,s[8:11],s50 offen sc1
s_mov_b64 exec,-1
oe_46:
v_mfma_f32_16x16x32_bf16 v[248:251],v[12:15],v[236:239],0
v_rcp_f32 v228,v244
s_nop 0
v_mul_f32 v40,v40,v228
v_mul_f32 v41,v41,v228
v_mfma_f32_16x16x32_bf16 v[56:59],v[192:195],v[236:239],0
v_mul_f32 v42,v42,v228
v_mul_f32 v43,v43,v228
v_mul_f32 v44,v44,v228
v_mfma_f32_16x16x32_bf16 v[60:63],v[196:199],v[236:239],0
v_mul_f32 v45,v45,v228
v_mul_f32 v46,v46,v228
v_mul_f32_e64 v47,v47,v228
v_mfma_f32_16x16x32_bf16 v[64:67],v[200:203],v[236:239],0
v_cvt_pk_bf16_f32 v40,v40,v41
v_cvt_pk_bf16_f32 v41,v42,v43
v_cvt_pk_bf16_f32 v42,v44,v45
v_mfma_f32_16x16x32_bf16 v[68:71],v[204:207],v[236:239],0
v_cvt_pk_bf16_f32 v43,v46,v47
buffer_store_dwordx4 v[40:43],v5,s[88:91],s31 offen sc1
v_mul_f32 v48,v48,v228
v_mfma_f32_16x16x16_bf16 v[248:251],v[12:13],v[242:243],v[248:251]
v_mul_f32 v49,v49,v228
v_mul_f32 v50,v50,v228
v_mul_f32 v51,v51,v228
v_mfma_f32_16x16x16_bf16 v[56:59],v[32:33],v[242:243],v[56:59]
v_mul_f32 v52,v52,v228
v_mul_f32 v53,v53,v228
v_mul_f32_e64 v54,v54,v228
v_mfma_f32_16x16x16_bf16 v[60:63],v[34:35],v[242:243],v[60:63]
v_mul_f32_e64 v55,v55,v228
v_cvt_pk_bf16_f32 v48,v48,v49
v_cvt_pk_bf16_f32 v49,v50,v51
v_mfma_f32_16x16x16_bf16 v[64:67],v[36:37],v[242:243],v[64:67]
v_cvt_pk_bf16_f32 v50,v52,v53
v_cvt_pk_bf16_f32 v51,v54,v55
buffer_store_dwordx4 v[48:51],v5,s[88:91],s31 offen offset:1024 sc1
v_mfma_f32_16x16x16_bf16 v[68:71],v[38:39],v[242:243],v[68:71]
v_rcp_f32 v228,v248
s_nop 0
v_mul_f32 v56,v56,v228
v_mul_f32 v57,v57,v228
v_mul_f32 v58,v58,v228
v_mul_f32 v59,v59,v228
v_mul_f32 v60,v60,v228
v_mul_f32 v61,v61,v228
v_mul_f32 v62,v62,v228
v_mul_f32 v63,v63,v228
v_cvt_pk_bf16_f32 v56,v56,v57
v_cvt_pk_bf16_f32 v57,v58,v59
v_cvt_pk_bf16_f32 v58,v60,v61
v_cvt_pk_bf16_f32 v59,v62,v63
buffer_store_dwordx4 v[56:59],v5,s[88:91],s36 offen sc1
v_mul_f32 v64,v64,v228
v_mul_f32 v65,v65,v228
v_mul_f32 v66,v66,v228
v_mul_f32 v67,v67,v228
v_mul_f32 v68,v68,v228
v_mul_f32 v69,v69,v228
v_mul_f32 v70,v70,v228
v_mul_f32 v71,v71,v228
v_cvt_pk_bf16_f32 v64,v64,v65
v_cvt_pk_bf16_f32 v65,v66,v67
v_cvt_pk_bf16_f32 v66,v68,v69
v_cvt_pk_bf16_f32 v67,v70,v71
buffer_store_dwordx4 v[64:67],v5,s[88:91],s36 offen offset:1024 sc1
s_add_u32 s26,s26,2
s_cmp_ge_u32 s26,64
s_cbranch_scc1 w_a2e
s_branch w_a2
w_a2e:
s_waitcnt vmcnt(0)
s_barrier
s_sub_u32 s50,s26,2
v_add_u32 v10,s50,v0
v_cmp_gt_u32 vcc,64,v10
v_lshlrev_b32 v10,12,v10
v_mov_b32 v11,1
s_lshl_b32 s50,s25,7
s_add_u32 s50,s50,20971520
s_cmp_eq_u32 s21,0
s_cselect_b32 s50,s50,1073741824
v_cndmask_b32 v10,v8,v10,vcc
s_mov_b64 exec,3
buffer_store_dword v11,v10,s[8:11],s50 offen sc1
s_mov_b64 exec,-1
s_add_u32 s61,s25,64
s_cmp_lg_u32 s23,0
s_cbranch_scc1 w_bwo
s_add_u32 s12,s6,39321600
s_addc_u32 s13,s7,0
s_mov_b32 s14,2359296
s_mov_b32 s15,0x20000
s_add_u32 s23,s23,1
s_cmp_lt_u32 s23,2
s_cbranch_scc1 a2_layer
s_branch w_fail
c_join:
v_mbcnt_lo_u32_b32 v0,-1,0
v_mbcnt_hi_u32_b32 v0,-1,v0
s_mov_b32 s38,0
s_mul_i32 s60,s23,16777216
s_add_u32 s8,s6,s60
s_addc_u32 s9,s7,0
s_mov_b32 s10,23068672
s_add_u32 s61,s24,96
s_add_u32 s24,s24,224
s_branch w_bwo
p_layer:
s_cmp_eq_u32 s62,2
s_cbranch_scc1 w_bqr
s_lshl_b32 s33,s62,1
s_add_u32 s33,s33,s39
s_mov_b32 s25,s37
v_lshlrev_b32 v1,4,v0
v_and_b32 v10,15,v0
v_lshrrev_b32 v11,4,v0
s_lshl_b32 s60,s21,2
v_add_u32_e64 v11,s60,v11
v_mul_u32_u24 v12,1152,v11
v_lshl_add_u32 v2,v10,3,v12
v_lshlrev_b32 v11,4,v11
v_mul_u32_u24 v12,272,v10
v_add_u32 v11,v12,v11
v_add_u32 v55,131072,v11
s_mul_i32 s60,s21,4352
s_add_u32 s60,s60,131072
v_and_b32 v12,48,v0
v_add3_u32 v6,v12,v1,s60
s_lshl_b32 s60,s21,15
v_add_u32 v5,s60,v1
v_mul_u32_u24 v10,9,v0
v_add_u32 v10,s25,v10
v_lshlrev_b32 v11,7,v10
v_mov_b32 v12,0x40000000
v_cmp_gt_u32 vcc,0x100,v10
s_nop 1
v_cndmask_b32 v9,v12,v11,vcc
s_mov_b32 s76,s74
s_mov_b32 s77,s75
s_mov_b32 s78,4718592
s_mov_b32 s79,0x20000
s_lshl_b32 s63,s21,15
s_add_u32 s63,s63,16384
v_lshrrev_b32 v10,4,v0
v_bfe_u32 v11,v0,2,2
v_lshl_add_u32 v10,v10,3,v11
v_lshlrev_b32 v10,6,v10
v_and_b32 v11,3,v0
v_lshl_add_u32 v10,v11,3,v10
v_add_u32 v3,s63,v10
v_bfe_u32 v10,v0,2,2
v_bfe_u32 v11,v0,4,1
v_lshl_add_u32 v10,v11,4,v10
v_lshrrev_b32 v11,5,v0
v_lshl_add_u32 v10,v11,2,v10
v_mul_u32_u24 v10,1152,v10
v_and_b32 v11,3,v0
v_lshl_add_u32 v4,v11,4,v10
s_mul_i32 s62,s21,1179648
s_lshl_b32 s61,s25,7
s_add_u32 s62,s62,s61
s_add_u32 s60,s62,0
s_add_u32 m0,s63,0
s_nop 0
buffer_load_dwordx4 v4,s[76:79],s60 offen lds
s_add_u32 s60,s62,9216
s_add_u32 m0,s63,1024
s_nop 0
buffer_load_dwordx4 v4,s[76:79],s60 offen lds
s_add_u32 s60,s62,36864
s_add_u32 m0,s63,2048
s_nop 0
buffer_load_dwordx4 v4,s[76:79],s60 offen lds
s_add_u32 s60,s62,46080
s_add_u32 m0,s63,3072
s_nop 0
buffer_load_dwordx4 v4,s[76:79],s60 offen lds
s_add_u32 s60,s62,64
s_add_u32 m0,s63,4096
s_nop 0
buffer_load_dwordx4 v4,s[76:79],s60 offen lds
s_add_u32 s60,s62,9280
s_add_u32 m0,s63,5120
s_nop 0
buffer_load_dwordx4 v4,s[76:79],s60 offen lds
s_add_u32 s60,s62,36928
s_add_u32 m0,s63,6144
s_nop 0
buffer_load_dwordx4 v4,s[76:79],s60 offen lds
s_add_u32 s60,s62,46144
s_add_u32 m0,s63,7168
s_nop 0
buffer_load_dwordx4 v4,s[76:79],s60 offen lds
s_add_u32 s60,s62,73728
s_add_u32 m0,s63,8192
s_nop 0
buffer_load_dwordx4 v4,s[76:79],s60 offen lds
s_add_u32 s60,s62,82944
s_add_u32 m0,s63,9216
s_nop 0
buffer_load_dwordx4 v4,s[76:79],s60 offen lds
s_add_u32 s60,s62,110592
s_add_u32 m0,s63,10240
s_nop 0
buffer_load_dwordx4 v4,s[76:79],s60 offen lds
s_add_u32 s60,s62,119808
s_add_u32 m0,s63,11264
s_nop 0
buffer_load_dwordx4 v4,s[76:79],s60 offen lds
s_waitcnt lgkmcnt(0)
s_add_u32 s60,s62,73792
s_add_u32 m0,s63,12288
s_nop 0
buffer_load_dwordx4 v4,s[76:79],s60 offen lds
s_add_u32 s60,s62,83008
s_add_u32 m0,s63,13312
s_nop 0
buffer_load_dwordx4 v4,s[76:79],s60 offen lds
s_add_u32 s60,s62,110656
s_add_u32 m0,s63,14336
s_nop 0
buffer_load_dwordx4 v4,s[76:79],s60 offen lds
s_add_u32 s60,s62,119872
s_add_u32 m0,s63,15360
s_nop 0
buffer_load_dwordx4 v4,s[76:79],s60 offen lds
s_waitcnt vmcnt(12)
ds_read_b64_tr_b16 a[0:1],v3
ds_read_b64_tr_b16 a[2:3],v3 offset:256
ds_read_b64_tr_b16 a[4:5],v3 offset:2048
ds_read_b64_tr_b16 a[6:7],v3 offset:2304
ds_read_b64_tr_b16 a[128:129],v3 offset:32
ds_read_b64_tr_b16 a[130:131],v3 offset:288
ds_read_b64_tr_b16 a[132:133],v3 offset:2080
ds_read_b64_tr_b16 a[134:135],v3 offset:2336
s_waitcnt lgkmcnt(0)
s_add_u32 s60,s62,147456
s_add_u32 m0,s63,0
s_nop 0
buffer_load_dwordx4 v4,s[76:79],s60 offen lds
s_add_u32 s60,s62,156672
s_add_u32 m0,s63,1024
s_nop 0
buffer_load_dwordx4 v4,s[76:79],s60 offen lds
s_add_u32 s60,s62,184320
s_add_u32 m0,s63,2048
s_nop 0
buffer_load_dwordx4 v4,s[76:79],s60 offen lds
s_add_u32 s60,s62,193536
s_add_u32 m0,s63,3072
s_nop 0
buffer_load_dwordx4 v4,s[76:79],s60 offen lds
s_waitcnt vmcnt(12)
ds_read_b64_tr_b16 v[128:129],v3 offset:4096
ds_read_b64_tr_b16 v[130:131],v3 offset:4352
ds_read_b64_tr_b16 v[132:133],v3 offset:6144
ds_read_b64_tr_b16 v[134:135],v3 offset:6400
ds_read_b64_tr_b16 v[16:17],v3 offset:4128
ds_read_b64_tr_b16 v[18:19],v3 offset:4384
ds_read_b64_tr_b16 v[20:21],v3 offset:6176
ds_read_b64_tr_b16 v[22:23],v3 offset:6432
s_waitcnt lgkmcnt(0)
ds_write_b128 v5,v[16:19]
ds_write_b128 v5,v[20:23] offset:1024
s_waitcnt lgkmcnt(0)
s_add_u32 s60,s62,147520
s_add_u32 m0,s63,4096
s_nop 0
buffer_load_dwordx4 v4,s[76:79],s60 offen lds
s_add_u32 s60,s62,156736
s_add_u32 m0,s63,5120
s_nop 0
buffer_load_dwordx4 v4,s[76:79],s60 offen lds
s_add_u32 s60,s62,184384
s_add_u32 m0,s63,6144
s_nop 0
buffer_load_dwordx4 v4,s[76:79],s60 offen lds
s_add_u32 s60,s62,193600
s_add_u32 m0,s63,7168
s_nop 0
buffer_load_dwordx4 v4,s[76:79],s60 offen lds
s_waitcnt vmcnt(12)
ds_read_b64_tr_b16 a[8:9],v3 offset:8192
ds_read_b64_tr_b16 a[10:11],v3 offset:8448
ds_read_b64_tr_b16 a[12:13],v3 offset:10240
ds_read_b64_tr_b16 a[14:15],v3 offset:10496
ds_read_b64_tr_b16 a[136:137],v3 offset:8224
ds_read_b64_tr_b16 a[138:139],v3 offset:8480
ds_read_b64_tr_b16 a[140:141],v3 offset:10272
ds_read_b64_tr_b16 a[142:143],v3 offset:10528
s_waitcnt lgkmcnt(0)
s_add_u32 s60,s62,221184
s_add_u32 m0,s63,8192
s_nop 0
buffer_load_dwordx4 v4,s[76:79],s60 offen lds
s_add_u32 s60,s62,230400
s_add_u32 m0,s63,9216
s_nop 0
buffer_load_dwordx4 v4,s[76:79],s60 offen lds
s_add_u32 s60,s62,258048
s_add_u32 m0,s63,10240
s_nop 0
buffer_load_dwordx4 v4,s[76:79],s60 offen lds
s_add_u32 s60,s62,267264
s_add_u32 m0,s63,11264
s_nop 0
buffer_load_dwordx4 v4,s[76:79],s60 offen lds
s_waitcnt vmcnt(12)
ds_read_b64_tr_b16 v[136:137],v3 offset:12288
ds_read_b64_tr_b16 v[138:139],v3 offset:12544
ds_read_b64_tr_b16 v[140:141],v3 offset:14336
ds_read_b64_tr_b16 v[142:143],v3 offset:14592
ds_read_b64_tr_b16 v[24:25],v3 offset:12320
ds_read_b64_tr_b16 v[26:27],v3 offset:12576
ds_read_b64_tr_b16 v[28:29],v3 offset:14368
ds_read_b64_tr_b16 v[30:31],v3 offset:14624
s_waitcnt lgkmcnt(0)
ds_write_b128 v5,v[24:27] offset:2048
ds_write_b128 v5,v[28:31] offset:3072
s_waitcnt lgkmcnt(0)
s_add_u32 s60,s62,221248
s_add_u32 m0,s63,12288
s_nop 0
buffer_load_dwordx4 v4,s[76:79],s60 offen lds
s_add_u32 s60,s62,230464
s_add_u32 m0,s63,13312
s_nop 0
buffer_load_dwordx4 v4,s[76:79],s60 offen lds
s_add_u32 s60,s62,258112
s_add_u32 m0,s63,14336
s_nop 0
buffer_load_dwordx4 v4,s[76:79],s60 offen lds
s_add_u32 s60,s62,267328
s_add_u32 m0,s63,15360
s_nop 0
buffer_load_dwordx4 v4,s[76:79],s60 offen lds
s_waitcnt vmcnt(12)
ds_read_b64_tr_b16 a[16:17],v3
ds_read_b64_tr_b16 a[18:19],v3 offset:256
ds_read_b64_tr_b16 a[20:21],v3 offset:2048
ds_read_b64_tr_b16 a[22:23],v3 offset:2304
ds_read_b64_tr_b16 a[144:145],v3 offset:32
ds_read_b64_tr_b16 a[146:147],v3 offset:288
ds_read_b64_tr_b16 a[148:149],v3 offset:2080
ds_read_b64_tr_b16 a[150:151],v3 offset:2336
s_waitcnt lgkmcnt(0)
s_add_u32 s60,s62,294912
s_add_u32 m0,s63,0
s_nop 0
buffer_load_dwordx4 v4,s[76:79],s60 offen lds
s_add_u32 s60,s62,304128
s_add_u32 m0,s63,1024
s_nop 0
buffer_load_dwordx4 v4,s[76:79],s60 offen lds
s_add_u32 s60,s62,331776
s_add_u32 m0,s63,2048
s_nop 0
buffer_load_dwordx4 v4,s[76:79],s60 offen lds
s_add_u32 s60,s62,340992
s_add_u32 m0,s63,3072
s_nop 0
buffer_load_dwordx4 v4,s[76:79],s60 offen lds
s_waitcnt vmcnt(12)
ds_read_b64_tr_b16 v[144:145],v3 offset:4096
ds_read_b64_tr_b16 v[146:147],v3 offset:4352
ds_read_b64_tr_b16 v[148:149],v3 offset:6144
ds_read_b64_tr_b16 v[150:151],v3 offset:6400
ds_read_b64_tr_b16 v[16:17],v3 offset:4128
ds_read_b64_tr_b16 v[18:19],v3 offset:4384
ds_read_b64_tr_b16 v[20:21],v3 offset:6176
ds_read_b64_tr_b16 v[22:23],v3 offset:6432
s_waitcnt lgkmcnt(0)
ds_write_b128 v5,v[16:19] offset:4096
ds_write_b128 v5,v[20:23] offset:5120
s_waitcnt lgkmcnt(0)
s_add_u32 s60,s62,294976
s_add_u32 m0,s63,4096
s_nop 0
buffer_load_dwordx4 v4,s[76:79],s60 offen lds
s_add_u32 s60,s62,304192
s_add_u32 m0,s63,5120
s_nop 0
buffer_load_dwordx4 v4,s[76:79],s60 offen lds
s_add_u32 s60,s62,331840
s_add_u32 m0,s63,6144
s_nop 0
buffer_load_dwordx4 v4,s[76:79],s60 offen lds
s_add_u32 s60,s62,341056
s_add_u32 m0,s63,7168
s_nop 0
buffer_load_dwordx4 v4,s[76:79],s60 offen lds
s_waitcnt vmcnt(12)
ds_read_b64_tr_b16 a[24:25],v3 offset:8192
ds_read_b64_tr_b16 a[26:27],v3 offset:8448
ds_read_b64_tr_b16 a[28:29],v3 offset:10240
ds_read_b64_tr_b16 a[30:31],v3 offset:10496
ds_read_b64_tr_b16 a[152:153],v3 offset:8224
ds_read_b64_tr_b16 a[154:155],v3 offset:8480
ds_read_b64_tr_b16 a[156:157],v3 offset:10272
ds_read_b64_tr_b16 a[158:159],v3 offset:10528
s_waitcnt lgkmcnt(0)
s_add_u32 s60,s62,368640
s_add_u32 m0,s63,8192
s_nop 0
buffer_load_dwordx4 v4,s[76:79],s60 offen lds
s_add_u32 s60,s62,377856
s_add_u32 m0,s63,9216
s_nop 0
buffer_load_dwordx4 v4,s[76:79],s60 offen lds
s_add_u32 s60,s62,405504
s_add_u32 m0,s63,10240
s_nop 0
buffer_load_dwordx4 v4,s[76:79],s60 offen lds
s_add_u32 s60,s62,414720
s_add_u32 m0,s63,11264
s_nop 0
buffer_load_dwordx4 v4,s[76:79],s60 offen lds
s_waitcnt vmcnt(12)
ds_read_b64_tr_b16 v[152:153],v3 offset:12288
ds_read_b64_tr_b16 v[154:155],v3 offset:12544
ds_read_b64_tr_b16 v[156:157],v3 offset:14336
ds_read_b64_tr_b16 v[158:159],v3 offset:14592
ds_read_b64_tr_b16 v[24:25],v3 offset:12320
ds_read_b64_tr_b16 v[26:27],v3 offset:12576
ds_read_b64_tr_b16 v[28:29],v3 offset:14368
ds_read_b64_tr_b16 v[30:31],v3 offset:14624
s_waitcnt lgkmcnt(0)
ds_write_b128 v5,v[24:27] offset:6144
ds_write_b128 v5,v[28:31] offset:7168
s_waitcnt lgkmcnt(0)
s_add_u32 s60,s62,368704
s_add_u32 m0,s63,12288
s_nop 0
buffer_load_dwordx4 v4,s[76:79],s60 offen lds
s_add_u32 s60,s62,377920
s_add_u32 m0,s63,13312
s_nop 0
buffer_load_dwordx4 v4,s[76:79],s60 offen lds
s_add_u32 s60,s62,405568
s_add_u32 m0,s63,14336
s_nop 0
buffer_load_dwordx4 v4,s[76:79],s60 offen lds
s_add_u32 s60,s62,414784
s_add_u32 m0,s63,15360
s_nop 0
buffer_load_dwordx4 v4,s[76:79],s60 offen lds
s_waitcnt vmcnt(12)
ds_read_b64_tr_b16 a[32:33],v3
ds_read_b64_tr_b16 a[34:35],v3 offset:256
ds_read_b64_tr_b16 a[36:37],v3 offset:2048
ds_read_b64_tr_b16 a[38:39],v3 offset:2304
ds_read_b64_tr_b16 a[160:161],v3 offset:32
ds_read_b64_tr_b16 a[162:163],v3 offset:288
ds_read_b64_tr_b16 a[164:165],v3 offset:2080
ds_read_b64_tr_b16 a[166:167],v3 offset:2336
s_waitcnt lgkmcnt(0)
s_add_u32 s60,s62,442368
s_add_u32 m0,s63,0
s_nop 0
buffer_load_dwordx4 v4,s[76:79],s60 offen lds
s_add_u32 s60,s62,451584
s_add_u32 m0,s63,1024
s_nop 0
buffer_load_dwordx4 v4,s[76:79],s60 offen lds
s_add_u32 s60,s62,479232
s_add_u32 m0,s63,2048
s_nop 0
buffer_load_dwordx4 v4,s[76:79],s60 offen lds
s_add_u32 s60,s62,488448
s_add_u32 m0,s63,3072
s_nop 0
buffer_load_dwordx4 v4,s[76:79],s60 offen lds
s_waitcnt vmcnt(12)
ds_read_b64_tr_b16 v[160:161],v3 offset:4096
ds_read_b64_tr_b16 v[162:163],v3 offset:4352
ds_read_b64_tr_b16 v[164:165],v3 offset:6144
ds_read_b64_tr_b16 v[166:167],v3 offset:6400
ds_read_b64_tr_b16 v[16:17],v3 offset:4128
ds_read_b64_tr_b16 v[18:19],v3 offset:4384
ds_read_b64_tr_b16 v[20:21],v3 offset:6176
ds_read_b64_tr_b16 v[22:23],v3 offset:6432
s_waitcnt lgkmcnt(0)
ds_write_b128 v5,v[16:19] offset:8192
ds_write_b128 v5,v[20:23] offset:9216
s_waitcnt lgkmcnt(0)
s_add_u32 s60,s62,442432
s_add_u32 m0,s63,4096
s_nop 0
buffer_load_dwordx4 v4,s[76:79],s60 offen lds
s_add_u32 s60,s62,451648
s_add_u32 m0,s63,5120
s_nop 0
buffer_load_dwordx4 v4,s[76:79],s60 offen lds
s_add_u32 s60,s62,479296
s_add_u32 m0,s63,6144
s_nop 0
buffer_load_dwordx4 v4,s[76:79],s60 offen lds
s_add_u32 s60,s62,488512
s_add_u32 m0,s63,7168
s_nop 0
buffer_load_dwordx4 v4,s[76:79],s60 offen lds
s_waitcnt vmcnt(12)
ds_read_b64_tr_b16 a[40:41],v3 offset:8192
ds_read_b64_tr_b16 a[42:43],v3 offset:8448
ds_read_b64_tr_b16 a[44:45],v3 offset:10240
ds_read_b64_tr_b16 a[46:47],v3 offset:10496
ds_read_b64_tr_b16 a[168:169],v3 offset:8224
ds_read_b64_tr_b16 a[170:171],v3 offset:8480
ds_read_b64_tr_b16 a[172:173],v3 offset:10272
ds_read_b64_tr_b16 a[174:175],v3 offset:10528
s_waitcnt lgkmcnt(0)
s_add_u32 s60,s62,516096
s_add_u32 m0,s63,8192
s_nop 0
buffer_load_dwordx4 v4,s[76:79],s60 offen lds
s_add_u32 s60,s62,525312
s_add_u32 m0,s63,9216
s_nop 0
buffer_load_dwordx4 v4,s[76:79],s60 offen lds
s_add_u32 s60,s62,552960
s_add_u32 m0,s63,10240
s_nop 0
buffer_load_dwordx4 v4,s[76:79],s60 offen lds
s_add_u32 s60,s62,562176
s_add_u32 m0,s63,11264
s_nop 0
buffer_load_dwordx4 v4,s[76:79],s60 offen lds
s_waitcnt vmcnt(12)
ds_read_b64_tr_b16 v[168:169],v3 offset:12288
ds_read_b64_tr_b16 v[170:171],v3 offset:12544
ds_read_b64_tr_b16 v[172:173],v3 offset:14336
ds_read_b64_tr_b16 v[174:175],v3 offset:14592
ds_read_b64_tr_b16 v[24:25],v3 offset:12320
ds_read_b64_tr_b16 v[26:27],v3 offset:12576
ds_read_b64_tr_b16 v[28:29],v3 offset:14368
ds_read_b64_tr_b16 v[30:31],v3 offset:14624
s_waitcnt lgkmcnt(0)
ds_write_b128 v5,v[24:27] offset:10240
ds_write_b128 v5,v[28:31] offset:11264
s_waitcnt lgkmcnt(0)
s_add_u32 s60,s62,516160
s_add_u32 m0,s63,12288
s_nop 0
buffer_load_dwordx4 v4,s[76:79],s60 offen lds
s_add_u32 s60,s62,525376
s_add_u32 m0,s63,13312
s_nop 0
buffer_load_dwordx4 v4,s[76:79],s60 offen lds
s_add_u32 s60,s62,553024
s_add_u32 m0,s63,14336
s_nop 0
buffer_load_dwordx4 v4,s[76:79],s60 offen lds
s_add_u32 s60,s62,562240
s_add_u32 m0,s63,15360
s_nop 0
buffer_load_dwordx4 v4,s[76:79],s60 offen lds
s_waitcnt vmcnt(12)
ds_read_b64_tr_b16 a[48:49],v3
ds_read_b64_tr_b16 a[50:51],v3 offset:256
ds_read_b64_tr_b16 a[52:53],v3 offset:2048
ds_read_b64_tr_b16 a[54:55],v3 offset:2304
ds_read_b64_tr_b16 a[176:177],v3 offset:32
ds_read_b64_tr_b16 a[178:179],v3 offset:288
ds_read_b64_tr_b16 a[180:181],v3 offset:2080
ds_read_b64_tr_b16 a[182:183],v3 offset:2336
s_waitcnt lgkmcnt(0)
s_add_u32 s60,s62,589824
s_add_u32 m0,s63,0
s_nop 0
buffer_load_dwordx4 v4,s[76:79],s60 offen lds
s_add_u32 s60,s62,599040
s_add_u32 m0,s63,1024
s_nop 0
buffer_load_dwordx4 v4,s[76:79],s60 offen lds
s_add_u32 s60,s62,626688
s_add_u32 m0,s63,2048
s_nop 0
buffer_load_dwordx4 v4,s[76:79],s60 offen lds
s_add_u32 s60,s62,635904
s_add_u32 m0,s63,3072
s_nop 0
buffer_load_dwordx4 v4,s[76:79],s60 offen lds
s_waitcnt vmcnt(12)
ds_read_b64_tr_b16 v[176:177],v3 offset:4096
ds_read_b64_tr_b16 v[178:179],v3 offset:4352
ds_read_b64_tr_b16 v[180:181],v3 offset:6144
ds_read_b64_tr_b16 v[182:183],v3 offset:6400
ds_read_b64_tr_b16 v[16:17],v3 offset:4128
ds_read_b64_tr_b16 v[18:19],v3 offset:4384
ds_read_b64_tr_b16 v[20:21],v3 offset:6176
ds_read_b64_tr_b16 v[22:23],v3 offset:6432
s_waitcnt lgkmcnt(0)
ds_write_b128 v5,v[16:19] offset:12288
ds_write_b128 v5,v[20:23] offset:13312
s_waitcnt lgkmcnt(0)
s_add_u32 s60,s62,589888
s_add_u32 m0,s63,4096
s_nop 0
buffer_load_dwordx4 v4,s[76:79],s60 offen lds
s_add_u32 s60,s62,599104
s_add_u32 m0,s63,5120
s_nop 0
buffer_load_dwordx4 v4,s[76:79],s60 offen lds
s_add_u32 s60,s62,626752
s_add_u32 m0,s63,6144
s_nop 0
buffer_load_dwordx4 v4,s[76:79],s60 offen lds
s_add_u32 s60,s62,635968
s_add_u32 m0,s63,7168
s_nop 0
buffer_load_dwordx4 v4,s[76:79],s60 offen lds
s_waitcnt vmcnt(12)
ds_read_b64_tr_b16 a[56:57],v3 offset:8192
ds_read_b64_tr_b16 a[58:59],v3 offset:8448
ds_read_b64_tr_b16 a[60:61],v3 offset:10240
ds_read_b64_tr_b16 a[62:63],v3 offset:10496
ds_read_b64_tr_b16 a[184:185],v3 offset:8224
ds_read_b64_tr_b16 a[186:187],v3 offset:8480
ds_read_b64_tr_b16 a[188:189],v3 offset:10272
ds_read_b64_tr_b16 a[190:191],v3 offset:10528
s_waitcnt lgkmcnt(0)
s_add_u32 s60,s62,663552
s_add_u32 m0,s63,8192
s_nop 0
buffer_load_dwordx4 v4,s[76:79],s60 offen lds
s_add_u32 s60,s62,672768
s_add_u32 m0,s63,9216
s_nop 0
buffer_load_dwordx4 v4,s[76:79],s60 offen lds
s_add_u32 s60,s62,700416
s_add_u32 m0,s63,10240
s_nop 0
buffer_load_dwordx4 v4,s[76:79],s60 offen lds
s_add_u32 s60,s62,709632
s_add_u32 m0,s63,11264
s_nop 0
buffer_load_dwordx4 v4,s[76:79],s60 offen lds
s_waitcnt vmcnt(12)
ds_read_b64_tr_b16 v[184:185],v3 offset:12288
ds_read_b64_tr_b16 v[186:187],v3 offset:12544
ds_read_b64_tr_b16 v[188:189],v3 offset:14336
ds_read_b64_tr_b16 v[190:191],v3 offset:14592
ds_read_b64_tr_b16 v[24:25],v3 offset:12320
ds_read_b64_tr_b16 v[26:27],v3 offset:12576
ds_read_b64_tr_b16 v[28:29],v3 offset:14368
ds_read_b64_tr_b16 v[30:31],v3 offset:14624
s_waitcnt lgkmcnt(0)
ds_write_b128 v5,v[24:27] offset:14336
ds_write_b128 v5,v[28:31] offset:15360
s_waitcnt lgkmcnt(0)
s_add_u32 s60,s62,663616
s_add_u32 m0,s63,12288
s_nop 0
buffer_load_dwordx4 v4,s[76:79],s60 offen lds
s_add_u32 s60,s62,672832
s_add_u32 m0,s63,13312
s_nop 0
buffer_load_dwordx4 v4,s[76:79],s60 offen lds
s_add_u32 s60,s62,700480
s_add_u32 m0,s63,14336
s_nop 0
buffer_load_dwordx4 v4,s[76:79],s60 offen lds
s_add_u32 s60,s62,709696
s_add_u32 m0,s63,15360
s_nop 0
buffer_load_dwordx4 v4,s[76:79],s60 offen lds
s_waitcnt vmcnt(12)
ds_read_b64_tr_b16 a[64:65],v3
ds_read_b64_tr_b16 a[66:67],v3 offset:256
ds_read_b64_tr_b16 a[68:69],v3 offset:2048
ds_read_b64_tr_b16 a[70:71],v3 offset:2304
ds_read_b64_tr_b16 a[192:193],v3 offset:32
ds_read_b64_tr_b16 a[194:195],v3 offset:288
ds_read_b64_tr_b16 a[196:197],v3 offset:2080
ds_read_b64_tr_b16 a[198:199],v3 offset:2336
s_waitcnt lgkmcnt(0)
s_add_u32 s60,s62,737280
s_add_u32 m0,s63,0
s_nop 0
buffer_load_dwordx4 v4,s[76:79],s60 offen lds
s_add_u32 s60,s62,746496
s_add_u32 m0,s63,1024
s_nop 0
buffer_load_dwordx4 v4,s[76:79],s60 offen lds
s_add_u32 s60,s62,774144
s_add_u32 m0,s63,2048
s_nop 0
buffer_load_dwordx4 v4,s[76:79],s60 offen lds
s_add_u32 s60,s62,783360
s_add_u32 m0,s63,3072
s_nop 0
buffer_load_dwordx4 v4,s[76:79],s60 offen lds
s_waitcnt vmcnt(12)
ds_read_b64_tr_b16 v[192:193],v3 offset:4096
ds_read_b64_tr_b16 v[194:195],v3 offset:4352
ds_read_b64_tr_b16 v[196:197],v3 offset:6144
ds_read_b64_tr_b16 v[198:199],v3 offset:6400
ds_read_b64_tr_b16 v[56:57],v3 offset:4128
ds_read_b64_tr_b16 v[58:59],v3 offset:4384
ds_read_b64_tr_b16 v[60:61],v3 offset:6176
ds_read_b64_tr_b16 v[62:63],v3 offset:6432
s_waitcnt lgkmcnt(0)
s_add_u32 s60,s62,737344
s_add_u32 m0,s63,4096
s_nop 0
buffer_load_dwordx4 v4,s[76:79],s60 offen lds
s_add_u32 s60,s62,746560
s_add_u32 m0,s63,5120
s_nop 0
buffer_load_dwordx4 v4,s[76:79],s60 offen lds
s_add_u32 s60,s62,774208
s_add_u32 m0,s63,6144
s_nop 0
buffer_load_dwordx4 v4,s[76:79],s60 offen lds
s_add_u32 s60,s62,783424
s_add_u32 m0,s63,7168
s_nop 0
buffer_load_dwordx4 v4,s[76:79],s60 offen lds
s_waitcnt vmcnt(12)
ds_read_b64_tr_b16 a[72:73],v3 offset:8192
ds_read_b64_tr_b16 a[74:75],v3 offset:8448
ds_read_b64_tr_b16 a[76:77],v3 offset:10240
ds_read_b64_tr_b16 a[78:79],v3 offset:10496
ds_read_b64_tr_b16 a[200:201],v3 offset:8224
ds_read_b64_tr_b16 a[202:203],v3 offset:8480
ds_read_b64_tr_b16 a[204:205],v3 offset:10272
ds_read_b64_tr_b16 a[206:207],v3 offset:10528
s_waitcnt lgkmcnt(0)
s_add_u32 s60,s62,811008
s_add_u32 m0,s63,8192
s_nop 0
buffer_load_dwordx4 v4,s[76:79],s60 offen lds
s_add_u32 s60,s62,820224
s_add_u32 m0,s63,9216
s_nop 0
buffer_load_dwordx4 v4,s[76:79],s60 offen lds
s_add_u32 s60,s62,847872
s_add_u32 m0,s63,10240
s_nop 0
buffer_load_dwordx4 v4,s[76:79],s60 offen lds
s_add_u32 s60,s62,857088
s_add_u32 m0,s63,11264
s_nop 0
buffer_load_dwordx4 v4,s[76:79],s60 offen lds
s_waitcnt vmcnt(12)
ds_read_b64_tr_b16 v[200:201],v3 offset:12288
ds_read_b64_tr_b16 v[202:203],v3 offset:12544
ds_read_b64_tr_b16 v[204:205],v3 offset:14336
ds_read_b64_tr_b16 v[206:207],v3 offset:14592
ds_read_b64_tr_b16 v[64:65],v3 offset:12320
ds_read_b64_tr_b16 v[66:67],v3 offset:12576
ds_read_b64_tr_b16 v[68:69],v3 offset:14368
ds_read_b64_tr_b16 v[70:71],v3 offset:14624
s_waitcnt lgkmcnt(0)
s_add_u32 s60,s62,811072
s_add_u32 m0,s63,12288
s_nop 0
buffer_load_dwordx4 v4,s[76:79],s60 offen lds
s_add_u32 s60,s62,820288
s_add_u32 m0,s63,13312
s_nop 0
buffer_load_dwordx4 v4,s[76:79],s60 offen lds
s_add_u32 s60,s62,847936
s_add_u32 m0,s63,14336
s_nop 0
buffer_load_dwordx4 v4,s[76:79],s60 offen lds
s_add_u32 s60,s62,857152
s_add_u32 m0,s63,15360
s_nop 0
buffer_load_dwordx4 v4,s[76:79],s60 offen lds
s_waitcnt vmcnt(12)
ds_read_b64_tr_b16 a[80:81],v3
ds_read_b64_tr_b16 a[82:83],v3 offset:256
ds_read_b64_tr_b16 a[84:85],v3 offset:2048
ds_read_b64_tr_b16 a[86:87],v3 offset:2304
ds_read_b64_tr_b16 a[208:209],v3 offset:32
ds_read_b64_tr_b16 a[210:211],v3 offset:288
ds_read_b64_tr_b16 a[212:213],v3 offset:2080
ds_read_b64_tr_b16 a[214:215],v3 offset:2336
s_waitcnt lgkmcnt(0)
s_add_u32 s60,s62,884736
s_add_u32 m0,s63,0
s_nop 0
buffer_load_dwordx4 v4,s[76:79],s60 offen lds
s_add_u32 s60,s62,893952
s_add_u32 m0,s63,1024
s_nop 0
buffer_load_dwordx4 v4,s[76:79],s60 offen lds
s_add_u32 s60,s62,921600
s_add_u32 m0,s63,2048
s_nop 0
buffer_load_dwordx4 v4,s[76:79],s60 offen lds
s_add_u32 s60,s62,930816
s_add_u32 m0,s63,3072
s_nop 0
buffer_load_dwordx4 v4,s[76:79],s60 offen lds
s_waitcnt vmcnt(12)
ds_read_b64_tr_b16 v[208:209],v3 offset:4096
ds_read_b64_tr_b16 v[210:211],v3 offset:4352
ds_read_b64_tr_b16 v[212:213],v3 offset:6144
ds_read_b64_tr_b16 v[214:215],v3 offset:6400
ds_read_b64_tr_b16 v[72:73],v3 offset:4128
ds_read_b64_tr_b16 v[74:75],v3 offset:4384
ds_read_b64_tr_b16 v[76:77],v3 offset:6176
ds_read_b64_tr_b16 v[78:79],v3 offset:6432
s_waitcnt lgkmcnt(0)
s_add_u32 s60,s62,884800
s_add_u32 m0,s63,4096
s_nop 0
buffer_load_dwordx4 v4,s[76:79],s60 offen lds
s_add_u32 s60,s62,894016
s_add_u32 m0,s63,5120
s_nop 0
buffer_load_dwordx4 v4,s[76:79],s60 offen lds
s_add_u32 s60,s62,921664
s_add_u32 m0,s63,6144
s_nop 0
buffer_load_dwordx4 v4,s[76:79],s60 offen lds
s_add_u32 s60,s62,930880
s_add_u32 m0,s63,7168
s_nop 0
buffer_load_dwordx4 v4,s[76:79],s60 offen lds
s_waitcnt vmcnt(12)
ds_read_b64_tr_b16 a[88:89],v3 offset:8192
ds_read_b64_tr_b16 a[90:91],v3 offset:8448
ds_read_b64_tr_b16 a[92:93],v3 offset:10240
ds_read_b64_tr_b16 a[94:95],v3 offset:10496
ds_read_b64_tr_b16 a[216:217],v3 offset:8224
ds_read_b64_tr_b16 a[218:219],v3 offset:8480
ds_read_b64_tr_b16 a[220:221],v3 offset:10272
ds_read_b64_tr_b16 a[222:223],v3 offset:10528
s_waitcnt lgkmcnt(0)
s_add_u32 s60,s62,958464
s_add_u32 m0,s63,8192
s_nop 0
buffer_load_dwordx4 v4,s[76:79],s60 offen lds
s_add_u32 s60,s62,967680
s_add_u32 m0,s63,9216
s_nop 0
buffer_load_dwordx4 v4,s[76:79],s60 offen lds
s_add_u32 s60,s62,995328
s_add_u32 m0,s63,10240
s_nop 0
buffer_load_dwordx4 v4,s[76:79],s60 offen lds
s_add_u32 s60,s62,1004544
s_add_u32 m0,s63,11264
s_nop 0
buffer_load_dwordx4 v4,s[76:79],s60 offen lds
s_waitcnt vmcnt(12)
ds_read_b64_tr_b16 v[216:217],v3 offset:12288
ds_read_b64_tr_b16 v[218:219],v3 offset:12544
ds_read_b64_tr_b16 v[220:221],v3 offset:14336
ds_read_b64_tr_b16 v[222:223],v3 offset:14592
ds_read_b64_tr_b16 v[80:81],v3 offset:12320
ds_read_b64_tr_b16 v[82:83],v3 offset:12576
ds_read_b64_tr_b16 v[84:85],v3 offset:14368
ds_read_b64_tr_b16 v[86:87],v3 offset:14624
s_waitcnt lgkmcnt(0)
s_add_u32 s60,s62,958528
s_add_u32 m0,s63,12288
s_nop 0
buffer_load_dwordx4 v4,s[76:79],s60 offen lds
s_add_u32 s60,s62,967744
s_add_u32 m0,s63,13312
s_nop 0
buffer_load_dwordx4 v4,s[76:79],s60 offen lds
s_add_u32 s60,s62,995392
s_add_u32 m0,s63,14336
s_nop 0
buffer_load_dwordx4 v4,s[76:79],s60 offen lds
s_add_u32 s60,s62,1004608
s_add_u32 m0,s63,15360
s_nop 0
buffer_load_dwordx4 v4,s[76:79],s60 offen lds
s_waitcnt vmcnt(12)
ds_read_b64_tr_b16 a[96:97],v3
ds_read_b64_tr_b16 a[98:99],v3 offset:256
ds_read_b64_tr_b16 a[100:101],v3 offset:2048
ds_read_b64_tr_b16 a[102:103],v3 offset:2304
ds_read_b64_tr_b16 a[224:225],v3 offset:32
ds_read_b64_tr_b16 a[226:227],v3 offset:288
ds_read_b64_tr_b16 a[228:229],v3 offset:2080
ds_read_b64_tr_b16 a[230:231],v3 offset:2336
s_waitcnt lgkmcnt(0)
s_add_u32 s60,s62,1032192
s_add_u32 m0,s63,0
s_nop 0
buffer_load_dwordx4 v4,s[76:79],s60 offen lds
s_add_u32 s60,s62,1041408
s_add_u32 m0,s63,1024
s_nop 0
buffer_load_dwordx4 v4,s[76:79],s60 offen lds
s_add_u32 s60,s62,1069056
s_add_u32 m0,s63,2048
s_nop 0
buffer_load_dwordx4 v4,s[76:79],s60 offen lds
s_add_u32 s60,s62,1078272
s_add_u32 m0,s63,3072
s_nop 0
buffer_load_dwordx4 v4,s[76:79],s60 offen lds
s_waitcnt vmcnt(12)
ds_read_b64_tr_b16 v[224:225],v3 offset:4096
ds_read_b64_tr_b16 v[226:227],v3 offset:4352
ds_read_b64_tr_b16 v[228:229],v3 offset:6144
ds_read_b64_tr_b16 v[230:231],v3 offset:6400
ds_read_b64_tr_b16 v[88:89],v3 offset:4128
ds_read_b64_tr_b16 v[90:91],v3 offset:4384
ds_read_b64_tr_b16 v[92:93],v3 offset:6176
ds_read_b64_tr_b16 v[94:95],v3 offset:6432
s_waitcnt lgkmcnt(0)
s_add_u32 s60,s62,1032256
s_add_u32 m0,s63,4096
s_nop 0
buffer_load_dwordx4 v4,s[76:79],s60 offen lds
s_add_u32 s60,s62,1041472
s_add_u32 m0,s63,5120
s_nop 0
buffer_load_dwordx4 v4,s[76:79],s60 offen lds
s_add_u32 s60,s62,1069120
s_add_u32 m0,s63,6144
s_nop 0
buffer_load_dwordx4 v4,s[76:79],s60 offen lds
s_add_u32 s60,s62,1078336
s_add_u32 m0,s63,7168
s_nop 0
buffer_load_dwordx4 v4,s[76:79],s60 offen lds
s_waitcnt vmcnt(12)
ds_read_b64_tr_b16 a[104:105],v3 offset:8192
ds_read_b64_tr_b16 a[106:107],v3 offset:8448
ds_read_b64_tr_b16 a[108:109],v3 offset:10240
ds_read_b64_tr_b16 a[110:111],v3 offset:10496
ds_read_b64_tr_b16 a[232:233],v3 offset:8224
ds_read_b64_tr_b16 a[234:235],v3 offset:8480
ds_read_b64_tr_b16 a[236:237],v3 offset:10272
ds_read_b64_tr_b16 a[238:239],v3 offset:10528
s_waitcnt lgkmcnt(0)
s_add_u32 s60,s62,1105920
s_add_u32 m0,s63,8192
s_nop 0
buffer_load_dwordx4 v4,s[76:79],s60 offen lds
s_add_u32 s60,s62,1115136
s_add_u32 m0,s63,9216
s_nop 0
buffer_load_dwordx4 v4,s[76:79],s60 offen lds
s_add_u32 s60,s62,1142784
s_add_u32 m0,s63,10240
s_nop 0
buffer_load_dwordx4 v4,s[76:79],s60 offen lds
s_add_u32 s60,s62,1152000
s_add_u32 m0,s63,11264
s_nop 0
buffer_load_dwordx4 v4,s[76:79],s60 offen lds
s_waitcnt vmcnt(12)
ds_read_b64_tr_b16 v[232:233],v3 offset:12288
ds_read_b64_tr_b16 v[234:235],v3 offset:12544
ds_read_b64_tr_b16 v[236:237],v3 offset:14336
ds_read_b64_tr_b16 v[238:239],v3 offset:14592
ds_read_b64_tr_b16 v[96:97],v3 offset:12320
ds_read_b64_tr_b16 v[98:99],v3 offset:12576
ds_read_b64_tr_b16 v[100:101],v3 offset:14368
ds_read_b64_tr_b16 v[102:103],v3 offset:14624
s_waitcnt lgkmcnt(0)
s_add_u32 s60,s62,1105984
s_add_u32 m0,s63,12288
s_nop 0
buffer_load_dwordx4 v4,s[76:79],s60 offen lds
s_add_u32 s60,s62,1115200
s_add_u32 m0,s63,13312
s_nop 0
buffer_load_dwordx4 v4,s[76:79],s60 offen lds
s_add_u32 s60,s62,1142848
s_add_u32 m0,s63,14336
s_nop 0
buffer_load_dwordx4 v4,s[76:79],s60 offen lds
s_add_u32 s60,s62,1152064
s_add_u32 m0,s63,15360
s_nop 0
buffer_load_dwordx4 v4,s[76:79],s60 offen lds
s_waitcnt vmcnt(12)
ds_read_b64_tr_b16 a[112:113],v3
ds_read_b64_tr_b16 a[114:115],v3 offset:256
ds_read_b64_tr_b16 a[116:117],v3 offset:2048
ds_read_b64_tr_b16 a[118:119],v3 offset:2304
ds_read_b64_tr_b16 a[240:241],v3 offset:32
ds_read_b64_tr_b16 a[242:243],v3 offset:288
ds_read_b64_tr_b16 a[244:245],v3 offset:2080
ds_read_b64_tr_b16 a[246:247],v3 offset:2336
s_waitcnt vmcnt(8)
ds_read_b64_tr_b16 v[240:241],v3 offset:4096
ds_read_b64_tr_b16 v[242:243],v3 offset:4352
ds_read_b64_tr_b16 v[244:245],v3 offset:6144
ds_read_b64_tr_b16 v[246:247],v3 offset:6400
ds_read_b64_tr_b16 v[104:105],v3 offset:4128
ds_read_b64_tr_b16 v[106:107],v3 offset:4384
ds_read_b64_tr_b16 v[108:109],v3 offset:6176
ds_read_b64_tr_b16 v[110:111],v3 offset:6432
s_waitcnt vmcnt(4)
ds_read_b64_tr_b16 a[120:121],v3 offset:8192
ds_read_b64_tr_b16 a[122:123],v3 offset:8448
ds_read_b64_tr_b16 a[124:125],v3 offset:10240
ds_read_b64_tr_b16 a[126:127],v3 offset:10496
ds_read_b64_tr_b16 a[248:249],v3 offset:8224
ds_read_b64_tr_b16 a[250:251],v3 offset:8480
ds_read_b64_tr_b16 a[252:253],v3 offset:10272
ds_read_b64_tr_b16 a[254:255],v3 offset:10528
s_waitcnt vmcnt(0)
ds_read_b64_tr_b16 v[248:249],v3 offset:12288
ds_read_b64_tr_b16 v[250:251],v3 offset:12544
ds_read_b64_tr_b16 v[252:253],v3 offset:14336
ds_read_b64_tr_b16 v[254:255],v3 offset:14592
ds_read_b64_tr_b16 v[112:113],v3 offset:12320
ds_read_b64_tr_b16 v[114:115],v3 offset:12576
ds_read_b64_tr_b16 v[116:117],v3 offset:14368
ds_read_b64_tr_b16 v[118:119],v3 offset:14624
s_waitcnt lgkmcnt(0)
ds_write_b128 v5,v[56:59] offset:16384
ds_write_b128 v5,v[60:63] offset:17408
ds_write_b128 v5,v[64:67] offset:18432
ds_write_b128 v5,v[68:71] offset:19456
ds_write_b128 v5,v[72:75] offset:20480
ds_write_b128 v5,v[76:79] offset:21504
ds_write_b128 v5,v[80:83] offset:22528
ds_write_b128 v5,v[84:87] offset:23552
ds_write_b128 v5,v[88:91] offset:24576
ds_write_b128 v5,v[92:95] offset:25600
ds_write_b128 v5,v[96:99] offset:26624
ds_write_b128 v5,v[100:103] offset:27648
ds_write_b128 v5,v[104:107] offset:28672
ds_write_b128 v5,v[108:111] offset:29696
ds_write_b128 v5,v[112:115] offset:30720
ds_write_b128 v5,v[116:119] offset:31744
s_waitcnt lgkmcnt(0)
s_cmp_lg_u32 s19,0
s_cbranch_scc1 ver_47
s_mov_b32 s19,1
v_mbcnt_lo_u32_b32 v18,-1,0
v_mbcnt_hi_u32_b32 v18,-1,v18
v_lshlrev_b32_e64 v12,2,v18
s_mov_b32 s63,0
el_48:
global_load_dword v13,v12,s[4:5] sc1
s_add_u32 s63,s63,1
s_cmp_gt_u32 s63,4000000
s_cbranch_scc1 w_fail
s_waitcnt vmcnt(0)
el_48s:
v_bfe_u32 v14,v13,0,8
v_bfe_u32 v15,v13,8,8
v_bfe_u32 v16,v13,16,8
v_bfe_u32 v17,v13,24,8
v_min_u32 v13,v14,v15
v_min3_u32 v13,v13,v16,v17
v_cmp_eq_u32 vcc,0,v13
s_cbranch_vccnz el_48
s_mov_b32 s62,0
elw_49:
s_add_u32 s62,s62,1
s_mov_b32 s61,0
v_cmp_eq_u32 vcc,s62,v14
s_bcnt1_i32_b64 s60,vcc
s_add_u32 s61,s61,s60
v_cmp_eq_u32 vcc,s62,v15
s_bcnt1_i32_b64 s60,vcc
s_add_u32 s61,s61,s60
v_cmp_eq_u32 vcc,s62,v16
s_bcnt1_i32_b64 s60,vcc
s_add_u32 s61,s61,s60
v_cmp_eq_u32 vcc,s62,v17
s_bcnt1_i32_b64 s60,vcc
s_add_u32 s61,s61,s60
s_cmp_ge_u32 s62,16
s_cbranch_scc1 w_fail
s_cmp_lt_u32 s61,32
s_cbranch_scc1 elw_49
s_mov_b32 s61,0
s_mov_b32 s63,0
v_cmp_gt_u32 vcc,s3,v14
s_bcnt1_i32_b64 s60,vcc
s_add_u32 s63,s63,s60
v_add_u32 v13,0,v12
v_cmp_gt_u32 s[16:17],s2,v13
v_cmp_eq_u32 vcc,s3,v14
s_and_b64 vcc,vcc,s[16:17]
s_bcnt1_i32_b64 s60,vcc
s_add_u32 s61,s61,s60
v_cmp_gt_u32 vcc,s3,v15
s_bcnt1_i32_b64 s60,vcc
s_add_u32 s63,s63,s60
v_add_u32 v13,1,v12
v_cmp_gt_u32 s[16:17],s2,v13
v_cmp_eq_u32 vcc,s3,v15
s_and_b64 vcc,vcc,s[16:17]
s_bcnt1_i32_b64 s60,vcc
s_add_u32 s61,s61,s60
v_cmp_gt_u32 vcc,s3,v16
s_bcnt1_i32_b64 s60,vcc
s_add_u32 s63,s63,s60
v_add_u32 v13,2,v12
v_cmp_gt_u32 s[16:17],s2,v13
v_cmp_eq_u32 vcc,s3,v16
s_and_b64 vcc,vcc,s[16:17]
s_bcnt1_i32_b64 s60,vcc
s_add_u32 s61,s61,s60
v_cmp_gt_u32 vcc,s3,v17
s_bcnt1_i32_b64 s60,vcc
s_add_u32 s63,s63,s60
v_add_u32 v13,3,v12
v_cmp_gt_u32 s[16:17],s2,v13
v_cmp_eq_u32 vcc,s3,v17
s_and_b64 vcc,vcc,s[16:17]
s_bcnt1_i32_b64 s60,vcc
s_add_u32 s61,s61,s60
s_add_u32 s18,s61,s63
s_cmp_gt_u32 s62,s3
s_cselect_b32 s60,32,0
s_add_u32 s18,s18,s60
s_cmp_lg_u32 s62,s3
s_cbranch_scc1 eld_50
s_cmp_lt_u32 s61,32
s_cselect_b32 s18,s61,s18
eld_50:
s_sub_u32 s60,255,s24
s_cmp_eq_u32 s60,s18
s_cbranch_scc1 ver_47
s_mov_b32 s24,s18
s_mov_b32 s10,268435456
s_waitcnt vmcnt(0) lgkmcnt(0)
s_branch k_role
ver_47:
v_and_b32 v7,7,v0
s_lshl_b32 s60,s21,3
v_add_u32 v7,s60,v7
v_lshlrev_b32_e64 v7,7,v7
aw_layer:
s_mul_i32 s60,s23,16777216
s_add_u32 s8,s6,s60
s_addc_u32 s9,s7,0
s_mov_b32 s10,23068672
s_mov_b32 s26,s33
s_add_u32 s32,s33,124
s_mul_i32 s61,s32,18432
s_lshl_b32 s60,s25,7
s_add_u32 s61,s61,s60
s_add_u32 s61,s61,9437184
v_mov_b32 v48,-1
v_mov_b32_e64 v49,-1
buffer_store_dwordx2 v[48:49],v2,s[8:11],s61 offen sc1
s_add_u32 s32,s33,120
s_mul_i32 s61,s32,18432
s_lshl_b32 s60,s25,7
s_add_u32 s61,s61,s60
s_add_u32 s61,s61,9437184
v_mov_b32 v48,-1
v_mov_b32 v49,-1
buffer_store_dwordx2 v[48:49],v2,s[8:11],s61 offen sc1
w_awo_wait:
s_lshr_b32 s63,s26,1
s_lshl_b32 s63,s63,12
s_add_u32 s63,s63,20971520
s_lshl_b32 s60,s21,10
s_add_u32 s63,s63,s60
v_min_u32 v10,7,v0
v_lshlrev_b32 v10,7,v10
s_branch wf_52_0f
wf_52_0:
s_sleep 1
wf_52_0f:
buffer_load_dword v11,v10,s[8:11],s63 offen sc1
s_add_u32 s38,s38,1
s_cmp_gt_u32 s38,3000000
s_cbranch_scc1 w_fail
s_waitcnt vmcnt(0)
v_cmp_gt_u32 vcc,1,v11
s_cbranch_vccnz wf_52_0
s_add_u32 s38,s38,64
s_cmp_gt_u32 s38,3000000
s_cbranch_scc1 w_fail
s_lshl_b32 s27,s26,17
s_lshl_b32 s60,s21,15
s_add_u32 s27,s27,s60
s_add_u32 s27,s27,94371840
buffer_load_dword v14,v9,s[88:91],s27 offen sc1
s_mul_i32 s28,s26,18432
s_lshl_b32 s60,s25,7
s_add_u32 s28,s28,s60
buffer_load_dwordx2 v[12:13],v2,s[12:15],s28 offen sc1
s_nop 15
s_add_u32 s29,s27,0
buffer_load_dwordx4 v[56:59],v1,s[88:91],s29 offen sc1
buffer_load_dwordx4 v[60:63],v1,s[88:91],s29 offen offset:1024 sc1
buffer_load_dwordx4 v[64:67],v1,s[88:91],s29 offen offset:2048 sc1
buffer_load_dwordx4 v[68:71],v1,s[88:91],s29 offen offset:3072 sc1
s_add_u32 s29,s27,4096
buffer_load_dwordx4 v[72:75],v1,s[88:91],s29 offen sc1
buffer_load_dwordx4 v[76:79],v1,s[88:91],s29 offen offset:1024 sc1
buffer_load_dwordx4 v[80:83],v1,s[88:91],s29 offen offset:2048 sc1
s_mov_b32 s31,0x40000000
v_mov_b32 v10,0
v_mov_b32 v11,1
s_mov_b64 exec,1
buffer_store_dword v11,v10,s[8:11],s31 offen sc1
s_mov_b64 exec,-1
w_awo:
s_add_u32 s32,s26,4
s_lshr_b32 s30,s32,1
s_lshl_b32 s30,s30,12
s_add_u32 s30,s30,20971520
s_lshr_b32 s31,s26,1
s_lshl_b32 s31,s31,5
s_and_b32 s60,s26,1
s_mul_i32 s60,s60,9
s_add_u32 s31,s31,s60
s_add_u32 s31,s31,s25
s_lshl_b32 s31,s31,7
s_add_u32 s31,s31,21233664
ds_read_b128 v[32:35],v5
ds_read_b128 v[36:39],v5 offset:1024
s_waitcnt vmcnt(7) lgkmcnt(1)
v_mfma_f32_16x16x32_bf16 v[16:19],a[0:3],v[56:59],0
ds_read_b128 v[40:43],v5 offset:2048
v_mfma_f32_16x16x32_bf16 v[20:23],a[128:131],v[56:59],0
buffer_load_dwordx4 v[84:87],v1,s[88:91],s29 offen offset:3072 sc1
v_mfma_f32_16x16x32_bf16 v[24:27],v[128:131],v[56:59],0
s_add_u32 s29,s27,8192
buffer_load_dwordx4 v[88:91],v1,s[88:91],s29 offen sc1
v_mfma_f32_16x16x32_bf16 v[28:31],v[32:35],v[56:59],0
s_waitcnt vmcnt(8) lgkmcnt(1)
v_mfma_f32_16x16x32_bf16 v[16:19],a[4:7],v[60:63],v[16:19]
ds_read_b128 v[32:35],v5 offset:3072
v_mfma_f32_16x16x32_bf16 v[20:23],a[132:135],v[60:63],v[20:23]
buffer_load_dwordx4 v[92:95],v1,s[88:91],s29 offen offset:1024 sc1
v_mfma_f32_16x16x32_bf16 v[24:27],v[132:135],v[60:63],v[24:27]
v_mfma_f32_16x16x32_bf16 v[28:31],v[36:39],v[60:63],v[28:31]
s_waitcnt vmcnt(8) lgkmcnt(1)
v_mfma_f32_16x16x32_bf16 v[16:19],a[8:11],v[64:67],v[16:19]
ds_read_b128 v[36:39],v5 offset:4096
v_mfma_f32_16x16x32_bf16 v[20:23],a[136:139],v[64:67],v[20:23]
buffer_load_dwordx4 v[96:99],v1,s[88:91],s29 offen offset:2048 sc1
v_mfma_f32_16x16x32_bf16 v[24:27],v[136:139],v[64:67],v[24:27]
v_mfma_f32_16x16x32_bf16 v[28:31],v[40:43],v[64:67],v[28:31]
s_waitcnt vmcnt(8) lgkmcnt(1)
v_mfma_f32_16x16x32_bf16 v[16:19],a[12:15],v[68:71],v[16:19]
ds_read_b128 v[40:43],v5 offset:5120
v_mfma_f32_16x16x32_bf16 v[20:23],a[140:143],v[68:71],v[20:23]
buffer_load_dwordx4 v[100:103],v1,s[88:91],s29 offen offset:3072 sc1
v_mfma_f32_16x16x32_bf16 v[24:27],v[140:143],v[68:71],v[24:27]
s_add_u32 s29,s27,12288
buffer_load_dwordx4 v[104:107],v1,s[88:91],s29 offen sc1
v_mfma_f32_16x16x32_bf16 v[28:31],v[32:35],v[68:71],v[28:31]
s_waitcnt vmcnt(9) lgkmcnt(1)
v_mfma_f32_16x16x32_bf16 v[16:19],a[16:19],v[72:75],v[16:19]
ds_read_b128 v[32:35],v5 offset:6144
v_mfma_f32_16x16x32_bf16 v[20:23],a[144:147],v[72:75],v[20:23]
buffer_load_dwordx4 v[108:111],v1,s[88:91],s29 offen offset:1024 sc1
v_mfma_f32_16x16x32_bf16 v[24:27],v[144:147],v[72:75],v[24:27]
v_mfma_f32_16x16x32_bf16 v[28:31],v[36:39],v[72:75],v[28:31]
s_waitcnt vmcnt(9) lgkmcnt(1)
v_mfma_f32_16x16x32_bf16 v[16:19],a[20:23],v[76:79],v[16:19]
ds_read_b128 v[36:39],v5 offset:7168
v_mfma_f32_16x16x32_bf16 v[20:23],a[148:151],v[76:79],v[20:23]
buffer_load_dwordx4 v[112:115],v1,s[88:91],s29 offen offset:2048 sc1
v_mfma_f32_16x16x32_bf16 v[24:27],v[148:151],v[76:79],v[24:27]
v_mfma_f32_16x16x32_bf16 v[28:31],v[40:43],v[76:79],v[28:31]
s_waitcnt vmcnt(9) lgkmcnt(1)
v_mfma_f32_16x16x32_bf16 v[16:19],a[24:27],v[80:83],v[16:19]
ds_read_b128 v[40:43],v5 offset:8192
v_mfma_f32_16x16x32_bf16 v[20:23],a[152:155],v[80:83],v[20:23]
buffer_load_dwordx4 v[116:119],v1,s[88:91],s29 offen offset:3072 sc1
v_mfma_f32_16x16x32_bf16 v[24:27],v[152:155],v[80:83],v[24:27]
s_add_u32 s29,s27,16384
buffer_load_dwordx4 v[120:123],v1,s[88:91],s29 offen sc1
v_mfma_f32_16x16x32_bf16 v[28:31],v[32:35],v[80:83],v[28:31]
s_waitcnt vmcnt(9) lgkmcnt(1)
v_mfma_f32_16x16x32_bf16 v[16:19],a[28:31],v[84:87],v[16:19]
ds_read_b128 v[32:35],v5 offset:9216
v_mfma_f32_16x16x32_bf16 v[20:23],a[156:159],v[84:87],v[20:23]
buffer_load_dwordx4 v[124:127],v1,s[88:91],s29 offen offset:1024 sc1
v_mfma_f32_16x16x32_bf16 v[24:27],v[156:159],v[84:87],v[24:27]
v_mfma_f32_16x16x32_bf16 v[28:31],v[36:39],v[84:87],v[28:31]
s_waitcnt vmcnt(9) lgkmcnt(1)
v_mfma_f32_16x16x32_bf16 v[16:19],a[32:35],v[88:91],v[16:19]
ds_read_b128 v[36:39],v5 offset:10240
v_mfma_f32_16x16x32_bf16 v[20:23],a[160:163],v[88:91],v[20:23]
buffer_load_dwordx4 v[56:59],v1,s[88:91],s29 offen offset:2048 sc1
v_mfma_f32_16x16x32_bf16 v[24:27],v[160:163],v[88:91],v[24:27]
v_mfma_f32_16x16x32_bf16 v[28:31],v[40:43],v[88:91],v[28:31]
s_waitcnt vmcnt(9) lgkmcnt(1)
v_mfma_f32_16x16x32_bf16 v[16:19],a[36:39],v[92:95],v[16:19]
ds_read_b128 v[40:43],v5 offset:11264
v_mfma_f32_16x16x32_bf16 v[20:23],a[164:167],v[92:95],v[20:23]
buffer_load_dwordx4 v[60:63],v1,s[88:91],s29 offen offset:3072 sc1
v_mfma_f32_16x16x32_bf16 v[24:27],v[164:167],v[92:95],v[24:27]
s_add_u32 s29,s27,20480
buffer_load_dwordx4 v[64:67],v1,s[88:91],s29 offen sc1
v_mfma_f32_16x16x32_bf16 v[28:31],v[32:35],v[92:95],v[28:31]
s_waitcnt vmcnt(10) lgkmcnt(1)
v_mfma_f32_16x16x32_bf16 v[16:19],a[40:43],v[96:99],v[16:19]
ds_read_b128 v[32:35],v5 offset:12288
v_mfma_f32_16x16x32_bf16 v[20:23],a[168:171],v[96:99],v[20:23]
buffer_load_dwordx4 v[68:71],v1,s[88:91],s29 offen offset:1024 sc1
v_mfma_f32_16x16x32_bf16 v[24:27],v[168:171],v[96:99],v[24:27]
v_mfma_f32_16x16x32_bf16 v[28:31],v[36:39],v[96:99],v[28:31]
s_waitcnt vmcnt(10) lgkmcnt(1)
v_mfma_f32_16x16x32_bf16 v[16:19],a[44:47],v[100:103],v[16:19]
ds_read_b128 v[36:39],v5 offset:13312
v_mfma_f32_16x16x32_bf16 v[20:23],a[172:175],v[100:103],v[20:23]
buffer_load_dwordx4 v[72:75],v1,s[88:91],s29 offen offset:2048 sc1
v_mfma_f32_16x16x32_bf16 v[24:27],v[172:175],v[100:103],v[24:27]
v_mfma_f32_16x16x32_bf16 v[28:31],v[40:43],v[100:103],v[28:31]
s_waitcnt vmcnt(10) lgkmcnt(1)
v_mfma_f32_16x16x32_bf16 v[16:19],a[48:51],v[104:107],v[16:19]
ds_read_b128 v[40:43],v5 offset:14336
v_mfma_f32_16x16x32_bf16 v[20:23],a[176:179],v[104:107],v[20:23]
buffer_load_dwordx4 v[76:79],v1,s[88:91],s29 offen offset:3072 sc1
v_mfma_f32_16x16x32_bf16 v[24:27],v[176:179],v[104:107],v[24:27]
s_add_u32 s29,s27,24576
buffer_load_dwordx4 v[80:83],v1,s[88:91],s29 offen sc1
v_mfma_f32_16x16x32_bf16 v[28:31],v[32:35],v[104:107],v[28:31]
s_waitcnt vmcnt(11) lgkmcnt(1)
v_mfma_f32_16x16x32_bf16 v[16:19],a[52:55],v[108:111],v[16:19]
ds_read_b128 v[32:35],v5 offset:15360
v_mfma_f32_16x16x32_bf16 v[20:23],a[180:183],v[108:111],v[20:23]
buffer_load_dwordx4 v[84:87],v1,s[88:91],s29 offen offset:1024 sc1
v_mfma_f32_16x16x32_bf16 v[24:27],v[180:183],v[108:111],v[24:27]
v_mfma_f32_16x16x32_bf16 v[28:31],v[36:39],v[108:111],v[28:31]
s_waitcnt vmcnt(11) lgkmcnt(1)
v_mfma_f32_16x16x32_bf16 v[16:19],a[56:59],v[112:115],v[16:19]
ds_read_b128 v[36:39],v5 offset:16384
v_mfma_f32_16x16x32_bf16 v[20:23],a[184:187],v[112:115],v[20:23]
buffer_load_dwordx4 v[88:91],v1,s[88:91],s29 offen offset:2048 sc1
v_mfma_f32_16x16x32_bf16 v[24:27],v[184:187],v[112:115],v[24:27]
v_mfma_f32_16x16x32_bf16 v[28:31],v[40:43],v[112:115],v[28:31]
s_waitcnt vmcnt(11) lgkmcnt(1)
v_mfma_f32_16x16x32_bf16 v[16:19],a[60:63],v[116:119],v[16:19]
ds_read_b128 v[40:43],v5 offset:17408
v_mfma_f32_16x16x32_bf16 v[20:23],a[188:191],v[116:119],v[20:23]
buffer_load_dwordx4 v[92:95],v1,s[88:91],s29 offen offset:3072 sc1
v_mfma_f32_16x16x32_bf16 v[24:27],v[188:191],v[116:119],v[24:27]
s_add_u32 s29,s27,28672
buffer_load_dwordx4 v[96:99],v1,s[88:91],s29 offen sc1
v_mfma_f32_16x16x32_bf16 v[28:31],v[32:35],v[116:119],v[28:31]
s_waitcnt vmcnt(12) lgkmcnt(1)
v_mfma_f32_16x16x32_bf16 v[16:19],a[64:67],v[120:123],v[16:19]
ds_read_b128 v[32:35],v5 offset:18432
v_mfma_f32_16x16x32_bf16 v[20:23],a[192:195],v[120:123],v[20:23]
buffer_load_dwordx4 v[100:103],v1,s[88:91],s29 offen offset:1024 sc1
v_mfma_f32_16x16x32_bf16 v[24:27],v[192:195],v[120:123],v[24:27]
v_mfma_f32_16x16x32_bf16 v[28:31],v[36:39],v[120:123],v[28:31]
s_waitcnt vmcnt(12) lgkmcnt(1)
v_mfma_f32_16x16x32_bf16 v[16:19],a[68:71],v[124:127],v[16:19]
ds_read_b128 v[36:39],v5 offset:19456
v_mfma_f32_16x16x32_bf16 v[20:23],a[196:199],v[124:127],v[20:23]
buffer_load_dwordx4 v[104:107],v1,s[88:91],s29 offen offset:2048 sc1
v_mfma_f32_16x16x32_bf16 v[24:27],v[196:199],v[124:127],v[24:27]
v_mfma_f32_16x16x32_bf16 v[28:31],v[40:43],v[124:127],v[28:31]
s_waitcnt vmcnt(12) lgkmcnt(1)
v_mfma_f32_16x16x32_bf16 v[16:19],a[72:75],v[56:59],v[16:19]
ds_read_b128 v[40:43],v5 offset:20480
v_mfma_f32_16x16x32_bf16 v[20:23],a[200:203],v[56:59],v[20:23]
buffer_load_dwordx4 v[108:111],v1,s[88:91],s29 offen offset:3072 sc1
v_mfma_f32_16x16x32_bf16 v[24:27],v[200:203],v[56:59],v[24:27]
v_mfma_f32_16x16x32_bf16 v[28:31],v[32:35],v[56:59],v[28:31]
s_waitcnt vmcnt(12) lgkmcnt(1)
v_mfma_f32_16x16x32_bf16 v[16:19],a[76:79],v[60:63],v[16:19]
ds_read_b128 v[32:35],v5 offset:21504
v_mfma_f32_16x16x32_bf16 v[20:23],a[204:207],v[60:63],v[20:23]
buffer_load_dword v8,v7,s[8:11],s30 offen sc1
v_mfma_f32_16x16x32_bf16 v[24:27],v[204:207],v[60:63],v[24:27]
v_mfma_f32_16x16x32_bf16 v[28:31],v[36:39],v[60:63],v[28:31]
s_waitcnt vmcnt(12) lgkmcnt(1)
v_mfma_f32_16x16x32_bf16 v[16:19],a[80:83],v[64:67],v[16:19]
ds_read_b128 v[36:39],v5 offset:22528
v_mfma_f32_16x16x32_bf16 v[20:23],a[208:211],v[64:67],v[20:23]
v_mfma_f32_16x16x32_bf16 v[24:27],v[208:211],v[64:67],v[24:27]
v_mfma_f32_16x16x32_bf16 v[28:31],v[40:43],v[64:67],v[28:31]
s_waitcnt vmcnt(11) lgkmcnt(1)
v_mfma_f32_16x16x32_bf16 v[16:19],a[84:87],v[68:71],v[16:19]
ds_read_b128 v[40:43],v5 offset:23552
v_mfma_f32_16x16x32_bf16 v[20:23],a[212:215],v[68:71],v[20:23]
v_mfma_f32_16x16x32_bf16 v[24:27],v[212:215],v[68:71],v[24:27]
v_mfma_f32_16x16x32_bf16 v[28:31],v[32:35],v[68:71],v[28:31]
s_waitcnt vmcnt(10) lgkmcnt(1)
v_mfma_f32_16x16x32_bf16 v[16:19],a[88:91],v[72:75],v[16:19]
ds_read_b128 v[32:35],v5 offset:24576
v_mfma_f32_16x16x32_bf16 v[20:23],a[216:219],v[72:75],v[20:23]
v_mfma_f32_16x16x32_bf16 v[24:27],v[216:219],v[72:75],v[24:27]
v_mfma_f32_16x16x32_bf16 v[28:31],v[36:39],v[72:75],v[28:31]
s_waitcnt vmcnt(9) lgkmcnt(1)
v_mfma_f32_16x16x32_bf16 v[16:19],a[92:95],v[76:79],v[16:19]
ds_read_b128 v[36:39],v5 offset:25600
v_mfma_f32_16x16x32_bf16 v[20:23],a[220:223],v[76:79],v[20:23]
v_mfma_f32_16x16x32_bf16 v[24:27],v[220:223],v[76:79],v[24:27]
v_mfma_f32_16x16x32_bf16 v[28:31],v[40:43],v[76:79],v[28:31]
s_waitcnt vmcnt(8) lgkmcnt(1)
v_mfma_f32_16x16x32_bf16 v[16:19],a[96:99],v[80:83],v[16:19]
ds_read_b128 v[40:43],v5 offset:26624
v_mfma_f32_16x16x32_bf16 v[20:23],a[224:227],v[80:83],v[20:23]
v_mfma_f32_16x16x32_bf16 v[24:27],v[224:227],v[80:83],v[24:27]
v_mfma_f32_16x16x32_bf16 v[28:31],v[32:35],v[80:83],v[28:31]
s_waitcnt vmcnt(7) lgkmcnt(1)
v_mfma_f32_16x16x32_bf16 v[16:19],a[100:103],v[84:87],v[16:19]
ds_read_b128 v[32:35],v5 offset:27648
v_mfma_f32_16x16x32_bf16 v[20:23],a[228:231],v[84:87],v[20:23]
v_mfma_f32_16x16x32_bf16 v[24:27],v[228:231],v[84:87],v[24:27]
v_mfma_f32_16x16x32_bf16 v[28:31],v[36:39],v[84:87],v[28:31]
s_waitcnt vmcnt(6) lgkmcnt(1)
v_mfma_f32_16x16x32_bf16 v[16:19],a[104:107],v[88:91],v[16:19]
ds_read_b128 v[36:39],v5 offset:28672
v_mfma_f32_16x16x32_bf16 v[20:23],a[232:235],v[88:91],v[20:23]
v_mfma_f32_16x16x32_bf16 v[24:27],v[232:235],v[88:91],v[24:27]
v_mfma_f32_16x16x32_bf16 v[28:31],v[40:43],v[88:91],v[28:31]
s_waitcnt vmcnt(5) lgkmcnt(1)
v_mfma_f32_16x16x32_bf16 v[16:19],a[108:111],v[92:95],v[16:19]
ds_read_b128 v[40:43],v5 offset:29696
v_mfma_f32_16x16x32_bf16 v[20:23],a[236:239],v[92:95],v[20:23]
v_mfma_f32_16x16x32_bf16 v[24:27],v[236:239],v[92:95],v[24:27]
v_mfma_f32_16x16x32_bf16 v[28:31],v[32:35],v[92:95],v[28:31]
s_waitcnt vmcnt(4) lgkmcnt(1)
v_mfma_f32_16x16x32_bf16 v[16:19],a[112:115],v[96:99],v[16:19]
ds_read_b128 v[32:35],v5 offset:30720
v_mfma_f32_16x16x32_bf16 v[20:23],a[240:243],v[96:99],v[20:23]
v_mfma_f32_16x16x32_bf16 v[24:27],v[240:243],v[96:99],v[24:27]
v_mfma_f32_16x16x32_bf16 v[28:31],v[36:39],v[96:99],v[28:31]
s_waitcnt vmcnt(3) lgkmcnt(1)
v_mfma_f32_16x16x32_bf16 v[16:19],a[116:119],v[100:103],v[16:19]
ds_read_b128 v[36:39],v5 offset:31744
v_mfma_f32_16x16x32_bf16 v[20:23],a[244:247],v[100:103],v[20:23]
v_mfma_f32_16x16x32_bf16 v[24:27],v[244:247],v[100:103],v[24:27]
v_mfma_f32_16x16x32_bf16 v[28:31],v[40:43],v[100:103],v[28:31]
s_cmp_ge_u32 s26,120
s_cselect_b32 s18,s31,0x40000000
s_cmp_eq_u32 s21,0
s_cselect_b32 s18,s18,0x40000000
v_mov_b32 v10,0
v_mov_b32 v11,1
s_mov_b64 exec,1
buffer_store_dword v11,v10,s[8:11],s18 offen sc1
s_mov_b64 exec,-1
s_waitcnt vmcnt(3) lgkmcnt(1)
v_mfma_f32_16x16x32_bf16 v[16:19],a[120:123],v[104:107],v[16:19]
v_mfma_f32_16x16x32_bf16 v[20:23],a[248:251],v[104:107],v[20:23]
v_mfma_f32_16x16x32_bf16 v[24:27],v[248:251],v[104:107],v[24:27]
v_mfma_f32_16x16x32_bf16 v[28:31],v[32:35],v[104:107],v[28:31]
s_waitcnt vmcnt(2) lgkmcnt(0)
v_mfma_f32_16x16x32_bf16 v[16:19],a[124:127],v[108:111],v[16:19]
v_mfma_f32_16x16x32_bf16 v[20:23],a[252:255],v[108:111],v[20:23]
v_mfma_f32_16x16x32_bf16 v[24:27],v[252:255],v[108:111],v[24:27]
v_mfma_f32_16x16x32_bf16 v[28:31],v[36:39],v[108:111],v[28:31]
v_cmp_u_f32 vcc,v16,v16
s_cbranch_vccnz w_awo_wait
ds_write_b128 v6,v[16:19]
ds_write_b128 v6,v[20:23] offset:1088
ds_write_b128 v6,v[24:27] offset:2176
s_nop 1
ds_write_b128 v6,v[28:31] offset:3264
s_add_u32 s61,s28,9437184
s_waitcnt lgkmcnt(0) vmcnt(0)
s_barrier
ds_read_b128 v[32:35],v55
ds_read_b128 v[36:39],v55 offset:4352
ds_read_b128 v[40:43],v55 offset:8704
ds_read_b128 v[44:47],v55 offset:13056
s_waitcnt lgkmcnt(0)
v_pk_add_f32 v[32:33],v[32:33],v[36:37]
v_pk_add_f32 v[40:41],v[40:41],v[44:45]
v_pk_add_f32 v[34:35],v[34:35],v[38:39]
v_pk_add_f32 v[42:43],v[42:43],v[46:47]
v_pk_add_f32 v[48:49],v[32:33],v[40:41]
v_pk_add_f32 v[50:51],v[34:35],v[42:43]
v_lshlrev_b32_e64 v52,16,v12
v_and_b32 v53,0xffff0000,v12
v_add_f32 v52,v52,v48
v_add_f32 v53,v53,v49
v_cvt_pk_bf16_f32 v48,v52,v53
v_lshlrev_b32_e64 v52,16,v13
v_and_b32 v53,0xffff0000,v13
v_add_f32 v52,v52,v50
v_add_f32 v53,v53,v51
v_cvt_pk_bf16_f32 v49,v52,v53
buffer_store_dwordx2 v[48:49],v2,s[8:11],s61 offen sc1
s_mov_b32 s26,s32
v_cmp_eq_u32 vcc,0,v8
s_cmp_ge_u32 s32,128
s_cbranch_scc1 w_awo_sync
s_cbranch_vccnz w_awo_sync
s_lshl_b32 s27,s26,17
s_lshl_b32 s60,s21,15
s_add_u32 s27,s27,s60
s_add_u32 s27,s27,94371840
buffer_load_dword v14,v9,s[88:91],s27 offen sc1
s_mul_i32 s28,s26,18432
s_lshl_b32 s60,s25,7
s_add_u32 s28,s28,s60
buffer_load_dwordx2 v[12:13],v2,s[12:15],s28 offen sc1
s_nop 15
s_add_u32 s29,s27,0
buffer_load_dwordx4 v[56:59],v1,s[88:91],s29 offen sc1
buffer_load_dwordx4 v[60:63],v1,s[88:91],s29 offen offset:1024 sc1
buffer_load_dwordx4 v[64:67],v1,s[88:91],s29 offen offset:2048 sc1
buffer_load_dwordx4 v[68:71],v1,s[88:91],s29 offen offset:3072 sc1
s_add_u32 s29,s27,4096
buffer_load_dwordx4 v[72:75],v1,s[88:91],s29 offen sc1
buffer_load_dwordx4 v[76:79],v1,s[88:91],s29 offen offset:1024 sc1
buffer_load_dwordx4 v[80:83],v1,s[88:91],s29 offen offset:2048 sc1
s_waitcnt vmcnt(9)
s_barrier
s_cmp_lg_u32 s21,0
s_cselect_b32 s31,0x40000000,s31
v_mov_b32 v10,0
v_mov_b32 v11,1
s_mov_b64 exec,1
buffer_store_dword v11,v10,s[8:11],s31 offen sc1
s_mov_b64 exec,-1
s_branch w_awo
w_awo_sync:
s_cmp_lt_u32 s32,124
s_cbranch_scc1 w_awo_s1
s_barrier
s_branch w_awo_s2
w_awo_s1:
s_waitcnt vmcnt(0)
s_barrier
s_cmp_lg_u32 s21,0
s_cselect_b32 s31,0x40000000,s31
v_mov_b32 v10,0
v_mov_b32_e64 v11,1
s_mov_b64 exec,1
buffer_store_dword v11,v10,s[8:11],s31 offen sc1
s_mov_b64 exec,-1
w_awo_s2:
s_cmp_lt_u32 s26,128
s_cbranch_scc1 w_awo_wait
s_mul_i32 s61,s33,9
s_add_u32 s61,s61,s37
s_add_u32 s61,s61,27
s_cmp_lg_u32 s23,0
s_cbranch_scc1 w_bwo
s_add_u32 s12,s6,39321600
s_addc_u32 s13,s7,0
s_mov_b32 s14,2359296
s_mov_b32 s15,0x20000
s_add_u32 s23,s23,1
s_cmp_lt_u32 s23,2
s_cbranch_scc1 aw_layer
s_branch w_fail
w_bqr:
s_mov_b32 s76,s68
s_mov_b32 s77,s69
s_mov_b32 s78,4718592
s_mov_b32 s79,0x20000
s_lshl_b32 s60,s61,2
s_add_u32 s60,s60,s21
s_lshl_b32 s60,s60,13
v_lshlrev_b32_e64 v3,7,v0
buffer_load_dword v4,v3,s[76:79],s60 offen sc1
s_add_u32 s60,s60,884736
buffer_load_dword v4,v3,s[76:79],s60 offen sc1
s_add_u32 s60,s60,884736
buffer_load_dword v4,v3,s[76:79],s60 offen sc1
s_add_u32 s60,s60,884736
buffer_load_dword v4,v3,s[76:79],s60 offen sc1
s_add_u32 s60,s60,884736
buffer_load_dword v4,v3,s[76:79],s60 offen sc1
s_add_u32 s60,s60,884736
buffer_load_dword v4,v3,s[76:79],s60 offen sc1
s_add_u32 s60,s60,884736
s_waitcnt vmcnt(0)
s_mul_i32 s61,s39,9
s_add_u32 s61,s61,s37
s_mul_i32 s26,s61,43691
s_lshr_b32 s26,s26,17
s_mul_i32 s60,s26,3
s_sub_u32 s25,s61,s60
s_sub_u32 s60,63,s26
s_cmp_eq_u32 s23,0
s_cselect_b32 s26,s26,s60
s_mov_b32 s76,s94
s_mov_b32 s77,s95
s_mov_b32 s78,663552
s_mov_b32 s79,0x20000
s_lshl_b32 s63,s21,14
s_add_u32 s63,s63,81920
v_lshrrev_b32 v10,4,v0
v_bfe_u32 v11,v0,2,2
v_lshl_add_u32 v10,v10,3,v11
v_lshlrev_b32 v10,6,v10
v_and_b32 v11,3,v0
v_lshl_add_u32 v10,v11,3,v10
v_add_u32 v3,s63,v10
v_bfe_u32 v10,v0,2,2
v_bfe_u32 v11,v0,4,1
v_lshl_add_u32 v10,v11,3,v10
v_lshrrev_b32 v11,5,v0
v_lshl_add_u32 v10,v11,2,v10
v_mul_u32_u24 v10,1152,v10
v_and_b32 v11,3,v0
v_lshlrev_b32 v11,4,v11
v_add_u32 v4,v11,v10
v_bfe_u32 v12,v0,1,1
v_mul_u32_u24 v12,82944,v12
v_and_b32_e64 v13,1,v0
v_lshl_add_u32 v12,v13,4,v12
v_add_u32 v5,v10,v12
v_lshrrev_b32 v12,3,v0
v_mul_u32_u24 v12,18,v12
v_bfe_u32 v13,v0,2,1
v_add_u32 v12,v12,v13
v_mul_u32_u24 v12,1152,v12
v_add_u32 v6,v11,v12
s_lshl_b32 s62,s25,2
s_add_u32 s62,s62,s21
s_mul_i32 s62,s62,96
s_add_u32 s60,s62,0
s_add_u32 m0,s63,0
s_nop 0
buffer_load_dwordx4 v4,s[76:79],s60 offen lds
s_add_u32 s60,s62,20736
s_add_u32 m0,s63,1024
s_nop 0
buffer_load_dwordx4 v4,s[76:79],s60 offen lds
s_add_u32 s60,s62,41472
s_add_u32 m0,s63,2048
s_nop 0
buffer_load_dwordx4 v4,s[76:79],s60 offen lds
s_add_u32 s60,s62,62208
s_add_u32 m0,s63,3072
s_nop 0
buffer_load_dwordx4 v4,s[76:79],s60 offen lds
s_add_u32 s60,s62,82944
s_add_u32 m0,s63,4096
s_nop 0
buffer_load_dwordx4 v4,s[76:79],s60 offen lds
s_add_u32 s60,s62,103680
s_add_u32 m0,s63,5120
s_nop 0
buffer_load_dwordx4 v4,s[76:79],s60 offen lds
s_add_u32 s60,s62,124416
s_add_u32 m0,s63,6144
s_nop 0
buffer_load_dwordx4 v4,s[76:79],s60 offen lds
s_add_u32 s60,s62,145152
s_add_u32 m0,s63,7168
s_nop 0
buffer_load_dwordx4 v4,s[76:79],s60 offen lds
s_add_u32 s60,s62,165888
s_add_u32 m0,s63,8192
s_nop 0
buffer_load_dwordx4 v4,s[76:79],s60 offen lds
s_add_u32 s60,s62,186624
s_add_u32 m0,s63,9216
s_nop 0
buffer_load_dwordx4 v4,s[76:79],s60 offen lds
s_add_u32 s60,s62,207360
s_add_u32 m0,s63,10240
s_nop 0
buffer_load_dwordx4 v4,s[76:79],s60 offen lds
s_add_u32 s60,s62,228096
s_add_u32 m0,s63,11264
s_nop 0
buffer_load_dwordx4 v4,s[76:79],s60 offen lds
s_waitcnt lgkmcnt(0)
s_add_u32 s60,s62,248832
s_add_u32 m0,s63,12288
s_nop 0
buffer_load_dwordx4 v4,s[76:79],s60 offen lds
s_add_u32 s60,s62,269568
s_add_u32 m0,s63,13312
s_nop 0
buffer_load_dwordx4 v4,s[76:79],s60 offen lds
s_add_u32 s60,s62,290304
s_add_u32 m0,s63,14336
s_nop 0
buffer_load_dwordx4 v4,s[76:79],s60 offen lds
s_add_u32 s60,s62,311040
s_add_u32 m0,s63,15360
s_nop 0
buffer_load_dwordx4 v4,s[76:79],s60 offen lds
s_waitcnt vmcnt(12)
ds_read_b64_tr_b16 a[0:1],v3
ds_read_b64_tr_b16 a[2:3],v3 offset:256
ds_read_b64_tr_b16 a[4:5],v3 offset:2048
ds_read_b64_tr_b16 a[6:7],v3 offset:2304
ds_read_b64_tr_b16 a[72:73],v3 offset:32
ds_read_b64_tr_b16 a[74:75],v3 offset:288
ds_read_b64_tr_b16 a[76:77],v3 offset:2080
ds_read_b64_tr_b16 a[78:79],v3 offset:2336
s_waitcnt lgkmcnt(0)
s_add_u32 s60,s62,331776
s_add_u32 m0,s63,0
s_nop 0
buffer_load_dwordx4 v4,s[76:79],s60 offen lds
s_add_u32 s60,s62,352512
s_add_u32 m0,s63,1024
s_nop 0
buffer_load_dwordx4 v4,s[76:79],s60 offen lds
s_add_u32 s60,s62,373248
s_add_u32 m0,s63,2048
s_nop 0
buffer_load_dwordx4 v4,s[76:79],s60 offen lds
s_add_u32 s60,s62,393984
s_add_u32 m0,s63,3072
s_nop 0
buffer_load_dwordx4 v4,s[76:79],s60 offen lds
s_waitcnt vmcnt(12)
ds_read_b64_tr_b16 a[8:9],v3 offset:4096
ds_read_b64_tr_b16 a[10:11],v3 offset:4352
ds_read_b64_tr_b16 a[12:13],v3 offset:6144
ds_read_b64_tr_b16 a[14:15],v3 offset:6400
ds_read_b64_tr_b16 a[80:81],v3 offset:4128
ds_read_b64_tr_b16 a[82:83],v3 offset:4384
ds_read_b64_tr_b16 a[84:85],v3 offset:6176
ds_read_b64_tr_b16 a[86:87],v3 offset:6432
s_waitcnt lgkmcnt(0)
s_add_u32 s60,s62,414720
s_add_u32 m0,s63,4096
s_nop 0
buffer_load_dwordx4 v4,s[76:79],s60 offen lds
s_add_u32 s60,s62,435456
s_add_u32 m0,s63,5120
s_nop 0
buffer_load_dwordx4 v4,s[76:79],s60 offen lds
s_add_u32 s60,s62,456192
s_add_u32 m0,s63,6144
s_nop 0
buffer_load_dwordx4 v4,s[76:79],s60 offen lds
s_add_u32 s60,s62,476928
s_add_u32 m0,s63,7168
s_nop 0
buffer_load_dwordx4 v4,s[76:79],s60 offen lds
s_waitcnt vmcnt(12)
ds_read_b64_tr_b16 a[16:17],v3 offset:8192
ds_read_b64_tr_b16 a[18:19],v3 offset:8448
ds_read_b64_tr_b16 a[20:21],v3 offset:10240
ds_read_b64_tr_b16 a[22:23],v3 offset:10496
ds_read_b64_tr_b16 a[88:89],v3 offset:8224
ds_read_b64_tr_b16 a[90:91],v3 offset:8480
ds_read_b64_tr_b16 a[92:93],v3 offset:10272
ds_read_b64_tr_b16 a[94:95],v3 offset:10528
s_waitcnt lgkmcnt(0)
s_add_u32 s60,s62,497664
s_add_u32 m0,s63,8192
s_nop 0
buffer_load_dwordx4 v4,s[76:79],s60 offen lds
s_add_u32 s60,s62,518400
s_add_u32 m0,s63,9216
s_nop 0
buffer_load_dwordx4 v4,s[76:79],s60 offen lds
s_add_u32 s60,s62,539136
s_add_u32 m0,s63,10240
s_nop 0
buffer_load_dwordx4 v4,s[76:79],s60 offen lds
s_add_u32 s60,s62,559872
s_add_u32 m0,s63,11264
s_nop 0
buffer_load_dwordx4 v4,s[76:79],s60 offen lds
s_waitcnt vmcnt(12)
ds_read_b64_tr_b16 a[24:25],v3 offset:12288
ds_read_b64_tr_b16 a[26:27],v3 offset:12544
ds_read_b64_tr_b16 a[28:29],v3 offset:14336
ds_read_b64_tr_b16 a[30:31],v3 offset:14592
ds_read_b64_tr_b16 a[96:97],v3 offset:12320
ds_read_b64_tr_b16 a[98:99],v3 offset:12576
ds_read_b64_tr_b16 a[100:101],v3 offset:14368
ds_read_b64_tr_b16 a[102:103],v3 offset:14624
s_waitcnt lgkmcnt(0)
s_add_u32 s60,s62,580608
s_add_u32 m0,s63,12288
s_nop 0
buffer_load_dwordx4 v4,s[76:79],s60 offen lds
s_add_u32 s60,s62,601344
s_add_u32 m0,s63,13312
s_nop 0
buffer_load_dwordx4 v4,s[76:79],s60 offen lds
s_add_u32 s60,s62,622080
s_add_u32 m0,s63,14336
s_nop 0
buffer_load_dwordx4 v4,s[76:79],s60 offen lds
s_add_u32 s60,s62,642816
s_add_u32 m0,s63,15360
s_nop 0
buffer_load_dwordx4 v4,s[76:79],s60 offen lds
s_waitcnt vmcnt(12)
ds_read_b64_tr_b16 a[32:33],v3
ds_read_b64_tr_b16 a[34:35],v3 offset:256
ds_read_b64_tr_b16 a[36:37],v3 offset:2048
ds_read_b64_tr_b16 a[38:39],v3 offset:2304
ds_read_b64_tr_b16 a[104:105],v3 offset:32
ds_read_b64_tr_b16 a[106:107],v3 offset:288
ds_read_b64_tr_b16 a[108:109],v3 offset:2080
ds_read_b64_tr_b16 a[110:111],v3 offset:2336
s_waitcnt lgkmcnt(0)
s_add_u32 s60,s62,64
s_add_u32 m0,s63,0
s_nop 0
buffer_load_dwordx4 v5,s[76:79],s60 offen lds
s_add_u32 s60,s62,20800
s_add_u32 m0,s63,1024
s_nop 0
buffer_load_dwordx4 v5,s[76:79],s60 offen lds
s_add_u32 s60,s62,41536
s_add_u32 m0,s63,2048
s_nop 0
buffer_load_dwordx4 v5,s[76:79],s60 offen lds
s_add_u32 s60,s62,62272
s_add_u32 m0,s63,3072
s_nop 0
buffer_load_dwordx4 v5,s[76:79],s60 offen lds
s_waitcnt vmcnt(12)
ds_read_b64_tr_b16 a[40:41],v3 offset:4096
ds_read_b64_tr_b16 a[42:43],v3 offset:4352
ds_read_b64_tr_b16 a[44:45],v3 offset:6144
ds_read_b64_tr_b16 a[46:47],v3 offset:6400
ds_read_b64_tr_b16 a[112:113],v3 offset:4128
ds_read_b64_tr_b16 a[114:115],v3 offset:4384
ds_read_b64_tr_b16 a[116:117],v3 offset:6176
ds_read_b64_tr_b16 a[118:119],v3 offset:6432
s_waitcnt lgkmcnt(0)
s_add_u32 s60,s62,165952
s_add_u32 m0,s63,4096
s_nop 0
buffer_load_dwordx4 v5,s[76:79],s60 offen lds
s_add_u32 s60,s62,186688
s_add_u32 m0,s63,5120
s_nop 0
buffer_load_dwordx4 v5,s[76:79],s60 offen lds
s_add_u32 s60,s62,207424
s_add_u32 m0,s63,6144
s_nop 0
buffer_load_dwordx4 v5,s[76:79],s60 offen lds
s_add_u32 s60,s62,228160
s_add_u32 m0,s63,7168
s_nop 0
buffer_load_dwordx4 v5,s[76:79],s60 offen lds
s_waitcnt vmcnt(12)
ds_read_b64_tr_b16 a[48:49],v3 offset:8192
ds_read_b64_tr_b16 a[50:51],v3 offset:8448
ds_read_b64_tr_b16 a[52:53],v3 offset:10240
ds_read_b64_tr_b16 a[54:55],v3 offset:10496
ds_read_b64_tr_b16 a[120:121],v3 offset:8224
ds_read_b64_tr_b16 a[122:123],v3 offset:8480
ds_read_b64_tr_b16 a[124:125],v3 offset:10272
ds_read_b64_tr_b16 a[126:127],v3 offset:10528
s_waitcnt lgkmcnt(0)
s_add_u32 s60,s62,331840
s_add_u32 m0,s63,8192
s_nop 0
buffer_load_dwordx4 v5,s[76:79],s60 offen lds
s_add_u32 s60,s62,352576
s_add_u32 m0,s63,9216
s_nop 0
buffer_load_dwordx4 v5,s[76:79],s60 offen lds
s_add_u32 s60,s62,373312
s_add_u32 m0,s63,10240
s_nop 0
buffer_load_dwordx4 v5,s[76:79],s60 offen lds
s_add_u32 s60,s62,394048
s_add_u32 m0,s63,11264
s_nop 0
buffer_load_dwordx4 v5,s[76:79],s60 offen lds
s_waitcnt vmcnt(12)
ds_read_b64_tr_b16 a[56:57],v3 offset:12288
ds_read_b64_tr_b16 a[58:59],v3 offset:12544
ds_read_b64_tr_b16 a[60:61],v3 offset:14336
ds_read_b64_tr_b16 a[62:63],v3 offset:14592
ds_read_b64_tr_b16 a[128:129],v3 offset:12320
ds_read_b64_tr_b16 a[130:131],v3 offset:12576
ds_read_b64_tr_b16 a[132:133],v3 offset:14368
ds_read_b64_tr_b16 a[134:135],v3 offset:14624
s_waitcnt lgkmcnt(0)
s_add_u32 s60,s62,497728
s_add_u32 m0,s63,12288
s_nop 0
buffer_load_dwordx4 v5,s[76:79],s60 offen lds
s_add_u32 s60,s62,518464
s_add_u32 m0,s63,13312
s_nop 0
buffer_load_dwordx4 v5,s[76:79],s60 offen lds
s_add_u32 s60,s62,539200
s_add_u32 m0,s63,14336
s_nop 0
buffer_load_dwordx4 v5,s[76:79],s60 offen lds
s_add_u32 s60,s62,559936
s_add_u32 m0,s63,15360
s_nop 0
buffer_load_dwordx4 v5,s[76:79],s60 offen lds
s_waitcnt vmcnt(12)
ds_read_b64_tr_b16 a[144:145],v3
ds_read_b64_tr_b16 a[146:147],v3 offset:256
ds_read_b64_tr_b16 a[148:149],v3 offset:2048
ds_read_b64_tr_b16 a[150:151],v3 offset:2304
ds_read_b64_tr_b16 a[152:153],v3 offset:32
ds_read_b64_tr_b16 a[154:155],v3 offset:288
ds_read_b64_tr_b16 a[156:157],v3 offset:2080
ds_read_b64_tr_b16 a[158:159],v3 offset:2336
s_waitcnt lgkmcnt(0)
s_add_u32 s60,s62,18432
s_add_u32 m0,s63,0
s_nop 0
buffer_load_dwordx4 v6,s[76:79],s60 offen lds
s_add_u32 s60,s62,184320
s_add_u32 m0,s63,1024
s_nop 0
buffer_load_dwordx4 v6,s[76:79],s60 offen lds
s_add_u32 s60,s62,350208
s_add_u32 m0,s63,2048
s_nop 0
buffer_load_dwordx4 v6,s[76:79],s60 offen lds
s_add_u32 s60,s62,516096
s_add_u32 m0,s63,3072
s_nop 0
buffer_load_dwordx4 v6,s[76:79],s60 offen lds
s_waitcnt vmcnt(12)
ds_read_b64_tr_b16 a[160:161],v3 offset:4096
ds_read_b64_tr_b16 a[162:163],v3 offset:4352
ds_read_b64_tr_b16 a[164:165],v3 offset:6144
ds_read_b64_tr_b16 a[166:167],v3 offset:6400
ds_read_b64_tr_b16 a[168:169],v3 offset:4128
ds_read_b64_tr_b16 a[170:171],v3 offset:4384
ds_read_b64_tr_b16 a[172:173],v3 offset:6176
ds_read_b64_tr_b16 a[174:175],v3 offset:6432
s_waitcnt lgkmcnt(0)
s_add_u32 s60,s62,18496
s_add_u32 m0,s63,4096
s_nop 0
buffer_load_dwordx4 v6,s[76:79],s60 offen lds
s_add_u32 s60,s62,184384
s_add_u32 m0,s63,5120
s_nop 0
buffer_load_dwordx4 v6,s[76:79],s60 offen lds
s_add_u32 s60,s62,350272
s_add_u32 m0,s63,6144
s_nop 0
buffer_load_dwordx4 v6,s[76:79],s60 offen lds
s_add_u32 s60,s62,516160
s_add_u32 m0,s63,7168
s_nop 0
buffer_load_dwordx4 v6,s[76:79],s60 offen lds
s_waitcnt vmcnt(12)
ds_read_b64_tr_b16 a[176:177],v3 offset:8192
ds_read_b64_tr_b16 a[178:179],v3 offset:8448
ds_read_b64_tr_b16 a[180:181],v3 offset:10240
ds_read_b64_tr_b16 a[182:183],v3 offset:10496
ds_read_b64_tr_b16 a[184:185],v3 offset:8224
ds_read_b64_tr_b16 a[186:187],v3 offset:8480
ds_read_b64_tr_b16 a[188:189],v3 offset:10272
ds_read_b64_tr_b16 a[190:191],v3 offset:10528
s_waitcnt vmcnt(8)
ds_read_b64_tr_b16 a[192:193],v3 offset:12288
ds_read_b64_tr_b16 a[194:195],v3 offset:12544
ds_read_b64_tr_b16 a[196:197],v3 offset:14336
ds_read_b64_tr_b16 a[198:199],v3 offset:14592
ds_read_b64_tr_b16 a[200:201],v3 offset:12320
ds_read_b64_tr_b16 a[202:203],v3 offset:12576
ds_read_b64_tr_b16 a[204:205],v3 offset:14368
ds_read_b64_tr_b16 a[206:207],v3 offset:14624
s_waitcnt vmcnt(4)
ds_read_b64_tr_b16 a[64:65],v3
ds_read_b64_tr_b16 a[66:67],v3 offset:256
ds_read_b64_tr_b16 a[68:69],v3 offset:2048
ds_read_b64_tr_b16 a[70:71],v3 offset:2304
ds_read_b64_tr_b16 a[136:137],v3 offset:32
ds_read_b64_tr_b16 a[138:139],v3 offset:288
ds_read_b64_tr_b16 a[140:141],v3 offset:2080
ds_read_b64_tr_b16 a[142:143],v3 offset:2336
s_waitcnt vmcnt(0)
ds_read_b64_tr_b16 a[208:209],v3 offset:4096
ds_read_b64_tr_b16 a[210:211],v3 offset:4352
ds_read_b64_tr_b16 a[212:213],v3 offset:6144
ds_read_b64_tr_b16 a[214:215],v3 offset:6400
s_waitcnt lgkmcnt(0)
s_mov_b32 s25,s37
s_mov_b32 s76,s92
s_mov_b32 s77,s93
s_mov_b32 s78,1990656
s_mov_b32 s79,0x20000
s_lshl_b32 s63,s21,14
s_add_u32 s63,s63,81920
v_lshrrev_b32 v12,4,v0
v_bfe_u32 v13,v0,2,2
v_lshl_add_u32 v12,v12,3,v13
v_lshlrev_b32 v12,6,v12
v_and_b32 v13,3,v0
v_lshl_add_u32 v12,v13,3,v12
v_add_u32 v61,s63,v12
s_lshl_b32 s25,s25,2
s_add_u32 s25,s25,s21
v_lshrrev_b32 v12,4,v0
v_mul_u32_u24 v12,3456,v12
v_bfe_u32 v13,v0,3,1
v_mul_u32_u24 v13,1152,v13
v_add_u32 v12,v12,v13
v_and_b32 v13,7,v0
v_and_b32 v14,15,v0
v_lshrrev_b32 v15,4,v0
v_lshlrev_b32 v11,4,v15
v_lshl_add_u32 v60,v14,6,v11
s_cmp_ge_u32 s25,32
s_cbranch_scc1 bq_rem_54
v_lshl_add_u32 v62,v13,2,v12
s_mul_i32 s62,s25,36
v_lshlrev_b32 v15,3,v15
v_lshl_add_u32 v6,v14,5,v15
s_lshl_b32 s28,s25,16
s_add_u32 s28,s28,14680064
s_mov_b32 s29,512
s_branch bq_e_55
bq_rem_54:
v_mul_u32_u24 v13,36,v13
v_add_u32 v62,v13,v12
s_sub_u32 s61,s25,32
s_mul_i32 s62,s61,288
s_add_u32 s62,s62,32
v_lshlrev_b32_e64 v15,14,v15
v_lshl_add_u32 v6,v14,3,v15
s_lshl_b32 s28,s61,16
s_add_u32 s28,s28,6815744
s_mov_b32 s29,128
bq_e_55:
v_lshrrev_b32_e64 v12,2,v0
v_bfe_u32 v13,v0,1,1
v_lshl_add_u32 v12,v13,6,v12
v_mul_u32_u24 v12,3456,v12
v_and_b32 v13,1,v0
v_lshl_add_u32 v16,v13,4,v12
s_lshl_b32 s61,s25,5
s_add_u32 s60,s62,0
s_add_u32 m0,s63,0
s_nop 0
buffer_load_dword v62,s[76:79],s60 offen lds
s_add_u32 s60,s62,13824
s_add_u32 m0,s63,256
s_nop 0
buffer_load_dword v62,s[76:79],s60 offen lds
s_add_u32 s60,s62,27648
s_add_u32 m0,s63,512
s_nop 0
buffer_load_dword v62,s[76:79],s60 offen lds
s_add_u32 s60,s62,41472
s_add_u32 m0,s63,768
s_nop 0
buffer_load_dword v62,s[76:79],s60 offen lds
s_add_u32 s60,s62,55296
s_add_u32 m0,s63,1024
s_nop 0
buffer_load_dword v62,s[76:79],s60 offen lds
s_add_u32 s60,s62,69120
s_add_u32 m0,s63,1280
s_nop 0
buffer_load_dword v62,s[76:79],s60 offen lds
s_add_u32 s60,s62,82944
s_add_u32 m0,s63,1536
s_nop 0
buffer_load_dword v62,s[76:79],s60 offen lds
s_add_u32 s60,s62,96768
s_add_u32 m0,s63,1792
s_nop 0
buffer_load_dword v62,s[76:79],s60 offen lds
s_add_u32 s60,s62,110592
s_add_u32 m0,s63,2048
s_nop 0
buffer_load_dword v62,s[76:79],s60 offen lds
s_add_u32 s60,s62,124416
s_add_u32 m0,s63,2304
s_nop 0
buffer_load_dword v62,s[76:79],s60 offen lds
s_add_u32 s60,s62,138240
s_add_u32 m0,s63,2560
s_nop 0
buffer_load_dword v62,s[76:79],s60 offen lds
s_add_u32 s60,s62,152064
s_add_u32 m0,s63,2816
s_nop 0
buffer_load_dword v62,s[76:79],s60 offen lds
s_add_u32 s60,s62,165888
s_add_u32 m0,s63,3072
s_nop 0
buffer_load_dword v62,s[76:79],s60 offen lds
s_add_u32 s60,s62,179712
s_add_u32 m0,s63,3328
s_nop 0
buffer_load_dword v62,s[76:79],s60 offen lds
s_add_u32 s60,s62,193536
s_add_u32 m0,s63,3584
s_nop 0
buffer_load_dword v62,s[76:79],s60 offen lds
s_add_u32 s60,s62,207360
s_add_u32 m0,s63,3840
s_nop 0
buffer_load_dword v62,s[76:79],s60 offen lds
s_add_u32 s60,s62,221184
s_add_u32 m0,s63,4096
s_nop 0
buffer_load_dword v62,s[76:79],s60 offen lds
s_add_u32 s60,s62,235008
s_add_u32 m0,s63,4352
s_nop 0
buffer_load_dword v62,s[76:79],s60 offen lds
s_add_u32 s60,s62,248832
s_add_u32 m0,s63,4608
s_nop 0
buffer_load_dword v62,s[76:79],s60 offen lds
s_add_u32 s60,s62,262656
s_add_u32 m0,s63,4864
s_nop 0
buffer_load_dword v62,s[76:79],s60 offen lds
s_add_u32 s60,s62,276480
s_add_u32 m0,s63,5120
s_nop 0
buffer_load_dword v62,s[76:79],s60 offen lds
s_add_u32 s60,s62,290304
s_add_u32 m0,s63,5376
s_nop 0
buffer_load_dword v62,s[76:79],s60 offen lds
s_add_u32 s60,s62,304128
s_add_u32 m0,s63,5632
s_nop 0
buffer_load_dword v62,s[76:79],s60 offen lds
s_add_u32 s60,s62,317952
s_add_u32 m0,s63,5888
s_nop 0
buffer_load_dword v62,s[76:79],s60 offen lds
s_add_u32 s60,s62,331776
s_add_u32 m0,s63,6144
s_nop 0
buffer_load_dword v62,s[76:79],s60 offen lds
s_add_u32 s60,s62,345600
s_add_u32 m0,s63,6400
s_nop 0
buffer_load_dword v62,s[76:79],s60 offen lds
s_add_u32 s60,s62,359424
s_add_u32 m0,s63,6656
s_nop 0
buffer_load_dword v62,s[76:79],s60 offen lds
s_add_u32 s60,s62,373248
s_add_u32 m0,s63,6912
s_nop 0
buffer_load_dword v62,s[76:79],s60 offen lds
s_add_u32 s60,s62,387072
s_add_u32 m0,s63,7168
s_nop 0
buffer_load_dword v62,s[76:79],s60 offen lds
s_add_u32 s60,s62,400896
s_add_u32 m0,s63,7424
s_nop 0
buffer_load_dword v62,s[76:79],s60 offen lds
s_add_u32 s60,s62,414720
s_add_u32 m0,s63,7680
s_nop 0
buffer_load_dword v62,s[76:79],s60 offen lds
s_add_u32 s60,s62,428544
s_add_u32 m0,s63,7936
s_nop 0
buffer_load_dword v62,s[76:79],s60 offen lds
s_add_u32 s60,s62,442368
s_add_u32 m0,s63,8192
s_nop 0
buffer_load_dword v62,s[76:79],s60 offen lds
s_add_u32 s60,s62,456192
s_add_u32 m0,s63,8448
s_nop 0
buffer_load_dword v62,s[76:79],s60 offen lds
s_add_u32 s60,s62,470016
s_add_u32 m0,s63,8704
s_nop 0
buffer_load_dword v62,s[76:79],s60 offen lds
s_add_u32 s60,s62,483840
s_add_u32 m0,s63,8960
s_nop 0
buffer_load_dword v62,s[76:79],s60 offen lds
s_add_u32 s60,s62,497664
s_add_u32 m0,s63,9216
s_nop 0
buffer_load_dword v62,s[76:79],s60 offen lds
s_add_u32 s60,s62,511488
s_add_u32 m0,s63,9472
s_nop 0
buffer_load_dword v62,s[76:79],s60 offen lds
s_add_u32 s60,s62,525312
s_add_u32 m0,s63,9728
s_nop 0
buffer_load_dword v62,s[76:79],s60 offen lds
s_add_u32 s60,s62,539136
s_add_u32 m0,s63,9984
s_nop 0
buffer_load_dword v62,s[76:79],s60 offen lds
s_add_u32 s60,s62,552960
s_add_u32 m0,s63,10240
s_nop 0
buffer_load_dword v62,s[76:79],s60 offen lds
s_add_u32 s60,s62,566784
s_add_u32 m0,s63,10496
s_nop 0
buffer_load_dword v62,s[76:79],s60 offen lds
s_add_u32 s60,s62,580608
s_add_u32 m0,s63,10752
s_nop 0
buffer_load_dword v62,s[76:79],s60 offen lds
s_add_u32 s60,s62,594432
s_add_u32 m0,s63,11008
s_nop 0
buffer_load_dword v62,s[76:79],s60 offen lds
s_add_u32 s60,s62,608256
s_add_u32 m0,s63,11264
s_nop 0
buffer_load_dword v62,s[76:79],s60 offen lds
s_add_u32 s60,s62,622080
s_add_u32 m0,s63,11520
s_nop 0
buffer_load_dword v62,s[76:79],s60 offen lds
s_add_u32 s60,s62,635904
s_add_u32 m0,s63,11776
s_nop 0
buffer_load_dword v62,s[76:79],s60 offen lds
s_add_u32 s60,s62,649728
s_add_u32 m0,s63,12032
s_nop 0
buffer_load_dword v62,s[76:79],s60 offen lds
s_waitcnt lgkmcnt(0)
s_add_u32 s60,s62,663552
s_add_u32 m0,s63,12288
s_nop 0
buffer_load_dword v62,s[76:79],s60 offen lds
s_add_u32 s60,s62,677376
s_add_u32 m0,s63,12544
s_nop 0
buffer_load_dword v62,s[76:79],s60 offen lds
s_add_u32 s60,s62,691200
s_add_u32 m0,s63,12800
s_nop 0
buffer_load_dword v62,s[76:79],s60 offen lds
s_add_u32 s60,s62,705024
s_add_u32 m0,s63,13056
s_nop 0
buffer_load_dword v62,s[76:79],s60 offen lds
s_add_u32 s60,s62,718848
s_add_u32 m0,s63,13312
s_nop 0
buffer_load_dword v62,s[76:79],s60 offen lds
s_add_u32 s60,s62,732672
s_add_u32 m0,s63,13568
s_nop 0
buffer_load_dword v62,s[76:79],s60 offen lds
s_add_u32 s60,s62,746496
s_add_u32 m0,s63,13824
s_nop 0
buffer_load_dword v62,s[76:79],s60 offen lds
s_add_u32 s60,s62,760320
s_add_u32 m0,s63,14080
s_nop 0
buffer_load_dword v62,s[76:79],s60 offen lds
s_add_u32 s60,s62,774144
s_add_u32 m0,s63,14336
s_nop 0
buffer_load_dword v62,s[76:79],s60 offen lds
s_add_u32 s60,s62,787968
s_add_u32 m0,s63,14592
s_nop 0
buffer_load_dword v62,s[76:79],s60 offen lds
s_add_u32 s60,s62,801792
s_add_u32 m0,s63,14848
s_nop 0
buffer_load_dword v62,s[76:79],s60 offen lds
s_add_u32 s60,s62,815616
s_add_u32 m0,s63,15104
s_nop 0
buffer_load_dword v62,s[76:79],s60 offen lds
s_add_u32 s60,s62,829440
s_add_u32 m0,s63,15360
s_nop 0
buffer_load_dword v62,s[76:79],s60 offen lds
s_add_u32 s60,s62,843264
s_add_u32 m0,s63,15616
s_nop 0
buffer_load_dword v62,s[76:79],s60 offen lds
s_add_u32 s60,s62,857088
s_add_u32 m0,s63,15872
s_nop 0
buffer_load_dword v62,s[76:79],s60 offen lds
s_add_u32 s60,s62,870912
s_add_u32 m0,s63,16128
s_nop 0
buffer_load_dword v62,s[76:79],s60 offen lds
s_waitcnt vmcnt(48)
ds_read_b64_tr_b16 a[216:217],v61
ds_read_b64_tr_b16 a[218:219],v61 offset:256
ds_read_b64_tr_b16 a[220:221],v61 offset:2048
ds_read_b64_tr_b16 a[222:223],v61 offset:2304
ds_read_b64_tr_b16 v[112:113],v61 offset:32
ds_read_b64_tr_b16 v[114:115],v61 offset:288
ds_read_b64_tr_b16 v[116:117],v61 offset:2080
ds_read_b64_tr_b16 v[118:119],v61 offset:2336
s_waitcnt lgkmcnt(0)
s_add_u32 s60,s62,884736
s_add_u32 m0,s63,0
s_nop 0
buffer_load_dword v62,s[76:79],s60 offen lds
s_add_u32 s60,s62,898560
s_add_u32 m0,s63,256
s_nop 0
buffer_load_dword v62,s[76:79],s60 offen lds
s_add_u32 s60,s62,912384
s_add_u32 m0,s63,512
s_nop 0
buffer_load_dword v62,s[76:79],s60 offen lds
s_add_u32 s60,s62,926208
s_add_u32 m0,s63,768
s_nop 0
buffer_load_dword v62,s[76:79],s60 offen lds
s_add_u32 s60,s62,940032
s_add_u32 m0,s63,1024
s_nop 0
buffer_load_dword v62,s[76:79],s60 offen lds
s_add_u32 s60,s62,953856
s_add_u32 m0,s63,1280
s_nop 0
buffer_load_dword v62,s[76:79],s60 offen lds
s_add_u32 s60,s62,967680
s_add_u32 m0,s63,1536
s_nop 0
buffer_load_dword v62,s[76:79],s60 offen lds
s_add_u32 s60,s62,981504
s_add_u32 m0,s63,1792
s_nop 0
buffer_load_dword v62,s[76:79],s60 offen lds
s_add_u32 s60,s62,995328
s_add_u32 m0,s63,2048
s_nop 0
buffer_load_dword v62,s[76:79],s60 offen lds
s_add_u32 s60,s62,1009152
s_add_u32 m0,s63,2304
s_nop 0
buffer_load_dword v62,s[76:79],s60 offen lds
s_add_u32 s60,s62,1022976
s_add_u32 m0,s63,2560
s_nop 0
buffer_load_dword v62,s[76:79],s60 offen lds
s_add_u32 s60,s62,1036800
s_add_u32 m0,s63,2816
s_nop 0
buffer_load_dword v62,s[76:79],s60 offen lds
s_add_u32 s60,s62,1050624
s_add_u32 m0,s63,3072
s_nop 0
buffer_load_dword v62,s[76:79],s60 offen lds
s_add_u32 s60,s62,1064448
s_add_u32 m0,s63,3328
s_nop 0
buffer_load_dword v62,s[76:79],s60 offen lds
s_add_u32 s60,s62,1078272
s_add_u32 m0,s63,3584
s_nop 0
buffer_load_dword v62,s[76:79],s60 offen lds
s_add_u32 s60,s62,1092096
s_add_u32 m0,s63,3840
s_nop 0
buffer_load_dword v62,s[76:79],s60 offen lds
s_waitcnt vmcnt(48)
ds_read_b64_tr_b16 a[224:225],v61 offset:4096
ds_read_b64_tr_b16 a[226:227],v61 offset:4352
ds_read_b64_tr_b16 a[228:229],v61 offset:6144
ds_read_b64_tr_b16 a[230:231],v61 offset:6400
ds_read_b64_tr_b16 v[120:121],v61 offset:4128
ds_read_b64_tr_b16 v[122:123],v61 offset:4384
ds_read_b64_tr_b16 v[124:125],v61 offset:6176
ds_read_b64_tr_b16 v[126:127],v61 offset:6432
s_waitcnt lgkmcnt(0)
s_add_u32 s60,s62,1105920
s_add_u32 m0,s63,4096
s_nop 0
buffer_load_dword v62,s[76:79],s60 offen lds
s_add_u32 s60,s62,1119744
s_add_u32 m0,s63,4352
s_nop 0
buffer_load_dword v62,s[76:79],s60 offen lds
s_add_u32 s60,s62,1133568
s_add_u32 m0,s63,4608
s_nop 0
buffer_load_dword v62,s[76:79],s60 offen lds
s_add_u32 s60,s62,1147392
s_add_u32 m0,s63,4864
s_nop 0
buffer_load_dword v62,s[76:79],s60 offen lds
s_add_u32 s60,s62,1161216
s_add_u32 m0,s63,5120
s_nop 0
buffer_load_dword v62,s[76:79],s60 offen lds
s_add_u32 s60,s62,1175040
s_add_u32 m0,s63,5376
s_nop 0
buffer_load_dword v62,s[76:79],s60 offen lds
s_add_u32 s60,s62,1188864
s_add_u32 m0,s63,5632
s_nop 0
buffer_load_dword v62,s[76:79],s60 offen lds
s_add_u32 s60,s62,1202688
s_add_u32 m0,s63,5888
s_nop 0
buffer_load_dword v62,s[76:79],s60 offen lds
s_add_u32 s60,s62,1216512
s_add_u32 m0,s63,6144
s_nop 0
buffer_load_dword v62,s[76:79],s60 offen lds
s_add_u32 s60,s62,1230336
s_add_u32 m0,s63,6400
s_nop 0
buffer_load_dword v62,s[76:79],s60 offen lds
s_add_u32 s60,s62,1244160
s_add_u32 m0,s63,6656
s_nop 0
buffer_load_dword v62,s[76:79],s60 offen lds
s_add_u32 s60,s62,1257984
s_add_u32 m0,s63,6912
s_nop 0
buffer_load_dword v62,s[76:79],s60 offen lds
s_add_u32 s60,s62,1271808
s_add_u32 m0,s63,7168
s_nop 0
buffer_load_dword v62,s[76:79],s60 offen lds
s_add_u32 s60,s62,1285632
s_add_u32 m0,s63,7424
s_nop 0
buffer_load_dword v62,s[76:79],s60 offen lds
s_add_u32 s60,s62,1299456
s_add_u32 m0,s63,7680
s_nop 0
buffer_load_dword v62,s[76:79],s60 offen lds
s_add_u32 s60,s62,1313280
s_add_u32 m0,s63,7936
s_nop 0
buffer_load_dword v62,s[76:79],s60 offen lds
s_waitcnt vmcnt(48)
ds_read_b64_tr_b16 a[232:233],v61 offset:8192
ds_read_b64_tr_b16 a[234:235],v61 offset:8448
ds_read_b64_tr_b16 a[236:237],v61 offset:10240
ds_read_b64_tr_b16 a[238:239],v61 offset:10496
ds_read_b64_tr_b16 v[128:129],v61 offset:8224
ds_read_b64_tr_b16 v[130:131],v61 offset:8480
ds_read_b64_tr_b16 v[132:133],v61 offset:10272
ds_read_b64_tr_b16 v[134:135],v61 offset:10528
s_waitcnt lgkmcnt(0)
s_add_u32 s60,s62,1327104
s_add_u32 m0,s63,8192
s_nop 0
buffer_load_dword v62,s[76:79],s60 offen lds
s_add_u32 s60,s62,1340928
s_add_u32 m0,s63,8448
s_nop 0
buffer_load_dword v62,s[76:79],s60 offen lds
s_add_u32 s60,s62,1354752
s_add_u32 m0,s63,8704
s_nop 0
buffer_load_dword v62,s[76:79],s60 offen lds
s_add_u32 s60,s62,1368576
s_add_u32 m0,s63,8960
s_nop 0
buffer_load_dword v62,s[76:79],s60 offen lds
s_add_u32 s60,s62,1382400
s_add_u32 m0,s63,9216
s_nop 0
buffer_load_dword v62,s[76:79],s60 offen lds
s_add_u32 s60,s62,1396224
s_add_u32 m0,s63,9472
s_nop 0
buffer_load_dword v62,s[76:79],s60 offen lds
s_add_u32 s60,s62,1410048
s_add_u32 m0,s63,9728
s_nop 0
buffer_load_dword v62,s[76:79],s60 offen lds
s_add_u32 s60,s62,1423872
s_add_u32 m0,s63,9984
s_nop 0
buffer_load_dword v62,s[76:79],s60 offen lds
s_add_u32 s60,s62,1437696
s_add_u32 m0,s63,10240
s_nop 0
buffer_load_dword v62,s[76:79],s60 offen lds
s_add_u32 s60,s62,1451520
s_add_u32 m0,s63,10496
s_nop 0
buffer_load_dword v62,s[76:79],s60 offen lds
s_add_u32 s60,s62,1465344
s_add_u32 m0,s63,10752
s_nop 0
buffer_load_dword v62,s[76:79],s60 offen lds
s_add_u32 s60,s62,1479168
s_add_u32 m0,s63,11008
s_nop 0
buffer_load_dword v62,s[76:79],s60 offen lds
s_add_u32 s60,s62,1492992
s_add_u32 m0,s63,11264
s_nop 0
buffer_load_dword v62,s[76:79],s60 offen lds
s_add_u32 s60,s62,1506816
s_add_u32 m0,s63,11520
s_nop 0
buffer_load_dword v62,s[76:79],s60 offen lds
s_add_u32 s60,s62,1520640
s_add_u32 m0,s63,11776
s_nop 0
buffer_load_dword v62,s[76:79],s60 offen lds
s_add_u32 s60,s62,1534464
s_add_u32 m0,s63,12032
s_nop 0
buffer_load_dword v62,s[76:79],s60 offen lds
s_waitcnt vmcnt(48)
ds_read_b64_tr_b16 a[240:241],v61 offset:12288
ds_read_b64_tr_b16 a[242:243],v61 offset:12544
ds_read_b64_tr_b16 a[244:245],v61 offset:14336
ds_read_b64_tr_b16 a[246:247],v61 offset:14592
ds_read_b64_tr_b16 v[136:137],v61 offset:12320
ds_read_b64_tr_b16 v[138:139],v61 offset:12576
ds_read_b64_tr_b16 v[140:141],v61 offset:14368
ds_read_b64_tr_b16 v[142:143],v61 offset:14624
s_waitcnt lgkmcnt(0)
s_add_u32 s60,s62,1548288
s_add_u32 m0,s63,12288
s_nop 0
buffer_load_dword v62,s[76:79],s60 offen lds
s_add_u32 s60,s62,1562112
s_add_u32 m0,s63,12544
s_nop 0
buffer_load_dword v62,s[76:79],s60 offen lds
s_add_u32 s60,s62,1575936
s_add_u32 m0,s63,12800
s_nop 0
buffer_load_dword v62,s[76:79],s60 offen lds
s_add_u32 s60,s62,1589760
s_add_u32 m0,s63,13056
s_nop 0
buffer_load_dword v62,s[76:79],s60 offen lds
s_add_u32 s60,s62,1603584
s_add_u32 m0,s63,13312
s_nop 0
buffer_load_dword v62,s[76:79],s60 offen lds
s_add_u32 s60,s62,1617408
s_add_u32 m0,s63,13568
s_nop 0
buffer_load_dword v62,s[76:79],s60 offen lds
s_add_u32 s60,s62,1631232
s_add_u32 m0,s63,13824
s_nop 0
buffer_load_dword v62,s[76:79],s60 offen lds
s_add_u32 s60,s62,1645056
s_add_u32 m0,s63,14080
s_nop 0
buffer_load_dword v62,s[76:79],s60 offen lds
s_add_u32 s60,s62,1658880
s_add_u32 m0,s63,14336
s_nop 0
buffer_load_dword v62,s[76:79],s60 offen lds
s_add_u32 s60,s62,1672704
s_add_u32 m0,s63,14592
s_nop 0
buffer_load_dword v62,s[76:79],s60 offen lds
s_add_u32 s60,s62,1686528
s_add_u32 m0,s63,14848
s_nop 0
buffer_load_dword v62,s[76:79],s60 offen lds
s_add_u32 s60,s62,1700352
s_add_u32 m0,s63,15104
s_nop 0
buffer_load_dword v62,s[76:79],s60 offen lds
s_add_u32 s60,s62,1714176
s_add_u32 m0,s63,15360
s_nop 0
buffer_load_dword v62,s[76:79],s60 offen lds
s_add_u32 s60,s62,1728000
s_add_u32 m0,s63,15616
s_nop 0
buffer_load_dword v62,s[76:79],s60 offen lds
s_add_u32 s60,s62,1741824
s_add_u32 m0,s63,15872
s_nop 0
buffer_load_dword v62,s[76:79],s60 offen lds
s_add_u32 s60,s62,1755648
s_add_u32 m0,s63,16128
s_nop 0
buffer_load_dword v62,s[76:79],s60 offen lds
s_waitcnt vmcnt(48)
ds_read_b64_tr_b16 a[248:249],v61
ds_read_b64_tr_b16 a[250:251],v61 offset:256
ds_read_b64_tr_b16 a[252:253],v61 offset:2048
ds_read_b64_tr_b16 a[254:255],v61 offset:2304
ds_read_b64_tr_b16 v[144:145],v61 offset:32
ds_read_b64_tr_b16 v[146:147],v61 offset:288
ds_read_b64_tr_b16 v[148:149],v61 offset:2080
ds_read_b64_tr_b16 v[150:151],v61 offset:2336
s_waitcnt lgkmcnt(0)
s_add_u32 s60,s62,1769472
s_add_u32 m0,s63,0
s_nop 0
buffer_load_dword v62,s[76:79],s60 offen lds
s_add_u32 s60,s62,1783296
s_add_u32 m0,s63,256
s_nop 0
buffer_load_dword v62,s[76:79],s60 offen lds
s_add_u32 s60,s62,1797120
s_add_u32 m0,s63,512
s_nop 0
buffer_load_dword v62,s[76:79],s60 offen lds
s_add_u32 s60,s62,1810944
s_add_u32 m0,s63,768
s_nop 0
buffer_load_dword v62,s[76:79],s60 offen lds
s_add_u32 s60,s62,1824768
s_add_u32 m0,s63,1024
s_nop 0
buffer_load_dword v62,s[76:79],s60 offen lds
s_add_u32 s60,s62,1838592
s_add_u32 m0,s63,1280
s_nop 0
buffer_load_dword v62,s[76:79],s60 offen lds
s_add_u32 s60,s62,1852416
s_add_u32 m0,s63,1536
s_nop 0
buffer_load_dword v62,s[76:79],s60 offen lds
s_add_u32 s60,s62,1866240
s_add_u32 m0,s63,1792
s_nop 0
buffer_load_dword v62,s[76:79],s60 offen lds
s_add_u32 s60,s62,1880064
s_add_u32 m0,s63,2048
s_nop 0
buffer_load_dword v62,s[76:79],s60 offen lds
s_add_u32 s60,s62,1893888
s_add_u32 m0,s63,2304
s_nop 0
buffer_load_dword v62,s[76:79],s60 offen lds
s_add_u32 s60,s62,1907712
s_add_u32 m0,s63,2560
s_nop 0
buffer_load_dword v62,s[76:79],s60 offen lds
s_add_u32 s60,s62,1921536
s_add_u32 m0,s63,2816
s_nop 0
buffer_load_dword v62,s[76:79],s60 offen lds
s_add_u32 s60,s62,1935360
s_add_u32 m0,s63,3072
s_nop 0
buffer_load_dword v62,s[76:79],s60 offen lds
s_add_u32 s60,s62,1949184
s_add_u32 m0,s63,3328
s_nop 0
buffer_load_dword v62,s[76:79],s60 offen lds
s_add_u32 s60,s62,1963008
s_add_u32 m0,s63,3584
s_nop 0
buffer_load_dword v62,s[76:79],s60 offen lds
s_add_u32 s60,s62,1976832
s_add_u32 m0,s63,3840
s_nop 0
buffer_load_dword v62,s[76:79],s60 offen lds
s_waitcnt vmcnt(48)
ds_read_b64_tr_b16 v[80:81],v61 offset:4096
ds_read_b64_tr_b16 v[82:83],v61 offset:4352
ds_read_b64_tr_b16 v[84:85],v61 offset:6144
ds_read_b64_tr_b16 v[86:87],v61 offset:6400
ds_read_b64_tr_b16 v[152:153],v61 offset:4128
ds_read_b64_tr_b16 v[154:155],v61 offset:4384
ds_read_b64_tr_b16 v[156:157],v61 offset:6176
ds_read_b64_tr_b16 v[158:159],v61 offset:6432
s_waitcnt lgkmcnt(0)
s_add_u32 s60,s61,2304
s_add_u32 m0,s63,4096
s_nop 0
buffer_load_dwordx4 v16,s[76:79],s60 offen lds
s_add_u32 s60,s61,57600
s_add_u32 m0,s63,5120
s_nop 0
buffer_load_dwordx4 v16,s[76:79],s60 offen lds
s_add_u32 s60,s61,112896
s_add_u32 m0,s63,6144
s_nop 0
buffer_load_dwordx4 v16,s[76:79],s60 offen lds
s_add_u32 s60,s61,168192
s_add_u32 m0,s63,7168
s_nop 0
buffer_load_dwordx4 v16,s[76:79],s60 offen lds
s_waitcnt vmcnt(36)
ds_read_b64_tr_b16 v[88:89],v61 offset:8192
ds_read_b64_tr_b16 v[90:91],v61 offset:8448
ds_read_b64_tr_b16 v[92:93],v61 offset:10240
ds_read_b64_tr_b16 v[94:95],v61 offset:10496
ds_read_b64_tr_b16 v[160:161],v61 offset:8224
ds_read_b64_tr_b16 v[162:163],v61 offset:8480
ds_read_b64_tr_b16 v[164:165],v61 offset:10272
ds_read_b64_tr_b16 v[166:167],v61 offset:10528
s_waitcnt lgkmcnt(0)
s_add_u32 s60,s61,444672
s_add_u32 m0,s63,8192
s_nop 0
buffer_load_dwordx4 v16,s[76:79],s60 offen lds
s_add_u32 s60,s61,499968
s_add_u32 m0,s63,9216
s_nop 0
buffer_load_dwordx4 v16,s[76:79],s60 offen lds
s_add_u32 s60,s61,555264
s_add_u32 m0,s63,10240
s_nop 0
buffer_load_dwordx4 v16,s[76:79],s60 offen lds
s_add_u32 s60,s61,610560
s_add_u32 m0,s63,11264
s_nop 0
buffer_load_dwordx4 v16,s[76:79],s60 offen lds
s_waitcnt vmcnt(24)
ds_read_b64_tr_b16 v[96:97],v61 offset:12288
ds_read_b64_tr_b16 v[98:99],v61 offset:12544
ds_read_b64_tr_b16 v[100:101],v61 offset:14336
ds_read_b64_tr_b16 v[102:103],v61 offset:14592
ds_read_b64_tr_b16 v[168:169],v61 offset:12320
ds_read_b64_tr_b16 v[170:171],v61 offset:12576
ds_read_b64_tr_b16 v[172:173],v61 offset:14368
ds_read_b64_tr_b16 v[174:175],v61 offset:14624
s_waitcnt lgkmcnt(0)
s_add_u32 s60,s61,887040
s_add_u32 m0,s63,12288
s_nop 0
buffer_load_dwordx4 v16,s[76:79],s60 offen lds
s_add_u32 s60,s61,942336
s_add_u32 m0,s63,13312
s_nop 0
buffer_load_dwordx4 v16,s[76:79],s60 offen lds
s_add_u32 s60,s61,997632
s_add_u32 m0,s63,14336
s_nop 0
buffer_load_dwordx4 v16,s[76:79],s60 offen lds
s_add_u32 s60,s61,1052928
s_add_u32 m0,s63,15360
s_nop 0
buffer_load_dwordx4 v16,s[76:79],s60 offen lds
s_waitcnt vmcnt(12)
ds_read_b64_tr_b16 v[104:105],v61
ds_read_b64_tr_b16 v[106:107],v61 offset:256
ds_read_b64_tr_b16 v[108:109],v61 offset:2048
ds_read_b64_tr_b16 v[110:111],v61 offset:2304
ds_read_b64_tr_b16 v[176:177],v61 offset:32
ds_read_b64_tr_b16 v[178:179],v61 offset:288
ds_read_b64_tr_b16 v[180:181],v61 offset:2080
ds_read_b64_tr_b16 v[182:183],v61 offset:2336
s_waitcnt lgkmcnt(0)
s_add_u32 s60,s61,1329408
s_add_u32 m0,s63,0
s_nop 0
buffer_load_dwordx4 v16,s[76:79],s60 offen lds
s_add_u32 s60,s61,1384704
s_add_u32 m0,s63,1024
s_nop 0
buffer_load_dwordx4 v16,s[76:79],s60 offen lds
s_add_u32 s60,s61,1440000
s_add_u32 m0,s63,2048
s_nop 0
buffer_load_dwordx4 v16,s[76:79],s60 offen lds
s_add_u32 s60,s61,1495296
s_add_u32 m0,s63,3072
s_nop 0
buffer_load_dwordx4 v16,s[76:79],s60 offen lds
s_waitcnt vmcnt(12)
ds_read_b64_tr_b16 v[184:185],v61 offset:4096
ds_read_b64_tr_b16 v[186:187],v61 offset:4352
ds_read_b64_tr_b16 v[188:189],v61 offset:6144
ds_read_b64_tr_b16 v[190:191],v61 offset:6400
ds_read_b64_tr_b16 v[192:193],v61 offset:4128
ds_read_b64_tr_b16 v[194:195],v61 offset:4384
ds_read_b64_tr_b16 v[196:197],v61 offset:6176
ds_read_b64_tr_b16 v[198:199],v61 offset:6432
s_waitcnt lgkmcnt(0)
s_add_u32 s60,s61,1771776
s_add_u32 m0,s63,4096
s_nop 0
buffer_load_dwordx4 v16,s[76:79],s60 offen lds
s_add_u32 s60,s61,1827072
s_add_u32 m0,s63,5120
s_nop 0
buffer_load_dwordx4 v16,s[76:79],s60 offen lds
s_add_u32 s60,s61,1882368
s_add_u32 m0,s63,6144
s_nop 0
buffer_load_dwordx4 v16,s[76:79],s60 offen lds
s_add_u32 s60,s61,1937664
s_add_u32 m0,s63,7168
s_nop 0
buffer_load_dwordx4 v16,s[76:79],s60 offen lds
s_waitcnt vmcnt(12)
ds_read_b64_tr_b16 v[200:201],v61 offset:8192
ds_read_b64_tr_b16 v[202:203],v61 offset:8448
ds_read_b64_tr_b16 v[204:205],v61 offset:10240
ds_read_b64_tr_b16 v[206:207],v61 offset:10496
ds_read_b64_tr_b16 v[208:209],v61 offset:8224
ds_read_b64_tr_b16 v[210:211],v61 offset:8480
ds_read_b64_tr_b16 v[212:213],v61 offset:10272
ds_read_b64_tr_b16 v[214:215],v61 offset:10528
s_waitcnt vmcnt(8)
ds_read_b64_tr_b16 v[216:217],v61 offset:12288
ds_read_b64_tr_b16 v[218:219],v61 offset:12544
ds_read_b64_tr_b16 v[220:221],v61 offset:14336
ds_read_b64_tr_b16 v[222:223],v61 offset:14592
ds_read_b64_tr_b16 v[224:225],v61 offset:12320
ds_read_b64_tr_b16 v[226:227],v61 offset:12576
ds_read_b64_tr_b16 v[228:229],v61 offset:14368
ds_read_b64_tr_b16 v[230:231],v61 offset:14624
s_waitcnt vmcnt(4)
ds_read_b64_tr_b16 v[232:233],v61
ds_read_b64_tr_b16 v[234:235],v61 offset:256
ds_read_b64_tr_b16 v[236:237],v61 offset:2048
ds_read_b64_tr_b16 v[238:239],v61 offset:2304
ds_read_b64_tr_b16 v[240:241],v61 offset:32
ds_read_b64_tr_b16 v[242:243],v61 offset:288
ds_read_b64_tr_b16 v[244:245],v61 offset:2080
ds_read_b64_tr_b16 v[246:247],v61 offset:2336
s_waitcnt vmcnt(0)
ds_read_b64_tr_b16 v[248:249],v61 offset:4096
ds_read_b64_tr_b16 v[250:251],v61 offset:4352
ds_read_b64_tr_b16 v[252:253],v61 offset:6144
ds_read_b64_tr_b16 v[254:255],v61 offset:6400
s_waitcnt lgkmcnt(0)
v_lshrrev_b32 v10,3,v0
v_and_b32 v11,7,v0
v_xor_b32 v11,v11,v10
s_lshl_b32 s60,s21,3
v_add_u32 v10,s60,v10
v_mul_u32_u24 v1,1152,v10
v_lshl_add_u32 v1,v11,4,v1
v_lshlrev_b32 v10,2,v10
v_add_u32 v9,37888,v10
s_mul_i32 s60,s21,9216
v_lshlrev_b32 v2,4,v0
v_add_u32 v2,s60,v2
v_lshrrev_b32 v10,4,v0
v_lshlrev_b32 v8,4,v10
v_add_u32 v8,37888,v8
v_and_b32 v11,7,v0
v_xor_b32 v10,v10,v11
v_lshlrev_b32 v10,4,v10
v_lshl_add_u32 v10,v11,7,v10
v_bfe_u32 v11,v0,3,1
v_mul_u32_u24 v11,9216,v11
v_add_u32 v4,v10,v11
v_xor_b32 v3,64,v4
v_and_b32 v10,15,v0
v_lshlrev_b32 v10,2,v10
v_add_u32 v7,37888,v10
s_mov_b32 s31,0
v_lshlrev_b32 v5,4,v0
v_lshrrev_b32 v10,2,v0
v_lshlrev_b32 v10,5,v10
v_and_b32_e64 v11,1,v0
v_lshl_add_u32 v10,v11,4,v10
v_bfe_u32 v11,v0,1,1
v_lshl_add_u32 v6,v11,11,v10
v_mov_b32 v16,0x3f803f80
v_mov_b32 v17,0x3f803f80
v_mov_b32 v18,0x3f803f80
v_mov_b32 v19,0x3f803f80
s_nop 1
v_mfma_f32_16x16x32_bf16 v[20:23],v[16:19],a[216:219],0
v_mfma_f32_16x16x32_bf16 v[24:27],v[16:19],v[112:115],0
v_mfma_f32_16x16x32_bf16 v[28:31],v[16:19],v[184:187],0
v_mfma_f32_16x16x32_bf16 v[20:23],v[16:19],a[220:223],v[20:23]
v_mfma_f32_16x16x32_bf16 v[24:27],v[16:19],v[116:119],v[24:27]
v_mfma_f32_16x16x32_bf16 v[28:31],v[16:19],v[188:191],v[28:31]
v_mfma_f32_16x16x32_bf16 v[20:23],v[16:19],a[224:227],v[20:23]
v_mfma_f32_16x16x32_bf16 v[24:27],v[16:19],v[120:123],v[24:27]
v_mfma_f32_16x16x32_bf16 v[28:31],v[16:19],v[192:195],v[28:31]
v_mfma_f32_16x16x32_bf16 v[20:23],v[16:19],a[228:231],v[20:23]
v_mfma_f32_16x16x32_bf16 v[24:27],v[16:19],v[124:127],v[24:27]
v_mfma_f32_16x16x32_bf16 v[28:31],v[16:19],v[196:199],v[28:31]
v_mfma_f32_16x16x32_bf16 v[20:23],v[16:19],a[232:235],v[20:23]
v_mfma_f32_16x16x32_bf16 v[24:27],v[16:19],v[128:131],v[24:27]
v_mfma_f32_16x16x32_bf16 v[28:31],v[16:19],v[200:203],v[28:31]
v_mfma_f32_16x16x32_bf16 v[20:23],v[16:19],a[236:239],v[20:23]
v_mfma_f32_16x16x32_bf16 v[24:27],v[16:19],v[132:135],v[24:27]
v_mfma_f32_16x16x32_bf16 v[28:31],v[16:19],v[204:207],v[28:31]
v_mfma_f32_16x16x32_bf16 v[20:23],v[16:19],a[240:243],v[20:23]
v_mfma_f32_16x16x32_bf16 v[24:27],v[16:19],v[136:139],v[24:27]
v_mfma_f32_16x16x32_bf16 v[28:31],v[16:19],v[208:211],v[28:31]
v_mfma_f32_16x16x32_bf16 v[20:23],v[16:19],a[244:247],v[20:23]
v_mfma_f32_16x16x32_bf16 v[24:27],v[16:19],v[140:143],v[24:27]
v_mfma_f32_16x16x32_bf16 v[28:31],v[16:19],v[212:215],v[28:31]
v_mfma_f32_16x16x32_bf16 v[20:23],v[16:19],a[248:251],v[20:23]
v_mfma_f32_16x16x32_bf16 v[24:27],v[16:19],v[144:147],v[24:27]
v_mfma_f32_16x16x32_bf16 v[28:31],v[16:19],v[216:219],v[28:31]
v_mfma_f32_16x16x32_bf16 v[20:23],v[16:19],a[252:255],v[20:23]
v_mfma_f32_16x16x32_bf16 v[24:27],v[16:19],v[148:151],v[24:27]
v_mfma_f32_16x16x32_bf16 v[28:31],v[16:19],v[220:223],v[28:31]
v_mfma_f32_16x16x32_bf16 v[20:23],v[16:19],v[80:83],v[20:23]
v_mfma_f32_16x16x32_bf16 v[24:27],v[16:19],v[152:155],v[24:27]
v_mfma_f32_16x16x32_bf16 v[28:31],v[16:19],v[224:227],v[28:31]
v_mfma_f32_16x16x32_bf16 v[20:23],v[16:19],v[84:87],v[20:23]
v_mfma_f32_16x16x32_bf16 v[24:27],v[16:19],v[156:159],v[24:27]
v_mfma_f32_16x16x32_bf16 v[28:31],v[16:19],v[228:231],v[28:31]
v_mfma_f32_16x16x32_bf16 v[20:23],v[16:19],v[88:91],v[20:23]
v_mfma_f32_16x16x32_bf16 v[24:27],v[16:19],v[160:163],v[24:27]
v_mfma_f32_16x16x32_bf16 v[28:31],v[16:19],v[232:235],v[28:31]
v_mfma_f32_16x16x32_bf16 v[20:23],v[16:19],v[92:95],v[20:23]
v_mfma_f32_16x16x32_bf16 v[24:27],v[16:19],v[164:167],v[24:27]
v_mfma_f32_16x16x32_bf16 v[28:31],v[16:19],v[236:239],v[28:31]
v_mfma_f32_16x16x32_bf16 v[20:23],v[16:19],v[96:99],v[20:23]
v_mfma_f32_16x16x32_bf16 v[24:27],v[16:19],v[168:171],v[24:27]
v_mfma_f32_16x16x32_bf16 v[28:31],v[16:19],v[240:243],v[28:31]
v_mfma_f32_16x16x32_bf16 v[20:23],v[16:19],v[100:103],v[20:23]
v_mfma_f32_16x16x32_bf16 v[24:27],v[16:19],v[172:175],v[24:27]
v_mfma_f32_16x16x32_bf16 v[28:31],v[16:19],v[244:247],v[28:31]
v_mfma_f32_16x16x32_bf16 v[20:23],v[16:19],v[104:107],v[20:23]
v_mfma_f32_16x16x32_bf16 v[24:27],v[16:19],v[176:179],v[24:27]
v_mfma_f32_16x16x32_bf16 v[28:31],v[16:19],v[248:251],v[28:31]
v_mfma_f32_16x16x32_bf16 v[20:23],v[16:19],v[108:111],v[20:23]
v_mfma_f32_16x16x32_bf16 v[24:27],v[16:19],v[180:183],v[24:27]
v_mfma_f32_16x16x32_bf16 v[28:31],v[16:19],v[252:255],v[28:31]
s_lshl_b32 s60,s21,9
v_add_u32_e64 v10,s60,v7
ds_write_b32 v10,v20 offset:256
s_nop 0
ds_write_b32 v10,v24 offset:320
s_nop 2
ds_write_b32 v10,v28 offset:384
s_waitcnt lgkmcnt(0)
s_cmp_lg_u32 s19,0
s_cbranch_scc1 ver_56
s_mov_b32 s19,1
v_mbcnt_lo_u32_b32 v18,-1,0
v_mbcnt_hi_u32_b32 v18,-1,v18
v_lshlrev_b32 v12,2,v18
s_mov_b32 s63,0
el_57:
global_load_dword v13,v12,s[4:5] sc1
s_add_u32 s63,s63,1
s_cmp_gt_u32 s63,4000000
s_cbranch_scc1 w_fail
s_waitcnt vmcnt(0)
el_57s:
v_bfe_u32 v14,v13,0,8
v_bfe_u32 v15,v13,8,8
v_bfe_u32 v16,v13,16,8
v_bfe_u32 v17,v13,24,8
v_min_u32 v13,v14,v15
v_min3_u32 v13,v13,v16,v17
v_cmp_eq_u32 vcc,0,v13
s_cbranch_vccnz el_57
s_mov_b32 s62,0
elw_58:
s_add_u32 s62,s62,1
s_mov_b32 s61,0
v_cmp_eq_u32 vcc,s62,v14
s_bcnt1_i32_b64 s60,vcc
s_add_u32 s61,s61,s60
v_cmp_eq_u32 vcc,s62,v15
s_bcnt1_i32_b64 s60,vcc
s_add_u32 s61,s61,s60
v_cmp_eq_u32 vcc,s62,v16
s_bcnt1_i32_b64 s60,vcc
s_add_u32 s61,s61,s60
v_cmp_eq_u32 vcc,s62,v17
s_bcnt1_i32_b64 s60,vcc
s_add_u32 s61,s61,s60
s_cmp_ge_u32 s62,16
s_cbranch_scc1 w_fail
s_cmp_lt_u32 s61,32
s_cbranch_scc1 elw_58
s_mov_b32 s61,0
s_mov_b32 s63,0
v_cmp_gt_u32 vcc,s3,v14
s_bcnt1_i32_b64 s60,vcc
s_add_u32 s63,s63,s60
v_add_u32_e64 v13,0,v12
v_cmp_gt_u32 s[16:17],s2,v13
v_cmp_eq_u32 vcc,s3,v14
s_and_b64 vcc,vcc,s[16:17]
s_bcnt1_i32_b64 s60,vcc
s_add_u32 s61,s61,s60
v_cmp_gt_u32 vcc,s3,v15
s_bcnt1_i32_b64 s60,vcc
s_add_u32 s63,s63,s60
v_add_u32 v13,1,v12
v_cmp_gt_u32 s[16:17],s2,v13
v_cmp_eq_u32 vcc,s3,v15
s_and_b64 vcc,vcc,s[16:17]
s_bcnt1_i32_b64 s60,vcc
s_add_u32 s61,s61,s60
v_cmp_gt_u32 vcc,s3,v16
s_bcnt1_i32_b64 s60,vcc
s_add_u32 s63,s63,s60
v_add_u32 v13,2,v12
v_cmp_gt_u32 s[16:17],s2,v13
v_cmp_eq_u32 vcc,s3,v16
s_and_b64 vcc,vcc,s[16:17]
s_bcnt1_i32_b64 s60,vcc
s_add_u32 s61,s61,s60
v_cmp_gt_u32 vcc,s3,v17
s_bcnt1_i32_b64 s60,vcc
s_add_u32 s63,s63,s60
v_add_u32 v13,3,v12
v_cmp_gt_u32 s[16:17],s2,v13
v_cmp_eq_u32 vcc,s3,v17
s_and_b64 vcc,vcc,s[16:17]
s_bcnt1_i32_b64 s60,vcc
s_add_u32 s61,s61,s60
s_add_u32 s18,s61,s63
s_cmp_gt_u32 s62,s3
s_cselect_b32 s60,32,0
s_add_u32 s18,s18,s60
s_cmp_lg_u32 s62,s3
s_cbranch_scc1 eld_59
s_cmp_lt_u32 s61,32
s_cselect_b32 s18,s61,s18
eld_59:
s_sub_u32 s60,255,s24
s_cmp_eq_u32 s60,s18
s_cbranch_scc1 ver_56
s_mov_b32 s24,s18
s_mov_b32 s10,268435456
s_waitcnt vmcnt(0) lgkmcnt(0)
s_branch k_role
ver_56:
bq_layer:
s_mul_i32 s60,s23,16777216
s_add_u32 s8,s6,s60
s_addc_u32 s9,s7,0
s_mov_b32 s10,23068672
s_mov_b32 s26,s39
s_mov_b32 s25,s37
s_lshl_b32 s30,s25,8
s_add_u32 s30,s30,6307840
s_add_u32 s12,s8,9437184
s_addc_u32 s13,s9,0
s_mov_b32 s14,2359296
s_mov_b32 s15,0x20000
v_lshrrev_b32 v10,3,v0
v_and_b32 v11,7,v0
v_xor_b32 v11,v11,v10
s_lshl_b32 s60,s21,3
v_add_u32 v10,s60,v10
v_mul_u32_u24 v1,1152,v10
v_lshl_add_u32 v1,v11,4,v1
v_lshlrev_b32 v10,2,v10
v_add_u32 v9,37888,v10
s_mul_i32 s60,s21,9216
v_lshlrev_b32 v2,4,v0
v_add_u32 v2,s60,v2
v_lshrrev_b32 v10,4,v0
v_lshlrev_b32 v8,4,v10
v_add_u32 v8,37888,v8
v_and_b32 v11,7,v0
v_xor_b32 v10,v10,v11
v_lshlrev_b32 v10,4,v10
v_lshl_add_u32 v10,v11,7,v10
v_bfe_u32 v11,v0,3,1
v_mul_u32_u24 v11,9216,v11
v_add_u32 v4,v10,v11
v_xor_b32 v3,64,v4
v_and_b32 v10,15,v0
v_lshlrev_b32 v10,2,v10
v_add_u32 v7,37888,v10
s_mov_b32 s31,0
v_lshlrev_b32 v5,4,v0
v_lshrrev_b32 v10,2,v0
v_lshlrev_b32 v10,5,v10
v_and_b32_e64 v11,1,v0
v_lshl_add_u32 v10,v11,4,v10
v_bfe_u32 v11,v0,1,1
v_lshl_add_u32 v6,v11,11,v10
s_mov_b32 s76,s92
s_mov_b32 s77,s93
s_mov_b32 s78,1990656
s_mov_b32 s79,0x20000
s_lshl_b32 s63,s21,14
s_add_u32 s63,s63,81920
v_lshrrev_b32 v12,4,v0
v_bfe_u32 v13,v0,2,2
v_lshl_add_u32 v12,v12,3,v13
v_lshlrev_b32 v12,6,v12
v_and_b32 v13,3,v0
v_lshl_add_u32 v12,v13,3,v12
v_add_u32 v61,s63,v12
s_lshl_b32 s25,s25,2
s_add_u32 s25,s25,s21
v_lshrrev_b32 v12,4,v0
v_mul_u32_u24 v12,3456,v12
v_bfe_u32 v13,v0,3,1
v_mul_u32_u24 v13,1152,v13
v_add_u32 v12,v12,v13
v_and_b32 v13,7,v0
v_and_b32 v14,15,v0
v_lshrrev_b32 v15,4,v0
v_lshlrev_b32_e64 v11,4,v15
v_lshl_add_u32 v60,v14,6,v11
s_cmp_ge_u32 s25,32
s_cbranch_scc1 bq_rem_61
v_lshl_add_u32 v62,v13,2,v12
s_mul_i32 s62,s25,36
v_lshlrev_b32 v15,3,v15
v_lshl_add_u32 v6,v14,5,v15
s_lshl_b32 s28,s25,16
s_add_u32 s28,s28,14680064
s_mov_b32 s29,512
s_branch bq_e_62
bq_rem_61:
v_mul_u32_u24 v13,36,v13
v_add_u32 v62,v13,v12
s_sub_u32 s61,s25,32
s_mul_i32 s62,s61,288
s_add_u32 s62,s62,32
v_lshlrev_b32_e64 v15,14,v15
v_lshl_add_u32 v6,v14,3,v15
s_lshl_b32 s28,s61,16
s_add_u32 s28,s28,6815744
s_mov_b32 s29,128
bq_e_62:
v_lshrrev_b32 v12,2,v0
v_bfe_u32 v13,v0,1,1
v_lshl_add_u32 v12,v13,6,v12
v_mul_u32_u24 v12,3456,v12
v_and_b32_e64 v13,1,v0
v_lshl_add_u32 v16,v13,4,v12
s_lshl_b32 s61,s25,5
s_add_u32 s60,s39,60
s_cmp_eq_u32 s39,0
s_cselect_b32 s26,63,s60
v_mov_b32 v16,-1
v_mov_b32 v17,-1
v_mov_b32 v18,-1
v_mov_b32 v19,-1
v_mov_b32 v20,-1
v_mov_b32 v21,-1
v_mov_b32 v22,-1
v_mov_b32 v23,-1
v_mov_b32 v24,-1
v_mov_b32 v25,-1
v_mov_b32 v26,-1
v_mov_b32 v27,-1
v_mov_b32 v28,-1
v_mov_b32 v29,-1
v_mov_b32 v30,-1
v_mov_b32 v31,-1
v_mov_b32 v32,-1
v_mov_b32 v33,-1
v_mov_b32 v34,-1
v_mov_b32 v35,-1
s_mul_i32 s60,s26,s29
s_lshl_b32 s60,s60,1
s_add_u32 s60,s60,s28
s_add_u32 s60,s60,0
s_cmp_ge_u32 s25,32
s_cselect_b32 s62,1,2
s_lshl_b32 s62,s62,20
buffer_store_dwordx2 v[16:17],v6,s[8:11],s60 offen sc1
s_add_u32 s61,s60,s29
buffer_store_dwordx2 v[20:21],v6,s[8:11],s61 offen sc1
s_add_u32 s60,s60,s62
buffer_store_dwordx2 v[24:25],v6,s[8:11],s60 offen sc1
s_add_u32 s61,s60,s29
buffer_store_dwordx2 v[28:29],v6,s[8:11],s61 offen sc1
s_mul_i32 s60,s26,36
s_add_u32 s60,s60,s25
s_lshl_b32 s60,s60,10
s_add_u32 s60,s60,12058624
buffer_store_dwordx4 v[32:35],v60,s[8:11],s60 offen sc1
s_add_u32 s26,s39,60
v_mov_b32 v16,-1
v_mov_b32 v17,-1
v_mov_b32 v18,-1
v_mov_b32 v19,-1
v_mov_b32 v20,-1
v_mov_b32 v21,-1
v_mov_b32 v22,-1
v_mov_b32 v23,-1
v_mov_b32 v24,-1
v_mov_b32 v25,-1
v_mov_b32 v26,-1
v_mov_b32 v27,-1
v_mov_b32 v28,-1
v_mov_b32 v29,-1
v_mov_b32 v30,-1
v_mov_b32 v31,-1
v_mov_b32 v32,-1
v_mov_b32 v33,-1
v_mov_b32 v34,-1
v_mov_b32 v35,-1
s_mul_i32 s60,s26,s29
s_lshl_b32 s60,s60,1
s_add_u32 s60,s60,s28
s_add_u32 s60,s60,0
s_cmp_ge_u32 s25,32
s_cselect_b32 s62,1,2
s_lshl_b32 s62,s62,20
buffer_store_dwordx2 v[16:17],v6,s[8:11],s60 offen sc1
s_add_u32 s61,s60,s29
buffer_store_dwordx2 v[20:21],v6,s[8:11],s61 offen sc1
s_add_u32 s60,s60,s62
buffer_store_dwordx2 v[24:25],v6,s[8:11],s60 offen sc1
s_add_u32 s61,s60,s29
buffer_store_dwordx2 v[28:29],v6,s[8:11],s61 offen sc1
s_mul_i32 s60,s26,36
s_add_u32 s60,s60,s25
s_lshl_b32 s60,s60,10
s_add_u32 s60,s60,12058624
buffer_store_dwordx4 v[32:35],v60,s[8:11],s60 offen sc1
s_mov_b32 s26,s39
w_bq:
s_lshl_b32 s63,s26,12
s_add_u32 s63,s63,21233664
s_cmp_lg_u32 s21,0
s_cbranch_scc1 wfo_64
v_min_u32 v10,17,v0
v_lshlrev_b32 v10,7,v10
s_branch wf_63_0f
wf_63_0:
s_sleep 1
wf_63_0f:
buffer_load_dword v11,v10,s[8:11],s63 offen sc1
s_add_u32 s38,s38,1
s_cmp_gt_u32 s38,3000000
s_cbranch_scc1 w_fail
s_waitcnt vmcnt(0)
v_cmp_gt_u32 vcc,1,v11
s_cbranch_vccnz wf_63_0
wfo_64:
s_barrier
w_bqf:
s_mul_i32 s27,s26,36864
s_mul_i32 s61,s21,9216
s_add_u32 s61,s61,s31
s_add_u32 m0,s61,0
s_nop 0
buffer_load_dwordx4 v1,s[12:15],s27 offen sc1 lds
s_add_u32 m0,s61,896
s_nop 0
buffer_load_dwordx4 v1,s[12:15],s27 offen offset:128 sc1 lds
s_add_u32 m0,s61,1792
s_nop 0
buffer_load_dwordx4 v1,s[12:15],s27 offen offset:256 sc1 lds
s_add_u32 m0,s61,2688
s_nop 0
buffer_load_dwordx4 v1,s[12:15],s27 offen offset:384 sc1 lds
s_add_u32 m0,s61,3584
s_nop 0
buffer_load_dwordx4 v1,s[12:15],s27 offen offset:512 sc1 lds
s_add_u32 m0,s61,4480
s_nop 0
buffer_load_dwordx4 v1,s[12:15],s27 offen offset:640 sc1 lds
s_add_u32 m0,s61,5376
s_nop 0
buffer_load_dwordx4 v1,s[12:15],s27 offen offset:768 sc1 lds
s_add_u32 m0,s61,6272
s_nop 0
buffer_load_dwordx4 v1,s[12:15],s27 offen offset:896 sc1 lds
s_add_u32 m0,s61,7168
s_nop 0
buffer_load_dwordx4 v1,s[12:15],s27 offen offset:1024 sc1 lds
s_add_u32 s38,s38,64
s_cmp_gt_u32 s38,3000000
s_cbranch_scc1 w_fail
s_lshl_b32 s63,s26,2
s_add_u32 s63,s63,s30
s_waitcnt vmcnt(0)
ds_read_b128 v[16:19],v2
ds_read_b128 v[20:23],v2 offset:1024
ds_read_b128 v[24:27],v2 offset:2048
ds_read_b128 v[28:31],v2 offset:3072
ds_read_b128 v[32:35],v2 offset:4096
ds_read_b128 v[36:39],v2 offset:5120
ds_read_b128 v[40:43],v2 offset:6144
ds_read_b128 v[44:47],v2 offset:7168
ds_read_b128 v[48:51],v2 offset:8192
v_mov_b32 v56,0x3f803f80
v_mov_b32 v52,0
v_mov_b32 v53,0
v_mov_b32 v54,0
v_mov_b32 v55,0
s_waitcnt lgkmcnt(8)
v_dot2c_f32_bf16 v52,v16,v56
v_dot2c_f32_bf16 v53,v16,v16
v_dot2c_f32_bf16 v54,v17,v56
v_dot2c_f32_bf16 v55,v17,v17
v_dot2c_f32_bf16 v52,v18,v56
v_dot2c_f32_bf16 v53,v18,v18
v_dot2c_f32_bf16 v54,v19,v56
v_dot2c_f32_bf16 v55,v19,v19
s_waitcnt lgkmcnt(7)
v_dot2c_f32_bf16 v52,v20,v56
v_dot2c_f32_bf16 v53,v20,v20
v_dot2c_f32_bf16 v54,v21,v56
v_dot2c_f32_bf16 v55,v21,v21
v_dot2c_f32_bf16 v52,v22,v56
v_dot2c_f32_bf16 v53,v22,v22
v_dot2c_f32_bf16 v54,v23,v56
v_dot2c_f32_bf16 v55,v23,v23
s_waitcnt lgkmcnt(6)
v_dot2c_f32_bf16 v52,v24,v56
v_dot2c_f32_bf16 v53,v24,v24
v_dot2c_f32_bf16 v54,v25,v56
v_dot2c_f32_bf16 v55,v25,v25
v_dot2c_f32_bf16 v52,v26,v56
v_dot2c_f32_bf16 v53,v26,v26
v_dot2c_f32_bf16 v54,v27,v56
v_dot2c_f32_bf16 v55,v27,v27
s_waitcnt lgkmcnt(5)
v_dot2c_f32_bf16 v52,v28,v56
v_dot2c_f32_bf16 v53,v28,v28
v_dot2c_f32_bf16 v54,v29,v56
v_dot2c_f32_bf16 v55,v29,v29
v_dot2c_f32_bf16 v52,v30,v56
v_dot2c_f32_bf16 v53,v30,v30
v_dot2c_f32_bf16 v54,v31,v56
v_dot2c_f32_bf16 v55,v31,v31
s_waitcnt lgkmcnt(4)
v_dot2c_f32_bf16 v52,v32,v56
v_dot2c_f32_bf16 v53,v32,v32
v_dot2c_f32_bf16 v54,v33,v56
v_dot2c_f32_bf16 v55,v33,v33
v_dot2c_f32_bf16 v52,v34,v56
v_dot2c_f32_bf16 v53,v34,v34
v_dot2c_f32_bf16 v54,v35,v56
v_dot2c_f32_bf16 v55,v35,v35
s_waitcnt lgkmcnt(3)
v_dot2c_f32_bf16 v52,v36,v56
v_dot2c_f32_bf16 v53,v36,v36
v_dot2c_f32_bf16 v54,v37,v56
v_dot2c_f32_bf16 v55,v37,v37
v_dot2c_f32_bf16 v52,v38,v56
v_dot2c_f32_bf16 v53,v38,v38
v_dot2c_f32_bf16 v54,v39,v56
v_dot2c_f32_bf16 v55,v39,v39
s_waitcnt lgkmcnt(2)
v_dot2c_f32_bf16 v52,v40,v56
v_dot2c_f32_bf16 v53,v40,v40
v_dot2c_f32_bf16 v54,v41,v56
v_dot2c_f32_bf16 v55,v41,v41
v_dot2c_f32_bf16 v52,v42,v56
v_dot2c_f32_bf16 v53,v42,v42
v_dot2c_f32_bf16 v54,v43,v56
v_dot2c_f32_bf16 v55,v43,v43
s_waitcnt lgkmcnt(1)
v_dot2c_f32_bf16 v52,v44,v56
v_dot2c_f32_bf16 v53,v44,v44
v_dot2c_f32_bf16 v54,v45,v56
v_dot2c_f32_bf16 v55,v45,v45
v_dot2c_f32_bf16 v52,v46,v56
v_dot2c_f32_bf16 v53,v46,v46
v_dot2c_f32_bf16 v54,v47,v56
v_dot2c_f32_bf16 v55,v47,v47
s_waitcnt lgkmcnt(0)
v_dot2c_f32_bf16 v52,v48,v56
v_dot2c_f32_bf16 v53,v48,v48
v_dot2c_f32_bf16 v54,v49,v56
v_dot2c_f32_bf16 v55,v49,v49
v_dot2c_f32_bf16 v52,v50,v56
v_dot2c_f32_bf16 v53,v50,v50
v_dot2c_f32_bf16 v54,v51,v56
v_dot2c_f32_bf16 v55,v51,v51
s_nop 2
v_add_f32 v52,v52,v54
v_add_f32_e64 v53,v53,v55
v_cmp_u_f32 vcc,v52,v52
v_add_f32_dpp v52,v52,v52 quad_perm:[1,0,3,2] row_mask:0xf bank_mask:0xf
v_add_f32_dpp v53,v53,v53 quad_perm:[1,0,3,2] row_mask:0xf bank_mask:0xf
s_nop 0
v_add_f32_dpp v52,v52,v52 quad_perm:[2,3,0,1] row_mask:0xf bank_mask:0xf
v_add_f32_dpp v53,v53,v53 quad_perm:[2,3,0,1] row_mask:0xf bank_mask:0xf
s_nop 0
v_add_f32_dpp v52,v52,v52 row_half_mirror row_mask:0xf bank_mask:0xf
v_add_f32_dpp v53,v53,v53 row_half_mirror row_mask:0xf bank_mask:0xf
s_cbranch_vccnz w_bqf
v_mul_f32 v52,0xbae38e39,v52
v_mul_f32 v54,v52,v52
v_mul_f32 v53,0x3ae38e39,v53
v_sub_f32 v53,v53,v54
v_max_f32 v53,0,v53
v_add_f32 v53,0x3727c5ac,v53
v_rsq_f32 v53,v53
s_nop 0
v_mul_f32 v54,v52,v53
ds_write2_b32 v9,v53,v54 offset0:0 offset1:32
s_waitcnt lgkmcnt(0)
s_barrier
s_lshl_b32 s60,s21,9
v_add_u32 v10,s60,v8
v_add_u32_e64 v11,s60,v7
ds_read_b128 v[64:67],v4
ds_read_b128 v[68:71],v4 offset:18432
s_waitcnt lgkmcnt(0)
v_mfma_f32_16x16x32_bf16 v[16:19],a[216:219],v[64:67],0
ds_read_b128 v[72:75],v3
v_mfma_f32_16x16x32_bf16 v[20:23],a[216:219],v[68:71],0
ds_read_b128 v[76:79],v3 offset:18432
v_mfma_f32_16x16x32_bf16 v[24:27],v[112:115],v[64:67],0
ds_read2_b32 v[12:13],v7 offset0:0 offset1:16
v_mfma_f32_16x16x32_bf16 v[28:31],v[112:115],v[68:71],0
v_mfma_f32_16x16x32_bf16 v[32:35],v[64:67],v[184:187],0
v_mfma_f32_16x16x32_bf16 v[36:39],v[68:71],v[184:187],0
s_waitcnt lgkmcnt(0)
v_mfma_f32_16x16x32_bf16 v[16:19],a[220:223],v[72:75],v[16:19]
ds_read_b128 v[64:67],v4 offset:1024
v_mfma_f32_16x16x32_bf16 v[20:23],a[220:223],v[76:79],v[20:23]
ds_read_b128 v[68:71],v4 offset:19456
v_mfma_f32_16x16x32_bf16 v[24:27],v[116:119],v[72:75],v[24:27]
ds_read2_b32 v[14:15],v7 offset0:32 offset1:48
v_mfma_f32_16x16x32_bf16 v[28:31],v[116:119],v[76:79],v[28:31]
v_mfma_f32_16x16x32_bf16 v[32:35],v[72:75],v[188:191],v[32:35]
v_mfma_f32_16x16x32_bf16 v[36:39],v[76:79],v[188:191],v[36:39]
s_waitcnt lgkmcnt(0)
v_mfma_f32_16x16x32_bf16 v[16:19],a[224:227],v[64:67],v[16:19]
ds_read_b128 v[72:75],v3 offset:1024
v_mfma_f32_16x16x32_bf16 v[20:23],a[224:227],v[68:71],v[20:23]
ds_read_b128 v[76:79],v3 offset:19456
v_mfma_f32_16x16x32_bf16 v[24:27],v[120:123],v[64:67],v[24:27]
ds_read_b128 v[40:43],v10 offset:256
v_mfma_f32_16x16x32_bf16 v[28:31],v[120:123],v[68:71],v[28:31]
v_mfma_f32_16x16x32_bf16 v[32:35],v[64:67],v[192:195],v[32:35]
v_mfma_f32_16x16x32_bf16 v[36:39],v[68:71],v[192:195],v[36:39]
s_waitcnt lgkmcnt(0)
v_mfma_f32_16x16x32_bf16 v[16:19],a[228:231],v[72:75],v[16:19]
ds_read_b128 v[64:67],v4 offset:2048
v_mfma_f32_16x16x32_bf16 v[20:23],a[228:231],v[76:79],v[20:23]
ds_read_b128 v[68:71],v4 offset:20480
v_mfma_f32_16x16x32_bf16 v[24:27],v[124:127],v[72:75],v[24:27]
ds_read_b128 v[44:47],v10 offset:320
v_mfma_f32_16x16x32_bf16 v[28:31],v[124:127],v[76:79],v[28:31]
v_mfma_f32_16x16x32_bf16 v[32:35],v[72:75],v[196:199],v[32:35]
v_mfma_f32_16x16x32_bf16 v[36:39],v[76:79],v[196:199],v[36:39]
s_waitcnt lgkmcnt(0)
v_mfma_f32_16x16x32_bf16 v[16:19],a[232:235],v[64:67],v[16:19]
ds_read_b128 v[72:75],v3 offset:2048
v_mfma_f32_16x16x32_bf16 v[20:23],a[232:235],v[68:71],v[20:23]
ds_read_b128 v[76:79],v3 offset:20480
v_mfma_f32_16x16x32_bf16 v[24:27],v[128:131],v[64:67],v[24:27]
ds_read_b32 v48,v11 offset:384
v_mfma_f32_16x16x32_bf16 v[28:31],v[128:131],v[68:71],v[28:31]
v_mfma_f32_16x16x32_bf16 v[32:35],v[64:67],v[200:203],v[32:35]
v_mfma_f32_16x16x32_bf16 v[36:39],v[68:71],v[200:203],v[36:39]
s_waitcnt lgkmcnt(0)
v_mfma_f32_16x16x32_bf16 v[16:19],a[236:239],v[72:75],v[16:19]
ds_read_b128 v[64:67],v4 offset:3072
v_mfma_f32_16x16x32_bf16 v[20:23],a[236:239],v[76:79],v[20:23]
ds_read_b128 v[68:71],v4 offset:21504
v_mfma_f32_16x16x32_bf16 v[24:27],v[132:135],v[72:75],v[24:27]
v_mfma_f32_16x16x32_bf16 v[28:31],v[132:135],v[76:79],v[28:31]
v_mfma_f32_16x16x32_bf16 v[32:35],v[72:75],v[204:207],v[32:35]
v_mfma_f32_16x16x32_bf16 v[36:39],v[76:79],v[204:207],v[36:39]
s_waitcnt lgkmcnt(0)
v_mfma_f32_16x16x32_bf16 v[16:19],a[240:243],v[64:67],v[16:19]
ds_read_b128 v[72:75],v3 offset:3072
v_mfma_f32_16x16x32_bf16 v[20:23],a[240:243],v[68:71],v[20:23]
ds_read_b128 v[76:79],v3 offset:21504
v_mfma_f32_16x16x32_bf16 v[24:27],v[136:139],v[64:67],v[24:27]
v_mfma_f32_16x16x32_bf16 v[28:31],v[136:139],v[68:71],v[28:31]
v_mfma_f32_16x16x32_bf16 v[32:35],v[64:67],v[208:211],v[32:35]
v_mfma_f32_16x16x32_bf16 v[36:39],v[68:71],v[208:211],v[36:39]
s_waitcnt lgkmcnt(0)
v_mfma_f32_16x16x32_bf16 v[16:19],a[244:247],v[72:75],v[16:19]
ds_read_b128 v[64:67],v4 offset:4096
v_mfma_f32_16x16x32_bf16 v[20:23],a[244:247],v[76:79],v[20:23]
ds_read_b128 v[68:71],v4 offset:22528
v_mfma_f32_16x16x32_bf16 v[24:27],v[140:143],v[72:75],v[24:27]
v_mfma_f32_16x16x32_bf16 v[28:31],v[140:143],v[76:79],v[28:31]
v_mfma_f32_16x16x32_bf16 v[32:35],v[72:75],v[212:215],v[32:35]
v_mfma_f32_16x16x32_bf16 v[36:39],v[76:79],v[212:215],v[36:39]
s_waitcnt lgkmcnt(0)
v_mfma_f32_16x16x32_bf16 v[16:19],a[248:251],v[64:67],v[16:19]
ds_read_b128 v[72:75],v3 offset:4096
v_mfma_f32_16x16x32_bf16 v[20:23],a[248:251],v[68:71],v[20:23]
ds_read_b128 v[76:79],v3 offset:22528
v_mfma_f32_16x16x32_bf16 v[24:27],v[144:147],v[64:67],v[24:27]
v_mul_f32 v52,0x3eae1a93,v12
v_mfma_f32_16x16x32_bf16 v[28:31],v[144:147],v[68:71],v[28:31]
v_mul_f32 v53,0x3eae1a93,v13
v_mfma_f32_16x16x32_bf16 v[32:35],v[64:67],v[216:219],v[32:35]
v_mul_f32 v54,0x3eae1a93,v14
v_mfma_f32_16x16x32_bf16 v[36:39],v[68:71],v[216:219],v[36:39]
v_mul_f32 v55,0x3eae1a93,v15
s_waitcnt lgkmcnt(0)
v_mfma_f32_16x16x32_bf16 v[16:19],a[252:255],v[72:75],v[16:19]
ds_read_b128 v[64:67],v4 offset:5120
v_mfma_f32_16x16x32_bf16 v[20:23],a[252:255],v[76:79],v[20:23]
ds_read_b128 v[68:71],v4 offset:23552
v_mfma_f32_16x16x32_bf16 v[24:27],v[148:151],v[72:75],v[24:27]
v_mfma_f32_16x16x32_bf16 v[28:31],v[148:151],v[76:79],v[28:31]
v_mfma_f32_16x16x32_bf16 v[32:35],v[72:75],v[220:223],v[32:35]
v_mfma_f32_16x16x32_bf16 v[36:39],v[76:79],v[220:223],v[36:39]
s_waitcnt lgkmcnt(0)
v_mfma_f32_16x16x32_bf16 v[16:19],v[80:83],v[64:67],v[16:19]
ds_read_b128 v[72:75],v3 offset:5120
v_mfma_f32_16x16x32_bf16 v[20:23],v[80:83],v[68:71],v[20:23]
ds_read_b128 v[76:79],v3 offset:23552
v_mfma_f32_16x16x32_bf16 v[24:27],v[152:155],v[64:67],v[24:27]
v_mfma_f32_16x16x32_bf16 v[28:31],v[152:155],v[68:71],v[28:31]
v_mfma_f32_16x16x32_bf16 v[32:35],v[64:67],v[224:227],v[32:35]
v_mfma_f32_16x16x32_bf16 v[36:39],v[68:71],v[224:227],v[36:39]
s_waitcnt lgkmcnt(0)
v_mfma_f32_16x16x32_bf16 v[16:19],v[84:87],v[72:75],v[16:19]
ds_read_b128 v[64:67],v4 offset:6144
v_mfma_f32_16x16x32_bf16 v[20:23],v[84:87],v[76:79],v[20:23]
ds_read_b128 v[68:71],v4 offset:24576
v_mfma_f32_16x16x32_bf16 v[24:27],v[156:159],v[72:75],v[24:27]
v_mfma_f32_16x16x32_bf16 v[28:31],v[156:159],v[76:79],v[28:31]
v_mfma_f32_16x16x32_bf16 v[32:35],v[72:75],v[228:231],v[32:35]
v_mfma_f32_16x16x32_bf16 v[36:39],v[76:79],v[228:231],v[36:39]
s_waitcnt lgkmcnt(0)
v_mfma_f32_16x16x32_bf16 v[16:19],v[88:91],v[64:67],v[16:19]
ds_read_b128 v[72:75],v3 offset:6144
v_mfma_f32_16x16x32_bf16 v[20:23],v[88:91],v[68:71],v[20:23]
ds_read_b128 v[76:79],v3 offset:24576
v_mfma_f32_16x16x32_bf16 v[24:27],v[160:163],v[64:67],v[24:27]
v_mfma_f32_16x16x32_bf16 v[28:31],v[160:163],v[68:71],v[28:31]
v_mfma_f32_16x16x32_bf16 v[32:35],v[64:67],v[232:235],v[32:35]
v_mfma_f32_16x16x32_bf16 v[36:39],v[68:71],v[232:235],v[36:39]
s_waitcnt lgkmcnt(0)
v_mfma_f32_16x16x32_bf16 v[16:19],v[92:95],v[72:75],v[16:19]
ds_read_b128 v[64:67],v4 offset:7168
v_mfma_f32_16x16x32_bf16 v[20:23],v[92:95],v[76:79],v[20:23]
ds_read_b128 v[68:71],v4 offset:25600
v_mfma_f32_16x16x32_bf16 v[24:27],v[164:167],v[72:75],v[24:27]
v_mfma_f32_16x16x32_bf16 v[28:31],v[164:167],v[76:79],v[28:31]
v_mfma_f32_16x16x32_bf16 v[32:35],v[72:75],v[236:239],v[32:35]
v_mfma_f32_16x16x32_bf16 v[36:39],v[76:79],v[236:239],v[36:39]
s_cmp_ge_u32 s26,60
s_cselect_b32 s18,s63,0x40000000
s_cmp_eq_u32 s21,0
s_cselect_b32 s18,s18,0x40000000
v_mov_b32 v58,0
v_mov_b32 v59,1
s_mov_b64 exec,1
buffer_store_dword v59,v58,s[8:11],s18 offen sc1
s_mov_b64 exec,-1
s_waitcnt lgkmcnt(0)
v_mfma_f32_16x16x32_bf16 v[16:19],v[96:99],v[64:67],v[16:19]
ds_read_b128 v[72:75],v3 offset:7168
v_mfma_f32_16x16x32_bf16 v[20:23],v[96:99],v[68:71],v[20:23]
ds_read_b128 v[76:79],v3 offset:25600
v_mfma_f32_16x16x32_bf16 v[24:27],v[168:171],v[64:67],v[24:27]
v_mfma_f32_16x16x32_bf16 v[28:31],v[168:171],v[68:71],v[28:31]
v_mfma_f32_16x16x32_bf16 v[32:35],v[64:67],v[240:243],v[32:35]
v_mfma_f32_16x16x32_bf16 v[36:39],v[68:71],v[240:243],v[36:39]
s_waitcnt lgkmcnt(0)
v_mfma_f32_16x16x32_bf16 v[16:19],v[100:103],v[72:75],v[16:19]
ds_read_b128 v[64:67],v4 offset:8192
v_mfma_f32_16x16x32_bf16 v[20:23],v[100:103],v[76:79],v[20:23]
ds_read_b128 v[68:71],v4 offset:26624
v_mfma_f32_16x16x32_bf16 v[24:27],v[172:175],v[72:75],v[24:27]
v_mfma_f32_16x16x32_bf16 v[28:31],v[172:175],v[76:79],v[28:31]
v_mfma_f32_16x16x32_bf16 v[32:35],v[72:75],v[244:247],v[32:35]
v_mfma_f32_16x16x32_bf16 v[36:39],v[76:79],v[244:247],v[36:39]
s_waitcnt lgkmcnt(0)
v_mfma_f32_16x16x32_bf16 v[16:19],v[104:107],v[64:67],v[16:19]
ds_read_b128 v[72:75],v3 offset:8192
v_mfma_f32_16x16x32_bf16 v[20:23],v[104:107],v[68:71],v[20:23]
ds_read_b128 v[76:79],v3 offset:26624
v_mfma_f32_16x16x32_bf16 v[24:27],v[176:179],v[64:67],v[24:27]
v_mfma_f32_16x16x32_bf16 v[28:31],v[176:179],v[68:71],v[28:31]
v_mfma_f32_16x16x32_bf16 v[32:35],v[64:67],v[248:251],v[32:35]
v_mfma_f32_16x16x32_bf16 v[36:39],v[68:71],v[248:251],v[36:39]
s_waitcnt lgkmcnt(0)
v_mfma_f32_16x16x32_bf16 v[16:19],v[108:111],v[72:75],v[16:19]
v_mfma_f32_16x16x32_bf16 v[20:23],v[108:111],v[76:79],v[20:23]
v_mfma_f32_16x16x32_bf16 v[24:27],v[180:183],v[72:75],v[24:27]
v_mfma_f32_16x16x32_bf16 v[28:31],v[180:183],v[76:79],v[28:31]
v_mfma_f32_16x16x32_bf16 v[32:35],v[72:75],v[252:255],v[32:35]
v_mfma_f32_16x16x32_bf16 v[36:39],v[76:79],v[252:255],v[36:39]
ds_read_b128 v[64:67],v8
ds_read_b128 v[68:71],v8 offset:128
ds_read_b128 v[72:75],v8 offset:64
ds_read_b128 v[76:79],v8 offset:192
v_pk_mul_f32 v[16:17],v[16:17],v[52:53] op_sel:[0,0] op_sel_hi:[1,0]
v_pk_mul_f32 v[18:19],v[18:19],v[52:53] op_sel:[0,0] op_sel_hi:[1,0]
v_pk_fma_f32 v[16:17],v[40:41],v[54:55],v[16:17] op_sel:[0,0,0] op_sel_hi:[1,0,1]
v_pk_fma_f32 v[18:19],v[42:43],v[54:55],v[18:19] op_sel:[0,0,0] op_sel_hi:[1,0,1]
v_pk_mul_f32 v[24:25],v[24:25],v[12:13] op_sel:[0,0] op_sel_hi:[1,0]
v_pk_mul_f32 v[26:27],v[26:27],v[12:13] op_sel:[0,0] op_sel_hi:[1,0]
v_pk_fma_f32 v[24:25],v[44:45],v[14:15],v[24:25] op_sel:[0,0,0] op_sel_hi:[1,0,1]
v_pk_fma_f32 v[26:27],v[46:47],v[14:15],v[26:27] op_sel:[0,0,0] op_sel_hi:[1,0,1]
v_pk_mul_f32 v[20:21],v[20:21],v[52:53] op_sel:[0,1] op_sel_hi:[1,1]
v_pk_mul_f32 v[22:23],v[22:23],v[52:53] op_sel:[0,1] op_sel_hi:[1,1]
v_pk_fma_f32 v[20:21],v[40:41],v[54:55],v[20:21] op_sel:[0,1,0] op_sel_hi:[1,1,1]
v_pk_fma_f32 v[22:23],v[42:43],v[54:55],v[22:23] op_sel:[0,1,0] op_sel_hi:[1,1,1]
v_pk_mul_f32 v[28:29],v[28:29],v[12:13] op_sel:[0,1] op_sel_hi:[1,1]
v_pk_mul_f32 v[30:31],v[30:31],v[12:13] op_sel:[0,1] op_sel_hi:[1,1]
v_pk_fma_f32 v[28:29],v[44:45],v[14:15],v[28:29] op_sel:[0,1,0] op_sel_hi:[1,1,1]
v_pk_fma_f32 v[30:31],v[46:47],v[14:15],v[30:31] op_sel:[0,1,0] op_sel_hi:[1,1,1]
s_waitcnt lgkmcnt(0)
v_pk_mul_f32 v[32:33],v[32:33],v[64:65]
v_pk_mul_f32 v[34:35],v[34:35],v[66:67]
v_pk_fma_f32 v[32:33],v[68:69],v[48:49],v[32:33] op_sel:[0,0,0] op_sel_hi:[1,0,1]
v_pk_fma_f32 v[34:35],v[70:71],v[48:49],v[34:35] op_sel:[0,0,0] op_sel_hi:[1,0,1]
v_pk_mul_f32 v[36:37],v[36:37],v[72:73]
v_pk_mul_f32 v[38:39],v[38:39],v[74:75]
v_pk_fma_f32 v[36:37],v[76:77],v[48:49],v[36:37] op_sel:[0,0,0] op_sel_hi:[1,0,1]
v_pk_fma_f32 v[38:39],v[78:79],v[48:49],v[38:39] op_sel:[0,0,0] op_sel_hi:[1,0,1]
s_mul_i32 s60,s26,s29
s_lshl_b32 s60,s60,1
s_add_u32 s60,s60,s28
s_add_u32 s60,s60,0
s_cmp_ge_u32 s25,32
s_cselect_b32 s62,1,2
s_lshl_b32 s62,s62,20
v_cvt_pk_bf16_f32 v16,v16,v17
v_cvt_pk_bf16_f32 v17,v18,v19
buffer_store_dwordx2 v[16:17],v6,s[8:11],s60 offen sc1
v_cvt_pk_bf16_f32 v20,v20,v21
v_cvt_pk_bf16_f32 v21,v22,v23
s_add_u32 s61,s60,s29
buffer_store_dwordx2 v[20:21],v6,s[8:11],s61 offen sc1
s_add_u32 s60,s60,s62
v_cvt_pk_bf16_f32 v24,v24,v25
v_cvt_pk_bf16_f32 v25,v26,v27
buffer_store_dwordx2 v[24:25],v6,s[8:11],s60 offen sc1
v_cvt_pk_bf16_f32 v28,v28,v29
v_cvt_pk_bf16_f32 v29,v30,v31
s_add_u32 s61,s60,s29
buffer_store_dwordx2 v[28:29],v6,s[8:11],s61 offen sc1
v_cvt_pk_bf16_f32 v32,v32,v33
v_cvt_pk_bf16_f32 v33,v34,v35
v_cvt_pk_bf16_f32 v34,v36,v37
v_cvt_pk_bf16_f32 v35,v38,v39
s_mul_i32 s60,s26,36
s_add_u32 s60,s60,s25
s_lshl_b32 s60,s60,10
s_add_u32 s60,s60,12058624
buffer_store_dwordx4 v[32:35],v60,s[8:11],s60 offen sc1
s_cmp_ge_u32 s26,60
s_cbranch_scc1 w_bqs
s_waitcnt vmcnt(0)
s_barrier
s_cmp_lg_u32 s21,0
s_cbranch_scc1 sg_65
v_mov_b32 v10,0
v_mov_b32_e64 v11,1
s_mov_b64 exec,1
buffer_store_dword v11,v10,s[8:11],s63 offen sc1
s_mov_b64 exec,-1
sg_65:
w_bqs:
s_add_u32 s26,s26,3
s_cmp_lt_u32 s26,64
s_cbranch_scc1 w_bq
s_mul_i32 s61,s39,9
s_add_u32 s61,s61,s37
s_mul_i32 s26,s61,43691
s_lshr_b32 s26,s26,17
s_mul_i32 s60,s26,3
s_sub_u32 s25,s61,s60
s_sub_u32 s60,63,s26
s_cmp_eq_u32 s23,0
s_cselect_b32 s26,s26,s60
s_branch w_bw0
w_bwo:
s_mul_i32 s26,s61,43691
s_lshr_b32 s26,s26,17
s_mul_i32 s60,s26,3
s_sub_u32 s25,s61,s60
s_sub_u32 s60,63,s26
s_cmp_eq_u32 s23,0
s_cselect_b32 s26,s26,s60
s_barrier
s_mov_b32 s76,s94
s_mov_b32 s77,s95
s_mov_b32 s78,663552
s_mov_b32 s79,0x20000
s_lshl_b32 s63,s21,14
s_add_u32 s63,s63,81920
v_lshrrev_b32 v10,4,v0
v_bfe_u32 v11,v0,2,2
v_lshl_add_u32 v10,v10,3,v11
v_lshlrev_b32 v10,6,v10
v_and_b32 v11,3,v0
v_lshl_add_u32 v10,v11,3,v10
v_add_u32_e64 v3,s63,v10
v_bfe_u32 v10,v0,2,2
v_bfe_u32 v11,v0,4,1
v_lshl_add_u32 v10,v11,3,v10
v_lshrrev_b32_e64 v11,5,v0
v_lshl_add_u32 v10,v11,2,v10
v_mul_u32_u24 v10,1152,v10
v_and_b32 v11,3,v0
v_lshlrev_b32 v11,4,v11
v_add_u32_e64 v4,v11,v10
v_bfe_u32 v12,v0,1,1
v_mul_u32_u24 v12,82944,v12
v_and_b32 v13,1,v0
v_lshl_add_u32 v12,v13,4,v12
v_add_u32 v5,v10,v12
v_lshrrev_b32 v12,3,v0
v_mul_u32_u24 v12,18,v12
v_bfe_u32 v13,v0,2,1
v_add_u32 v12,v12,v13
v_mul_u32_u24 v12,1152,v12
v_add_u32 v6,v11,v12
s_lshl_b32 s62,s25,2
s_add_u32 s62,s62,s21
s_mul_i32 s62,s62,96
s_add_u32 s60,s62,0
s_add_u32 m0,s63,0
s_nop 0
buffer_load_dwordx4 v4,s[76:79],s60 offen lds
s_add_u32 s60,s62,20736
s_add_u32 m0,s63,1024
s_nop 0
buffer_load_dwordx4 v4,s[76:79],s60 offen lds
s_add_u32 s60,s62,41472
s_add_u32 m0,s63,2048
s_nop 0
buffer_load_dwordx4 v4,s[76:79],s60 offen lds
s_add_u32 s60,s62,62208
s_add_u32 m0,s63,3072
s_nop 0
buffer_load_dwordx4 v4,s[76:79],s60 offen lds
s_add_u32 s60,s62,82944
s_add_u32 m0,s63,4096
s_nop 0
buffer_load_dwordx4 v4,s[76:79],s60 offen lds
s_add_u32 s60,s62,103680
s_add_u32 m0,s63,5120
s_nop 0
buffer_load_dwordx4 v4,s[76:79],s60 offen lds
s_add_u32 s60,s62,124416
s_add_u32 m0,s63,6144
s_nop 0
buffer_load_dwordx4 v4,s[76:79],s60 offen lds
s_add_u32 s60,s62,145152
s_add_u32 m0,s63,7168
s_nop 0
buffer_load_dwordx4 v4,s[76:79],s60 offen lds
s_add_u32 s60,s62,165888
s_add_u32 m0,s63,8192
s_nop 0
buffer_load_dwordx4 v4,s[76:79],s60 offen lds
s_add_u32 s60,s62,186624
s_add_u32 m0,s63,9216
s_nop 0
buffer_load_dwordx4 v4,s[76:79],s60 offen lds
s_add_u32 s60,s62,207360
s_add_u32 m0,s63,10240
s_nop 0
buffer_load_dwordx4 v4,s[76:79],s60 offen lds
s_add_u32 s60,s62,228096
s_add_u32 m0,s63,11264
s_nop 0
buffer_load_dwordx4 v4,s[76:79],s60 offen lds
s_waitcnt lgkmcnt(0)
s_add_u32 s60,s62,248832
s_add_u32 m0,s63,12288
s_nop 0
buffer_load_dwordx4 v4,s[76:79],s60 offen lds
s_add_u32 s60,s62,269568
s_add_u32 m0,s63,13312
s_nop 0
buffer_load_dwordx4 v4,s[76:79],s60 offen lds
s_add_u32 s60,s62,290304
s_add_u32 m0,s63,14336
s_nop 0
buffer_load_dwordx4 v4,s[76:79],s60 offen lds
s_add_u32 s60,s62,311040
s_add_u32 m0,s63,15360
s_nop 0
buffer_load_dwordx4 v4,s[76:79],s60 offen lds
s_waitcnt vmcnt(12)
ds_read_b64_tr_b16 a[0:1],v3
ds_read_b64_tr_b16 a[2:3],v3 offset:256
ds_read_b64_tr_b16 a[4:5],v3 offset:2048
ds_read_b64_tr_b16 a[6:7],v3 offset:2304
ds_read_b64_tr_b16 a[72:73],v3 offset:32
ds_read_b64_tr_b16 a[74:75],v3 offset:288
ds_read_b64_tr_b16 a[76:77],v3 offset:2080
ds_read_b64_tr_b16 a[78:79],v3 offset:2336
s_waitcnt lgkmcnt(0)
s_add_u32 s60,s62,331776
s_add_u32 m0,s63,0
s_nop 0
buffer_load_dwordx4 v4,s[76:79],s60 offen lds
s_add_u32 s60,s62,352512
s_add_u32 m0,s63,1024
s_nop 0
buffer_load_dwordx4 v4,s[76:79],s60 offen lds
s_add_u32 s60,s62,373248
s_add_u32 m0,s63,2048
s_nop 0
buffer_load_dwordx4 v4,s[76:79],s60 offen lds
s_add_u32 s60,s62,393984
s_add_u32 m0,s63,3072
s_nop 0
buffer_load_dwordx4 v4,s[76:79],s60 offen lds
s_waitcnt vmcnt(12)
ds_read_b64_tr_b16 a[8:9],v3 offset:4096
ds_read_b64_tr_b16 a[10:11],v3 offset:4352
ds_read_b64_tr_b16 a[12:13],v3 offset:6144
ds_read_b64_tr_b16 a[14:15],v3 offset:6400
ds_read_b64_tr_b16 a[80:81],v3 offset:4128
ds_read_b64_tr_b16 a[82:83],v3 offset:4384
ds_read_b64_tr_b16 a[84:85],v3 offset:6176
ds_read_b64_tr_b16 a[86:87],v3 offset:6432
s_waitcnt lgkmcnt(0)
s_add_u32 s60,s62,414720
s_add_u32 m0,s63,4096
s_nop 0
buffer_load_dwordx4 v4,s[76:79],s60 offen lds
s_add_u32 s60,s62,435456
s_add_u32 m0,s63,5120
s_nop 0
buffer_load_dwordx4 v4,s[76:79],s60 offen lds
s_add_u32 s60,s62,456192
s_add_u32 m0,s63,6144
s_nop 0
buffer_load_dwordx4 v4,s[76:79],s60 offen lds
s_add_u32 s60,s62,476928
s_add_u32 m0,s63,7168
s_nop 0
buffer_load_dwordx4 v4,s[76:79],s60 offen lds
s_waitcnt vmcnt(12)
ds_read_b64_tr_b16 a[16:17],v3 offset:8192
ds_read_b64_tr_b16 a[18:19],v3 offset:8448
ds_read_b64_tr_b16 a[20:21],v3 offset:10240
ds_read_b64_tr_b16 a[22:23],v3 offset:10496
ds_read_b64_tr_b16 a[88:89],v3 offset:8224
ds_read_b64_tr_b16 a[90:91],v3 offset:8480
ds_read_b64_tr_b16 a[92:93],v3 offset:10272
ds_read_b64_tr_b16 a[94:95],v3 offset:10528
s_waitcnt lgkmcnt(0)
s_add_u32 s60,s62,497664
s_add_u32 m0,s63,8192
s_nop 0
buffer_load_dwordx4 v4,s[76:79],s60 offen lds
s_add_u32 s60,s62,518400
s_add_u32 m0,s63,9216
s_nop 0
buffer_load_dwordx4 v4,s[76:79],s60 offen lds
s_add_u32 s60,s62,539136
s_add_u32 m0,s63,10240
s_nop 0
buffer_load_dwordx4 v4,s[76:79],s60 offen lds
s_add_u32 s60,s62,559872
s_add_u32 m0,s63,11264
s_nop 0
buffer_load_dwordx4 v4,s[76:79],s60 offen lds
s_waitcnt vmcnt(12)
ds_read_b64_tr_b16 a[24:25],v3 offset:12288
ds_read_b64_tr_b16 a[26:27],v3 offset:12544
ds_read_b64_tr_b16 a[28:29],v3 offset:14336
ds_read_b64_tr_b16 a[30:31],v3 offset:14592
ds_read_b64_tr_b16 a[96:97],v3 offset:12320
ds_read_b64_tr_b16 a[98:99],v3 offset:12576
ds_read_b64_tr_b16 a[100:101],v3 offset:14368
ds_read_b64_tr_b16 a[102:103],v3 offset:14624
s_waitcnt lgkmcnt(0)
s_add_u32 s60,s62,580608
s_add_u32 m0,s63,12288
s_nop 0
buffer_load_dwordx4 v4,s[76:79],s60 offen lds
s_add_u32 s60,s62,601344
s_add_u32 m0,s63,13312
s_nop 0
buffer_load_dwordx4 v4,s[76:79],s60 offen lds
s_add_u32 s60,s62,622080
s_add_u32 m0,s63,14336
s_nop 0
buffer_load_dwordx4 v4,s[76:79],s60 offen lds
s_add_u32 s60,s62,642816
s_add_u32 m0,s63,15360
s_nop 0
buffer_load_dwordx4 v4,s[76:79],s60 offen lds
s_waitcnt vmcnt(12)
ds_read_b64_tr_b16 a[32:33],v3
ds_read_b64_tr_b16 a[34:35],v3 offset:256
ds_read_b64_tr_b16 a[36:37],v3 offset:2048
ds_read_b64_tr_b16 a[38:39],v3 offset:2304
ds_read_b64_tr_b16 a[104:105],v3 offset:32
ds_read_b64_tr_b16 a[106:107],v3 offset:288
ds_read_b64_tr_b16 a[108:109],v3 offset:2080
ds_read_b64_tr_b16 a[110:111],v3 offset:2336
s_waitcnt lgkmcnt(0)
s_add_u32 s60,s62,64
s_add_u32 m0,s63,0
s_nop 0
buffer_load_dwordx4 v5,s[76:79],s60 offen lds
s_add_u32 s60,s62,20800
s_add_u32 m0,s63,1024
s_nop 0
buffer_load_dwordx4 v5,s[76:79],s60 offen lds
s_add_u32 s60,s62,41536
s_add_u32 m0,s63,2048
s_nop 0
buffer_load_dwordx4 v5,s[76:79],s60 offen lds
s_add_u32 s60,s62,62272
s_add_u32 m0,s63,3072
s_nop 0
buffer_load_dwordx4 v5,s[76:79],s60 offen lds
s_waitcnt vmcnt(12)
ds_read_b64_tr_b16 a[40:41],v3 offset:4096
ds_read_b64_tr_b16 a[42:43],v3 offset:4352
ds_read_b64_tr_b16 a[44:45],v3 offset:6144
ds_read_b64_tr_b16 a[46:47],v3 offset:6400
ds_read_b64_tr_b16 a[112:113],v3 offset:4128
ds_read_b64_tr_b16 a[114:115],v3 offset:4384
ds_read_b64_tr_b16 a[116:117],v3 offset:6176
ds_read_b64_tr_b16 a[118:119],v3 offset:6432
s_waitcnt lgkmcnt(0)
s_add_u32 s60,s62,165952
s_add_u32 m0,s63,4096
s_nop 0
buffer_load_dwordx4 v5,s[76:79],s60 offen lds
s_add_u32 s60,s62,186688
s_add_u32 m0,s63,5120
s_nop 0
buffer_load_dwordx4 v5,s[76:79],s60 offen lds
s_add_u32 s60,s62,207424
s_add_u32 m0,s63,6144
s_nop 0
buffer_load_dwordx4 v5,s[76:79],s60 offen lds
s_add_u32 s60,s62,228160
s_add_u32 m0,s63,7168
s_nop 0
buffer_load_dwordx4 v5,s[76:79],s60 offen lds
s_waitcnt vmcnt(12)
ds_read_b64_tr_b16 a[48:49],v3 offset:8192
ds_read_b64_tr_b16 a[50:51],v3 offset:8448
ds_read_b64_tr_b16 a[52:53],v3 offset:10240
ds_read_b64_tr_b16 a[54:55],v3 offset:10496
ds_read_b64_tr_b16 a[120:121],v3 offset:8224
ds_read_b64_tr_b16 a[122:123],v3 offset:8480
ds_read_b64_tr_b16 a[124:125],v3 offset:10272
ds_read_b64_tr_b16 a[126:127],v3 offset:10528
s_waitcnt lgkmcnt(0)
s_add_u32 s60,s62,331840
s_add_u32 m0,s63,8192
s_nop 0
buffer_load_dwordx4 v5,s[76:79],s60 offen lds
s_add_u32 s60,s62,352576
s_add_u32 m0,s63,9216
s_nop 0
buffer_load_dwordx4 v5,s[76:79],s60 offen lds
s_add_u32 s60,s62,373312
s_add_u32 m0,s63,10240
s_nop 0
buffer_load_dwordx4 v5,s[76:79],s60 offen lds
s_add_u32 s60,s62,394048
s_add_u32 m0,s63,11264
s_nop 0
buffer_load_dwordx4 v5,s[76:79],s60 offen lds
s_waitcnt vmcnt(12)
ds_read_b64_tr_b16 a[56:57],v3 offset:12288
ds_read_b64_tr_b16 a[58:59],v3 offset:12544
ds_read_b64_tr_b16 a[60:61],v3 offset:14336
ds_read_b64_tr_b16 a[62:63],v3 offset:14592
ds_read_b64_tr_b16 a[128:129],v3 offset:12320
ds_read_b64_tr_b16 a[130:131],v3 offset:12576
ds_read_b64_tr_b16 a[132:133],v3 offset:14368
ds_read_b64_tr_b16 a[134:135],v3 offset:14624
s_waitcnt lgkmcnt(0)
s_add_u32 s60,s62,497728
s_add_u32 m0,s63,12288
s_nop 0
buffer_load_dwordx4 v5,s[76:79],s60 offen lds
s_add_u32 s60,s62,518464
s_add_u32 m0,s63,13312
s_nop 0
buffer_load_dwordx4 v5,s[76:79],s60 offen lds
s_add_u32 s60,s62,539200
s_add_u32 m0,s63,14336
s_nop 0
buffer_load_dwordx4 v5,s[76:79],s60 offen lds
s_add_u32 s60,s62,559936
s_add_u32 m0,s63,15360
s_nop 0
buffer_load_dwordx4 v5,s[76:79],s60 offen lds
s_waitcnt vmcnt(12)
ds_read_b64_tr_b16 a[144:145],v3
ds_read_b64_tr_b16 a[146:147],v3 offset:256
ds_read_b64_tr_b16 a[148:149],v3 offset:2048
ds_read_b64_tr_b16 a[150:151],v3 offset:2304
ds_read_b64_tr_b16 a[152:153],v3 offset:32
ds_read_b64_tr_b16 a[154:155],v3 offset:288
ds_read_b64_tr_b16 a[156:157],v3 offset:2080
ds_read_b64_tr_b16 a[158:159],v3 offset:2336
s_waitcnt lgkmcnt(0)
s_add_u32 s60,s62,18432
s_add_u32 m0,s63,0
s_nop 0
buffer_load_dwordx4 v6,s[76:79],s60 offen lds
s_add_u32 s60,s62,184320
s_add_u32 m0,s63,1024
s_nop 0
buffer_load_dwordx4 v6,s[76:79],s60 offen lds
s_add_u32 s60,s62,350208
s_add_u32 m0,s63,2048
s_nop 0
buffer_load_dwordx4 v6,s[76:79],s60 offen lds
s_add_u32 s60,s62,516096
s_add_u32 m0,s63,3072
s_nop 0
buffer_load_dwordx4 v6,s[76:79],s60 offen lds
s_waitcnt vmcnt(12)
ds_read_b64_tr_b16 a[160:161],v3 offset:4096
ds_read_b64_tr_b16 a[162:163],v3 offset:4352
ds_read_b64_tr_b16 a[164:165],v3 offset:6144
ds_read_b64_tr_b16 a[166:167],v3 offset:6400
ds_read_b64_tr_b16 a[168:169],v3 offset:4128
ds_read_b64_tr_b16 a[170:171],v3 offset:4384
ds_read_b64_tr_b16 a[172:173],v3 offset:6176
ds_read_b64_tr_b16 a[174:175],v3 offset:6432
s_waitcnt lgkmcnt(0)
s_add_u32 s60,s62,18496
s_add_u32 m0,s63,4096
s_nop 0
buffer_load_dwordx4 v6,s[76:79],s60 offen lds
s_add_u32 s60,s62,184384
s_add_u32 m0,s63,5120
s_nop 0
buffer_load_dwordx4 v6,s[76:79],s60 offen lds
s_add_u32 s60,s62,350272
s_add_u32 m0,s63,6144
s_nop 0
buffer_load_dwordx4 v6,s[76:79],s60 offen lds
s_add_u32 s60,s62,516160
s_add_u32 m0,s63,7168
s_nop 0
buffer_load_dwordx4 v6,s[76:79],s60 offen lds
s_waitcnt vmcnt(12)
ds_read_b64_tr_b16 a[176:177],v3 offset:8192
ds_read_b64_tr_b16 a[178:179],v3 offset:8448
ds_read_b64_tr_b16 a[180:181],v3 offset:10240
ds_read_b64_tr_b16 a[182:183],v3 offset:10496
ds_read_b64_tr_b16 a[184:185],v3 offset:8224
ds_read_b64_tr_b16 a[186:187],v3 offset:8480
ds_read_b64_tr_b16 a[188:189],v3 offset:10272
ds_read_b64_tr_b16 a[190:191],v3 offset:10528
s_waitcnt vmcnt(8)
ds_read_b64_tr_b16 a[192:193],v3 offset:12288
ds_read_b64_tr_b16 a[194:195],v3 offset:12544
ds_read_b64_tr_b16 a[196:197],v3 offset:14336
ds_read_b64_tr_b16 a[198:199],v3 offset:14592
ds_read_b64_tr_b16 a[200:201],v3 offset:12320
ds_read_b64_tr_b16 a[202:203],v3 offset:12576
ds_read_b64_tr_b16 a[204:205],v3 offset:14368
ds_read_b64_tr_b16 a[206:207],v3 offset:14624
s_waitcnt vmcnt(4)
ds_read_b64_tr_b16 a[64:65],v3
ds_read_b64_tr_b16 a[66:67],v3 offset:256
ds_read_b64_tr_b16 a[68:69],v3 offset:2048
ds_read_b64_tr_b16 a[70:71],v3 offset:2304
ds_read_b64_tr_b16 a[136:137],v3 offset:32
ds_read_b64_tr_b16 a[138:139],v3 offset:288
ds_read_b64_tr_b16 a[140:141],v3 offset:2080
ds_read_b64_tr_b16 a[142:143],v3 offset:2336
s_waitcnt vmcnt(0)
ds_read_b64_tr_b16 a[208:209],v3 offset:4096
ds_read_b64_tr_b16 a[210:211],v3 offset:4352
ds_read_b64_tr_b16 a[212:213],v3 offset:6144
ds_read_b64_tr_b16 a[214:215],v3 offset:6400
s_waitcnt lgkmcnt(0)
w_bw0:
s_add_u32 s12,s8,9437184
s_addc_u32 s13,s9,0
s_mov_b32 s14,2359296
s_mov_b32 s15,0x20000
v_lshlrev_b32 v1,4,v0
v_and_b32 v10,15,v0
v_lshrrev_b32 v11,4,v0
v_mul_u32_u24 v12,1152,v10
v_lshl_add_u32 v2,v11,3,v12
v_lshlrev_b32 v12,2,v10
v_lshl_add_u32 v8,v11,15,v12
v_lshlrev_b32 v12,5,v10
v_and_b32 v13,1,v11
v_lshl_add_u32 v12,v13,4,v12
v_lshrrev_b32 v13,1,v11
v_lshl_add_u32 v7,v13,16,v12
v_mul_u32_u24 v12,400,v10
v_lshl_add_u32 v12,v11,3,v12
s_mul_i32 s60,s21,96
v_add_u32 v3,s60,v12
v_lshrrev_b32 v10,3,v0
v_and_b32 v11,7,v0
v_lshlrev_b32 v11,4,v11
v_mul_u32_u24 v12,1152,v10
v_add_u32_e64 v5,v11,v12
v_mul_u32_u24 v12,400,v10
s_mul_i32 s60,s21,3200
v_add3_u32 v4,v11,v12,s60
s_add_u32 s80,s6,39321600
s_addc_u32 s81,s7,0
s_mov_b32 s82,2359296
s_mov_b32 s83,0x20000
s_cmp_eq_u32 s23,0
s_cbranch_scc1 w_bw1
s_mov_b32 s80,s96
s_mov_b32 s81,s97
s_mov_b32 s82,2359296
s_mov_b32 s83,0x20000
w_bw1:
s_mov_b32 s10,39845888
s_lshl_b32 s63,s26,12
s_add_u32 s63,s63,21233664
s_lshl_b32 s63,s26,2
s_add_u32 s63,s63,6307840
s_cmp_lg_u32 s21,0
s_cbranch_scc1 wfo_67
v_min_u32 v10,0,v0
v_lshlrev_b32_e64 v10,2,v10
s_branch wf_66_0f
wf_66_0:
s_sleep 8
wf_66_0f:
buffer_load_dword v11,v10,s[8:11],s63 offen sc1
s_add_u32 s38,s38,1
s_cmp_gt_u32 s38,3000000
s_cbranch_scc1 w_fail
s_waitcnt vmcnt(0)
v_cmp_gt_u32 vcc,1,v11
s_cbranch_vccnz wf_66_0
wfo_67:
s_barrier
w_bw2:
s_mul_i32 s28,s26,36864
s_lshl_b32 s60,s25,2
s_add_u32 s60,s60,s21
s_mul_i32 s60,s60,96
s_add_u32 s28,s28,s60
s_add_u32 s61,s28,18432
buffer_load_dwordx2 v[68:69],v2,s[12:15],s28 offen sc1
buffer_load_dwordx2 v[70:71],v2,s[12:15],s28 offen offset:32 sc1
buffer_load_dwordx2 v[72:73],v2,s[12:15],s28 offen offset:64 sc1
buffer_load_dwordx2 v[74:75],v2,s[12:15],s61 offen sc1
buffer_load_dwordx2 v[76:77],v2,s[12:15],s61 offen offset:32 sc1
buffer_load_dwordx2 v[78:79],v2,s[12:15],s61 offen offset:64 sc1
s_lshl_b32 s29,s23,6
s_add_u32 s29,s29,s26
s_cmp_ge_u32 s29,9
s_cbranch_scc1 w_bwp
s_mul_i32 s60,s21,9120
s_add_u32 s60,s60,s28
s_add_u32 s60,s60,0
v_mov_b32 v12,-1
v_mov_b32 v13,-1
v_mov_b32 v14,-1
v_mov_b32_e64 v15,-1
buffer_store_dwordx4 v[12:15],v5,s[80:83],s60 offen sc1
buffer_store_dwordx4 v[12:15],v5,s[80:83],s60 offen offset:128 sc1
buffer_store_dwordx4 v[12:15],v5,s[80:83],s60 offen offset:256 sc1
s_waitcnt vmcnt(0)
w_bwp:
w_bwr:
s_lshl_b32 s63,s26,12
s_add_u32 s63,s63,21495808
s_cmp_lg_u32 s21,0
s_cbranch_scc1 wfo_69
v_min_u32 v10,31,v0
v_lshlrev_b32_e64 v10,7,v10
s_branch wf_68_0f
wf_68_0:
s_sleep 1
wf_68_0f:
buffer_load_dword v11,v10,s[8:11],s63 offen sc1
s_add_u32 s38,s38,1
s_cmp_gt_u32 s38,3000000
s_cbranch_scc1 w_fail
s_waitcnt vmcnt(0)
v_cmp_gt_u32 vcc,1,v11
s_cbranch_vccnz wf_68_0
wfo_69:
s_barrier
s_add_u32 s38,s38,64
s_cmp_gt_u32 s38,3000000
s_cbranch_scc1 w_fail
s_lshl_b32 s63,s26,5
s_add_u32 s63,s63,s25
s_lshl_b32 s63,s63,7
s_add_u32 s63,s63,38535168
s_lshl_b32 s61,s26,10
s_lshl_b32 s60,s21,19
s_add_u32 s61,s61,s60
s_lshl_b32 s62,s21,13
s_add_u32 s60,s61,18874368
s_add_u32 m0,s62,0
s_nop 0
buffer_load_dwordx4 v7,s[8:11],s60 offen sc1 lds
s_add_u32 s60,s61,18874880
s_add_u32 m0,s62,1024
s_nop 0
buffer_load_dwordx4 v7,s[8:11],s60 offen sc1 lds
s_add_u32 s60,s61,19005440
s_add_u32 m0,s62,2048
s_nop 0
buffer_load_dwordx4 v7,s[8:11],s60 offen sc1 lds
s_add_u32 s60,s61,19005952
s_add_u32 m0,s62,3072
s_nop 0
buffer_load_dwordx4 v7,s[8:11],s60 offen sc1 lds
s_add_u32 s60,s61,19136512
s_add_u32 m0,s62,4096
s_nop 0
buffer_load_dwordx4 v7,s[8:11],s60 offen sc1 lds
s_add_u32 s60,s61,19137024
s_add_u32 m0,s62,5120
s_nop 0
buffer_load_dwordx4 v7,s[8:11],s60 offen sc1 lds
s_add_u32 s60,s61,19267584
s_add_u32 m0,s62,6144
s_nop 0
buffer_load_dwordx4 v7,s[8:11],s60 offen sc1 lds
s_add_u32 s60,s61,19268096
s_add_u32 m0,s62,7168
s_nop 0
buffer_load_dwordx4 v7,s[8:11],s60 offen sc1 lds
s_lshl_b32 s61,s26,7
s_lshr_b32 s60,s21,1
s_lshl_b32 s60,s60,17
s_add_u32 s61,s61,s60
s_and_b32 s60,s21,1
s_lshl_b32 s60,s60,6
s_add_u32 s61,s61,s60
s_lshl_b32 s62,s21,10
s_add_u32 s60,s61,7077888
s_add_u32 m0,s62,32768
s_nop 0
buffer_load_dword v8,s[8:11],s60 offen sc1 lds
s_add_u32 s60,s61,7086080
s_add_u32 m0,s62,33024
s_nop 0
buffer_load_dword v8,s[8:11],s60 offen sc1 lds
s_add_u32 s60,s61,7094272
s_add_u32 m0,s62,33280
s_nop 0
buffer_load_dword v8,s[8:11],s60 offen sc1 lds
s_add_u32 s60,s61,7102464
s_add_u32 m0,s62,33536
s_nop 0
buffer_load_dword v8,s[8:11],s60 offen sc1 lds
v_lshrrev_b32 v10,2,v1
s_waitcnt vmcnt(0)
s_barrier
ds_read_b128 v[36:39],v1
ds_read_b128 v[40:43],v1 offset:1024
s_waitcnt lgkmcnt(0)
v_mfma_f32_16x16x32_bf16 v[12:15],a[0:3],v[36:39],0
ds_read_b128 v[44:47],v1 offset:2048
v_mfma_f32_16x16x32_bf16 v[16:19],a[0:3],v[40:43],0
ds_read_b128 v[48:51],v1 offset:3072
v_mfma_f32_16x16x32_bf16 v[20:23],a[72:75],v[36:39],0
ds_read2st64_b32 v[52:53],v10 offset0:128 offset1:129
v_mfma_f32_16x16x32_bf16 v[24:27],a[72:75],v[40:43],0
v_mfma_f32_16x16x32_bf16 v[28:31],a[144:147],v[36:39],0
v_mfma_f32_16x16x32_bf16 v[32:35],a[144:147],v[40:43],0
s_waitcnt lgkmcnt(0)
v_mfma_f32_16x16x32_bf16 v[12:15],a[4:7],v[44:47],v[12:15]
ds_read_b128 v[36:39],v1 offset:4096
v_mfma_f32_16x16x32_bf16 v[16:19],a[4:7],v[48:51],v[16:19]
ds_read_b128 v[40:43],v1 offset:5120
v_mfma_f32_16x16x32_bf16 v[20:23],a[76:79],v[44:47],v[20:23]
ds_read2st64_b32 v[54:55],v10 offset0:130 offset1:131
v_mfma_f32_16x16x32_bf16 v[24:27],a[76:79],v[48:51],v[24:27]
v_mfma_f32_16x16x32_bf16 v[28:31],a[148:151],v[44:47],v[28:31]
v_mfma_f32_16x16x32_bf16 v[32:35],a[148:151],v[48:51],v[32:35]
s_waitcnt lgkmcnt(0)
v_mfma_f32_16x16x32_bf16 v[12:15],a[8:11],v[36:39],v[12:15]
ds_read_b128 v[44:47],v1 offset:6144
v_mfma_f32_16x16x32_bf16 v[16:19],a[8:11],v[40:43],v[16:19]
ds_read_b128 v[48:51],v1 offset:7168
v_mfma_f32_16x16x32_bf16 v[20:23],a[80:83],v[36:39],v[20:23]
ds_read2st64_b32 v[56:57],v10 offset0:132 offset1:133
v_mfma_f32_16x16x32_bf16 v[24:27],a[80:83],v[40:43],v[24:27]
v_mfma_f32_16x16x32_bf16 v[28:31],a[152:155],v[36:39],v[28:31]
v_mfma_f32_16x16x32_bf16 v[32:35],a[152:155],v[40:43],v[32:35]
s_waitcnt lgkmcnt(0)
v_mfma_f32_16x16x32_bf16 v[12:15],a[12:15],v[44:47],v[12:15]
ds_read_b128 v[36:39],v1 offset:8192
v_mfma_f32_16x16x32_bf16 v[16:19],a[12:15],v[48:51],v[16:19]
ds_read_b128 v[40:43],v1 offset:9216
v_mfma_f32_16x16x32_bf16 v[20:23],a[84:87],v[44:47],v[20:23]
ds_read2st64_b32 v[58:59],v10 offset0:134 offset1:135
v_mfma_f32_16x16x32_bf16 v[24:27],a[84:87],v[48:51],v[24:27]
v_mfma_f32_16x16x32_bf16 v[28:31],a[156:159],v[44:47],v[28:31]
v_mfma_f32_16x16x32_bf16 v[32:35],a[156:159],v[48:51],v[32:35]
s_waitcnt lgkmcnt(0)
v_mfma_f32_16x16x32_bf16 v[12:15],a[16:19],v[36:39],v[12:15]
ds_read_b128 v[44:47],v1 offset:10240
v_mfma_f32_16x16x32_bf16 v[16:19],a[16:19],v[40:43],v[16:19]
ds_read_b128 v[48:51],v1 offset:11264
v_mfma_f32_16x16x32_bf16 v[20:23],a[88:91],v[36:39],v[20:23]
ds_read2st64_b32 v[60:61],v10 offset0:136 offset1:137
v_mfma_f32_16x16x32_bf16 v[24:27],a[88:91],v[40:43],v[24:27]
v_mfma_f32_16x16x32_bf16 v[28:31],a[160:163],v[36:39],v[28:31]
v_mfma_f32_16x16x32_bf16 v[32:35],a[160:163],v[40:43],v[32:35]
s_waitcnt lgkmcnt(0)
v_mfma_f32_16x16x32_bf16 v[12:15],a[20:23],v[44:47],v[12:15]
ds_read_b128 v[36:39],v1 offset:12288
v_mfma_f32_16x16x32_bf16 v[16:19],a[20:23],v[48:51],v[16:19]
ds_read_b128 v[40:43],v1 offset:13312
v_mfma_f32_16x16x32_bf16 v[20:23],a[92:95],v[44:47],v[20:23]
ds_read2st64_b32 v[62:63],v10 offset0:138 offset1:139
v_mfma_f32_16x16x32_bf16 v[24:27],a[92:95],v[48:51],v[24:27]
v_mfma_f32_16x16x32_bf16 v[28:31],a[164:167],v[44:47],v[28:31]
v_mfma_f32_16x16x32_bf16 v[32:35],a[164:167],v[48:51],v[32:35]
s_waitcnt lgkmcnt(0)
v_mfma_f32_16x16x32_bf16 v[12:15],a[24:27],v[36:39],v[12:15]
ds_read_b128 v[44:47],v1 offset:14336
v_mfma_f32_16x16x32_bf16 v[16:19],a[24:27],v[40:43],v[16:19]
ds_read_b128 v[48:51],v1 offset:15360
v_mfma_f32_16x16x32_bf16 v[20:23],a[96:99],v[36:39],v[20:23]
ds_read2st64_b32 v[64:65],v10 offset0:140 offset1:141
v_mfma_f32_16x16x32_bf16 v[24:27],a[96:99],v[40:43],v[24:27]
v_mfma_f32_16x16x32_bf16 v[28:31],a[168:171],v[36:39],v[28:31]
v_mfma_f32_16x16x32_bf16 v[32:35],a[168:171],v[40:43],v[32:35]
s_waitcnt lgkmcnt(0)
v_mfma_f32_16x16x32_bf16 v[12:15],a[28:31],v[44:47],v[12:15]
ds_read_b128 v[36:39],v1 offset:16384
v_mfma_f32_16x16x32_bf16 v[16:19],a[28:31],v[48:51],v[16:19]
ds_read_b128 v[40:43],v1 offset:17408
v_mfma_f32_16x16x32_bf16 v[20:23],a[100:103],v[44:47],v[20:23]
ds_read2st64_b32 v[66:67],v10 offset0:142 offset1:143
v_mfma_f32_16x16x32_bf16 v[24:27],a[100:103],v[48:51],v[24:27]
v_mfma_f32_16x16x32_bf16 v[28:31],a[172:175],v[44:47],v[28:31]
v_mfma_f32_16x16x32_bf16 v[32:35],a[172:175],v[48:51],v[32:35]
s_waitcnt lgkmcnt(0)
v_mfma_f32_16x16x32_bf16 v[12:15],a[32:35],v[36:39],v[12:15]
ds_read_b128 v[44:47],v1 offset:18432
v_mfma_f32_16x16x32_bf16 v[16:19],a[32:35],v[40:43],v[16:19]
ds_read_b128 v[48:51],v1 offset:19456
v_mfma_f32_16x16x32_bf16 v[20:23],a[104:107],v[36:39],v[20:23]
v_mfma_f32_16x16x32_bf16 v[24:27],a[104:107],v[40:43],v[24:27]
v_mfma_f32_16x16x32_bf16 v[28:31],a[176:179],v[36:39],v[28:31]
v_mfma_f32_16x16x32_bf16 v[32:35],a[176:179],v[40:43],v[32:35]
s_waitcnt lgkmcnt(0)
v_mfma_f32_16x16x32_bf16 v[12:15],a[36:39],v[44:47],v[12:15]
ds_read_b128 v[36:39],v1 offset:20480
v_mfma_f32_16x16x32_bf16 v[16:19],a[36:39],v[48:51],v[16:19]
ds_read_b128 v[40:43],v1 offset:21504
v_mfma_f32_16x16x32_bf16 v[20:23],a[108:111],v[44:47],v[20:23]
v_mfma_f32_16x16x32_bf16 v[24:27],a[108:111],v[48:51],v[24:27]
v_mfma_f32_16x16x32_bf16 v[28:31],a[180:183],v[44:47],v[28:31]
v_mfma_f32_16x16x32_bf16 v[32:35],a[180:183],v[48:51],v[32:35]
s_waitcnt lgkmcnt(0)
v_mfma_f32_16x16x32_bf16 v[12:15],a[40:43],v[36:39],v[12:15]
ds_read_b128 v[44:47],v1 offset:22528
v_mfma_f32_16x16x32_bf16 v[16:19],a[40:43],v[40:43],v[16:19]
ds_read_b128 v[48:51],v1 offset:23552
v_mfma_f32_16x16x32_bf16 v[20:23],a[112:115],v[36:39],v[20:23]
v_mfma_f32_16x16x32_bf16 v[24:27],a[112:115],v[40:43],v[24:27]
v_mfma_f32_16x16x32_bf16 v[28:31],a[184:187],v[36:39],v[28:31]
v_mfma_f32_16x16x32_bf16 v[32:35],a[184:187],v[40:43],v[32:35]
s_waitcnt lgkmcnt(0)
v_mfma_f32_16x16x32_bf16 v[12:15],a[44:47],v[44:47],v[12:15]
ds_read_b128 v[36:39],v1 offset:24576
v_mfma_f32_16x16x32_bf16 v[16:19],a[44:47],v[48:51],v[16:19]
ds_read_b128 v[40:43],v1 offset:25600
v_mfma_f32_16x16x32_bf16 v[20:23],a[116:119],v[44:47],v[20:23]
v_mfma_f32_16x16x32_bf16 v[24:27],a[116:119],v[48:51],v[24:27]
v_mfma_f32_16x16x32_bf16 v[28:31],a[188:191],v[44:47],v[28:31]
v_mfma_f32_16x16x32_bf16 v[32:35],a[188:191],v[48:51],v[32:35]
s_waitcnt lgkmcnt(0)
v_mfma_f32_16x16x32_bf16 v[12:15],a[48:51],v[36:39],v[12:15]
ds_read_b128 v[44:47],v1 offset:26624
v_mfma_f32_16x16x32_bf16 v[16:19],a[48:51],v[40:43],v[16:19]
ds_read_b128 v[48:51],v1 offset:27648
v_mfma_f32_16x16x32_bf16 v[20:23],a[120:123],v[36:39],v[20:23]
v_mfma_f32_16x16x32_bf16 v[24:27],a[120:123],v[40:43],v[24:27]
v_mfma_f32_16x16x32_bf16 v[28:31],a[192:195],v[36:39],v[28:31]
v_mfma_f32_16x16x32_bf16 v[32:35],a[192:195],v[40:43],v[32:35]
s_waitcnt lgkmcnt(0)
v_mfma_f32_16x16x32_bf16 v[12:15],a[52:55],v[44:47],v[12:15]
ds_read_b128 v[36:39],v1 offset:28672
v_mfma_f32_16x16x32_bf16 v[16:19],a[52:55],v[48:51],v[16:19]
ds_read_b128 v[40:43],v1 offset:29696
v_mfma_f32_16x16x32_bf16 v[20:23],a[124:127],v[44:47],v[20:23]
v_mfma_f32_16x16x32_bf16 v[24:27],a[124:127],v[48:51],v[24:27]
v_mfma_f32_16x16x32_bf16 v[28:31],a[196:199],v[44:47],v[28:31]
v_mfma_f32_16x16x32_bf16 v[32:35],a[196:199],v[48:51],v[32:35]
s_waitcnt lgkmcnt(0)
v_mfma_f32_16x16x32_bf16 v[12:15],a[56:59],v[36:39],v[12:15]
ds_read_b128 v[44:47],v1 offset:30720
v_mfma_f32_16x16x32_bf16 v[16:19],a[56:59],v[40:43],v[16:19]
ds_read_b128 v[48:51],v1 offset:31744
v_mfma_f32_16x16x32_bf16 v[20:23],a[128:131],v[36:39],v[20:23]
v_mfma_f32_16x16x32_bf16 v[24:27],a[128:131],v[40:43],v[24:27]
v_mfma_f32_16x16x32_bf16 v[28:31],a[200:203],v[36:39],v[28:31]
v_mfma_f32_16x16x32_bf16 v[32:35],a[200:203],v[40:43],v[32:35]
s_waitcnt lgkmcnt(0)
v_mfma_f32_16x16x32_bf16 v[12:15],a[60:63],v[44:47],v[12:15]
v_mfma_f32_16x16x32_bf16 v[16:19],a[60:63],v[48:51],v[16:19]
v_mfma_f32_16x16x32_bf16 v[20:23],a[132:135],v[44:47],v[20:23]
v_mfma_f32_16x16x32_bf16 v[24:27],a[132:135],v[48:51],v[24:27]
v_mfma_f32_16x16x32_bf16 v[28:31],a[204:207],v[44:47],v[28:31]
v_mfma_f32_16x16x32_bf16 v[32:35],a[204:207],v[48:51],v[32:35]
v_mfma_f32_16x16x32_bf16 v[12:15],a[64:67],v[52:55],v[12:15]
v_mfma_f32_16x16x32_bf16 v[16:19],a[64:67],v[56:59],v[16:19]
v_mfma_f32_16x16x32_bf16 v[20:23],a[136:139],v[52:55],v[20:23]
v_mfma_f32_16x16x32_bf16 v[24:27],a[136:139],v[56:59],v[24:27]
v_mfma_f32_16x16x32_bf16 v[28:31],a[208:211],v[52:55],v[28:31]
v_mfma_f32_16x16x32_bf16 v[32:35],a[208:211],v[56:59],v[32:35]
s_cmp_lt_u32 s29,9
s_cselect_b32 s18,s63,0x40000000
s_cmp_eq_u32 s21,0
s_cselect_b32 s18,s18,0x40000000
v_mov_b32 v9,0
v_mov_b32 v11,1
s_mov_b64 exec,1
buffer_store_dword v11,v9,s[8:11],s18 offen sc1
s_mov_b64 exec,-1
v_mfma_f32_16x16x32_bf16 v[12:15],a[68:71],v[60:63],v[12:15]
v_mfma_f32_16x16x32_bf16 v[16:19],a[68:71],v[64:67],v[16:19]
v_mfma_f32_16x16x32_bf16 v[20:23],a[140:143],v[60:63],v[20:23]
v_mfma_f32_16x16x32_bf16 v[24:27],a[140:143],v[64:67],v[24:27]
v_mfma_f32_16x16x32_bf16 v[28:31],a[212:215],v[60:63],v[28:31]
v_mfma_f32_16x16x32_bf16 v[32:35],a[212:215],v[64:67],v[32:35]
v_cmp_u_f32 vcc,v12,v16
s_cbranch_vccnz w_bwr
v_lshlrev_b32_e64 v36,16,v68
v_and_b32 v37,0xffff0000,v68
v_add_f32 v36,v36,v12
v_add_f32 v37,v37,v13
v_cvt_pk_bf16_f32 v12,v36,v37
v_lshlrev_b32_e64 v36,16,v69
v_and_b32 v37,0xffff0000,v69
v_add_f32 v36,v36,v14
v_add_f32 v37,v37,v15
v_cvt_pk_bf16_f32 v13,v36,v37
ds_write_b64 v3,v[12:13] offset:40960
v_lshlrev_b32 v36,16,v74
v_and_b32 v37,0xffff0000,v74
v_add_f32 v36,v36,v16
v_add_f32 v37,v37,v17
v_cvt_pk_bf16_f32 v16,v36,v37
v_lshlrev_b32 v36,16,v75
v_and_b32 v37,0xffff0000,v75
v_add_f32 v36,v36,v18
v_add_f32 v37,v37,v19
v_cvt_pk_bf16_f32 v17,v36,v37
ds_write_b64 v3,v[16:17] offset:47360
v_lshlrev_b32 v36,16,v70
v_and_b32 v37,0xffff0000,v70
v_add_f32 v36,v36,v20
v_add_f32 v37,v37,v21
v_cvt_pk_bf16_f32 v20,v36,v37
v_lshlrev_b32 v36,16,v71
v_and_b32 v37,0xffff0000,v71
v_add_f32 v36,v36,v22
v_add_f32 v37,v37,v23
v_cvt_pk_bf16_f32 v21,v36,v37
ds_write_b64 v3,v[20:21] offset:40992
v_lshlrev_b32 v36,16,v76
v_and_b32 v37,0xffff0000,v76
v_add_f32 v36,v36,v24
v_add_f32 v37,v37,v25
v_cvt_pk_bf16_f32 v24,v36,v37
v_lshlrev_b32 v36,16,v77
v_and_b32 v37,0xffff0000,v77
v_add_f32 v36,v36,v26
v_add_f32 v37,v37,v27
v_cvt_pk_bf16_f32 v25,v36,v37
ds_write_b64 v3,v[24:25] offset:47392
v_lshlrev_b32 v36,16,v72
v_and_b32 v37,0xffff0000,v72
v_add_f32 v36,v36,v28
v_add_f32 v37,v37,v29
v_cvt_pk_bf16_f32 v28,v36,v37
v_lshlrev_b32 v36,16,v73
v_and_b32 v37,0xffff0000,v73
v_add_f32 v36,v36,v30
v_add_f32 v37,v37,v31
v_cvt_pk_bf16_f32 v29,v36,v37
ds_write_b64 v3,v[28:29] offset:41024
v_lshlrev_b32 v36,16,v78
v_and_b32 v37,0xffff0000,v78
v_add_f32 v36,v36,v32
v_add_f32 v37,v37,v33
v_cvt_pk_bf16_f32 v32,v36,v37
v_lshlrev_b32 v36,16,v79
v_and_b32 v37,0xffff0000,v79
v_add_f32 v36,v36,v34
v_add_f32 v37,v37,v35
v_cvt_pk_bf16_f32 v33,v36,v37
ds_write_b64 v3,v[32:33] offset:47424
s_mul_i32 s60,s21,9120
s_add_u32 s60,s60,s28
s_add_u32 s60,s60,0
s_waitcnt lgkmcnt(0)
s_barrier
ds_read_b128 v[12:15],v4 offset:40960
ds_read_b128 v[16:19],v4 offset:41088
ds_read_b128 v[20:23],v4 offset:41216
s_waitcnt lgkmcnt(2)
buffer_store_dwordx4 v[12:15],v5,s[80:83],s60 offen sc1
s_waitcnt lgkmcnt(1)
buffer_store_dwordx4 v[16:19],v5,s[80:83],s60 offen offset:128 sc1
s_waitcnt lgkmcnt(0)
buffer_store_dwordx4 v[20:23],v5,s[80:83],s60 offen offset:256 sc1
s_cmp_eq_u32 s23,0
s_cbranch_scc0 w_bw5
s_waitcnt vmcnt(0)
s_barrier
s_cmp_lg_u32 s21,0
s_cbranch_scc1 sg_70
v_mov_b32 v10,0
v_mov_b32 v11,1
s_mov_b64 exec,1
buffer_store_dword v11,v10,s[8:11],s63 offen sc1
s_mov_b64 exec,-1
sg_70:
s_cmp_ge_u32 s26,9
s_cbranch_scc1 w_bw4
w_bw4:
s_add_u32 s26,s26,9
s_cmp_lt_u32 s26,64
s_cbranch_scc1 w_bw2
w_bw5:
w_bw6:
s_add_u32 s12,s6,39321600
s_addc_u32 s13,s7,0
s_mov_b32 s14,2359296
s_mov_b32 s15,0x20000
s_add_u32 s23,s23,1
s_cmp_lt_u32 s23,2
s_cbranch_scc1 bq_layer
s_branch w_fail
w_fail:
s_waitcnt vmcnt(0) lgkmcnt(0)
s_endpgm
chain:
s_mov_b32 s12,s66
s_mov_b32 s13,s67
s_mov_b32 s14,9216
s_mov_b32 s15,0x20000
s_mov_b32 s76,s68
s_mov_b32 s77,s69
s_mov_b32 s78,4718592
s_mov_b32 s79,0x20000
s_mov_b32 s80,s70
s_mov_b32 s81,s71
s_mov_b32 s82,4718592
s_mov_b32 s83,0x20000
s_mov_b32 s84,s72
s_mov_b32 s85,s73
s_mov_b32 s86,4718592
s_mov_b32 s87,0x20000
s_mov_b32 s88,s74
s_mov_b32 s89,s75
s_mov_b32 s90,4718592
s_mov_b32 s91,0x20000
s_mov_b32 s52,0
s_mov_b32 s38,0
s_cmp_eq_u32 s21,1
s_cbranch_scc1 c_w1
s_cmp_eq_u32 s21,2
s_cbranch_scc1 c_w2
s_cmp_eq_u32 s21,3
s_cbranch_scc1 c_w3
c_w0:
v_mov_b32 v10,v0
v_and_b32 v11,15,v10
v_lshrrev_b32 v12,4,v10
v_lshlrev_b32 v13,4,v10
v_add_u32 v3,8192,v13
v_add_u32 v0,0,v13
v_lshlrev_b32 v13,3,v10
v_lshrrev_b32 v14,5,v10
v_lshlrev_b32 v14,6,v14
v_xor_b32 v1,v14,v13
v_lshlrev_b32 v13,2,v11
v_lshl_add_u32 v2,v12,11,v13
v_and_b32 v13,3,v10
v_lshrrev_b32 v14,2,v10
v_lshlrev_b32 v15,7,v13
v_lshl_add_u32 v15,v14,3,v15
v_lshrrev_b32 v16,1,v13
v_lshlrev_b32 v16,6,v16
v_xor_b32 v4,v16,v15
v_and_b32 v15,1,v10
v_lshlrev_b32_e64 v15,4,v15
v_lshl_add_u32 v9,v14,5,v15
s_mov_b32 s46,0xcccccccc
s_mov_b32 s47,0xcccccccc
s_mov_b32 s48,0x33333333
s_mov_b32 s49,0x33333333
v_mov_b32 v15,0x4444
v_mov_b32 v16,0xeeee
v_cndmask_b32 v5,v15,v16,s[46:47]
v_lshrrev_b32 v15,3,v11
v_lshl_add_u32 v15,v15,2,v12
v_lshlrev_b32 v15,11,v15
v_and_b32_e64 v17,7,v11
v_lshl_add_u32 v6,v17,3,v15
v_and_b32 v15,2,v11
v_lshrrev_b32 v16,1,v12
v_add_u32 v15,v15,v16
v_lshlrev_b32 v15,4,v15
v_and_b32 v16,1,v11
v_and_b32 v17,1,v12
v_lshl_add_u32 v16,v16,1,v17
v_lshl_add_u32 v7,v16,2,v15
v_lshrrev_b32 v15,2,v11
v_and_b32 v16,1,v15
v_lshl_add_u32 v16,v16,1,v13
v_mov_b32 v17,99
v_cmp_gt_u32 vcc,2,v13
s_nop 1
v_cndmask_b32 v16,v17,v16,vcc
v_mov_b32 v17,0x3f80
v_mov_b32 v18,0x3f800000
v_cmp_lt_u32 vcc,1,v15
s_nop 1
v_cndmask_b32 v17,v17,v18,vcc
v_cmp_eq_u32 vcc,0,v16
s_nop 1
v_cndmask_b32 v20,0,v17,vcc
v_cmp_eq_u32 vcc,1,v16
s_nop 1
v_cndmask_b32 v21,0,v17,vcc
v_cmp_eq_u32 vcc,2,v16
s_nop 1
v_cndmask_b32 v22,0,v17,vcc
v_cmp_eq_u32_e64 vcc,3,v16
s_nop 1
v_cndmask_b32 v23,0,v17,vcc
ds_write_b128 v0,v[20:23] offset:1024
v_lshrrev_b32 v17,4,v10
v_and_b32 v18,15,v10
v_lshlrev_b32 v16,1,v17
v_xor_b32 v16,v16,v18
v_lshlrev_b32_e64 v16,4,v16
v_bfe_u32 v18,v10,2,3
v_lshlrev_b32 v18,1,v18
v_bfe_u32 v245,v10,1,1
v_add_u32 v245,0,v245
v_xor_b32 v245,v245,v18
v_lshlrev_b32 v245,4,v245
v_and_b32_e64 v18,1,v10
v_lshl_add_u32 v245,v18,3,v245
v_bfe_u32 v18,v10,2,2
v_lshl_add_u32 v17,v17,3,v18
v_lshl_add_u32 v244,v17,8,v245
v_xor_b32 v245,32,v244
v_bfe_u32 v17,v10,4,1
v_lshrrev_b32 v18,5,v10
v_lshlrev_b32_e64 v19,2,v18
v_lshl_add_u32 v19,v17,4,v19
v_lshl_add_u32 v240,v19,13,v16
v_xor_b32 v241,0x80,v240
v_lshl_add_u32 v19,v18,3,v17
v_lshl_add_u32 v242,v19,13,v16
v_xor_b32 v243,0x80,v242
v_lshrrev_b32 v84,5,v10
v_and_b32 v85,31,v10
v_lshlrev_b32 v86,2,v84
v_xor_b32 v85,v85,v86
v_xor_b32 v85,0,v85
v_mul_u32_u24 v84,1152,v84
v_lshl_add_u32 v11,v85,4,v84
v_lshrrev_b32 v84,3,v10
v_mul_u32_u24 v84,1152,v84
v_and_b32_e64 v85,7,v10
v_lshl_add_u32 v12,v85,4,v84
v_bfe_u32 v84,v10,2,1
v_bfe_u32 v85,v10,4,1
v_lshl_add_u32 v86,v85,1,v84
v_xor_b32 v86,0,v86
v_lshlrev_b32 v86,6,v86
v_bfe_u32 v87,v10,3,1
v_lshl_add_u32 v86,v87,5,v86
v_and_b32 v87,3,v10
v_lshl_add_u32 v86,v87,3,v86
v_lshl_add_u32 v84,v85,4,v84
v_lshrrev_b32 v85,5,v10
v_lshl_add_u32 v84,v85,2,v84
v_lshl_add_u32 v13,v84,9,v86
v_lshrrev_b32 v84,2,v10
v_lshlrev_b32 v84,7,v84
v_lshl_add_u32 v84,v87,3,v84
v_add_u32 v14,0,v84
s_lshl_b32 s56,s24,8
s_mul_i32 s32,s24,147456
s_barrier
s_add_u32 s60,s56,0
s_mov_b32 m0,30720
s_nop 0
buffer_load_dwordx4 v240,s[80:83],s60 offen lds
s_add_u32 s60,s56,8192
s_mov_b32 m0,31744
s_nop 0
buffer_load_dwordx4 v240,s[80:83],s60 offen lds
s_add_u32 s60,s56,16384
s_mov_b32 m0,32768
s_nop 0
buffer_load_dwordx4 v241,s[80:83],s60 offen lds
s_add_u32 s60,s56,24576
s_mov_b32 m0,33792
s_nop 0
buffer_load_dwordx4 v241,s[80:83],s60 offen lds
s_add_u32 s60,s56,524288
s_mov_b32 m0,69632
s_nop 0
buffer_load_dwordx4 v240,s[80:83],s60 offen lds
s_add_u32 s60,s56,532480
s_mov_b32 m0,70656
s_nop 0
buffer_load_dwordx4 v240,s[80:83],s60 offen lds
s_add_u32 s60,s56,540672
s_mov_b32 m0,71680
s_nop 0
buffer_load_dwordx4 v241,s[80:83],s60 offen lds
s_add_u32 s60,s56,548864
s_mov_b32 m0,72704
s_nop 0
buffer_load_dwordx4 v241,s[80:83],s60 offen lds
s_add_u32 s60,s56,1048576
s_mov_b32 m0,108544
s_nop 0
buffer_load_dwordx4 v240,s[80:83],s60 offen lds
s_add_u32 s60,s56,1056768
s_mov_b32 m0,109568
s_nop 0
buffer_load_dwordx4 v240,s[80:83],s60 offen lds
s_add_u32 s60,s56,1064960
s_mov_b32 m0,110592
s_nop 0
buffer_load_dwordx4 v241,s[80:83],s60 offen lds
s_add_u32 s60,s56,1073152
s_mov_b32 m0,111616
s_nop 0
buffer_load_dwordx4 v241,s[80:83],s60 offen lds
s_waitcnt vmcnt(8) lgkmcnt(0)
s_barrier
s_add_u32 s60,s56,1572864
s_mov_b32 m0,147456
s_nop 0
buffer_load_dwordx4 v240,s[80:83],s60 offen lds
s_add_u32 s60,s56,1581056
s_mov_b32 m0,148480
s_nop 0
buffer_load_dwordx4 v240,s[80:83],s60 offen lds
s_add_u32 s60,s56,1589248
s_mov_b32 m0,149504
s_nop 0
buffer_load_dwordx4 v241,s[80:83],s60 offen lds
s_add_u32 s60,s56,1597440
s_mov_b32 m0,150528
s_nop 0
buffer_load_dwordx4 v241,s[80:83],s60 offen lds
v_add_u32 v15,30720,v244
ds_read_b64_tr_b16 a[0:1],v15
ds_read_b64_tr_b16 a[2:3],v15 offset:1024
ds_read_b64_tr_b16 a[4:5],v15 offset:8192
ds_read_b64_tr_b16 a[6:7],v15 offset:9216
v_add_u32 v246,30720,v245
ds_read_b64_tr_b16 v[80:81],v246
ds_read_b64_tr_b16 v[82:83],v246 offset:1024
ds_read_b64_tr_b16 v[84:85],v246 offset:8192
ds_read_b64_tr_b16 v[86:87],v246 offset:9216
s_waitcnt lgkmcnt(0)
ds_write_b128 v3,v[80:83] offset:2048
ds_write_b128 v3,v[84:87] offset:3072
s_waitcnt vmcnt(8) lgkmcnt(0)
s_barrier
s_add_u32 s60,s56,2097152
s_mov_b32 m0,30720
s_nop 0
buffer_load_dwordx4 v240,s[80:83],s60 offen lds
s_add_u32 s60,s56,2105344
s_mov_b32 m0,31744
s_nop 0
buffer_load_dwordx4 v240,s[80:83],s60 offen lds
s_add_u32 s60,s56,2113536
s_mov_b32 m0,32768
s_nop 0
buffer_load_dwordx4 v241,s[80:83],s60 offen lds
s_add_u32 s60,s56,2121728
s_mov_b32 m0,33792
s_nop 0
buffer_load_dwordx4 v241,s[80:83],s60 offen lds
v_add_u32 v15,69632,v244
ds_read_b64_tr_b16 a[32:33],v15
ds_read_b64_tr_b16 a[34:35],v15 offset:1024
ds_read_b64_tr_b16 a[36:37],v15 offset:8192
ds_read_b64_tr_b16 a[38:39],v15 offset:9216
v_add_u32 v246,69632,v245
ds_read_b64_tr_b16 v[80:81],v246
ds_read_b64_tr_b16 v[82:83],v246 offset:1024
ds_read_b64_tr_b16 v[84:85],v246 offset:8192
ds_read_b64_tr_b16 v[86:87],v246 offset:9216
s_waitcnt lgkmcnt(0)
ds_write_b128 v3,v[80:83] offset:6144
ds_write_b128 v3,v[84:87] offset:7168
s_waitcnt vmcnt(8) lgkmcnt(0)
s_barrier
s_add_u32 s60,s56,2621440
s_mov_b32 m0,69632
s_nop 0
buffer_load_dwordx4 v240,s[80:83],s60 offen lds
s_add_u32 s60,s56,2629632
s_mov_b32 m0,70656
s_nop 0
buffer_load_dwordx4 v240,s[80:83],s60 offen lds
s_add_u32 s60,s56,2637824
s_mov_b32 m0,71680
s_nop 0
buffer_load_dwordx4 v241,s[80:83],s60 offen lds
s_add_u32 s60,s56,2646016
s_mov_b32 m0,72704
s_nop 0
buffer_load_dwordx4 v241,s[80:83],s60 offen lds
v_add_u32 v15,108544,v244
ds_read_b64_tr_b16 a[64:65],v15
ds_read_b64_tr_b16 a[66:67],v15 offset:1024
ds_read_b64_tr_b16 a[68:69],v15 offset:8192
ds_read_b64_tr_b16 a[70:71],v15 offset:9216
v_add_u32 v246,108544,v245
ds_read_b64_tr_b16 v[80:81],v246
ds_read_b64_tr_b16 v[82:83],v246 offset:1024
ds_read_b64_tr_b16 v[84:85],v246 offset:8192
ds_read_b64_tr_b16 v[86:87],v246 offset:9216
s_waitcnt lgkmcnt(0)
ds_write_b128 v3,v[80:83] offset:10240
ds_write_b128 v3,v[84:87] offset:11264
s_nop 0
s_barrier
s_cmp_eq_u32 s21,0
s_cbranch_scc0 ann_71
v_mov_b32 v40,s2
v_mov_b32_e64 v41,s3
s_mov_b64 exec,1
global_store_byte v40,v41,s[4:5] sc1
s_mov_b64 exec,-1
ann_71:
s_waitcnt vmcnt(8) lgkmcnt(0)
s_barrier
s_add_u32 s60,s56,3145728
s_mov_b32 m0,108544
s_nop 0
buffer_load_dwordx4 v240,s[80:83],s60 offen lds
s_add_u32 s60,s56,3153920
s_mov_b32 m0,109568
s_nop 0
buffer_load_dwordx4 v240,s[80:83],s60 offen lds
s_add_u32 s60,s56,3162112
s_mov_b32 m0,110592
s_nop 0
buffer_load_dwordx4 v241,s[80:83],s60 offen lds
s_add_u32 s60,s56,3170304
s_mov_b32 m0,111616
s_nop 0
buffer_load_dwordx4 v241,s[80:83],s60 offen lds
v_add_u32 v15,147456,v244
ds_read_b64_tr_b16 a[96:97],v15
ds_read_b64_tr_b16 a[98:99],v15 offset:1024
ds_read_b64_tr_b16 a[100:101],v15 offset:8192
ds_read_b64_tr_b16 a[102:103],v15 offset:9216
v_add_u32 v246,147456,v245
ds_read_b64_tr_b16 v[80:81],v246
ds_read_b64_tr_b16 v[82:83],v246 offset:1024
ds_read_b64_tr_b16 v[84:85],v246 offset:8192
ds_read_b64_tr_b16 v[86:87],v246 offset:9216
s_waitcnt lgkmcnt(0)
ds_write_b128 v3,v[80:83] offset:14336
ds_write_b128 v3,v[84:87] offset:15360
s_waitcnt vmcnt(8) lgkmcnt(0)
s_barrier
s_add_u32 s60,s56,3670016
s_mov_b32 m0,147456
s_nop 0
buffer_load_dwordx4 v240,s[80:83],s60 offen lds
s_add_u32 s60,s56,3678208
s_mov_b32 m0,148480
s_nop 0
buffer_load_dwordx4 v240,s[80:83],s60 offen lds
s_add_u32 s60,s56,3686400
s_mov_b32 m0,149504
s_nop 0
buffer_load_dwordx4 v241,s[80:83],s60 offen lds
s_add_u32 s60,s56,3694592
s_mov_b32 m0,150528
s_nop 0
buffer_load_dwordx4 v241,s[80:83],s60 offen lds
v_add_u32 v15,30720,v244
ds_read_b64_tr_b16 a[128:129],v15
ds_read_b64_tr_b16 a[130:131],v15 offset:1024
ds_read_b64_tr_b16 a[132:133],v15 offset:8192
ds_read_b64_tr_b16 a[134:135],v15 offset:9216
v_add_u32 v246,30720,v245
ds_read_b64_tr_b16 v[80:81],v246
ds_read_b64_tr_b16 v[82:83],v246 offset:1024
ds_read_b64_tr_b16 v[84:85],v246 offset:8192
ds_read_b64_tr_b16 v[86:87],v246 offset:9216
s_waitcnt lgkmcnt(0)
ds_write_b128 v3,v[80:83] offset:18432
ds_write_b128 v3,v[84:87] offset:19456
s_waitcnt vmcnt(8) lgkmcnt(0)
s_barrier
s_add_u32 s60,s56,4194304
s_mov_b32 m0,30720
s_nop 0
buffer_load_dwordx4 v242,s[80:83],s60 offen lds
s_add_u32 s60,s56,4210688
s_mov_b32 m0,31744
s_nop 0
buffer_load_dwordx4 v242,s[80:83],s60 offen lds
s_add_u32 s60,s56,4227072
s_mov_b32 m0,32768
s_nop 0
buffer_load_dwordx4 v243,s[80:83],s60 offen lds
s_add_u32 s60,s56,4243456
s_mov_b32 m0,33792
s_nop 0
buffer_load_dwordx4 v243,s[80:83],s60 offen lds
v_add_u32 v15,69632,v244
ds_read_b64_tr_b16 a[152:153],v15
ds_read_b64_tr_b16 a[154:155],v15 offset:1024
ds_read_b64_tr_b16 a[156:157],v15 offset:8192
ds_read_b64_tr_b16 a[158:159],v15 offset:9216
v_add_u32 v246,69632,v245
ds_read_b64_tr_b16 a[160:161],v246
ds_read_b64_tr_b16 a[162:163],v246 offset:1024
ds_read_b64_tr_b16 a[164:165],v246 offset:8192
ds_read_b64_tr_b16 a[166:167],v246 offset:9216
s_waitcnt vmcnt(8) lgkmcnt(0)
s_barrier
s_add_u32 s60,s56,0
s_mov_b32 m0,69632
s_nop 0
buffer_load_dwordx4 v240,s[76:79],s60 offen lds
s_add_u32 s60,s56,8192
s_mov_b32 m0,70656
s_nop 0
buffer_load_dwordx4 v240,s[76:79],s60 offen lds
s_add_u32 s60,s56,16384
s_mov_b32 m0,71680
s_nop 0
buffer_load_dwordx4 v241,s[76:79],s60 offen lds
s_add_u32 s60,s56,24576
s_mov_b32 m0,72704
s_nop 0
buffer_load_dwordx4 v241,s[76:79],s60 offen lds
v_add_u32 v15,108544,v244
ds_read_b64_tr_b16 v[64:65],v15
ds_read_b64_tr_b16 v[66:67],v15 offset:1024
ds_read_b64_tr_b16 v[68:69],v15 offset:8192
ds_read_b64_tr_b16 v[70:71],v15 offset:9216
v_add_u32 v246,108544,v245
ds_read_b64_tr_b16 a[184:185],v246
ds_read_b64_tr_b16 a[186:187],v246 offset:1024
ds_read_b64_tr_b16 a[188:189],v246 offset:8192
ds_read_b64_tr_b16 a[190:191],v246 offset:9216
v_lshlrev_b32 v40,2,v10
global_load_dword v41,v40,s[4:5] sc1
s_waitcnt vmcnt(8) lgkmcnt(0)
s_barrier
s_add_u32 s60,s56,524288
s_mov_b32 m0,108544
s_nop 0
buffer_load_dwordx4 v240,s[76:79],s60 offen lds
s_add_u32 s60,s56,532480
s_mov_b32 m0,109568
s_nop 0
buffer_load_dwordx4 v240,s[76:79],s60 offen lds
s_add_u32 s60,s56,540672
s_mov_b32 m0,110592
s_nop 0
buffer_load_dwordx4 v241,s[76:79],s60 offen lds
s_add_u32 s60,s56,548864
s_mov_b32 m0,111616
s_nop 0
buffer_load_dwordx4 v241,s[76:79],s60 offen lds
v_add_u32 v15,147456,v244
ds_read_b64_tr_b16 a[208:209],v15
ds_read_b64_tr_b16 a[210:211],v15 offset:1024
ds_read_b64_tr_b16 a[212:213],v15 offset:8192
ds_read_b64_tr_b16 a[214:215],v15 offset:9216
v_add_u32 v246,147456,v245
ds_read_b64_tr_b16 v[72:73],v246
ds_read_b64_tr_b16 v[74:75],v246 offset:1024
ds_read_b64_tr_b16 v[76:77],v246 offset:8192
ds_read_b64_tr_b16 v[78:79],v246 offset:9216
s_waitcnt vmcnt(8) lgkmcnt(0)
s_barrier
s_add_u32 s60,s56,1048576
s_mov_b32 m0,147456
s_nop 0
buffer_load_dwordx4 v240,s[76:79],s60 offen lds
s_add_u32 s60,s56,1056768
s_mov_b32 m0,148480
s_nop 0
buffer_load_dwordx4 v240,s[76:79],s60 offen lds
s_add_u32 s60,s56,1064960
s_mov_b32 m0,149504
s_nop 0
buffer_load_dwordx4 v241,s[76:79],s60 offen lds
s_add_u32 s60,s56,1073152
s_mov_b32 m0,150528
s_nop 0
buffer_load_dwordx4 v241,s[76:79],s60 offen lds
v_add_u32 v15,30720,v244
ds_read_b64_tr_b16 a[216:217],v15
ds_read_b64_tr_b16 a[218:219],v15 offset:1024
ds_read_b64_tr_b16 a[220:221],v15 offset:8192
ds_read_b64_tr_b16 a[222:223],v15 offset:9216
v_add_u32 v246,30720,v245
ds_read_b64_tr_b16 a[224:225],v246
ds_read_b64_tr_b16 a[226:227],v246 offset:1024
ds_read_b64_tr_b16 a[228:229],v246 offset:8192
ds_read_b64_tr_b16 a[230:231],v246 offset:9216
s_waitcnt vmcnt(8) lgkmcnt(0)
s_barrier
s_add_u32 s60,s56,1572864
s_mov_b32 m0,30720
s_nop 0
buffer_load_dwordx4 v240,s[76:79],s60 offen lds
s_add_u32 s60,s56,1581056
s_mov_b32 m0,31744
s_nop 0
buffer_load_dwordx4 v240,s[76:79],s60 offen lds
s_add_u32 s60,s56,1589248
s_mov_b32 m0,32768
s_nop 0
buffer_load_dwordx4 v241,s[76:79],s60 offen lds
s_add_u32 s60,s56,1597440
s_mov_b32 m0,33792
s_nop 0
buffer_load_dwordx4 v241,s[76:79],s60 offen lds
v_add_u32 v15,69632,v244
ds_read_b64_tr_b16 v[80:81],v15
ds_read_b64_tr_b16 v[82:83],v15 offset:1024
ds_read_b64_tr_b16 v[84:85],v15 offset:8192
ds_read_b64_tr_b16 v[86:87],v15 offset:9216
s_waitcnt lgkmcnt(0)
ds_write_b128 v3,v[80:83]
ds_write_b128 v3,v[84:87] offset:1024
v_add_u32 v246,69632,v245
ds_read_b64_tr_b16 a[8:9],v246
ds_read_b64_tr_b16 a[10:11],v246 offset:1024
ds_read_b64_tr_b16 a[12:13],v246 offset:8192
ds_read_b64_tr_b16 a[14:15],v246 offset:9216
s_waitcnt vmcnt(8) lgkmcnt(0)
s_barrier
s_add_u32 s60,s56,2097152
s_mov_b32 m0,69632
s_nop 0
buffer_load_dwordx4 v240,s[76:79],s60 offen lds
s_add_u32 s60,s56,2105344
s_mov_b32 m0,70656
s_nop 0
buffer_load_dwordx4 v240,s[76:79],s60 offen lds
s_add_u32 s60,s56,2113536
s_mov_b32 m0,71680
s_nop 0
buffer_load_dwordx4 v241,s[76:79],s60 offen lds
s_add_u32 s60,s56,2121728
s_mov_b32 m0,72704
s_nop 0
buffer_load_dwordx4 v241,s[76:79],s60 offen lds
v_add_u32 v15,108544,v244
ds_read_b64_tr_b16 v[80:81],v15
ds_read_b64_tr_b16 v[82:83],v15 offset:1024
ds_read_b64_tr_b16 v[84:85],v15 offset:8192
ds_read_b64_tr_b16 v[86:87],v15 offset:9216
s_waitcnt lgkmcnt(0)
ds_write_b128 v3,v[80:83] offset:4096
ds_write_b128 v3,v[84:87] offset:5120
v_add_u32 v246,108544,v245
ds_read_b64_tr_b16 a[40:41],v246
ds_read_b64_tr_b16 a[42:43],v246 offset:1024
ds_read_b64_tr_b16 a[44:45],v246 offset:8192
ds_read_b64_tr_b16 a[46:47],v246 offset:9216
s_cmp_lg_u32 s19,0
s_cbranch_scc1 ver_72
s_mov_b32 s19,1
v_mbcnt_lo_u32_b32 v46,-1,0
v_mbcnt_hi_u32_b32 v46,-1,v46
v_lshlrev_b32 v40,2,v46
s_mov_b32 s63,0
s_branch el_73s
el_73:
global_load_dword v41,v40,s[4:5] sc1
s_add_u32 s63,s63,1
s_cmp_gt_u32 s63,4000000
s_cbranch_scc1 ch0_fail
s_waitcnt vmcnt(0)
el_73s:
v_bfe_u32 v42,v41,0,8
v_bfe_u32 v43,v41,8,8
v_bfe_u32 v44,v41,16,8
v_bfe_u32 v45,v41,24,8
v_min_u32 v41,v42,v43
v_min3_u32 v41,v41,v44,v45
v_cmp_eq_u32 vcc,0,v41
s_cbranch_vccnz el_73
s_mov_b32 s62,0
elw_74:
s_add_u32 s62,s62,1
s_mov_b32 s61,0
v_cmp_eq_u32 vcc,s62,v42
s_bcnt1_i32_b64 s60,vcc
s_add_u32 s61,s61,s60
v_cmp_eq_u32 vcc,s62,v43
s_bcnt1_i32_b64 s60,vcc
s_add_u32 s61,s61,s60
v_cmp_eq_u32 vcc,s62,v44
s_bcnt1_i32_b64 s60,vcc
s_add_u32 s61,s61,s60
v_cmp_eq_u32 vcc,s62,v45
s_bcnt1_i32_b64 s60,vcc
s_add_u32 s61,s61,s60
s_cmp_ge_u32 s62,16
s_cbranch_scc1 ch0_fail
s_cmp_lt_u32 s61,32
s_cbranch_scc1 elw_74
s_mov_b32 s61,0
s_mov_b32 s63,0
v_cmp_gt_u32 vcc,s3,v42
s_bcnt1_i32_b64 s60,vcc
s_add_u32 s63,s63,s60
v_add_u32 v41,0,v40
v_cmp_gt_u32 s[16:17],s2,v41
v_cmp_eq_u32 vcc,s3,v42
s_and_b64 vcc,vcc,s[16:17]
s_bcnt1_i32_b64 s60,vcc
s_add_u32 s61,s61,s60
v_cmp_gt_u32 vcc,s3,v43
s_bcnt1_i32_b64 s60,vcc
s_add_u32 s63,s63,s60
v_add_u32 v41,1,v40
v_cmp_gt_u32 s[16:17],s2,v41
v_cmp_eq_u32 vcc,s3,v43
s_and_b64 vcc,vcc,s[16:17]
s_bcnt1_i32_b64 s60,vcc
s_add_u32 s61,s61,s60
v_cmp_gt_u32 vcc,s3,v44
s_bcnt1_i32_b64 s60,vcc
s_add_u32 s63,s63,s60
v_add_u32_e64 v41,2,v40
v_cmp_gt_u32 s[16:17],s2,v41
v_cmp_eq_u32 vcc,s3,v44
s_and_b64 vcc,vcc,s[16:17]
s_bcnt1_i32_b64 s60,vcc
s_add_u32 s61,s61,s60
v_cmp_gt_u32 vcc,s3,v45
s_bcnt1_i32_b64 s60,vcc
s_add_u32 s63,s63,s60
v_add_u32 v41,3,v40
v_cmp_gt_u32 s[16:17],s2,v41
v_cmp_eq_u32 vcc,s3,v45
s_and_b64 vcc,vcc,s[16:17]
s_bcnt1_i32_b64 s60,vcc
s_add_u32 s61,s61,s60
s_add_u32 s18,s61,s63
s_cmp_gt_u32 s62,s3
s_cselect_b32 s60,32,0
s_add_u32 s18,s18,s60
s_cmp_lg_u32 s62,s3
s_cbranch_scc1 eld_75
s_cmp_lt_u32 s61,32
s_cselect_b32 s18,s61,s18
eld_75:
s_add_u32 s60,s24,0
s_cmp_eq_u32 s60,s18
s_cbranch_scc1 ver_72
s_mov_b32 s24,s18
s_mov_b32 s10,268435456
s_waitcnt vmcnt(0) lgkmcnt(0)
s_branch k_role
ver_72:
s_lshl_b32 s39,s24,6
s_add_u32 s34,s39,0
s_add_u32 s41,s34,65536
s_add_u32 s35,s34,131072
s_add_u32 s44,s34,196608
s_add_u32 s36,s39,262144
s_add_u32 s30,s39,2097152
s_add_u32 s31,s39,2097152
s_and_b32 s27,s24,3
s_lshl_b32 s27,s27,11
s_add_u32 s27,s27,2097152
s_mov_b32 s28,2105344
s_mov_b32 s29,2109440
s_lshl_b32 s39,s24,11
s_add_u32 s37,s39,0
s_mov_b32 s26,0
s_mov_b32 s42,1040356334
s_mov_b32 s18,0x3f803f80
s_mov_b32 s58,562036736
v_mov_b32 v20,-1
v_mov_b32 v21,-1
v_mov_b32 v22,-1
v_mov_b32 v23,-1
s_mov_b32 s20,0
s_lshl_b32 s39,s24,2
s_add_u32 s57,s39,6311936
s_and_b32 s39,s24,1
s_lshl_b32 s39,s39,7
s_add_u32 s59,s39,6311936
s_mov_b64 exec,3
v_mov_b32 v28,0
buffer_load_dword v24,v4,s[8:11],s57 offen sc1
s_mov_b64 exec,-1
s_lshl_b32 s45,s24,9
s_add_u32 s45,s45,2129920
s_waitcnt vmcnt(8) lgkmcnt(0)
s_barrier
s_add_u32 s60,s56,2621440
s_mov_b32 m0,108544
s_nop 0
buffer_load_dwordx4 v240,s[76:79],s60 offen lds
s_add_u32 s60,s56,2629632
s_mov_b32 m0,109568
s_nop 0
buffer_load_dwordx4 v240,s[76:79],s60 offen lds
s_add_u32 s60,s56,2637824
s_mov_b32 m0,110592
s_nop 0
buffer_load_dwordx4 v241,s[76:79],s60 offen lds
s_add_u32 s60,s56,2646016
s_mov_b32 m0,111616
s_nop 0
buffer_load_dwordx4 v241,s[76:79],s60 offen lds
v_add_u32 v15,147456,v244
ds_read_b64_tr_b16 v[80:81],v15
ds_read_b64_tr_b16 v[82:83],v15 offset:1024
ds_read_b64_tr_b16 v[84:85],v15 offset:8192
ds_read_b64_tr_b16 v[86:87],v15 offset:9216
s_waitcnt lgkmcnt(0)
ds_write_b128 v3,v[80:83] offset:8192
ds_write_b128 v3,v[84:87] offset:9216
v_add_u32 v246,147456,v245
ds_read_b64_tr_b16 a[72:73],v246
ds_read_b64_tr_b16 a[74:75],v246 offset:1024
ds_read_b64_tr_b16 a[76:77],v246 offset:8192
ds_read_b64_tr_b16 a[78:79],v246 offset:9216
s_waitcnt vmcnt(8) lgkmcnt(0)
s_barrier
s_add_u32 s60,s56,3145728
s_mov_b32 m0,147456
s_nop 0
buffer_load_dwordx4 v240,s[76:79],s60 offen lds
s_add_u32 s60,s56,3153920
s_mov_b32 m0,148480
s_nop 0
buffer_load_dwordx4 v240,s[76:79],s60 offen lds
s_add_u32 s60,s56,3162112
s_mov_b32 m0,149504
s_nop 0
buffer_load_dwordx4 v241,s[76:79],s60 offen lds
s_add_u32 s60,s56,3170304
s_mov_b32 m0,150528
s_nop 0
buffer_load_dwordx4 v241,s[76:79],s60 offen lds
v_add_u32 v15,30720,v244
ds_read_b64_tr_b16 v[80:81],v15
ds_read_b64_tr_b16 v[82:83],v15 offset:1024
ds_read_b64_tr_b16 v[84:85],v15 offset:8192
ds_read_b64_tr_b16 v[86:87],v15 offset:9216
s_waitcnt lgkmcnt(0)
ds_write_b128 v3,v[80:83] offset:12288
ds_write_b128 v3,v[84:87] offset:13312
v_add_u32 v246,30720,v245
ds_read_b64_tr_b16 a[104:105],v246
ds_read_b64_tr_b16 a[106:107],v246 offset:1024
ds_read_b64_tr_b16 a[108:109],v246 offset:8192
ds_read_b64_tr_b16 a[110:111],v246 offset:9216
s_waitcnt vmcnt(8) lgkmcnt(0)
s_barrier
s_add_u32 s60,s56,3670016
s_mov_b32 m0,30720
s_nop 0
buffer_load_dwordx4 v240,s[76:79],s60 offen lds
s_add_u32 s60,s56,3678208
s_mov_b32 m0,31744
s_nop 0
buffer_load_dwordx4 v240,s[76:79],s60 offen lds
s_add_u32 s60,s56,3686400
s_mov_b32 m0,32768
s_nop 0
buffer_load_dwordx4 v241,s[76:79],s60 offen lds
s_add_u32 s60,s56,3694592
s_mov_b32 m0,33792
s_nop 0
buffer_load_dwordx4 v241,s[76:79],s60 offen lds
v_add_u32 v15,69632,v244
ds_read_b64_tr_b16 v[80:81],v15
ds_read_b64_tr_b16 v[82:83],v15 offset:1024
ds_read_b64_tr_b16 v[84:85],v15 offset:8192
ds_read_b64_tr_b16 v[86:87],v15 offset:9216
s_waitcnt lgkmcnt(0)
ds_write_b128 v3,v[80:83] offset:16384
ds_write_b128 v3,v[84:87] offset:17408
v_add_u32 v246,69632,v245
ds_read_b64_tr_b16 a[136:137],v246
ds_read_b64_tr_b16 a[138:139],v246 offset:1024
ds_read_b64_tr_b16 a[140:141],v246 offset:8192
ds_read_b64_tr_b16 a[142:143],v246 offset:9216
s_waitcnt vmcnt(8) lgkmcnt(0)
s_barrier
s_add_u32 s60,s56,4194304
s_mov_b32 m0,69632
s_nop 0
buffer_load_dwordx4 v242,s[76:79],s60 offen lds
s_add_u32 s60,s56,4210688
s_mov_b32 m0,70656
s_nop 0
buffer_load_dwordx4 v242,s[76:79],s60 offen lds
s_add_u32 s60,s56,4227072
s_mov_b32 m0,71680
s_nop 0
buffer_load_dwordx4 v243,s[76:79],s60 offen lds
s_add_u32 s60,s56,4243456
s_mov_b32 m0,72704
s_nop 0
buffer_load_dwordx4 v243,s[76:79],s60 offen lds
v_add_u32 v15,108544,v244
ds_read_b64_tr_b16 a[144:145],v15
ds_read_b64_tr_b16 a[146:147],v15 offset:1024
ds_read_b64_tr_b16 a[148:149],v15 offset:8192
ds_read_b64_tr_b16 a[150:151],v15 offset:9216
v_add_u32 v246,108544,v245
ds_read_b64_tr_b16 v[80:81],v246
ds_read_b64_tr_b16 v[82:83],v246 offset:1024
ds_read_b64_tr_b16 v[84:85],v246 offset:8192
ds_read_b64_tr_b16 v[86:87],v246 offset:9216
s_waitcnt lgkmcnt(0)
ds_write_b128 v3,v[80:83] offset:20480
ds_write_b128 v3,v[84:87] offset:21504
s_waitcnt vmcnt(8) lgkmcnt(0)
s_barrier
s_add_u32 s60,s56,0
s_mov_b32 m0,108544
s_nop 0
buffer_load_dwordx4 v240,s[84:87],s60 offen lds
s_add_u32 s60,s56,8192
s_mov_b32 m0,109568
s_nop 0
buffer_load_dwordx4 v240,s[84:87],s60 offen lds
s_add_u32 s60,s56,16384
s_mov_b32 m0,110592
s_nop 0
buffer_load_dwordx4 v241,s[84:87],s60 offen lds
s_add_u32 s60,s56,24576
s_mov_b32 m0,111616
s_nop 0
buffer_load_dwordx4 v241,s[84:87],s60 offen lds
v_add_u32 v15,147456,v244
ds_read_b64_tr_b16 a[168:169],v15
ds_read_b64_tr_b16 a[170:171],v15 offset:1024
ds_read_b64_tr_b16 a[172:173],v15 offset:8192
ds_read_b64_tr_b16 a[174:175],v15 offset:9216
v_add_u32 v246,147456,v245
ds_read_b64_tr_b16 a[176:177],v246
ds_read_b64_tr_b16 a[178:179],v246 offset:1024
ds_read_b64_tr_b16 a[180:181],v246 offset:8192
ds_read_b64_tr_b16 a[182:183],v246 offset:9216
s_waitcnt vmcnt(8) lgkmcnt(0)
s_barrier
s_add_u32 s60,s56,524288
s_mov_b32 m0,147456
s_nop 0
buffer_load_dwordx4 v240,s[84:87],s60 offen lds
s_add_u32 s60,s56,532480
s_mov_b32 m0,148480
s_nop 0
buffer_load_dwordx4 v240,s[84:87],s60 offen lds
s_add_u32 s60,s56,540672
s_mov_b32 m0,149504
s_nop 0
buffer_load_dwordx4 v241,s[84:87],s60 offen lds
s_add_u32 s60,s56,548864
s_mov_b32 m0,150528
s_nop 0
buffer_load_dwordx4 v241,s[84:87],s60 offen lds
v_add_u32 v15,30720,v244
ds_read_b64_tr_b16 v[48:49],v15
ds_read_b64_tr_b16 v[50:51],v15 offset:1024
ds_read_b64_tr_b16 v[52:53],v15 offset:8192
ds_read_b64_tr_b16 v[54:55],v15 offset:9216
v_add_u32 v246,30720,v245
ds_read_b64_tr_b16 a[192:193],v246
ds_read_b64_tr_b16 a[194:195],v246 offset:1024
ds_read_b64_tr_b16 a[196:197],v246 offset:8192
ds_read_b64_tr_b16 a[198:199],v246 offset:9216
s_waitcnt vmcnt(8) lgkmcnt(0)
s_barrier
s_add_u32 s60,s56,1048576
s_mov_b32 m0,30720
s_nop 0
buffer_load_dwordx4 v240,s[84:87],s60 offen lds
s_add_u32 s60,s56,1056768
s_mov_b32 m0,31744
s_nop 0
buffer_load_dwordx4 v240,s[84:87],s60 offen lds
s_add_u32 s60,s56,1064960
s_mov_b32 m0,32768
s_nop 0
buffer_load_dwordx4 v241,s[84:87],s60 offen lds
s_add_u32 s60,s56,1073152
s_mov_b32 m0,33792
s_nop 0
buffer_load_dwordx4 v241,s[84:87],s60 offen lds
v_add_u32 v15,69632,v244
ds_read_b64_tr_b16 a[200:201],v15
ds_read_b64_tr_b16 a[202:203],v15 offset:1024
ds_read_b64_tr_b16 a[204:205],v15 offset:8192
ds_read_b64_tr_b16 a[206:207],v15 offset:9216
v_add_u32 v246,69632,v245
ds_read_b64_tr_b16 v[56:57],v246
ds_read_b64_tr_b16 v[58:59],v246 offset:1024
ds_read_b64_tr_b16 v[60:61],v246 offset:8192
ds_read_b64_tr_b16 v[62:63],v246 offset:9216
s_waitcnt vmcnt(8) lgkmcnt(0)
s_barrier
s_add_u32 s60,s56,1572864
s_mov_b32 m0,69632
s_nop 0
buffer_load_dwordx4 v240,s[84:87],s60 offen lds
s_add_u32 s60,s56,1581056
s_mov_b32 m0,70656
s_nop 0
buffer_load_dwordx4 v240,s[84:87],s60 offen lds
s_add_u32 s60,s56,1589248
s_mov_b32 m0,71680
s_nop 0
buffer_load_dwordx4 v241,s[84:87],s60 offen lds
s_add_u32 s60,s56,1597440
s_mov_b32 m0,72704
s_nop 0
buffer_load_dwordx4 v241,s[84:87],s60 offen lds
v_add_u32 v15,108544,v244
ds_read_b64_tr_b16 a[16:17],v15
ds_read_b64_tr_b16 a[18:19],v15 offset:1024
ds_read_b64_tr_b16 a[20:21],v15 offset:8192
ds_read_b64_tr_b16 a[22:23],v15 offset:9216
v_add_u32 v246,108544,v245
ds_read_b64_tr_b16 a[24:25],v246
ds_read_b64_tr_b16 a[26:27],v246 offset:1024
ds_read_b64_tr_b16 a[28:29],v246 offset:8192
ds_read_b64_tr_b16 a[30:31],v246 offset:9216
s_waitcnt vmcnt(8) lgkmcnt(0)
s_barrier
s_add_u32 s60,s56,2097152
s_mov_b32 m0,108544
s_nop 0
buffer_load_dwordx4 v240,s[84:87],s60 offen lds
s_add_u32 s60,s56,2105344
s_mov_b32 m0,109568
s_nop 0
buffer_load_dwordx4 v240,s[84:87],s60 offen lds
s_add_u32 s60,s56,2113536
s_mov_b32 m0,110592
s_nop 0
buffer_load_dwordx4 v241,s[84:87],s60 offen lds
s_add_u32 s60,s56,2121728
s_mov_b32 m0,111616
s_nop 0
buffer_load_dwordx4 v241,s[84:87],s60 offen lds
v_add_u32 v15,147456,v244
ds_read_b64_tr_b16 a[48:49],v15
ds_read_b64_tr_b16 a[50:51],v15 offset:1024
ds_read_b64_tr_b16 a[52:53],v15 offset:8192
ds_read_b64_tr_b16 a[54:55],v15 offset:9216
v_add_u32 v246,147456,v245
ds_read_b64_tr_b16 a[56:57],v246
ds_read_b64_tr_b16 a[58:59],v246 offset:1024
ds_read_b64_tr_b16 a[60:61],v246 offset:8192
ds_read_b64_tr_b16 a[62:63],v246 offset:9216
s_waitcnt vmcnt(8) lgkmcnt(0)
s_barrier
s_add_u32 s60,s56,2621440
s_mov_b32 m0,147456
s_nop 0
buffer_load_dwordx4 v240,s[84:87],s60 offen lds
s_add_u32 s60,s56,2629632
s_mov_b32 m0,148480
s_nop 0
buffer_load_dwordx4 v240,s[84:87],s60 offen lds
s_add_u32 s60,s56,2637824
s_mov_b32 m0,149504
s_nop 0
buffer_load_dwordx4 v241,s[84:87],s60 offen lds
s_add_u32 s60,s56,2646016
s_mov_b32 m0,150528
s_nop 0
buffer_load_dwordx4 v241,s[84:87],s60 offen lds
v_add_u32 v15,30720,v244
ds_read_b64_tr_b16 a[80:81],v15
ds_read_b64_tr_b16 a[82:83],v15 offset:1024
ds_read_b64_tr_b16 a[84:85],v15 offset:8192
ds_read_b64_tr_b16 a[86:87],v15 offset:9216
v_add_u32 v246,30720,v245
ds_read_b64_tr_b16 a[88:89],v246
ds_read_b64_tr_b16 a[90:91],v246 offset:1024
ds_read_b64_tr_b16 a[92:93],v246 offset:8192
ds_read_b64_tr_b16 a[94:95],v246 offset:9216
s_waitcnt vmcnt(8) lgkmcnt(0)
s_barrier
s_add_u32 s60,s56,3145728
s_mov_b32 m0,30720
s_nop 0
buffer_load_dwordx4 v240,s[84:87],s60 offen lds
s_add_u32 s60,s56,3153920
s_mov_b32 m0,31744
s_nop 0
buffer_load_dwordx4 v240,s[84:87],s60 offen lds
s_add_u32 s60,s56,3162112
s_mov_b32 m0,32768
s_nop 0
buffer_load_dwordx4 v241,s[84:87],s60 offen lds
s_add_u32 s60,s56,3170304
s_mov_b32 m0,33792
s_nop 0
buffer_load_dwordx4 v241,s[84:87],s60 offen lds
v_add_u32 v15,69632,v244
ds_read_b64_tr_b16 a[112:113],v15
ds_read_b64_tr_b16 a[114:115],v15 offset:1024
ds_read_b64_tr_b16 a[116:117],v15 offset:8192
ds_read_b64_tr_b16 a[118:119],v15 offset:9216
v_add_u32 v246,69632,v245
ds_read_b64_tr_b16 a[120:121],v246
ds_read_b64_tr_b16 a[122:123],v246 offset:1024
ds_read_b64_tr_b16 a[124:125],v246 offset:8192
ds_read_b64_tr_b16 a[126:127],v246 offset:9216
s_waitcnt vmcnt(8) lgkmcnt(0)
s_barrier
s_add_u32 s60,s56,3670016
s_mov_b32 m0,69632
s_nop 0
buffer_load_dwordx4 v240,s[84:87],s60 offen lds
s_add_u32 s60,s56,3678208
s_mov_b32 m0,70656
s_nop 0
buffer_load_dwordx4 v240,s[84:87],s60 offen lds
s_add_u32 s60,s56,3686400
s_mov_b32 m0,71680
s_nop 0
buffer_load_dwordx4 v241,s[84:87],s60 offen lds
s_add_u32 s60,s56,3694592
s_mov_b32 m0,72704
s_nop 0
buffer_load_dwordx4 v241,s[84:87],s60 offen lds
v_add_u32 v15,108544,v244
ds_read_b64_tr_b16 a[232:233],v15
ds_read_b64_tr_b16 a[234:235],v15 offset:1024
ds_read_b64_tr_b16 a[236:237],v15 offset:8192
ds_read_b64_tr_b16 a[238:239],v15 offset:9216
v_add_u32 v246,108544,v245
ds_read_b64_tr_b16 a[240:241],v246
ds_read_b64_tr_b16 a[242:243],v246 offset:1024
ds_read_b64_tr_b16 a[244:245],v246 offset:8192
ds_read_b64_tr_b16 a[246:247],v246 offset:9216
s_waitcnt vmcnt(8) lgkmcnt(0)
s_barrier
s_add_u32 s60,s56,4194304
s_mov_b32 m0,108544
s_nop 0
buffer_load_dwordx4 v242,s[84:87],s60 offen lds
s_add_u32 s60,s56,4210688
s_mov_b32 m0,109568
s_nop 0
buffer_load_dwordx4 v242,s[84:87],s60 offen lds
s_add_u32 s60,s56,4227072
s_mov_b32 m0,110592
s_nop 0
buffer_load_dwordx4 v243,s[84:87],s60 offen lds
s_add_u32 s60,s56,4243456
s_mov_b32 m0,111616
s_nop 0
buffer_load_dwordx4 v243,s[84:87],s60 offen lds
v_add_u32 v15,147456,v244
ds_read_b64_tr_b16 a[248:249],v15
ds_read_b64_tr_b16 a[250:251],v15 offset:1024
ds_read_b64_tr_b16 a[252:253],v15 offset:8192
ds_read_b64_tr_b16 a[254:255],v15 offset:9216
v_add_u32 v246,147456,v245
ds_read_b64_tr_b16 v[88:89],v246
ds_read_b64_tr_b16 v[90:91],v246 offset:1024
ds_read_b64_tr_b16 v[92:93],v246 offset:8192
ds_read_b64_tr_b16 v[94:95],v246 offset:9216
s_waitcnt vmcnt(8) lgkmcnt(0)
s_barrier
s_add_u32 s60,s32,0
s_mov_b32 m0,147456
s_nop 0
buffer_load_dwordx4 v11,s[88:91],s60 offen lds
s_add_u32 s60,s32,2304
s_mov_b32 m0,148480
s_nop 0
buffer_load_dwordx4 v11,s[88:91],s60 offen lds
s_add_u32 s60,s32,4608
s_mov_b32 m0,149504
s_nop 0
buffer_load_dwordx4 v11,s[88:91],s60 offen lds
s_add_u32 s60,s32,6912
s_mov_b32 m0,150528
s_nop 0
buffer_load_dwordx4 v11,s[88:91],s60 offen lds
v_add_u32 v15,30720,v244
ds_read_b64_tr_b16 v[96:97],v15
ds_read_b64_tr_b16 v[98:99],v15 offset:1024
ds_read_b64_tr_b16 v[100:101],v15 offset:8192
ds_read_b64_tr_b16 v[102:103],v15 offset:9216
v_add_u32 v246,30720,v245
ds_read_b64_tr_b16 v[104:105],v246
ds_read_b64_tr_b16 v[106:107],v246 offset:1024
ds_read_b64_tr_b16 v[108:109],v246 offset:8192
ds_read_b64_tr_b16 v[110:111],v246 offset:9216
s_waitcnt vmcnt(8) lgkmcnt(0)
s_barrier
s_add_u32 s60,s32,36864
s_mov_b32 m0,30720
s_nop 0
buffer_load_dwordx4 v11,s[88:91],s60 offen lds
s_add_u32 s60,s32,39168
s_mov_b32 m0,31744
s_nop 0
buffer_load_dwordx4 v11,s[88:91],s60 offen lds
s_add_u32 s60,s32,41472
s_mov_b32 m0,32768
s_nop 0
buffer_load_dwordx4 v11,s[88:91],s60 offen lds
s_add_u32 s60,s32,43776
s_mov_b32 m0,33792
s_nop 0
buffer_load_dwordx4 v11,s[88:91],s60 offen lds
v_add_u32 v15,69632,v244
ds_read_b64_tr_b16 v[112:113],v15
ds_read_b64_tr_b16 v[114:115],v15 offset:1024
ds_read_b64_tr_b16 v[116:117],v15 offset:8192
ds_read_b64_tr_b16 v[118:119],v15 offset:9216
v_add_u32 v246,69632,v245
ds_read_b64_tr_b16 v[120:121],v246
ds_read_b64_tr_b16 v[122:123],v246 offset:1024
ds_read_b64_tr_b16 v[124:125],v246 offset:8192
ds_read_b64_tr_b16 v[126:127],v246 offset:9216
s_waitcnt vmcnt(8) lgkmcnt(0)
s_barrier
s_add_u32 s60,s32,73728
s_mov_b32 m0,69632
s_nop 0
buffer_load_dwordx4 v11,s[88:91],s60 offen lds
s_add_u32 s60,s32,76032
s_mov_b32 m0,70656
s_nop 0
buffer_load_dwordx4 v11,s[88:91],s60 offen lds
s_add_u32 s60,s32,78336
s_mov_b32 m0,71680
s_nop 0
buffer_load_dwordx4 v11,s[88:91],s60 offen lds
s_add_u32 s60,s32,80640
s_mov_b32 m0,72704
s_nop 0
buffer_load_dwordx4 v11,s[88:91],s60 offen lds
v_add_u32 v15,108544,v244
ds_read_b64_tr_b16 v[128:129],v15
ds_read_b64_tr_b16 v[130:131],v15 offset:1024
ds_read_b64_tr_b16 v[132:133],v15 offset:8192
ds_read_b64_tr_b16 v[134:135],v15 offset:9216
v_add_u32 v246,108544,v245
ds_read_b64_tr_b16 v[136:137],v246
ds_read_b64_tr_b16 v[138:139],v246 offset:1024
ds_read_b64_tr_b16 v[140:141],v246 offset:8192
ds_read_b64_tr_b16 v[142:143],v246 offset:9216
s_waitcnt vmcnt(8) lgkmcnt(0)
s_barrier
s_add_u32 s60,s32,110592
s_mov_b32 m0,108544
s_nop 0
buffer_load_dwordx4 v11,s[88:91],s60 offen lds
s_add_u32 s60,s32,112896
s_mov_b32 m0,109568
s_nop 0
buffer_load_dwordx4 v11,s[88:91],s60 offen lds
s_add_u32 s60,s32,115200
s_mov_b32 m0,110592
s_nop 0
buffer_load_dwordx4 v11,s[88:91],s60 offen lds
s_add_u32 s60,s32,117504
s_mov_b32 m0,111616
s_nop 0
buffer_load_dwordx4 v11,s[88:91],s60 offen lds
v_add_u32 v15,147456,v13
ds_read_b64_tr_b16 v[16:17],v15
ds_read_b64_tr_b16 v[18:19],v15 offset:1024
ds_read_b64_tr_b16 v[20:21],v15 offset:4096
ds_read_b64_tr_b16 v[22:23],v15 offset:5120
ds_read_b64_tr_b16 v[24:25],v15 offset:256
ds_read_b64_tr_b16 v[26:27],v15 offset:1280
ds_read_b64_tr_b16 v[28:29],v15 offset:4352
ds_read_b64_tr_b16 v[30:31],v15 offset:5376
s_waitcnt vmcnt(8) lgkmcnt(0)
s_barrier
s_add_u32 s60,s32,512
s_mov_b32 m0,147456
s_nop 0
buffer_load_dwordx4 v11,s[88:91],s60 offen lds
s_add_u32 s60,s32,2816
s_mov_b32 m0,148480
s_nop 0
buffer_load_dwordx4 v11,s[88:91],s60 offen lds
s_add_u32 s60,s32,5120
s_mov_b32 m0,149504
s_nop 0
buffer_load_dwordx4 v11,s[88:91],s60 offen lds
s_add_u32 s60,s32,7424
s_mov_b32 m0,150528
s_nop 0
buffer_load_dwordx4 v11,s[88:91],s60 offen lds
v_add_u32 v15,30720,v13
ds_read_b64_tr_b16 v[160:161],v15
ds_read_b64_tr_b16 v[162:163],v15 offset:1024
ds_read_b64_tr_b16 v[164:165],v15 offset:4096
ds_read_b64_tr_b16 v[166:167],v15 offset:5120
ds_read_b64_tr_b16 v[184:185],v15 offset:256
ds_read_b64_tr_b16 v[186:187],v15 offset:1280
ds_read_b64_tr_b16 v[188:189],v15 offset:4352
ds_read_b64_tr_b16 v[190:191],v15 offset:5376
s_waitcnt vmcnt(8) lgkmcnt(0)
s_barrier
s_add_u32 s60,s32,37376
s_mov_b32 m0,30720
s_nop 0
buffer_load_dwordx4 v11,s[88:91],s60 offen lds
s_add_u32 s60,s32,39680
s_mov_b32 m0,31744
s_nop 0
buffer_load_dwordx4 v11,s[88:91],s60 offen lds
s_add_u32 s60,s32,41984
s_mov_b32 m0,32768
s_nop 0
buffer_load_dwordx4 v11,s[88:91],s60 offen lds
s_add_u32 s60,s32,44288
s_mov_b32 m0,33792
s_nop 0
buffer_load_dwordx4 v11,s[88:91],s60 offen lds
v_add_u32 v15,69632,v13
ds_read_b64_tr_b16 v[168:169],v15
ds_read_b64_tr_b16 v[170:171],v15 offset:1024
ds_read_b64_tr_b16 v[172:173],v15 offset:4096
ds_read_b64_tr_b16 v[174:175],v15 offset:5120
ds_read_b64_tr_b16 v[192:193],v15 offset:256
ds_read_b64_tr_b16 v[194:195],v15 offset:1280
ds_read_b64_tr_b16 v[196:197],v15 offset:4352
ds_read_b64_tr_b16 v[198:199],v15 offset:5376
s_waitcnt vmcnt(8) lgkmcnt(0)
s_barrier
s_add_u32 s60,s32,74240
s_mov_b32 m0,69632
s_nop 0
buffer_load_dwordx4 v11,s[88:91],s60 offen lds
s_add_u32 s60,s32,76544
s_mov_b32 m0,70656
s_nop 0
buffer_load_dwordx4 v11,s[88:91],s60 offen lds
s_add_u32 s60,s32,78848
s_mov_b32 m0,71680
s_nop 0
buffer_load_dwordx4 v11,s[88:91],s60 offen lds
s_add_u32 s60,s32,81152
s_mov_b32 m0,72704
s_nop 0
buffer_load_dwordx4 v11,s[88:91],s60 offen lds
v_add_u32 v15,108544,v13
ds_read_b64_tr_b16 v[176:177],v15
ds_read_b64_tr_b16 v[178:179],v15 offset:1024
ds_read_b64_tr_b16 v[180:181],v15 offset:4096
ds_read_b64_tr_b16 v[182:183],v15 offset:5120
ds_read_b64_tr_b16 v[200:201],v15 offset:256
ds_read_b64_tr_b16 v[202:203],v15 offset:1280
ds_read_b64_tr_b16 v[204:205],v15 offset:4352
ds_read_b64_tr_b16 v[206:207],v15 offset:5376
s_waitcnt vmcnt(8) lgkmcnt(0)
s_barrier
s_add_u32 s60,s32,111104
s_mov_b32 m0,108544
s_nop 0
buffer_load_dwordx4 v11,s[88:91],s60 offen lds
s_add_u32 s60,s32,113408
s_mov_b32 m0,109568
s_nop 0
buffer_load_dwordx4 v11,s[88:91],s60 offen lds
s_add_u32 s60,s32,115712
s_mov_b32 m0,110592
s_nop 0
buffer_load_dwordx4 v11,s[88:91],s60 offen lds
s_add_u32 s60,s32,118016
s_mov_b32 m0,111616
s_nop 0
buffer_load_dwordx4 v11,s[88:91],s60 offen lds
v_add_u32 v15,147456,v13
ds_read_b64_tr_b16 v[144:145],v15
ds_read_b64_tr_b16 v[146:147],v15 offset:1024
ds_read_b64_tr_b16 v[148:149],v15 offset:4096
ds_read_b64_tr_b16 v[150:151],v15 offset:5120
ds_read_b64_tr_b16 v[152:153],v15 offset:256
ds_read_b64_tr_b16 v[154:155],v15 offset:1280
ds_read_b64_tr_b16 v[156:157],v15 offset:4352
ds_read_b64_tr_b16 v[158:159],v15 offset:5376
s_waitcnt vmcnt(8) lgkmcnt(0)
s_barrier
s_add_u32 s60,s32,1024
s_mov_b32 m0,147456
s_nop 0
buffer_load_dwordx4 v12,s[88:91],s60 offen lds
s_add_u32 s60,s32,10240
s_mov_b32 m0,148480
s_nop 0
buffer_load_dwordx4 v12,s[88:91],s60 offen lds
s_add_u32 s60,s32,19456
s_mov_b32 m0,149504
s_nop 0
buffer_load_dwordx4 v12,s[88:91],s60 offen lds
s_add_u32 s60,s32,28672
s_mov_b32 m0,150528
s_nop 0
buffer_load_dwordx4 v12,s[88:91],s60 offen lds
v_add_u32 v15,30720,v13
ds_read_b64_tr_b16 v[32:33],v15
ds_read_b64_tr_b16 v[34:35],v15 offset:1024
ds_read_b64_tr_b16 v[36:37],v15 offset:4096
ds_read_b64_tr_b16 v[38:39],v15 offset:5120
ds_read_b64_tr_b16 v[40:41],v15 offset:256
ds_read_b64_tr_b16 v[42:43],v15 offset:1280
ds_read_b64_tr_b16 v[44:45],v15 offset:4352
ds_read_b64_tr_b16 v[46:47],v15 offset:5376
s_waitcnt vmcnt(8) lgkmcnt(0)
s_barrier
v_add_u32 v15,69632,v13
ds_read_b64_tr_b16 v[208:209],v15
ds_read_b64_tr_b16 v[210:211],v15 offset:1024
ds_read_b64_tr_b16 v[212:213],v15 offset:4096
ds_read_b64_tr_b16 v[214:215],v15 offset:5120
ds_read_b64_tr_b16 v[224:225],v15 offset:256
ds_read_b64_tr_b16 v[226:227],v15 offset:1280
ds_read_b64_tr_b16 v[228:229],v15 offset:4352
ds_read_b64_tr_b16 v[230:231],v15 offset:5376
s_waitcnt vmcnt(4) lgkmcnt(0)
s_barrier
v_add_u32 v15,108544,v13
ds_read_b64_tr_b16 v[216:217],v15
ds_read_b64_tr_b16 v[218:219],v15 offset:1024
ds_read_b64_tr_b16 v[220:221],v15 offset:4096
ds_read_b64_tr_b16 v[222:223],v15 offset:5120
ds_read_b64_tr_b16 v[232:233],v15 offset:256
ds_read_b64_tr_b16 v[234:235],v15 offset:1280
ds_read_b64_tr_b16 v[236:237],v15 offset:4352
ds_read_b64_tr_b16 v[238:239],v15 offset:5376
s_waitcnt vmcnt(0) lgkmcnt(0)
s_barrier
v_add_u32 v15,147456,v14
ds_read_b64_tr_b16 v[240:241],v15
ds_read_b64_tr_b16 v[242:243],v15 offset:2048
ds_read_b64_tr_b16 v[244:245],v15 offset:4096
ds_read_b64_tr_b16 v[246:247],v15 offset:6144
ds_read_b64_tr_b16 v[248:249],v15 offset:8192
ds_read_b64_tr_b16 v[250:251],v15 offset:10240
ds_read_b64_tr_b16 v[252:253],v15 offset:12288
ds_read_b64_tr_b16 v[254:255],v15 offset:14336
s_waitcnt lgkmcnt(0)
s_barrier
ds_write_b128 v3,v[64:67] offset:22528
ds_write_b128 v3,v[68:71] offset:23552
ds_write_b128 v3,v[48:51] offset:24576
ds_write_b128 v3,v[52:55] offset:25600
ds_write_b128 v3,v[56:59] offset:26624
ds_write_b128 v3,v[60:63] offset:27648
ds_write_b128 v3,v[72:75] offset:28672
ds_write_b128 v3,v[76:79] offset:29696
ds_write_b128 v3,v[16:19] offset:30720
ds_write_b128 v3,v[20:23] offset:31744
ds_write_b128 v3,v[24:27] offset:32768
ds_write_b128 v3,v[28:31] offset:33792
ds_write_b128 v3,v[32:35] offset:34816
ds_write_b128 v3,v[36:39] offset:35840
ds_write_b128 v3,v[40:43] offset:36864
ds_write_b128 v3,v[44:47] offset:37888
s_waitcnt lgkmcnt(0)
v_mov_b32 v11,v10
ch0_layer:
s_mov_b32 s25,0
s_mul_i32 s39,s24,1064960
s_add_u32 s32,s39,41951232
s_add_u32 s56,s39,41943040
s_lshl_b32 s39,s24,6
s_add_u32 s39,s39,s52
s_add_u32 s54,s39,8388608
s_add_u32 s55,s39,8388608
s_mov_b32 s38,0
ch0_entry:
v_and_b32 v10,8,v2
v_add_u32 v10,v9,v10
v_mov_b32 v48,0
v_mov_b32 v49,0
v_mov_b32 v50,0
v_mov_b32 v51,0
v_mov_b32 v52,0
v_mov_b32 v53,0
v_mov_b32 v54,0
v_mov_b32 v55,0
v_mov_b32 v56,0
v_mov_b32 v57,0
v_mov_b32 v58,0
v_mov_b32 v59,0
v_mov_b32 v60,0
v_mov_b32 v61,0
v_mov_b32 v62,0
v_mov_b32_e64 v63,0
ds_read_b128 v[64:67],v3
ds_read_b128 v[68:71],v3 offset:1024
ds_read_b128 v[72:75],v3 offset:2048
ds_read_b128 v[76:79],v3 offset:3072
v_mov_b32 v80,0
v_mov_b32 v81,0
v_mov_b32 v82,0
v_mov_b32 v83,0
v_mov_b32 v84,0
v_mov_b32 v85,0
v_mov_b32 v86,0
v_mov_b32 v87,0
buffer_load_dwordx4 v[44:47],v0,s[8:11],s27 offen
buffer_load_dwordx4 v[12:15],v0,s[8:11],s27 offen offset:1024
buffer_load_dwordx4 v[16:19],v0,s[8:11],s28 offen
buffer_load_dwordx4 v[20:23],v0,s[8:11],s28 offen offset:1024
s_waitcnt vmcnt(0)
v_lshrrev_b32 v11,2,v0
v_and_b32 v11,127,v11
s_barrier
ch0_top:
s_waitcnt vmcnt(3) lgkmcnt(2)
v_cmp_eq_u32 vcc,-1,v44
s_cbranch_vccnz ch0_retry0
ch0_ok0:
v_smfmac_f32_16x16x64_bf16 v[48:51],v[44:47],v[64:71],v5
ds_read_b128 v[64:67],v3 offset:4096
v_smfmac_f32_16x16x64_bf16 v[56:59],v[44:47],a[0:7],v5
ds_read_b128 v[68:71],v3 offset:5120
buffer_load_dwordx4 v[24:27],v0,s[8:11],s28 offen offset:2048
v_smfmac_f32_16x16x64_bf16 v[52:55],v[44:47],a[8:15],v5
s_waitcnt vmcnt(3) lgkmcnt(2)
v_smfmac_f32_16x16x64_bf16 v[60:63],v[44:47],v[72:79],v5
ds_read_b128 v[72:75],v3 offset:6144
v_cmp_eq_u32 vcc,-1,v12
v_smfmac_f32_16x16x64_bf16 v[80:83],v[44:47],a[16:23],v5
ds_read_b128 v[76:79],v3 offset:7168
buffer_load_dwordx4 v[28:31],v0,s[8:11],s28 offen offset:3072
v_smfmac_f32_16x16x64_bf16 v[84:87],v[44:47],a[24:31],v5
s_cbranch_vccnz ch0_retry1
ch0_ok1:
s_waitcnt lgkmcnt(2)
v_smfmac_f32_16x16x64_bf16 v[48:51],v[12:15],v[64:71],v5
ds_read_b128 v[64:67],v3 offset:8192
v_smfmac_f32_16x16x64_bf16 v[56:59],v[12:15],a[32:39],v5
ds_read_b128 v[68:71],v3 offset:9216
buffer_load_dwordx4 v[32:35],v0,s[8:11],s29 offen
v_smfmac_f32_16x16x64_bf16 v[52:55],v[12:15],a[40:47],v5
s_waitcnt vmcnt(4) lgkmcnt(2)
v_smfmac_f32_16x16x64_bf16 v[60:63],v[12:15],v[72:79],v5
ds_read_b128 v[72:75],v3 offset:10240
v_cmp_eq_u32 vcc,-1,v16
v_smfmac_f32_16x16x64_bf16 v[80:83],v[12:15],a[48:55],v5
ds_read_b128 v[76:79],v3 offset:11264
buffer_load_dwordx4 v[36:39],v0,s[8:11],s29 offen offset:1024
v_smfmac_f32_16x16x64_bf16 v[84:87],v[12:15],a[56:63],v5
s_cbranch_vccnz ch0_retry2
ch0_ok2:
s_waitcnt lgkmcnt(2)
v_smfmac_f32_16x16x64_bf16 v[48:51],v[16:19],v[64:71],v5
ds_read_b128 v[64:67],v3 offset:12288
v_smfmac_f32_16x16x64_bf16 v[56:59],v[16:19],a[64:71],v5
ds_read_b128 v[68:71],v3 offset:13312
buffer_load_dwordx4 v[40:43],v0,s[8:11],s29 offen offset:2048
v_and_b32 v12,32,v0
v_smfmac_f32_16x16x64_bf16 v[52:55],v[16:19],a[72:79],v5
s_waitcnt vmcnt(5) lgkmcnt(2)
v_lshl_add_u32 v12,v12,4,v9
v_smfmac_f32_16x16x64_bf16 v[60:63],v[16:19],v[72:79],v5
ds_read_b128 v[72:75],v3 offset:14336
v_cmp_eq_u32_e64 vcc,-1,v20
v_smfmac_f32_16x16x64_bf16 v[80:83],v[16:19],a[80:87],v5
ds_read_b128 v[76:79],v3 offset:15360
buffer_load_dwordx4 v[44:47],v12,s[8:11],s56 offen sc1
v_smfmac_f32_16x16x64_bf16 v[84:87],v[16:19],a[88:95],v5
s_cbranch_vccnz ch0_retry3
ch0_ok3:
s_waitcnt lgkmcnt(2)
v_smfmac_f32_16x16x64_bf16 v[48:51],v[20:23],v[64:71],v5
ds_read_b128 v[64:67],v3 offset:16384
v_smfmac_f32_16x16x64_bf16 v[56:59],v[20:23],a[96:103],v5
ds_read_b128 v[68:71],v3 offset:17408
buffer_load_dwordx4 v[12:15],v12,s[8:11],s56 offen offset:1024 sc1
v_smfmac_f32_16x16x64_bf16 v[52:55],v[20:23],a[104:111],v5
s_waitcnt vmcnt(6) lgkmcnt(2)
v_smfmac_f32_16x16x64_bf16 v[60:63],v[20:23],v[72:79],v5
ds_read_b128 v[72:75],v3 offset:18432
v_cmp_eq_u32 vcc,-1,v24
v_smfmac_f32_16x16x64_bf16 v[80:83],v[20:23],a[112:119],v5
ds_read_b128 v[76:79],v3 offset:19456
buffer_load_dwordx4 v[16:19],v0,s[8:11],s32 offen sc1
v_smfmac_f32_16x16x64_bf16 v[84:87],v[20:23],a[120:127],v5
s_cbranch_vccnz ch0_retry4
ch0_ok4:
s_waitcnt vmcnt(6) lgkmcnt(2)
v_smfmac_f32_16x16x64_bf16 v[48:51],v[24:27],v[64:71],v5
ds_read_b128 v[64:67],v3 offset:20480
v_cmp_eq_u32_e64 vcc,-1,v28
v_smfmac_f32_16x16x64_bf16 v[56:59],v[24:27],a[128:135],v5
ds_read_b128 v[68:71],v3 offset:21504
buffer_load_dwordx4 v[20:23],v0,s[8:11],s32 offen offset:1024 sc1
v_smfmac_f32_16x16x64_bf16 v[52:55],v[24:27],a[136:143],v5
s_cbranch_vccnz ch0_retry5
ch0_ok5:
s_waitcnt vmcnt(6) lgkmcnt(2)
v_smfmac_f32_16x16x64_bf16 v[60:63],v[24:27],v[72:79],v5
ds_read_b128 v[72:75],v3 offset:22528
v_cmp_eq_u32_e64 vcc,-1,v32
v_smfmac_f32_16x16x64_bf16 v[48:51],v[28:31],a[144:151],v5
ds_read_b128 v[76:79],v3 offset:23552
s_barrier
v_smfmac_f32_16x16x64_bf16 v[56:59],v[28:31],a[152:159],v5
s_cbranch_vccnz ch0_retry6
ch0_ok6:
s_waitcnt vmcnt(5) lgkmcnt(2)
v_smfmac_f32_16x16x64_bf16 v[52:55],v[28:31],v[64:71],v5
ds_read_b128 v[64:67],v3 offset:24576
v_cmp_eq_u32 vcc,-1,v36
v_smfmac_f32_16x16x64_bf16 v[60:63],v[28:31],a[160:167],v5
ds_read_b128 v[68:71],v3 offset:25600
v_smfmac_f32_16x16x64_bf16 v[48:51],v[32:35],a[168:175],v5
s_cbranch_vccnz ch0_retry7
ch0_ok7:
s_waitcnt vmcnt(4) lgkmcnt(2)
v_smfmac_f32_16x16x64_bf16 v[56:59],v[32:35],v[72:79],v5
ds_read_b128 v[72:75],v3 offset:26624
v_cmp_eq_u32_e64 vcc,-1,v40
v_smfmac_f32_16x16x64_bf16 v[52:55],v[32:35],a[176:183],v5
ds_read_b128 v[76:79],v3 offset:27648
v_smfmac_f32_16x16x64_bf16 v[60:63],v[32:35],a[184:191],v5
s_cbranch_vccnz ch0_retry8
ch0_ok8:
s_waitcnt lgkmcnt(2)
v_smfmac_f32_16x16x64_bf16 v[48:51],v[36:39],v[64:71],v5
ds_read_b128 v[64:67],v3 offset:28672
v_smfmac_f32_16x16x64_bf16 v[52:55],v[36:39],a[192:199],v5
ds_read_b128 v[68:71],v3 offset:29696
v_smfmac_f32_16x16x64_bf16 v[48:51],v[40:43],a[200:207],v5
s_waitcnt lgkmcnt(2)
v_smfmac_f32_16x16x64_bf16 v[52:55],v[40:43],v[72:79],v5
v_smfmac_f32_16x16x64_bf16 v[56:59],v[36:39],a[208:215],v5
v_add_f32 v48,v48,v50
v_smfmac_f32_16x16x64_bf16 v[56:59],v[40:43],a[216:223],v5
s_waitcnt lgkmcnt(0)
v_add_f32 v49,v49,v51
v_smfmac_f32_16x16x64_bf16 v[60:63],v[36:39],v[64:71],v5
v_cvt_pk_bf16_f32 v50,v48,v49
v_smfmac_f32_16x16x64_bf16 v[60:63],v[40:43],a[224:231],v5
v_add_f32 v52,v52,v54
v_add_f32 v53,v53,v55
v_cvt_pk_bf16_f32 v54,v52,v53
v_add_f32 v56,v56,v58
v_add_f32 v57,v57,v59
v_cvt_pk_bf16_f32 v51,v56,v57
v_add_f32 v60,v60,v62
v_add_f32 v61,v61,v63
v_cvt_pk_bf16_f32 v55,v60,v61
ds_write2st64_b64 v1,v[50:51],v[54:55] offset0:8 offset1:9
v_smfmac_f32_16x16x64_bf16 v[80:83],v[24:27],a[232:239],v5
v_mov_b32_e64 v76,s18
v_smfmac_f32_16x16x64_bf16 v[84:87],v[24:27],a[240:247],v5
v_mov_b32 v77,s18
v_smfmac_f32_16x16x64_bf16 v[80:83],v[28:31],a[248:255],v5
v_mov_b32 v78,s18
v_smfmac_f32_16x16x64_bf16 v[84:87],v[28:31],v[88:95],v5
v_mov_b32 v79,s18
v_smfmac_f32_16x16x64_bf16 v[80:83],v[32:35],v[96:103],v5
v_mov_b32 v24,0
s_waitcnt lgkmcnt(0)
s_barrier
v_smfmac_f32_16x16x64_bf16 v[84:87],v[32:35],v[104:111],v5
ds_read_b64_tr_b16 v[48:49],v4 offset:4096
ds_read_b64_tr_b16 v[50:51],v4 offset:4608
v_smfmac_f32_16x16x64_bf16 v[80:83],v[36:39],v[112:119],v5
ds_read_b64_tr_b16 v[52:53],v4 offset:5120
ds_read_b64_tr_b16 v[54:55],v4 offset:5632
v_smfmac_f32_16x16x64_bf16 v[84:87],v[36:39],v[120:127],v5
ds_read_b64_tr_b16 v[56:57],v4 offset:6144
ds_read_b64_tr_b16 v[58:59],v4 offset:6656
v_smfmac_f32_16x16x64_bf16 v[80:83],v[40:43],v[128:135],v5
ds_read_b64_tr_b16 v[60:61],v4 offset:7168
ds_read_b64_tr_b16 v[62:63],v4 offset:7680
s_waitcnt lgkmcnt(6) vmcnt(2)
v_mfma_f32_16x16x32_bf16 v[64:67],v[44:47],v[48:51],0
s_waitcnt lgkmcnt(4)
v_mov_b32 v25,0
v_mfma_f32_16x16x32_bf16 v[68:71],v[44:47],v[52:55],0
s_waitcnt lgkmcnt(2)
v_mov_b32_e64 v26,0
v_mfma_f32_16x16x32_bf16 v[64:67],v[12:15],v[56:59],v[64:67]
s_waitcnt lgkmcnt(0)
v_mov_b32 v27,0
v_mfma_f32_16x16x32_bf16 v[68:71],v[12:15],v[60:63],v[68:71]
v_mov_b32_e64 v44,0
v_mfma_f32_16x16x32_bf16 v[72:75],v[48:51],v[48:51],0
v_mul_f32 v64,s42,v64
v_mul_f32 v65,s42,v65
v_mfma_f32_16x16x32_bf16 v[72:75],v[52:55],v[52:55],v[72:75]
v_fmac_f32 v64,s42,v70
v_fmac_f32 v65,s42,v71
v_exp_f32 v66,v64
v_exp_f32 v67,v65
s_mov_b64 exec,s[48:49]
v_cvt_pk_bf16_f32 v66,v66,v67
ds_write_b32 v9,v66 offset:512
s_mov_b64 exec,-1
v_mfma_f32_16x16x32_bf16 v[72:75],v[56:59],v[56:59],v[72:75]
v_mov_b32 v45,0
v_mov_b32 v46,0
v_mfma_f32_16x16x32_bf16 v[72:75],v[60:63],v[60:63],v[72:75]
v_mov_b32 v47,0
v_mov_b32 v12,0
v_mov_b32 v13,0
v_mov_b32 v14,0
v_mov_b32_e64 v15,0
v_mfma_f32_16x16x32_bf16 v[48:51],v[76:79],v[76:79],0
s_waitcnt lgkmcnt(0)
s_barrier
ds_read_b128 v[56:59],v9 offset:512
v_smfmac_f32_16x16x64_bf16 v[84:87],v[40:43],v[136:143],v5
v_mul_f32 v74,s42,v74
v_mul_f32 v75,s42,v75
v_exp_f32 v72,v74
v_exp_f32 v73,v75
v_mov_b32 v61,0
v_cvt_pk_bf16_f32 v72,v72,v73
v_mov_b32 v62,0
s_nop 0
v_mov_b32_dpp v60,v72 quad_perm:[0,1,0,1] row_mask:0xf bank_mask:0xf
s_waitcnt vmcnt(0) lgkmcnt(0)
v_mfma_f32_16x16x32_bf16 v[48:51],v[76:79],v[56:59],0
ds_read_b128 v[28:31],v3 offset:30720
v_mov_b32_dpp v63,v72 quad_perm:[0,1,0,1] row_mask:0xf bank_mask:0xf
v_add_f32_e64 v80,v80,v82
v_mfma_f32_16x16x32_bf16 v[52:55],v[16:19],v[56:59],0
ds_read_b128 v[32:35],v3 offset:31744
v_add_f32_e64 v81,v81,v83
v_cvt_pk_bf16_f32 v82,v80,v81
v_mfma_f32_16x16x32_bf16 v[68:71],v[20:23],v[56:59],0
ds_read_b128 v[36:39],v3 offset:32768
v_add_f32 v84,v84,v86
v_add_f32 v85,v85,v87
v_mfma_f32_16x16x16_bf16 v[48:51],v[76:77],v[60:61],v[48:51]
ds_read_b128 v[40:43],v3 offset:33792
v_cvt_pk_bf16_f32 v83,v84,v85
s_nop 1
v_mfma_f32_16x16x16_bf16 v[52:55],v[82:83],v[60:61],v[52:55]
v_mov_b32 v84,0
v_mov_b32 v85,0
v_mfma_f32_16x16x16_bf16 v[68:71],v[82:83],v[62:63],v[68:71]
v_rcp_f32 v66,v48
v_subrev_u32_e64 v67,s58,v48
v_cndmask_b32 v48,0,v66,s[48:49]
v_cndmask_b32 v50,0,v66,s[46:47]
v_mul_f32 v52,v52,v48
v_mul_f32 v53,v53,v48
v_mul_f32 v54,v54,v48
v_mul_f32 v55,v55,v48
v_cmp_lt_u32 vcc,0x3c000000,v67
v_pk_fma_f32 v[52:53],v[68:69],v[50:51],v[52:53] op_sel_hi:[1,0,1]
v_pk_fma_f32 v[54:55],v[70:71],v[50:51],v[54:55] op_sel_hi:[1,0,1]
v_cvt_pk_bf16_f32 v58,v52,v53
v_cvt_pk_bf16_f32 v59,v54,v55
v_mfma_f32_16x16x32_bf16 v[68:71],v[76:79],v[76:79],0
ds_write_b64 v10,v[58:59] offset:2048
s_cbranch_vccnz ch0_slowsm
ch0_smdone:
v_mov_b32_dpp v60,v58 quad_perm:[0,1,0,1] row_mask:0xf bank_mask:0xf
v_mov_b32_dpp v61,v59 quad_perm:[0,1,0,1] row_mask:0xf bank_mask:0xf
v_mov_b32_dpp v62,v58 quad_perm:[2,3,2,3] row_mask:0xf bank_mask:0xf
v_mov_b32_dpp v63,v59 quad_perm:[2,3,2,3] row_mask:0xf bank_mask:0xf
s_waitcnt lgkmcnt(1)
s_nop 0
v_mfma_f32_16x16x32_bf16 v[16:19],v[60:63],v[240:243],0
v_mov_b32 v86,0
v_mov_b32_e64 v87,0
v_smfmac_f32_16x16x64_bf16 v[44:47],v[60:63],v[28:35],v5
s_waitcnt lgkmcnt(0)
s_barrier
ds_read_b128 v[48:51],v9 offset:2560
ds_read_b128 v[52:55],v9 offset:3072
ds_read_b128 v[56:59],v9 offset:3584
v_smfmac_f32_16x16x64_bf16 v[12:15],v[60:63],v[36:43],v5
v_smfmac_f32_16x16x64_bf16 v[24:27],v[60:63],v[144:151],v5
v_smfmac_f32_16x16x64_bf16 v[84:87],v[60:63],v[152:159],v5
ds_read_b128 v[64:67],v3 offset:34816
s_waitcnt lgkmcnt(3)
v_smfmac_f32_16x16x64_bf16 v[44:47],v[48:51],v[160:167],v5
ds_read_b128 v[68:71],v3 offset:35840
s_waitcnt lgkmcnt(3)
v_smfmac_f32_16x16x64_bf16 v[44:47],v[52:55],v[168:175],v5
ds_read_b128 v[72:75],v3 offset:36864
s_waitcnt lgkmcnt(3)
v_smfmac_f32_16x16x64_bf16 v[44:47],v[56:59],v[176:183],v5
ds_read_b128 v[76:79],v3 offset:37888
v_smfmac_f32_16x16x64_bf16 v[12:15],v[48:51],v[184:191],v5
v_smfmac_f32_16x16x64_bf16 v[12:15],v[52:55],v[192:199],v5
v_cvt_pk_bf16_f32 v44,v44,v45
v_cvt_pk_bf16_f32 v45,v46,v47
v_and_or_b32 v44,v44,-2,s26
v_smfmac_f32_16x16x64_bf16 v[12:15],v[56:59],v[200:207],v5
buffer_store_dwordx2 v[44:45],v6,s[8:11],s34 offen
s_waitcnt lgkmcnt(2)
v_smfmac_f32_16x16x64_bf16 v[24:27],v[48:51],v[64:71],v5
v_smfmac_f32_16x16x64_bf16 v[24:27],v[52:55],v[208:215],v5
v_cvt_pk_bf16_f32 v12,v12,v13
v_cvt_pk_bf16_f32 v13,v14,v15
v_and_or_b32 v12,v12,-2,s26
v_smfmac_f32_16x16x64_bf16 v[24:27],v[56:59],v[216:223],v5
buffer_store_dwordx2 v[12:13],v6,s[8:11],s41 offen
s_waitcnt lgkmcnt(0)
v_smfmac_f32_16x16x64_bf16 v[84:87],v[48:51],v[72:79],v5
v_smfmac_f32_16x16x64_bf16 v[84:87],v[52:55],v[224:231],v5
v_cvt_pk_bf16_f32 v24,v24,v25
v_cvt_pk_bf16_f32 v25,v26,v27
v_and_or_b32 v24,v24,-2,s26
v_smfmac_f32_16x16x64_bf16 v[84:87],v[56:59],v[232:239],v5
buffer_store_dwordx2 v[24:25],v6,s[8:11],s35 offen
v_mfma_f32_16x16x32_bf16 v[16:19],v[48:51],v[244:247],v[16:19]
v_mfma_f32_16x16x32_bf16 v[16:19],v[52:55],v[248:251],v[16:19]
v_cvt_pk_bf16_f32 v26,v84,v85
v_cvt_pk_bf16_f32 v27,v86,v87
v_and_or_b32 v26,v26,-2,s26
v_mfma_f32_16x16x32_bf16 v[16:19],v[56:59],v[252:255],v[16:19]
buffer_store_dwordx2 v[26:27],v6,s[8:11],s44 offen
ds_read_b128 v[64:67],v3
ds_read_b128 v[68:71],v3 offset:1024
ds_read_b128 v[72:75],v3 offset:2048
ds_read_b128 v[76:79],v3 offset:3072
s_nop 2
v_cvt_pk_bf16_f32 v16,v16,v17
v_and_or_b32 v16,v16,-2,s26
buffer_store_dword v16,v2,s[8:11],s36 offen
v_mov_b32 v48,0
s_add_u32 s20,s20,2
v_mov_b32 v49,0
s_add_u32 s25,s25,1
v_mov_b32 v50,0
s_add_u32 s32,s32,16384
v_mov_b32 v51,0
s_add_u32 s56,s56,16384
v_mov_b32 v52,0
s_add_u32 s27,s27,0x4000
v_mov_b32 v53,0
s_add_u32 s28,s28,0x4000
v_mov_b32_e64 v54,0
s_add_u32 s29,s29,0x4000
v_mov_b32 v55,0
s_add_u32 s45,s45,0x4000
v_mov_b32 v56,0
s_nop 0
v_mov_b32 v57,0
s_nop 0
v_mov_b32 v58,0
s_nop 0
v_mov_b32 v59,0
s_nop 0
v_mov_b32 v60,0
s_nop 0
v_mov_b32 v61,0
s_nop 0
v_mov_b32 v62,0
s_nop 0
v_mov_b32 v63,0
s_nop 0
v_mov_b32 v21,0
v_mov_b32 v80,0
s_nop 0
v_mov_b32 v81,0
s_nop 0
v_mov_b32 v82,0
s_nop 0
v_mov_b32 v83,0
s_nop 0
v_mov_b32 v84,0
s_nop 0
v_mov_b32 v85,0
s_nop 0
v_mov_b32 v86,0
s_nop 0
v_mov_b32 v87,0
s_nop 0
v_mov_b32 v5,v5
s_nop 3
v_mov_b32 v5,v5
s_nop 3
v_mov_b32 v5,v5
s_nop 3
v_mov_b32 v5,v5
s_nop 3
v_mov_b32 v5,v5
s_nop 3
v_mov_b32 v5,v5
s_nop 3
v_mov_b32 v5,v5
s_nop 3
v_mov_b32 v5,v5
s_nop 3
v_mov_b32 v5,v5
s_nop 3
v_mov_b32 v5,v5
s_nop 3
v_mov_b32 v5,v5
s_nop 3
v_mov_b32 v5,v5
s_nop 3
v_mov_b32 v5,v5
s_nop 3
v_mov_b32 v5,v5
s_nop 3
v_mov_b32 v5,v5
s_nop 3
v_mov_b32 v5,v5
s_nop 3
v_mov_b32 v5,v5
s_nop 3
v_mov_b32 v5,v5
s_nop 3
v_mov_b32 v5,v5
s_nop 3
v_mov_b32 v5,v5
s_nop 3
v_mov_b32 v5,v5
s_nop 0
ch0_hpoll:
v_cmp_gt_u32 vcc,s20,v21
v_cmp_ne_u32 s[16:17],s20,v21
buffer_load_dword v21,v11,s[8:11],s59 offen sc1
s_cbranch_vccz ch0_hseen
v_cmp_gt_u32 vcc,s20,v21
v_cmp_ne_u32 s[16:17],s20,v21
buffer_load_dword v21,v11,s[8:11],s59 offen sc1
s_cbranch_vccz ch0_hseen
v_cmp_gt_u32 vcc,s20,v21
v_cmp_ne_u32 s[16:17],s20,v21
buffer_load_dword v21,v11,s[8:11],s59 offen sc1
s_cbranch_vccz ch0_hseen
v_cmp_gt_u32 vcc,s20,v21
v_cmp_ne_u32 s[16:17],s20,v21
buffer_load_dword v21,v11,s[8:11],s59 offen sc1
s_add_u32 s38,s38,1
s_cmp_gt_u32 s38,2000000
s_cbranch_vccz ch0_hseen
s_cbranch_scc0 ch0_hpoll
s_branch ch0_fail
ch0_hslow:
ds_write_b32 v7,v48
s_waitcnt lgkmcnt(0)
s_branch ch0_hok
ch0_hseen:
ch0_hok:
s_barrier
buffer_load_dwordx4 v[44:47],v0,s[8:11],s27 offen
v_mov_b32 v5,v5
s_nop 3
buffer_load_dwordx4 v[12:15],v0,s[8:11],s27 offen offset:1024
v_mov_b32 v5,v5
s_nop 3
v_mov_b32 v5,v5
s_nop 2
buffer_load_dwordx4 v[16:19],v0,s[8:11],s28 offen
v_mov_b32 v5,v5
s_nop 3
v_mov_b32 v5,v5
s_nop 2
buffer_load_dwordx4 v[20:23],v0,s[8:11],s28 offen offset:1024
s_xor_b32 s26,s26,1
s_cmp_eq_u32 s25,63
s_cbranch_scc1 ch0_done
s_branch ch0_top
ch0_slowsm:
s_mov_b64 exec,s[48:49]
ds_write_b64 v9,v[64:65] offset:4096
s_mov_b64 exec,-1
s_waitcnt lgkmcnt(0)
s_barrier
ds_read_b128 v[48:51],v9 offset:4096
ds_read_b128 v[52:55],v9 offset:4608
v_mov_b32_dpp v72,v74 quad_perm:[0,1,0,1] row_mask:0xf bank_mask:0xf
v_mov_b32_dpp v73,v75 quad_perm:[0,1,0,1] row_mask:0xf bank_mask:0xf
s_waitcnt lgkmcnt(0)
v_max_f32 v68,v48,v49
v_max3_f32 v68,v68,v50,v51
v_max3_f32 v68,v68,v52,v53
v_max3_f32 v68,v68,v54,v55
v_max3_f32 v68,v68,v72,v73
v_mov_b32 v69,v68
s_nop 1
v_permlane16_swap_b32 v68,v69
v_max_f32 v68,v68,v69
v_mov_b32 v69,v68
s_nop 1
v_permlane32_swap_b32 v68,v69
v_max_f32 v68,v68,v69
v_sub_f32 v48,v48,v68
v_exp_f32 v48,v48
v_sub_f32 v49,v49,v68
v_exp_f32 v49,v49
v_sub_f32 v50,v50,v68
v_exp_f32 v50,v50
v_sub_f32 v51,v51,v68
v_exp_f32 v51,v51
v_sub_f32 v52,v52,v68
v_exp_f32 v52,v52
v_sub_f32 v53,v53,v68
v_exp_f32 v53,v53
v_sub_f32 v54,v54,v68
v_exp_f32 v54,v54
v_sub_f32 v55,v55,v68
v_exp_f32 v55,v55
v_sub_f32 v72,v72,v68
v_exp_f32 v72,v72
v_sub_f32 v73,v73,v68
v_exp_f32 v73,v73
v_cvt_pk_bf16_f32 v56,v48,v49
v_cvt_pk_bf16_f32 v57,v50,v51
v_cvt_pk_bf16_f32 v58,v52,v53
v_cvt_pk_bf16_f32 v59,v54,v55
v_cvt_pk_bf16_f32 v60,v72,v73
v_cvt_pk_bf16_f32 v63,v72,v73
v_mfma_f32_16x16x32_bf16 v[48:51],v[76:79],v[56:59],0
v_mfma_f32_16x16x32_bf16 v[52:55],v[16:19],v[56:59],0
v_mfma_f32_16x16x32_bf16 v[68:71],v[20:23],v[56:59],0
v_mfma_f32_16x16x16_bf16 v[48:51],v[76:77],v[60:61],v[48:51]
v_mfma_f32_16x16x16_bf16 v[52:55],v[82:83],v[60:61],v[52:55]
v_mfma_f32_16x16x16_bf16 v[68:71],v[82:83],v[62:63],v[68:71]
v_rcp_f32 v66,v48
s_nop 0
v_cndmask_b32 v48,0,v66,s[48:49]
v_cndmask_b32 v50,0,v66,s[46:47]
v_mul_f32 v52,v52,v48
v_mul_f32 v53,v53,v48
v_mul_f32 v54,v54,v48
v_mul_f32 v55,v55,v48
v_pk_fma_f32 v[52:53],v[68:69],v[50:51],v[52:53] op_sel_hi:[1,0,1]
v_pk_fma_f32 v[54:55],v[70:71],v[50:51],v[54:55] op_sel_hi:[1,0,1]
v_cvt_pk_bf16_f32 v58,v52,v53
v_cvt_pk_bf16_f32 v59,v54,v55
v_mfma_f32_16x16x32_bf16 v[68:71],v[76:79],v[76:79],0
ds_write_b64 v10,v[58:59] offset:2048
s_branch ch0_smdone
ch0_retry0:
buffer_load_dwordx4 v[44:47],v0,s[8:11],s27 offen sc1
buffer_load_dwordx4 v[12:15],v0,s[8:11],s27 offen offset:1024 sc1
buffer_load_dwordx4 v[16:19],v0,s[8:11],s28 offen sc1
buffer_load_dwordx4 v[20:23],v0,s[8:11],s28 offen offset:1024 sc1
s_add_u32 s38,s38,1
s_cmp_gt_u32 s38,2000000
s_cbranch_scc1 ch0_fail
s_waitcnt vmcnt(0)
v_cmp_eq_u32_e64 vcc,-1,v44
s_cbranch_vccnz ch0_retry0
s_branch ch0_ok0
ch0_retry1:
buffer_load_dwordx4 v[12:15],v0,s[8:11],s27 offen offset:1024 sc1
buffer_load_dwordx4 v[16:19],v0,s[8:11],s28 offen sc1
buffer_load_dwordx4 v[20:23],v0,s[8:11],s28 offen offset:1024 sc1
buffer_load_dwordx4 v[24:27],v0,s[8:11],s28 offen offset:2048 sc1
buffer_load_dwordx4 v[28:31],v0,s[8:11],s28 offen offset:3072 sc1
s_add_u32 s38,s38,1
s_cmp_gt_u32 s38,2000000
s_cbranch_scc1 ch0_fail
s_waitcnt vmcnt(0)
v_cmp_eq_u32 vcc,-1,v12
s_cbranch_vccnz ch0_retry1
s_branch ch0_ok1
ch0_retry2:
buffer_load_dwordx4 v[16:19],v0,s[8:11],s28 offen sc1
buffer_load_dwordx4 v[20:23],v0,s[8:11],s28 offen offset:1024 sc1
buffer_load_dwordx4 v[24:27],v0,s[8:11],s28 offen offset:2048 sc1
buffer_load_dwordx4 v[28:31],v0,s[8:11],s28 offen offset:3072 sc1
buffer_load_dwordx4 v[32:35],v0,s[8:11],s29 offen sc1
buffer_load_dwordx4 v[36:39],v0,s[8:11],s29 offen offset:1024 sc1
s_add_u32 s38,s38,1
s_cmp_gt_u32 s38,2000000
s_cbranch_scc1 ch0_fail
s_waitcnt vmcnt(0)
v_cmp_eq_u32 vcc,-1,v16
s_cbranch_vccnz ch0_retry2
s_branch ch0_ok2
ch0_retry3:
buffer_load_dwordx4 v[20:23],v0,s[8:11],s28 offen offset:1024 sc1
buffer_load_dwordx4 v[24:27],v0,s[8:11],s28 offen offset:2048 sc1
buffer_load_dwordx4 v[28:31],v0,s[8:11],s28 offen offset:3072 sc1
buffer_load_dwordx4 v[32:35],v0,s[8:11],s29 offen sc1
buffer_load_dwordx4 v[36:39],v0,s[8:11],s29 offen offset:1024 sc1
buffer_load_dwordx4 v[40:43],v0,s[8:11],s29 offen offset:2048 sc1
s_add_u32 s38,s38,1
s_cmp_gt_u32 s38,2000000
s_cbranch_scc1 ch0_fail
s_waitcnt vmcnt(0)
v_cmp_eq_u32 vcc,-1,v20
s_cbranch_vccnz ch0_retry3
s_branch ch0_ok3
ch0_retry4:
buffer_load_dwordx4 v[24:27],v0,s[8:11],s28 offen offset:2048 sc1
buffer_load_dwordx4 v[28:31],v0,s[8:11],s28 offen offset:3072 sc1
buffer_load_dwordx4 v[32:35],v0,s[8:11],s29 offen sc1
buffer_load_dwordx4 v[36:39],v0,s[8:11],s29 offen offset:1024 sc1
buffer_load_dwordx4 v[40:43],v0,s[8:11],s29 offen offset:2048 sc1
s_add_u32 s38,s38,1
s_cmp_gt_u32 s38,2000000
s_cbranch_scc1 ch0_fail
s_waitcnt vmcnt(0)
v_cmp_eq_u32 vcc,-1,v24
s_cbranch_vccnz ch0_retry4
s_branch ch0_ok4
ch0_retry5:
buffer_load_dwordx4 v[28:31],v0,s[8:11],s28 offen offset:3072 sc1
buffer_load_dwordx4 v[32:35],v0,s[8:11],s29 offen sc1
buffer_load_dwordx4 v[36:39],v0,s[8:11],s29 offen offset:1024 sc1
buffer_load_dwordx4 v[40:43],v0,s[8:11],s29 offen offset:2048 sc1
s_add_u32 s38,s38,1
s_cmp_gt_u32 s38,2000000
s_cbranch_scc1 ch0_fail
s_waitcnt vmcnt(0)
v_cmp_eq_u32 vcc,-1,v28
s_cbranch_vccnz ch0_retry5
s_branch ch0_ok5
ch0_retry6:
buffer_load_dwordx4 v[32:35],v0,s[8:11],s29 offen sc1
buffer_load_dwordx4 v[36:39],v0,s[8:11],s29 offen offset:1024 sc1
buffer_load_dwordx4 v[40:43],v0,s[8:11],s29 offen offset:2048 sc1
s_add_u32 s38,s38,1
s_cmp_gt_u32 s38,2000000
s_cbranch_scc1 ch0_fail
s_waitcnt vmcnt(0)
v_cmp_eq_u32 vcc,-1,v32
s_cbranch_vccnz ch0_retry6
s_branch ch0_ok6
ch0_retry7:
buffer_load_dwordx4 v[36:39],v0,s[8:11],s29 offen offset:1024 sc1
buffer_load_dwordx4 v[40:43],v0,s[8:11],s29 offen offset:2048 sc1
s_add_u32 s38,s38,1
s_cmp_gt_u32 s38,2000000
s_cbranch_scc1 ch0_fail
s_waitcnt vmcnt(0)
v_cmp_eq_u32 vcc,-1,v36
s_cbranch_vccnz ch0_retry7
s_branch ch0_ok7
ch0_retry8:
buffer_load_dwordx4 v[40:43],v0,s[8:11],s29 offen offset:2048 sc1
s_add_u32 s38,s38,1
s_cmp_gt_u32 s38,2000000
s_cbranch_scc1 ch0_fail
s_waitcnt vmcnt(0)
v_cmp_eq_u32_e64 vcc,-1,v40
s_cbranch_vccnz ch0_retry8
s_branch ch0_ok8
ch0_done:
s_waitcnt vmcnt(0) lgkmcnt(0)
s_cmp_lg_u32 s52,0
s_cbranch_scc1 c_join
s_mov_b32 s52,16777216
s_mov_b32 s23,1
s_add_u32 s27,s27,0x4000
s_add_u32 s28,s28,0x4000
s_add_u32 s29,s29,0x4000
s_add_u32 s45,s45,0x4000
v_lshrrev_b32 v18,4,v0
s_waitcnt vmcnt(0)
s_mov_b32 s63,6308092
v_mov_b32 v12,0
ch0_idle:
s_sleep 16
buffer_load_dword v13,v12,s[8:11],s63 offen sc1
s_add_u32 s38,s38,1
s_cmp_gt_u32 s38,2000000
s_cbranch_scc1 ch0_fail
s_waitcnt vmcnt(0)
v_cmp_eq_u32 vcc,0,v13
s_cbranch_vccnz ch0_idle
s_branch ch0_layer
ch0_fail:
s_waitcnt vmcnt(0) lgkmcnt(0)
s_endpgm
c_w1:
v_mov_b32 v10,v0
v_and_b32 v11,15,v10
v_lshrrev_b32 v12,4,v10
v_lshlrev_b32 v13,4,v10
v_add_u32 v3,47104,v13
v_add_u32 v0,0,v13
v_lshlrev_b32 v13,3,v10
v_lshrrev_b32 v14,5,v10
v_lshlrev_b32 v14,6,v14
v_xor_b32 v1,v14,v13
v_lshlrev_b32 v13,2,v11
v_lshl_add_u32 v2,v12,11,v13
v_and_b32 v13,3,v10
v_lshrrev_b32 v14,2,v10
v_lshlrev_b32 v15,7,v13
v_lshl_add_u32 v15,v14,3,v15
v_lshrrev_b32 v16,1,v13
v_lshlrev_b32 v16,6,v16
v_xor_b32 v4,v16,v15
v_and_b32 v15,1,v10
v_lshlrev_b32_e64 v15,4,v15
v_lshl_add_u32 v9,v14,5,v15
s_mov_b32 s46,0xcccccccc
s_mov_b32 s47,0xcccccccc
s_mov_b32 s48,0x33333333
s_mov_b32 s49,0x33333333
v_mov_b32 v15,0x4444
v_mov_b32 v16,0xeeee
v_cndmask_b32 v5,v15,v16,s[46:47]
v_lshrrev_b32_e64 v15,3,v11
v_lshl_add_u32 v15,v15,2,v12
v_lshlrev_b32 v15,11,v15
v_and_b32 v17,7,v11
v_lshl_add_u32 v6,v17,3,v15
v_and_b32 v15,2,v11
v_lshrrev_b32 v16,1,v12
v_add_u32 v15,v15,v16
v_lshlrev_b32 v15,4,v15
v_and_b32 v16,1,v11
v_and_b32 v17,1,v12
v_lshl_add_u32 v16,v16,1,v17
v_lshl_add_u32 v7,v16,2,v15
v_lshrrev_b32 v17,4,v10
v_and_b32 v18,15,v10
v_lshlrev_b32 v16,1,v17
v_xor_b32 v16,v16,v18
v_lshlrev_b32 v16,4,v16
v_bfe_u32 v18,v10,2,3
v_lshlrev_b32 v18,1,v18
v_bfe_u32 v245,v10,1,1
v_add_u32 v245,4,v245
v_xor_b32 v245,v245,v18
v_lshlrev_b32 v245,4,v245
v_and_b32 v18,1,v10
v_lshl_add_u32 v245,v18,3,v245
v_bfe_u32 v18,v10,2,2
v_lshl_add_u32 v17,v17,3,v18
v_lshl_add_u32 v244,v17,8,v245
v_xor_b32_e64 v245,32,v244
v_bfe_u32 v17,v10,4,1
v_lshrrev_b32 v18,5,v10
v_lshlrev_b32 v19,2,v18
v_lshl_add_u32 v19,v17,4,v19
v_lshl_add_u32 v240,v19,13,v16
v_xor_b32 v241,0x80,v240
v_lshl_add_u32 v19,v18,3,v17
v_lshl_add_u32 v242,v19,13,v16
v_xor_b32 v243,0x80,v242
v_lshrrev_b32 v84,5,v10
v_and_b32 v85,31,v10
v_lshlrev_b32 v86,2,v84
v_xor_b32 v85,v85,v86
v_xor_b32_e64 v85,0,v85
v_mul_u32_u24 v84,1152,v84
v_lshl_add_u32 v11,v85,4,v84
v_lshrrev_b32 v84,3,v10
v_mul_u32_u24 v84,1152,v84
v_and_b32 v85,7,v10
v_lshl_add_u32 v12,v85,4,v84
v_bfe_u32 v84,v10,2,1
v_bfe_u32 v85,v10,4,1
v_lshl_add_u32 v86,v85,1,v84
v_xor_b32 v86,1,v86
v_lshlrev_b32 v86,6,v86
v_bfe_u32 v87,v10,3,1
v_lshl_add_u32 v86,v87,5,v86
v_and_b32_e64 v87,3,v10
v_lshl_add_u32 v86,v87,3,v86
v_lshl_add_u32 v84,v85,4,v84
v_lshrrev_b32 v85,5,v10
v_lshl_add_u32 v84,v85,2,v84
v_lshl_add_u32 v13,v84,9,v86
v_lshrrev_b32 v84,2,v10
v_lshlrev_b32 v84,7,v84
v_lshl_add_u32 v84,v87,3,v84
v_add_u32 v14,32,v84
s_lshl_b32 s56,s24,8
s_mul_i32 s32,s24,147456
s_barrier
s_add_u32 s60,s56,65536
s_mov_b32 m0,34816
s_nop 0
buffer_load_dwordx4 v240,s[80:83],s60 offen lds
s_add_u32 s60,s56,73728
s_mov_b32 m0,35840
s_nop 0
buffer_load_dwordx4 v240,s[80:83],s60 offen lds
s_add_u32 s60,s56,81920
s_mov_b32 m0,36864
s_nop 0
buffer_load_dwordx4 v241,s[80:83],s60 offen lds
s_add_u32 s60,s56,90112
s_mov_b32 m0,37888
s_nop 0
buffer_load_dwordx4 v241,s[80:83],s60 offen lds
s_add_u32 s60,s56,589824
s_mov_b32 m0,73728
s_nop 0
buffer_load_dwordx4 v240,s[80:83],s60 offen lds
s_add_u32 s60,s56,598016
s_mov_b32 m0,74752
s_nop 0
buffer_load_dwordx4 v240,s[80:83],s60 offen lds
s_add_u32 s60,s56,606208
s_mov_b32 m0,75776
s_nop 0
buffer_load_dwordx4 v241,s[80:83],s60 offen lds
s_add_u32 s60,s56,614400
s_mov_b32 m0,76800
s_nop 0
buffer_load_dwordx4 v241,s[80:83],s60 offen lds
s_add_u32 s60,s56,1114112
s_mov_b32 m0,112640
s_nop 0
buffer_load_dwordx4 v240,s[80:83],s60 offen lds
s_add_u32 s60,s56,1122304
s_mov_b32 m0,113664
s_nop 0
buffer_load_dwordx4 v240,s[80:83],s60 offen lds
s_add_u32 s60,s56,1130496
s_mov_b32 m0,114688
s_nop 0
buffer_load_dwordx4 v241,s[80:83],s60 offen lds
s_add_u32 s60,s56,1138688
s_mov_b32 m0,115712
s_nop 0
buffer_load_dwordx4 v241,s[80:83],s60 offen lds
s_waitcnt vmcnt(8) lgkmcnt(0)
s_barrier
s_add_u32 s60,s56,1638400
s_mov_b32 m0,151552
s_nop 0
buffer_load_dwordx4 v240,s[80:83],s60 offen lds
s_add_u32 s60,s56,1646592
s_mov_b32 m0,152576
s_nop 0
buffer_load_dwordx4 v240,s[80:83],s60 offen lds
s_add_u32 s60,s56,1654784
s_mov_b32 m0,153600
s_nop 0
buffer_load_dwordx4 v241,s[80:83],s60 offen lds
s_add_u32 s60,s56,1662976
s_mov_b32 m0,154624
s_nop 0
buffer_load_dwordx4 v241,s[80:83],s60 offen lds
v_add_u32 v15,30720,v244
ds_read_b64_tr_b16 a[0:1],v15
ds_read_b64_tr_b16 a[2:3],v15 offset:1024
ds_read_b64_tr_b16 a[4:5],v15 offset:8192
ds_read_b64_tr_b16 a[6:7],v15 offset:9216
v_add_u32 v246,30720,v245
ds_read_b64_tr_b16 v[80:81],v246
ds_read_b64_tr_b16 v[82:83],v246 offset:1024
ds_read_b64_tr_b16 v[84:85],v246 offset:8192
ds_read_b64_tr_b16 v[86:87],v246 offset:9216
s_waitcnt lgkmcnt(0)
ds_write_b128 v3,v[80:83] offset:2048
ds_write_b128 v3,v[84:87] offset:3072
s_waitcnt vmcnt(8) lgkmcnt(0)
s_barrier
s_add_u32 s60,s56,2162688
s_mov_b32 m0,34816
s_nop 0
buffer_load_dwordx4 v240,s[80:83],s60 offen lds
s_add_u32 s60,s56,2170880
s_mov_b32 m0,35840
s_nop 0
buffer_load_dwordx4 v240,s[80:83],s60 offen lds
s_add_u32 s60,s56,2179072
s_mov_b32 m0,36864
s_nop 0
buffer_load_dwordx4 v241,s[80:83],s60 offen lds
s_add_u32 s60,s56,2187264
s_mov_b32 m0,37888
s_nop 0
buffer_load_dwordx4 v241,s[80:83],s60 offen lds
v_add_u32 v15,69632,v244
ds_read_b64_tr_b16 a[32:33],v15
ds_read_b64_tr_b16 a[34:35],v15 offset:1024
ds_read_b64_tr_b16 a[36:37],v15 offset:8192
ds_read_b64_tr_b16 a[38:39],v15 offset:9216
v_add_u32 v246,69632,v245
ds_read_b64_tr_b16 v[80:81],v246
ds_read_b64_tr_b16 v[82:83],v246 offset:1024
ds_read_b64_tr_b16 v[84:85],v246 offset:8192
ds_read_b64_tr_b16 v[86:87],v246 offset:9216
s_waitcnt lgkmcnt(0)
ds_write_b128 v3,v[80:83] offset:6144
ds_write_b128 v3,v[84:87] offset:7168
s_waitcnt vmcnt(8) lgkmcnt(0)
s_barrier
s_add_u32 s60,s56,2686976
s_mov_b32 m0,73728
s_nop 0
buffer_load_dwordx4 v240,s[80:83],s60 offen lds
s_add_u32 s60,s56,2695168
s_mov_b32 m0,74752
s_nop 0
buffer_load_dwordx4 v240,s[80:83],s60 offen lds
s_add_u32 s60,s56,2703360
s_mov_b32 m0,75776
s_nop 0
buffer_load_dwordx4 v241,s[80:83],s60 offen lds
s_add_u32 s60,s56,2711552
s_mov_b32 m0,76800
s_nop 0
buffer_load_dwordx4 v241,s[80:83],s60 offen lds
v_add_u32 v15,108544,v244
ds_read_b64_tr_b16 a[64:65],v15
ds_read_b64_tr_b16 a[66:67],v15 offset:1024
ds_read_b64_tr_b16 a[68:69],v15 offset:8192
ds_read_b64_tr_b16 a[70:71],v15 offset:9216
v_add_u32 v246,108544,v245
ds_read_b64_tr_b16 v[80:81],v246
ds_read_b64_tr_b16 v[82:83],v246 offset:1024
ds_read_b64_tr_b16 v[84:85],v246 offset:8192
ds_read_b64_tr_b16 v[86:87],v246 offset:9216
s_waitcnt lgkmcnt(0)
ds_write_b128 v3,v[80:83] offset:10240
ds_write_b128 v3,v[84:87] offset:11264
s_nop 0
s_barrier
s_cmp_eq_u32 s21,0
s_cbranch_scc0 ann_77
v_mov_b32 v40,s2
v_mov_b32 v41,s3
s_mov_b64 exec,1
global_store_byte v40,v41,s[4:5] sc1
s_mov_b64 exec,-1
ann_77:
s_waitcnt vmcnt(8) lgkmcnt(0)
s_barrier
s_add_u32 s60,s56,3211264
s_mov_b32 m0,112640
s_nop 0
buffer_load_dwordx4 v240,s[80:83],s60 offen lds
s_add_u32 s60,s56,3219456
s_mov_b32 m0,113664
s_nop 0
buffer_load_dwordx4 v240,s[80:83],s60 offen lds
s_add_u32 s60,s56,3227648
s_mov_b32 m0,114688
s_nop 0
buffer_load_dwordx4 v241,s[80:83],s60 offen lds
s_add_u32 s60,s56,3235840
s_mov_b32 m0,115712
s_nop 0
buffer_load_dwordx4 v241,s[80:83],s60 offen lds
v_add_u32 v15,147456,v244
ds_read_b64_tr_b16 a[96:97],v15
ds_read_b64_tr_b16 a[98:99],v15 offset:1024
ds_read_b64_tr_b16 a[100:101],v15 offset:8192
ds_read_b64_tr_b16 a[102:103],v15 offset:9216
v_add_u32 v246,147456,v245
ds_read_b64_tr_b16 v[80:81],v246
ds_read_b64_tr_b16 v[82:83],v246 offset:1024
ds_read_b64_tr_b16 v[84:85],v246 offset:8192
ds_read_b64_tr_b16 v[86:87],v246 offset:9216
s_waitcnt lgkmcnt(0)
ds_write_b128 v3,v[80:83] offset:14336
ds_write_b128 v3,v[84:87] offset:15360
s_waitcnt vmcnt(8) lgkmcnt(0)
s_barrier
s_add_u32 s60,s56,3735552
s_mov_b32 m0,151552
s_nop 0
buffer_load_dwordx4 v240,s[80:83],s60 offen lds
s_add_u32 s60,s56,3743744
s_mov_b32 m0,152576
s_nop 0
buffer_load_dwordx4 v240,s[80:83],s60 offen lds
s_add_u32 s60,s56,3751936
s_mov_b32 m0,153600
s_nop 0
buffer_load_dwordx4 v241,s[80:83],s60 offen lds
s_add_u32 s60,s56,3760128
s_mov_b32 m0,154624
s_nop 0
buffer_load_dwordx4 v241,s[80:83],s60 offen lds
v_add_u32 v15,30720,v244
ds_read_b64_tr_b16 a[128:129],v15
ds_read_b64_tr_b16 a[130:131],v15 offset:1024
ds_read_b64_tr_b16 a[132:133],v15 offset:8192
ds_read_b64_tr_b16 a[134:135],v15 offset:9216
v_add_u32 v246,30720,v245
ds_read_b64_tr_b16 v[80:81],v246
ds_read_b64_tr_b16 v[82:83],v246 offset:1024
ds_read_b64_tr_b16 v[84:85],v246 offset:8192
ds_read_b64_tr_b16 v[86:87],v246 offset:9216
s_waitcnt lgkmcnt(0)
ds_write_b128 v3,v[80:83] offset:18432
ds_write_b128 v3,v[84:87] offset:19456
s_waitcnt vmcnt(8) lgkmcnt(0)
s_barrier
s_add_u32 s60,s56,4325376
s_mov_b32 m0,34816
s_nop 0
buffer_load_dwordx4 v242,s[80:83],s60 offen lds
s_add_u32 s60,s56,4341760
s_mov_b32 m0,35840
s_nop 0
buffer_load_dwordx4 v242,s[80:83],s60 offen lds
s_add_u32 s60,s56,4358144
s_mov_b32 m0,36864
s_nop 0
buffer_load_dwordx4 v243,s[80:83],s60 offen lds
s_add_u32 s60,s56,4374528
s_mov_b32 m0,37888
s_nop 0
buffer_load_dwordx4 v243,s[80:83],s60 offen lds
v_add_u32 v15,69632,v244
ds_read_b64_tr_b16 a[152:153],v15
ds_read_b64_tr_b16 a[154:155],v15 offset:1024
ds_read_b64_tr_b16 a[156:157],v15 offset:8192
ds_read_b64_tr_b16 a[158:159],v15 offset:9216
v_add_u32 v246,69632,v245
ds_read_b64_tr_b16 a[160:161],v246
ds_read_b64_tr_b16 a[162:163],v246 offset:1024
ds_read_b64_tr_b16 a[164:165],v246 offset:8192
ds_read_b64_tr_b16 a[166:167],v246 offset:9216
s_waitcnt vmcnt(8) lgkmcnt(0)
s_barrier
s_add_u32 s60,s56,65536
s_mov_b32 m0,73728
s_nop 0
buffer_load_dwordx4 v240,s[76:79],s60 offen lds
s_add_u32 s60,s56,73728
s_mov_b32 m0,74752
s_nop 0
buffer_load_dwordx4 v240,s[76:79],s60 offen lds
s_add_u32 s60,s56,81920
s_mov_b32 m0,75776
s_nop 0
buffer_load_dwordx4 v241,s[76:79],s60 offen lds
s_add_u32 s60,s56,90112
s_mov_b32 m0,76800
s_nop 0
buffer_load_dwordx4 v241,s[76:79],s60 offen lds
v_add_u32 v15,108544,v244
ds_read_b64_tr_b16 v[64:65],v15
ds_read_b64_tr_b16 v[66:67],v15 offset:1024
ds_read_b64_tr_b16 v[68:69],v15 offset:8192
ds_read_b64_tr_b16 v[70:71],v15 offset:9216
v_add_u32 v246,108544,v245
ds_read_b64_tr_b16 a[184:185],v246
ds_read_b64_tr_b16 a[186:187],v246 offset:1024
ds_read_b64_tr_b16 a[188:189],v246 offset:8192
ds_read_b64_tr_b16 a[190:191],v246 offset:9216
v_lshlrev_b32 v40,2,v10
global_load_dword v41,v40,s[4:5] sc1
v_and_b32 v28,3,v10
v_bfe_u32 v30,v10,4,1
v_lshrrev_b32 v29,5,v10
v_mul_u32_u24 v29,1152,v29
v_lshl_add_u32 v28,v28,1,v30
v_lshl_add_u32 v29,v28,1,v29
s_and_b32 s39,s24,3
s_mul_i32 s39,s39,2304
s_lshr_b32 s40,s24,3
s_lshl_b32 s40,s40,6
s_add_u32 s39,s39,s40
s_bfe_u32 s40,s24,0x10002
s_lshl_b32 s40,s40,4
s_add_u32 s39,s39,s40
buffer_load_ushort v31,v29,s[12:15],s39 offen
buffer_load_ushort v32,v29,s[12:15],s39 offen offset:32
v_and_b32 v28,3,v10
v_bfe_u32 v30,v10,4,1
v_lshrrev_b32 v29,5,v10
v_mul_u32_u24 v29,1152,v29
v_lshl_add_u32 v28,v28,1,v30
v_lshl_add_u32 v29,v28,1,v29
s_and_b32 s39,s24,3
s_mul_i32 s39,s39,2304
s_lshr_b32 s40,s24,3
s_lshl_b32 s40,s40,6
s_add_u32 s39,s39,s40
s_bfe_u32 s40,s24,0x10002
s_lshl_b32 s40,s40,4
s_add_u32 s39,s39,s40
buffer_load_ushort v33,v29,s[12:15],s39 offen offset:768
buffer_load_ushort v34,v29,s[12:15],s39 offen offset:800
s_waitcnt vmcnt(8) lgkmcnt(0)
s_barrier
s_add_u32 s60,s56,589824
s_mov_b32 m0,112640
s_nop 0
buffer_load_dwordx4 v240,s[76:79],s60 offen lds
s_add_u32 s60,s56,598016
s_mov_b32 m0,113664
s_nop 0
buffer_load_dwordx4 v240,s[76:79],s60 offen lds
s_add_u32 s60,s56,606208
s_mov_b32 m0,114688
s_nop 0
buffer_load_dwordx4 v241,s[76:79],s60 offen lds
s_add_u32 s60,s56,614400
s_mov_b32 m0,115712
s_nop 0
buffer_load_dwordx4 v241,s[76:79],s60 offen lds
v_add_u32 v15,147456,v244
ds_read_b64_tr_b16 a[208:209],v15
ds_read_b64_tr_b16 a[210:211],v15 offset:1024
ds_read_b64_tr_b16 a[212:213],v15 offset:8192
ds_read_b64_tr_b16 a[214:215],v15 offset:9216
v_add_u32 v246,147456,v245
ds_read_b64_tr_b16 v[72:73],v246
ds_read_b64_tr_b16 v[74:75],v246 offset:1024
ds_read_b64_tr_b16 v[76:77],v246 offset:8192
ds_read_b64_tr_b16 v[78:79],v246 offset:9216
s_waitcnt vmcnt(8) lgkmcnt(0)
s_barrier
s_add_u32 s60,s56,1114112
s_mov_b32 m0,151552
s_nop 0
buffer_load_dwordx4 v240,s[76:79],s60 offen lds
s_add_u32 s60,s56,1122304
s_mov_b32 m0,152576
s_nop 0
buffer_load_dwordx4 v240,s[76:79],s60 offen lds
s_add_u32 s60,s56,1130496
s_mov_b32 m0,153600
s_nop 0
buffer_load_dwordx4 v241,s[76:79],s60 offen lds
s_add_u32 s60,s56,1138688
s_mov_b32 m0,154624
s_nop 0
buffer_load_dwordx4 v241,s[76:79],s60 offen lds
v_add_u32 v15,30720,v244
ds_read_b64_tr_b16 a[216:217],v15
ds_read_b64_tr_b16 a[218:219],v15 offset:1024
ds_read_b64_tr_b16 a[220:221],v15 offset:8192
ds_read_b64_tr_b16 a[222:223],v15 offset:9216
v_add_u32 v246,30720,v245
ds_read_b64_tr_b16 a[224:225],v246
ds_read_b64_tr_b16 a[226:227],v246 offset:1024
ds_read_b64_tr_b16 a[228:229],v246 offset:8192
ds_read_b64_tr_b16 a[230:231],v246 offset:9216
s_waitcnt vmcnt(8) lgkmcnt(0)
s_barrier
s_add_u32 s60,s56,1638400
s_mov_b32 m0,34816
s_nop 0
buffer_load_dwordx4 v240,s[76:79],s60 offen lds
s_add_u32 s60,s56,1646592
s_mov_b32 m0,35840
s_nop 0
buffer_load_dwordx4 v240,s[76:79],s60 offen lds
s_add_u32 s60,s56,1654784
s_mov_b32 m0,36864
s_nop 0
buffer_load_dwordx4 v241,s[76:79],s60 offen lds
s_add_u32 s60,s56,1662976
s_mov_b32 m0,37888
s_nop 0
buffer_load_dwordx4 v241,s[76:79],s60 offen lds
v_add_u32 v15,69632,v244
ds_read_b64_tr_b16 v[80:81],v15
ds_read_b64_tr_b16 v[82:83],v15 offset:1024
ds_read_b64_tr_b16 v[84:85],v15 offset:8192
ds_read_b64_tr_b16 v[86:87],v15 offset:9216
s_waitcnt lgkmcnt(0)
ds_write_b128 v3,v[80:83]
ds_write_b128 v3,v[84:87] offset:1024
v_add_u32 v246,69632,v245
ds_read_b64_tr_b16 a[8:9],v246
ds_read_b64_tr_b16 a[10:11],v246 offset:1024
ds_read_b64_tr_b16 a[12:13],v246 offset:8192
ds_read_b64_tr_b16 a[14:15],v246 offset:9216
s_waitcnt vmcnt(8) lgkmcnt(0)
s_barrier
s_add_u32 s60,s56,2162688
s_mov_b32 m0,73728
s_nop 0
buffer_load_dwordx4 v240,s[76:79],s60 offen lds
s_add_u32 s60,s56,2170880
s_mov_b32 m0,74752
s_nop 0
buffer_load_dwordx4 v240,s[76:79],s60 offen lds
s_add_u32 s60,s56,2179072
s_mov_b32 m0,75776
s_nop 0
buffer_load_dwordx4 v241,s[76:79],s60 offen lds
s_add_u32 s60,s56,2187264
s_mov_b32 m0,76800
s_nop 0
buffer_load_dwordx4 v241,s[76:79],s60 offen lds
v_add_u32 v15,108544,v244
ds_read_b64_tr_b16 v[80:81],v15
ds_read_b64_tr_b16 v[82:83],v15 offset:1024
ds_read_b64_tr_b16 v[84:85],v15 offset:8192
ds_read_b64_tr_b16 v[86:87],v15 offset:9216
s_waitcnt lgkmcnt(0)
ds_write_b128 v3,v[80:83] offset:4096
ds_write_b128 v3,v[84:87] offset:5120
v_add_u32 v246,108544,v245
ds_read_b64_tr_b16 a[40:41],v246
ds_read_b64_tr_b16 a[42:43],v246 offset:1024
ds_read_b64_tr_b16 a[44:45],v246 offset:8192
ds_read_b64_tr_b16 a[46:47],v246 offset:9216
s_cmp_lg_u32 s19,0
s_cbranch_scc1 ver_78
s_mov_b32 s19,1
v_mbcnt_lo_u32_b32 v46,-1,0
v_mbcnt_hi_u32_b32 v46,-1,v46
v_lshlrev_b32_e64 v40,2,v46
s_mov_b32 s63,0
s_branch el_79s
el_79:
global_load_dword v41,v40,s[4:5] sc1
s_add_u32 s63,s63,1
s_cmp_gt_u32 s63,4000000
s_cbranch_scc1 ch1_fail
s_waitcnt vmcnt(0)
el_79s:
v_bfe_u32 v42,v41,0,8
v_bfe_u32 v43,v41,8,8
v_bfe_u32 v44,v41,16,8
v_bfe_u32 v45,v41,24,8
v_min_u32 v41,v42,v43
v_min3_u32 v41,v41,v44,v45
v_cmp_eq_u32 vcc,0,v41
s_cbranch_vccnz el_79
s_mov_b32 s62,0
elw_80:
s_add_u32 s62,s62,1
s_mov_b32 s61,0
v_cmp_eq_u32 vcc,s62,v42
s_bcnt1_i32_b64 s60,vcc
s_add_u32 s61,s61,s60
v_cmp_eq_u32 vcc,s62,v43
s_bcnt1_i32_b64 s60,vcc
s_add_u32 s61,s61,s60
v_cmp_eq_u32 vcc,s62,v44
s_bcnt1_i32_b64 s60,vcc
s_add_u32 s61,s61,s60
v_cmp_eq_u32 vcc,s62,v45
s_bcnt1_i32_b64 s60,vcc
s_add_u32 s61,s61,s60
s_cmp_ge_u32 s62,16
s_cbranch_scc1 ch1_fail
s_cmp_lt_u32 s61,32
s_cbranch_scc1 elw_80
s_mov_b32 s61,0
s_mov_b32 s63,0
v_cmp_gt_u32 vcc,s3,v42
s_bcnt1_i32_b64 s60,vcc
s_add_u32 s63,s63,s60
v_add_u32 v41,0,v40
v_cmp_gt_u32 s[16:17],s2,v41
v_cmp_eq_u32 vcc,s3,v42
s_and_b64 vcc,vcc,s[16:17]
s_bcnt1_i32_b64 s60,vcc
s_add_u32 s61,s61,s60
v_cmp_gt_u32 vcc,s3,v43
s_bcnt1_i32_b64 s60,vcc
s_add_u32 s63,s63,s60
v_add_u32 v41,1,v40
v_cmp_gt_u32 s[16:17],s2,v41
v_cmp_eq_u32 vcc,s3,v43
s_and_b64 vcc,vcc,s[16:17]
s_bcnt1_i32_b64 s60,vcc
s_add_u32 s61,s61,s60
v_cmp_gt_u32 vcc,s3,v44
s_bcnt1_i32_b64 s60,vcc
s_add_u32 s63,s63,s60
v_add_u32 v41,2,v40
v_cmp_gt_u32 s[16:17],s2,v41
v_cmp_eq_u32 vcc,s3,v44
s_and_b64 vcc,vcc,s[16:17]
s_bcnt1_i32_b64 s60,vcc
s_add_u32 s61,s61,s60
v_cmp_gt_u32 vcc,s3,v45
s_bcnt1_i32_b64 s60,vcc
s_add_u32 s63,s63,s60
v_add_u32 v41,3,v40
v_cmp_gt_u32 s[16:17],s2,v41
v_cmp_eq_u32 vcc,s3,v45
s_and_b64 vcc,vcc,s[16:17]
s_bcnt1_i32_b64 s60,vcc
s_add_u32 s61,s61,s60
s_add_u32 s18,s61,s63
s_cmp_gt_u32 s62,s3
s_cselect_b32 s60,32,0
s_add_u32 s18,s18,s60
s_cmp_lg_u32 s62,s3
s_cbranch_scc1 eld_81
s_cmp_lt_u32 s61,32
s_cselect_b32 s18,s61,s18
eld_81:
s_add_u32 s60,s24,0
s_cmp_eq_u32 s60,s18
s_cbranch_scc1 ver_78
s_mov_b32 s24,s18
s_mov_b32 s10,268435456
s_waitcnt vmcnt(0) lgkmcnt(0)
s_branch k_role
ver_78:
s_lshl_b32 s39,s24,6
s_add_u32 s34,s39,16384
s_add_u32 s41,s34,65536
s_add_u32 s35,s34,131072
s_add_u32 s44,s34,196608
s_add_u32 s36,s39,270336
s_add_u32 s30,s39,2097152
s_add_u32 s31,s39,2109440
s_and_b32 s27,s24,3
s_lshl_b32 s27,s27,11
s_add_u32 s27,s27,2097152
s_mov_b32 s28,2105344
s_mov_b32 s29,2109440
s_lshl_b32 s39,s24,11
s_add_u32 s37,s39,0
s_mov_b32 s26,0
s_mov_b32 s42,1040356334
s_mov_b32 s18,0x3f803f80
s_mov_b32 s58,562036736
v_mov_b32 v20,-1
v_mov_b32 v21,-1
v_mov_b32 v22,-1
v_mov_b32 v23,-1
s_add_u32 s45,s37,196608
s_mov_b32 s20,0
s_lshl_b32 s39,s24,2
s_add_u32 s57,s39,6311936
s_and_b32 s39,s24,1
s_lshl_b32 s39,s39,7
s_add_u32 s59,s39,6311936
s_mov_b64 exec,3
v_mov_b32 v28,0
buffer_load_dword v24,v4,s[8:11],s57 offen sc1
s_mov_b64 exec,-1
buffer_load_dwordx4 v[24:27],v0,s[8:11],s37 offen sc1
buffer_load_dwordx4 v[24:27],v0,s[8:11],s37 offen offset:1024 sc1
s_add_u32 s39,s30,0x4000
buffer_load_dword v24,v7,s[8:11],s39 offen sc1
buffer_load_dword v24,v7,s[8:11],s30 offen sc1
buffer_load_dwordx4 v[24:27],v0,s[8:11],s45 offen sc1
buffer_load_dwordx4 v[24:27],v0,s[8:11],s45 offen offset:1024 sc1
s_add_u32 s39,s31,0x4000
buffer_load_dword v24,v7,s[8:11],s39 offen sc1
buffer_load_dword v24,v7,s[8:11],s31 offen sc1
v_lshl_or_b32 v28,v32,16,v31
v_min_u32 v8,-2,v28
v_bfe_u32 v29,v0,6,2
v_lshl_add_u32 v29,v29,11,v7
buffer_store_dword v8,v29,s[8:11],s30 offen
v_lshl_or_b32 v28,v34,16,v33
v_min_u32_e64 v10,-2,v28
buffer_store_dword v10,v7,s[8:11],s31 offen
s_waitcnt vmcnt(8) lgkmcnt(0)
s_barrier
s_add_u32 s60,s56,2686976
s_mov_b32 m0,112640
s_nop 0
buffer_load_dwordx4 v240,s[76:79],s60 offen lds
s_add_u32 s60,s56,2695168
s_mov_b32 m0,113664
s_nop 0
buffer_load_dwordx4 v240,s[76:79],s60 offen lds
s_add_u32 s60,s56,2703360
s_mov_b32 m0,114688
s_nop 0
buffer_load_dwordx4 v241,s[76:79],s60 offen lds
s_add_u32 s60,s56,2711552
s_mov_b32 m0,115712
s_nop 0
buffer_load_dwordx4 v241,s[76:79],s60 offen lds
v_add_u32 v15,147456,v244
ds_read_b64_tr_b16 v[80:81],v15
ds_read_b64_tr_b16 v[82:83],v15 offset:1024
ds_read_b64_tr_b16 v[84:85],v15 offset:8192
ds_read_b64_tr_b16 v[86:87],v15 offset:9216
s_waitcnt lgkmcnt(0)
ds_write_b128 v3,v[80:83] offset:8192
ds_write_b128 v3,v[84:87] offset:9216
v_add_u32 v246,147456,v245
ds_read_b64_tr_b16 a[72:73],v246
ds_read_b64_tr_b16 a[74:75],v246 offset:1024
ds_read_b64_tr_b16 a[76:77],v246 offset:8192
ds_read_b64_tr_b16 a[78:79],v246 offset:9216
s_waitcnt vmcnt(8) lgkmcnt(0)
s_barrier
s_add_u32 s60,s56,3211264
s_mov_b32 m0,151552
s_nop 0
buffer_load_dwordx4 v240,s[76:79],s60 offen lds
s_add_u32 s60,s56,3219456
s_mov_b32 m0,152576
s_nop 0
buffer_load_dwordx4 v240,s[76:79],s60 offen lds
s_add_u32 s60,s56,3227648
s_mov_b32 m0,153600
s_nop 0
buffer_load_dwordx4 v241,s[76:79],s60 offen lds
s_add_u32 s60,s56,3235840
s_mov_b32 m0,154624
s_nop 0
buffer_load_dwordx4 v241,s[76:79],s60 offen lds
v_add_u32 v15,30720,v244
ds_read_b64_tr_b16 v[80:81],v15
ds_read_b64_tr_b16 v[82:83],v15 offset:1024
ds_read_b64_tr_b16 v[84:85],v15 offset:8192
ds_read_b64_tr_b16 v[86:87],v15 offset:9216
s_waitcnt lgkmcnt(0)
ds_write_b128 v3,v[80:83] offset:12288
ds_write_b128 v3,v[84:87] offset:13312
v_add_u32 v246,30720,v245
ds_read_b64_tr_b16 a[104:105],v246
ds_read_b64_tr_b16 a[106:107],v246 offset:1024
ds_read_b64_tr_b16 a[108:109],v246 offset:8192
ds_read_b64_tr_b16 a[110:111],v246 offset:9216
s_waitcnt vmcnt(8) lgkmcnt(0)
s_barrier
s_add_u32 s60,s56,3735552
s_mov_b32 m0,34816
s_nop 0
buffer_load_dwordx4 v240,s[76:79],s60 offen lds
s_add_u32 s60,s56,3743744
s_mov_b32 m0,35840
s_nop 0
buffer_load_dwordx4 v240,s[76:79],s60 offen lds
s_add_u32 s60,s56,3751936
s_mov_b32 m0,36864
s_nop 0
buffer_load_dwordx4 v241,s[76:79],s60 offen lds
s_add_u32 s60,s56,3760128
s_mov_b32 m0,37888
s_nop 0
buffer_load_dwordx4 v241,s[76:79],s60 offen lds
v_add_u32 v15,69632,v244
ds_read_b64_tr_b16 v[80:81],v15
ds_read_b64_tr_b16 v[82:83],v15 offset:1024
ds_read_b64_tr_b16 v[84:85],v15 offset:8192
ds_read_b64_tr_b16 v[86:87],v15 offset:9216
s_waitcnt lgkmcnt(0)
ds_write_b128 v3,v[80:83] offset:16384
ds_write_b128 v3,v[84:87] offset:17408
v_add_u32 v246,69632,v245
ds_read_b64_tr_b16 a[136:137],v246
ds_read_b64_tr_b16 a[138:139],v246 offset:1024
ds_read_b64_tr_b16 a[140:141],v246 offset:8192
ds_read_b64_tr_b16 a[142:143],v246 offset:9216
s_waitcnt vmcnt(8) lgkmcnt(0)
s_barrier
s_add_u32 s60,s56,4325376
s_mov_b32 m0,73728
s_nop 0
buffer_load_dwordx4 v242,s[76:79],s60 offen lds
s_add_u32 s60,s56,4341760
s_mov_b32 m0,74752
s_nop 0
buffer_load_dwordx4 v242,s[76:79],s60 offen lds
s_add_u32 s60,s56,4358144
s_mov_b32 m0,75776
s_nop 0
buffer_load_dwordx4 v243,s[76:79],s60 offen lds
s_add_u32 s60,s56,4374528
s_mov_b32 m0,76800
s_nop 0
buffer_load_dwordx4 v243,s[76:79],s60 offen lds
v_add_u32 v15,108544,v244
ds_read_b64_tr_b16 a[144:145],v15
ds_read_b64_tr_b16 a[146:147],v15 offset:1024
ds_read_b64_tr_b16 a[148:149],v15 offset:8192
ds_read_b64_tr_b16 a[150:151],v15 offset:9216
v_add_u32 v246,108544,v245
ds_read_b64_tr_b16 v[80:81],v246
ds_read_b64_tr_b16 v[82:83],v246 offset:1024
ds_read_b64_tr_b16 v[84:85],v246 offset:8192
ds_read_b64_tr_b16 v[86:87],v246 offset:9216
s_waitcnt lgkmcnt(0)
ds_write_b128 v3,v[80:83] offset:20480
ds_write_b128 v3,v[84:87] offset:21504
s_waitcnt vmcnt(8) lgkmcnt(0)
s_barrier
s_add_u32 s60,s56,65536
s_mov_b32 m0,112640
s_nop 0
buffer_load_dwordx4 v240,s[84:87],s60 offen lds
s_add_u32 s60,s56,73728
s_mov_b32 m0,113664
s_nop 0
buffer_load_dwordx4 v240,s[84:87],s60 offen lds
s_add_u32 s60,s56,81920
s_mov_b32 m0,114688
s_nop 0
buffer_load_dwordx4 v241,s[84:87],s60 offen lds
s_add_u32 s60,s56,90112
s_mov_b32 m0,115712
s_nop 0
buffer_load_dwordx4 v241,s[84:87],s60 offen lds
v_add_u32 v15,147456,v244
ds_read_b64_tr_b16 a[168:169],v15
ds_read_b64_tr_b16 a[170:171],v15 offset:1024
ds_read_b64_tr_b16 a[172:173],v15 offset:8192
ds_read_b64_tr_b16 a[174:175],v15 offset:9216
v_add_u32 v246,147456,v245
ds_read_b64_tr_b16 a[176:177],v246
ds_read_b64_tr_b16 a[178:179],v246 offset:1024
ds_read_b64_tr_b16 a[180:181],v246 offset:8192
ds_read_b64_tr_b16 a[182:183],v246 offset:9216
s_waitcnt vmcnt(8) lgkmcnt(0)
s_barrier
s_add_u32 s60,s56,589824
s_mov_b32 m0,151552
s_nop 0
buffer_load_dwordx4 v240,s[84:87],s60 offen lds
s_add_u32 s60,s56,598016
s_mov_b32 m0,152576
s_nop 0
buffer_load_dwordx4 v240,s[84:87],s60 offen lds
s_add_u32 s60,s56,606208
s_mov_b32 m0,153600
s_nop 0
buffer_load_dwordx4 v241,s[84:87],s60 offen lds
s_add_u32 s60,s56,614400
s_mov_b32 m0,154624
s_nop 0
buffer_load_dwordx4 v241,s[84:87],s60 offen lds
v_add_u32 v15,30720,v244
ds_read_b64_tr_b16 v[48:49],v15
ds_read_b64_tr_b16 v[50:51],v15 offset:1024
ds_read_b64_tr_b16 v[52:53],v15 offset:8192
ds_read_b64_tr_b16 v[54:55],v15 offset:9216
v_add_u32 v246,30720,v245
ds_read_b64_tr_b16 a[192:193],v246
ds_read_b64_tr_b16 a[194:195],v246 offset:1024
ds_read_b64_tr_b16 a[196:197],v246 offset:8192
ds_read_b64_tr_b16 a[198:199],v246 offset:9216
s_waitcnt vmcnt(8) lgkmcnt(0)
s_barrier
s_add_u32 s60,s56,1114112
s_mov_b32 m0,34816
s_nop 0
buffer_load_dwordx4 v240,s[84:87],s60 offen lds
s_add_u32 s60,s56,1122304
s_mov_b32 m0,35840
s_nop 0
buffer_load_dwordx4 v240,s[84:87],s60 offen lds
s_add_u32 s60,s56,1130496
s_mov_b32 m0,36864
s_nop 0
buffer_load_dwordx4 v241,s[84:87],s60 offen lds
s_add_u32 s60,s56,1138688
s_mov_b32 m0,37888
s_nop 0
buffer_load_dwordx4 v241,s[84:87],s60 offen lds
v_add_u32 v15,69632,v244
ds_read_b64_tr_b16 a[200:201],v15
ds_read_b64_tr_b16 a[202:203],v15 offset:1024
ds_read_b64_tr_b16 a[204:205],v15 offset:8192
ds_read_b64_tr_b16 a[206:207],v15 offset:9216
v_add_u32 v246,69632,v245
ds_read_b64_tr_b16 v[56:57],v246
ds_read_b64_tr_b16 v[58:59],v246 offset:1024
ds_read_b64_tr_b16 v[60:61],v246 offset:8192
ds_read_b64_tr_b16 v[62:63],v246 offset:9216
s_waitcnt vmcnt(8) lgkmcnt(0)
s_barrier
s_add_u32 s60,s56,1638400
s_mov_b32 m0,73728
s_nop 0
buffer_load_dwordx4 v240,s[84:87],s60 offen lds
s_add_u32 s60,s56,1646592
s_mov_b32 m0,74752
s_nop 0
buffer_load_dwordx4 v240,s[84:87],s60 offen lds
s_add_u32 s60,s56,1654784
s_mov_b32 m0,75776
s_nop 0
buffer_load_dwordx4 v241,s[84:87],s60 offen lds
s_add_u32 s60,s56,1662976
s_mov_b32 m0,76800
s_nop 0
buffer_load_dwordx4 v241,s[84:87],s60 offen lds
v_add_u32 v15,108544,v244
ds_read_b64_tr_b16 a[16:17],v15
ds_read_b64_tr_b16 a[18:19],v15 offset:1024
ds_read_b64_tr_b16 a[20:21],v15 offset:8192
ds_read_b64_tr_b16 a[22:23],v15 offset:9216
v_add_u32 v246,108544,v245
ds_read_b64_tr_b16 a[24:25],v246
ds_read_b64_tr_b16 a[26:27],v246 offset:1024
ds_read_b64_tr_b16 a[28:29],v246 offset:8192
ds_read_b64_tr_b16 a[30:31],v246 offset:9216
s_waitcnt vmcnt(8) lgkmcnt(0)
s_barrier
s_add_u32 s60,s56,2162688
s_mov_b32 m0,112640
s_nop 0
buffer_load_dwordx4 v240,s[84:87],s60 offen lds
s_add_u32 s60,s56,2170880
s_mov_b32 m0,113664
s_nop 0
buffer_load_dwordx4 v240,s[84:87],s60 offen lds
s_add_u32 s60,s56,2179072
s_mov_b32 m0,114688
s_nop 0
buffer_load_dwordx4 v241,s[84:87],s60 offen lds
s_add_u32 s60,s56,2187264
s_mov_b32 m0,115712
s_nop 0
buffer_load_dwordx4 v241,s[84:87],s60 offen lds
v_add_u32 v15,147456,v244
ds_read_b64_tr_b16 a[48:49],v15
ds_read_b64_tr_b16 a[50:51],v15 offset:1024
ds_read_b64_tr_b16 a[52:53],v15 offset:8192
ds_read_b64_tr_b16 a[54:55],v15 offset:9216
v_add_u32 v246,147456,v245
ds_read_b64_tr_b16 a[56:57],v246
ds_read_b64_tr_b16 a[58:59],v246 offset:1024
ds_read_b64_tr_b16 a[60:61],v246 offset:8192
ds_read_b64_tr_b16 a[62:63],v246 offset:9216
s_waitcnt vmcnt(8) lgkmcnt(0)
s_barrier
s_add_u32 s60,s56,2686976
s_mov_b32 m0,151552
s_nop 0
buffer_load_dwordx4 v240,s[84:87],s60 offen lds
s_add_u32 s60,s56,2695168
s_mov_b32 m0,152576
s_nop 0
buffer_load_dwordx4 v240,s[84:87],s60 offen lds
s_add_u32 s60,s56,2703360
s_mov_b32 m0,153600
s_nop 0
buffer_load_dwordx4 v241,s[84:87],s60 offen lds
s_add_u32 s60,s56,2711552
s_mov_b32 m0,154624
s_nop 0
buffer_load_dwordx4 v241,s[84:87],s60 offen lds
v_add_u32 v15,30720,v244
ds_read_b64_tr_b16 a[80:81],v15
ds_read_b64_tr_b16 a[82:83],v15 offset:1024
ds_read_b64_tr_b16 a[84:85],v15 offset:8192
ds_read_b64_tr_b16 a[86:87],v15 offset:9216
v_add_u32 v246,30720,v245
ds_read_b64_tr_b16 a[88:89],v246
ds_read_b64_tr_b16 a[90:91],v246 offset:1024
ds_read_b64_tr_b16 a[92:93],v246 offset:8192
ds_read_b64_tr_b16 a[94:95],v246 offset:9216
s_waitcnt vmcnt(8) lgkmcnt(0)
s_barrier
s_add_u32 s60,s56,3211264
s_mov_b32 m0,34816
s_nop 0
buffer_load_dwordx4 v240,s[84:87],s60 offen lds
s_add_u32 s60,s56,3219456
s_mov_b32 m0,35840
s_nop 0
buffer_load_dwordx4 v240,s[84:87],s60 offen lds
s_add_u32 s60,s56,3227648
s_mov_b32 m0,36864
s_nop 0
buffer_load_dwordx4 v241,s[84:87],s60 offen lds
s_add_u32 s60,s56,3235840
s_mov_b32 m0,37888
s_nop 0
buffer_load_dwordx4 v241,s[84:87],s60 offen lds
v_add_u32 v15,69632,v244
ds_read_b64_tr_b16 a[112:113],v15
ds_read_b64_tr_b16 a[114:115],v15 offset:1024
ds_read_b64_tr_b16 a[116:117],v15 offset:8192
ds_read_b64_tr_b16 a[118:119],v15 offset:9216
v_add_u32 v246,69632,v245
ds_read_b64_tr_b16 a[120:121],v246
ds_read_b64_tr_b16 a[122:123],v246 offset:1024
ds_read_b64_tr_b16 a[124:125],v246 offset:8192
ds_read_b64_tr_b16 a[126:127],v246 offset:9216
s_waitcnt vmcnt(8) lgkmcnt(0)
s_barrier
s_add_u32 s60,s56,3735552
s_mov_b32 m0,73728
s_nop 0
buffer_load_dwordx4 v240,s[84:87],s60 offen lds
s_add_u32 s60,s56,3743744
s_mov_b32 m0,74752
s_nop 0
buffer_load_dwordx4 v240,s[84:87],s60 offen lds
s_add_u32 s60,s56,3751936
s_mov_b32 m0,75776
s_nop 0
buffer_load_dwordx4 v241,s[84:87],s60 offen lds
s_add_u32 s60,s56,3760128
s_mov_b32 m0,76800
s_nop 0
buffer_load_dwordx4 v241,s[84:87],s60 offen lds
v_add_u32 v15,108544,v244
ds_read_b64_tr_b16 a[232:233],v15
ds_read_b64_tr_b16 a[234:235],v15 offset:1024
ds_read_b64_tr_b16 a[236:237],v15 offset:8192
ds_read_b64_tr_b16 a[238:239],v15 offset:9216
v_add_u32 v246,108544,v245
ds_read_b64_tr_b16 a[240:241],v246
ds_read_b64_tr_b16 a[242:243],v246 offset:1024
ds_read_b64_tr_b16 a[244:245],v246 offset:8192
ds_read_b64_tr_b16 a[246:247],v246 offset:9216
s_waitcnt vmcnt(8) lgkmcnt(0)
s_barrier
s_add_u32 s60,s56,4325376
s_mov_b32 m0,112640
s_nop 0
buffer_load_dwordx4 v242,s[84:87],s60 offen lds
s_add_u32 s60,s56,4341760
s_mov_b32 m0,113664
s_nop 0
buffer_load_dwordx4 v242,s[84:87],s60 offen lds
s_add_u32 s60,s56,4358144
s_mov_b32 m0,114688
s_nop 0
buffer_load_dwordx4 v243,s[84:87],s60 offen lds
s_add_u32 s60,s56,4374528
s_mov_b32 m0,115712
s_nop 0
buffer_load_dwordx4 v243,s[84:87],s60 offen lds
v_add_u32 v15,147456,v244
ds_read_b64_tr_b16 a[248:249],v15
ds_read_b64_tr_b16 a[250:251],v15 offset:1024
ds_read_b64_tr_b16 a[252:253],v15 offset:8192
ds_read_b64_tr_b16 a[254:255],v15 offset:9216
v_add_u32 v246,147456,v245
ds_read_b64_tr_b16 v[88:89],v246
ds_read_b64_tr_b16 v[90:91],v246 offset:1024
ds_read_b64_tr_b16 v[92:93],v246 offset:8192
ds_read_b64_tr_b16 v[94:95],v246 offset:9216
s_waitcnt vmcnt(8) lgkmcnt(0)
s_barrier
s_add_u32 s60,s32,9216
s_mov_b32 m0,151552
s_nop 0
buffer_load_dwordx4 v11,s[88:91],s60 offen lds
s_add_u32 s60,s32,11520
s_mov_b32 m0,152576
s_nop 0
buffer_load_dwordx4 v11,s[88:91],s60 offen lds
s_add_u32 s60,s32,13824
s_mov_b32 m0,153600
s_nop 0
buffer_load_dwordx4 v11,s[88:91],s60 offen lds
s_add_u32 s60,s32,16128
s_mov_b32 m0,154624
s_nop 0
buffer_load_dwordx4 v11,s[88:91],s60 offen lds
v_add_u32 v15,30720,v244
ds_read_b64_tr_b16 v[96:97],v15
ds_read_b64_tr_b16 v[98:99],v15 offset:1024
ds_read_b64_tr_b16 v[100:101],v15 offset:8192
ds_read_b64_tr_b16 v[102:103],v15 offset:9216
v_add_u32 v246,30720,v245
ds_read_b64_tr_b16 v[104:105],v246
ds_read_b64_tr_b16 v[106:107],v246 offset:1024
ds_read_b64_tr_b16 v[108:109],v246 offset:8192
ds_read_b64_tr_b16 v[110:111],v246 offset:9216
s_waitcnt vmcnt(8) lgkmcnt(0)
s_barrier
s_add_u32 s60,s32,46080
s_mov_b32 m0,34816
s_nop 0
buffer_load_dwordx4 v11,s[88:91],s60 offen lds
s_add_u32 s60,s32,48384
s_mov_b32 m0,35840
s_nop 0
buffer_load_dwordx4 v11,s[88:91],s60 offen lds
s_add_u32 s60,s32,50688
s_mov_b32 m0,36864
s_nop 0
buffer_load_dwordx4 v11,s[88:91],s60 offen lds
s_add_u32 s60,s32,52992
s_mov_b32 m0,37888
s_nop 0
buffer_load_dwordx4 v11,s[88:91],s60 offen lds
v_add_u32 v15,69632,v244
ds_read_b64_tr_b16 v[112:113],v15
ds_read_b64_tr_b16 v[114:115],v15 offset:1024
ds_read_b64_tr_b16 v[116:117],v15 offset:8192
ds_read_b64_tr_b16 v[118:119],v15 offset:9216
v_add_u32 v246,69632,v245
ds_read_b64_tr_b16 v[120:121],v246
ds_read_b64_tr_b16 v[122:123],v246 offset:1024
ds_read_b64_tr_b16 v[124:125],v246 offset:8192
ds_read_b64_tr_b16 v[126:127],v246 offset:9216
s_waitcnt vmcnt(8) lgkmcnt(0)
s_barrier
s_add_u32 s60,s32,82944
s_mov_b32 m0,73728
s_nop 0
buffer_load_dwordx4 v11,s[88:91],s60 offen lds
s_add_u32 s60,s32,85248
s_mov_b32 m0,74752
s_nop 0
buffer_load_dwordx4 v11,s[88:91],s60 offen lds
s_add_u32 s60,s32,87552
s_mov_b32 m0,75776
s_nop 0
buffer_load_dwordx4 v11,s[88:91],s60 offen lds
s_add_u32 s60,s32,89856
s_mov_b32 m0,76800
s_nop 0
buffer_load_dwordx4 v11,s[88:91],s60 offen lds
v_add_u32 v15,108544,v244
ds_read_b64_tr_b16 v[128:129],v15
ds_read_b64_tr_b16 v[130:131],v15 offset:1024
ds_read_b64_tr_b16 v[132:133],v15 offset:8192
ds_read_b64_tr_b16 v[134:135],v15 offset:9216
v_add_u32 v246,108544,v245
ds_read_b64_tr_b16 v[136:137],v246
ds_read_b64_tr_b16 v[138:139],v246 offset:1024
ds_read_b64_tr_b16 v[140:141],v246 offset:8192
ds_read_b64_tr_b16 v[142:143],v246 offset:9216
s_waitcnt vmcnt(8) lgkmcnt(0)
s_barrier
s_add_u32 s60,s32,119808
s_mov_b32 m0,112640
s_nop 0
buffer_load_dwordx4 v11,s[88:91],s60 offen lds
s_add_u32 s60,s32,122112
s_mov_b32 m0,113664
s_nop 0
buffer_load_dwordx4 v11,s[88:91],s60 offen lds
s_add_u32 s60,s32,124416
s_mov_b32 m0,114688
s_nop 0
buffer_load_dwordx4 v11,s[88:91],s60 offen lds
s_add_u32 s60,s32,126720
s_mov_b32 m0,115712
s_nop 0
buffer_load_dwordx4 v11,s[88:91],s60 offen lds
v_add_u32 v15,147456,v13
ds_read_b64_tr_b16 v[160:161],v15
ds_read_b64_tr_b16 v[162:163],v15 offset:1024
ds_read_b64_tr_b16 v[164:165],v15 offset:4096
ds_read_b64_tr_b16 v[166:167],v15 offset:5120
ds_read_b64_tr_b16 v[184:185],v15 offset:256
ds_read_b64_tr_b16 v[186:187],v15 offset:1280
ds_read_b64_tr_b16 v[188:189],v15 offset:4352
ds_read_b64_tr_b16 v[190:191],v15 offset:5376
s_waitcnt vmcnt(8) lgkmcnt(0)
s_barrier
s_add_u32 s60,s32,9728
s_mov_b32 m0,151552
s_nop 0
buffer_load_dwordx4 v11,s[88:91],s60 offen lds
s_add_u32 s60,s32,12032
s_mov_b32 m0,152576
s_nop 0
buffer_load_dwordx4 v11,s[88:91],s60 offen lds
s_add_u32 s60,s32,14336
s_mov_b32 m0,153600
s_nop 0
buffer_load_dwordx4 v11,s[88:91],s60 offen lds
s_add_u32 s60,s32,16640
s_mov_b32 m0,154624
s_nop 0
buffer_load_dwordx4 v11,s[88:91],s60 offen lds
v_add_u32 v15,30720,v13
ds_read_b64_tr_b16 v[16:17],v15
ds_read_b64_tr_b16 v[18:19],v15 offset:1024
ds_read_b64_tr_b16 v[20:21],v15 offset:4096
ds_read_b64_tr_b16 v[22:23],v15 offset:5120
ds_read_b64_tr_b16 v[24:25],v15 offset:256
ds_read_b64_tr_b16 v[26:27],v15 offset:1280
ds_read_b64_tr_b16 v[28:29],v15 offset:4352
ds_read_b64_tr_b16 v[30:31],v15 offset:5376
s_waitcnt vmcnt(8) lgkmcnt(0)
s_barrier
s_add_u32 s60,s32,46592
s_mov_b32 m0,34816
s_nop 0
buffer_load_dwordx4 v11,s[88:91],s60 offen lds
s_add_u32 s60,s32,48896
s_mov_b32 m0,35840
s_nop 0
buffer_load_dwordx4 v11,s[88:91],s60 offen lds
s_add_u32 s60,s32,51200
s_mov_b32 m0,36864
s_nop 0
buffer_load_dwordx4 v11,s[88:91],s60 offen lds
s_add_u32 s60,s32,53504
s_mov_b32 m0,37888
s_nop 0
buffer_load_dwordx4 v11,s[88:91],s60 offen lds
v_add_u32 v15,69632,v13
ds_read_b64_tr_b16 v[168:169],v15
ds_read_b64_tr_b16 v[170:171],v15 offset:1024
ds_read_b64_tr_b16 v[172:173],v15 offset:4096
ds_read_b64_tr_b16 v[174:175],v15 offset:5120
ds_read_b64_tr_b16 v[192:193],v15 offset:256
ds_read_b64_tr_b16 v[194:195],v15 offset:1280
ds_read_b64_tr_b16 v[196:197],v15 offset:4352
ds_read_b64_tr_b16 v[198:199],v15 offset:5376
s_waitcnt vmcnt(8) lgkmcnt(0)
s_barrier
s_add_u32 s60,s32,83456
s_mov_b32 m0,73728
s_nop 0
buffer_load_dwordx4 v11,s[88:91],s60 offen lds
s_add_u32 s60,s32,85760
s_mov_b32 m0,74752
s_nop 0
buffer_load_dwordx4 v11,s[88:91],s60 offen lds
s_add_u32 s60,s32,88064
s_mov_b32 m0,75776
s_nop 0
buffer_load_dwordx4 v11,s[88:91],s60 offen lds
s_add_u32 s60,s32,90368
s_mov_b32 m0,76800
s_nop 0
buffer_load_dwordx4 v11,s[88:91],s60 offen lds
v_add_u32 v15,108544,v13
ds_read_b64_tr_b16 v[176:177],v15
ds_read_b64_tr_b16 v[178:179],v15 offset:1024
ds_read_b64_tr_b16 v[180:181],v15 offset:4096
ds_read_b64_tr_b16 v[182:183],v15 offset:5120
ds_read_b64_tr_b16 v[200:201],v15 offset:256
ds_read_b64_tr_b16 v[202:203],v15 offset:1280
ds_read_b64_tr_b16 v[204:205],v15 offset:4352
ds_read_b64_tr_b16 v[206:207],v15 offset:5376
s_waitcnt vmcnt(8) lgkmcnt(0)
s_barrier
s_add_u32 s60,s32,120320
s_mov_b32 m0,112640
s_nop 0
buffer_load_dwordx4 v11,s[88:91],s60 offen lds
s_add_u32 s60,s32,122624
s_mov_b32 m0,113664
s_nop 0
buffer_load_dwordx4 v11,s[88:91],s60 offen lds
s_add_u32 s60,s32,124928
s_mov_b32 m0,114688
s_nop 0
buffer_load_dwordx4 v11,s[88:91],s60 offen lds
s_add_u32 s60,s32,127232
s_mov_b32 m0,115712
s_nop 0
buffer_load_dwordx4 v11,s[88:91],s60 offen lds
v_add_u32 v15,147456,v13
ds_read_b64_tr_b16 v[32:33],v15
ds_read_b64_tr_b16 v[34:35],v15 offset:1024
ds_read_b64_tr_b16 v[36:37],v15 offset:4096
ds_read_b64_tr_b16 v[38:39],v15 offset:5120
ds_read_b64_tr_b16 v[40:41],v15 offset:256
ds_read_b64_tr_b16 v[42:43],v15 offset:1280
ds_read_b64_tr_b16 v[44:45],v15 offset:4352
ds_read_b64_tr_b16 v[46:47],v15 offset:5376
s_waitcnt vmcnt(8) lgkmcnt(0)
s_barrier
s_add_u32 s60,s32,37888
s_mov_b32 m0,151552
s_nop 0
buffer_load_dwordx4 v12,s[88:91],s60 offen lds
s_add_u32 s60,s32,47104
s_mov_b32 m0,152576
s_nop 0
buffer_load_dwordx4 v12,s[88:91],s60 offen lds
s_add_u32 s60,s32,56320
s_mov_b32 m0,153600
s_nop 0
buffer_load_dwordx4 v12,s[88:91],s60 offen lds
s_add_u32 s60,s32,65536
s_mov_b32 m0,154624
s_nop 0
buffer_load_dwordx4 v12,s[88:91],s60 offen lds
v_add_u32 v15,30720,v13
ds_read_b64_tr_b16 v[144:145],v15
ds_read_b64_tr_b16 v[146:147],v15 offset:1024
ds_read_b64_tr_b16 v[148:149],v15 offset:4096
ds_read_b64_tr_b16 v[150:151],v15 offset:5120
ds_read_b64_tr_b16 v[152:153],v15 offset:256
ds_read_b64_tr_b16 v[154:155],v15 offset:1280
ds_read_b64_tr_b16 v[156:157],v15 offset:4352
ds_read_b64_tr_b16 v[158:159],v15 offset:5376
s_waitcnt vmcnt(8) lgkmcnt(0)
s_barrier
v_add_u32 v15,69632,v13
ds_read_b64_tr_b16 v[208:209],v15
ds_read_b64_tr_b16 v[210:211],v15 offset:1024
ds_read_b64_tr_b16 v[212:213],v15 offset:4096
ds_read_b64_tr_b16 v[214:215],v15 offset:5120
ds_read_b64_tr_b16 v[224:225],v15 offset:256
ds_read_b64_tr_b16 v[226:227],v15 offset:1280
ds_read_b64_tr_b16 v[228:229],v15 offset:4352
ds_read_b64_tr_b16 v[230:231],v15 offset:5376
s_waitcnt vmcnt(4) lgkmcnt(0)
s_barrier
v_add_u32 v15,108544,v13
ds_read_b64_tr_b16 v[216:217],v15
ds_read_b64_tr_b16 v[218:219],v15 offset:1024
ds_read_b64_tr_b16 v[220:221],v15 offset:4096
ds_read_b64_tr_b16 v[222:223],v15 offset:5120
ds_read_b64_tr_b16 v[232:233],v15 offset:256
ds_read_b64_tr_b16 v[234:235],v15 offset:1280
ds_read_b64_tr_b16 v[236:237],v15 offset:4352
ds_read_b64_tr_b16 v[238:239],v15 offset:5376
s_waitcnt vmcnt(0) lgkmcnt(0)
s_barrier
v_add_u32 v15,147456,v14
ds_read_b64_tr_b16 v[240:241],v15
ds_read_b64_tr_b16 v[242:243],v15 offset:2048
ds_read_b64_tr_b16 v[244:245],v15 offset:4096
ds_read_b64_tr_b16 v[246:247],v15 offset:6144
ds_read_b64_tr_b16 v[248:249],v15 offset:8192
ds_read_b64_tr_b16 v[250:251],v15 offset:10240
ds_read_b64_tr_b16 v[252:253],v15 offset:12288
ds_read_b64_tr_b16 v[254:255],v15 offset:14336
s_waitcnt lgkmcnt(0)
s_barrier
ds_write_b128 v3,v[64:67] offset:22528
ds_write_b128 v3,v[68:71] offset:23552
ds_write_b128 v3,v[48:51] offset:24576
ds_write_b128 v3,v[52:55] offset:25600
ds_write_b128 v3,v[56:59] offset:26624
ds_write_b128 v3,v[60:63] offset:27648
ds_write_b128 v3,v[72:75] offset:28672
ds_write_b128 v3,v[76:79] offset:29696
ds_write_b128 v3,v[16:19] offset:30720
ds_write_b128 v3,v[20:23] offset:31744
ds_write_b128 v3,v[24:27] offset:32768
ds_write_b128 v3,v[28:31] offset:33792
ds_write_b128 v3,v[32:35] offset:34816
ds_write_b128 v3,v[36:39] offset:35840
ds_write_b128 v3,v[40:43] offset:36864
ds_write_b128 v3,v[44:47] offset:37888
s_waitcnt lgkmcnt(0)
v_mov_b32 v11,v10
ch1_layer:
s_mov_b32 s25,0
s_mul_i32 s39,s24,1064960
s_add_u32 s32,s39,41953280
s_add_u32 s56,s39,41945088
s_lshl_b32 s39,s24,6
s_add_u32 s39,s39,s52
s_add_u32 s54,s39,8388608
s_add_u32 s55,s39,8394752
s_mov_b32 s38,0
ch1_entry:
v_and_b32 v10,8,v2
v_add_u32 v10,v9,v10
v_mov_b32 v48,0
v_mov_b32 v49,0
v_mov_b32 v50,0
v_mov_b32 v51,0
v_mov_b32 v52,0
v_mov_b32 v53,0
v_mov_b32 v54,0
v_mov_b32 v55,0
v_mov_b32 v56,0
v_mov_b32 v57,0
v_mov_b32 v58,0
v_mov_b32 v59,0
v_mov_b32 v60,0
v_mov_b32 v61,0
v_mov_b32 v62,0
v_mov_b32 v63,0
ds_read_b128 v[64:67],v3
ds_read_b128 v[68:71],v3 offset:1024
ds_read_b128 v[72:75],v3 offset:2048
ds_read_b128 v[76:79],v3 offset:3072
v_mov_b32 v80,0
v_mov_b32 v81,0
v_mov_b32 v82,0
v_mov_b32 v83,0
v_mov_b32 v84,0
v_mov_b32 v85,0
v_mov_b32 v86,0
v_mov_b32 v87,0
buffer_load_dwordx4 v[44:47],v0,s[8:11],s27 offen
buffer_load_dwordx4 v[12:15],v0,s[8:11],s27 offen offset:1024
buffer_load_dwordx4 v[16:19],v0,s[8:11],s28 offen
buffer_load_dwordx4 v[20:23],v0,s[8:11],s28 offen offset:1024
s_waitcnt vmcnt(0)
s_barrier
ch1_top:
s_waitcnt vmcnt(3) lgkmcnt(2)
v_cmp_eq_u32_e64 vcc,-1,v44
s_cbranch_vccnz ch1_retry0
ch1_ok0:
v_smfmac_f32_16x16x64_bf16 v[48:51],v[44:47],v[64:71],v5
ds_read_b128 v[64:67],v3 offset:4096
v_smfmac_f32_16x16x64_bf16 v[56:59],v[44:47],a[0:7],v5
ds_read_b128 v[68:71],v3 offset:5120
buffer_load_dwordx4 v[24:27],v0,s[8:11],s28 offen offset:2048
v_smfmac_f32_16x16x64_bf16 v[52:55],v[44:47],a[8:15],v5
s_waitcnt vmcnt(3) lgkmcnt(2)
v_smfmac_f32_16x16x64_bf16 v[60:63],v[44:47],v[72:79],v5
ds_read_b128 v[72:75],v3 offset:6144
v_cmp_eq_u32 vcc,-1,v12
v_smfmac_f32_16x16x64_bf16 v[80:83],v[44:47],a[16:23],v5
ds_read_b128 v[76:79],v3 offset:7168
buffer_load_dwordx4 v[28:31],v0,s[8:11],s28 offen offset:3072
v_smfmac_f32_16x16x64_bf16 v[84:87],v[44:47],a[24:31],v5
s_cbranch_vccnz ch1_retry1
ch1_ok1:
s_waitcnt lgkmcnt(2)
v_smfmac_f32_16x16x64_bf16 v[48:51],v[12:15],v[64:71],v5
ds_read_b128 v[64:67],v3 offset:8192
v_smfmac_f32_16x16x64_bf16 v[56:59],v[12:15],a[32:39],v5
ds_read_b128 v[68:71],v3 offset:9216
buffer_load_dwordx4 v[32:35],v0,s[8:11],s29 offen
v_smfmac_f32_16x16x64_bf16 v[52:55],v[12:15],a[40:47],v5
s_waitcnt vmcnt(4) lgkmcnt(2)
v_smfmac_f32_16x16x64_bf16 v[60:63],v[12:15],v[72:79],v5
ds_read_b128 v[72:75],v3 offset:10240
v_cmp_eq_u32 vcc,-1,v16
v_smfmac_f32_16x16x64_bf16 v[80:83],v[12:15],a[48:55],v5
ds_read_b128 v[76:79],v3 offset:11264
buffer_load_dwordx4 v[36:39],v0,s[8:11],s29 offen offset:1024
v_smfmac_f32_16x16x64_bf16 v[84:87],v[12:15],a[56:63],v5
s_cbranch_vccnz ch1_retry2
ch1_ok2:
s_waitcnt lgkmcnt(2)
v_smfmac_f32_16x16x64_bf16 v[48:51],v[16:19],v[64:71],v5
ds_read_b128 v[64:67],v3 offset:12288
v_smfmac_f32_16x16x64_bf16 v[56:59],v[16:19],a[64:71],v5
ds_read_b128 v[68:71],v3 offset:13312
buffer_load_dwordx4 v[40:43],v0,s[8:11],s29 offen offset:2048
v_and_b32 v12,32,v0
v_smfmac_f32_16x16x64_bf16 v[52:55],v[16:19],a[72:79],v5
s_waitcnt vmcnt(5) lgkmcnt(2)
v_lshl_add_u32 v12,v12,4,v9
v_smfmac_f32_16x16x64_bf16 v[60:63],v[16:19],v[72:79],v5
ds_read_b128 v[72:75],v3 offset:14336
v_cmp_eq_u32_e64 vcc,-1,v20
v_smfmac_f32_16x16x64_bf16 v[80:83],v[16:19],a[80:87],v5
ds_read_b128 v[76:79],v3 offset:15360
buffer_load_dwordx4 v[44:47],v12,s[8:11],s56 offen sc1
v_smfmac_f32_16x16x64_bf16 v[84:87],v[16:19],a[88:95],v5
s_cbranch_vccnz ch1_retry3
ch1_ok3:
s_waitcnt lgkmcnt(2)
v_smfmac_f32_16x16x64_bf16 v[48:51],v[20:23],v[64:71],v5
ds_read_b128 v[64:67],v3 offset:16384
v_smfmac_f32_16x16x64_bf16 v[56:59],v[20:23],a[96:103],v5
ds_read_b128 v[68:71],v3 offset:17408
buffer_load_dwordx4 v[12:15],v12,s[8:11],s56 offen offset:1024 sc1
v_smfmac_f32_16x16x64_bf16 v[52:55],v[20:23],a[104:111],v5
s_waitcnt vmcnt(6) lgkmcnt(2)
v_smfmac_f32_16x16x64_bf16 v[60:63],v[20:23],v[72:79],v5
ds_read_b128 v[72:75],v3 offset:18432
v_cmp_eq_u32 vcc,-1,v24
v_smfmac_f32_16x16x64_bf16 v[80:83],v[20:23],a[112:119],v5
ds_read_b128 v[76:79],v3 offset:19456
buffer_load_dwordx4 v[16:19],v0,s[8:11],s32 offen sc1
v_smfmac_f32_16x16x64_bf16 v[84:87],v[20:23],a[120:127],v5
s_cbranch_vccnz ch1_retry4
ch1_ok4:
s_waitcnt vmcnt(6) lgkmcnt(2)
v_smfmac_f32_16x16x64_bf16 v[48:51],v[24:27],v[64:71],v5
ds_read_b128 v[64:67],v3 offset:20480
v_cmp_eq_u32_e64 vcc,-1,v28
v_smfmac_f32_16x16x64_bf16 v[56:59],v[24:27],a[128:135],v5
ds_read_b128 v[68:71],v3 offset:21504
buffer_load_dwordx4 v[20:23],v0,s[8:11],s32 offen offset:1024 sc1
v_smfmac_f32_16x16x64_bf16 v[52:55],v[24:27],a[136:143],v5
s_cbranch_vccnz ch1_retry5
ch1_ok5:
s_waitcnt vmcnt(6) lgkmcnt(2)
v_smfmac_f32_16x16x64_bf16 v[60:63],v[24:27],v[72:79],v5
ds_read_b128 v[72:75],v3 offset:22528
v_cmp_eq_u32_e64 vcc,-1,v32
v_smfmac_f32_16x16x64_bf16 v[48:51],v[28:31],a[144:151],v5
ds_read_b128 v[76:79],v3 offset:23552
s_barrier
v_smfmac_f32_16x16x64_bf16 v[56:59],v[28:31],a[152:159],v5
s_cbranch_vccnz ch1_retry6
ch1_ok6:
s_waitcnt vmcnt(5) lgkmcnt(2)
v_smfmac_f32_16x16x64_bf16 v[52:55],v[28:31],v[64:71],v5
ds_read_b128 v[64:67],v3 offset:24576
v_cmp_eq_u32 vcc,-1,v36
v_smfmac_f32_16x16x64_bf16 v[60:63],v[28:31],a[160:167],v5
ds_read_b128 v[68:71],v3 offset:25600
v_smfmac_f32_16x16x64_bf16 v[48:51],v[32:35],a[168:175],v5
s_cbranch_vccnz ch1_retry7
ch1_ok7:
s_waitcnt vmcnt(4) lgkmcnt(2)
v_smfmac_f32_16x16x64_bf16 v[56:59],v[32:35],v[72:79],v5
ds_read_b128 v[72:75],v3 offset:26624
v_cmp_eq_u32_e64 vcc,-1,v40
v_smfmac_f32_16x16x64_bf16 v[52:55],v[32:35],a[176:183],v5
ds_read_b128 v[76:79],v3 offset:27648
buffer_store_dword v8,v7,s[8:11],s54 offen sc1
v_smfmac_f32_16x16x64_bf16 v[60:63],v[32:35],a[184:191],v5
s_cbranch_vccnz ch1_retry8
ch1_ok8:
s_waitcnt lgkmcnt(2)
v_smfmac_f32_16x16x64_bf16 v[48:51],v[36:39],v[64:71],v5
ds_read_b128 v[64:67],v3 offset:28672
v_smfmac_f32_16x16x64_bf16 v[52:55],v[36:39],a[192:199],v5
ds_read_b128 v[68:71],v3 offset:29696
buffer_store_dword v11,v7,s[8:11],s55 offen sc1
v_smfmac_f32_16x16x64_bf16 v[48:51],v[40:43],a[200:207],v5
s_waitcnt lgkmcnt(2)
v_smfmac_f32_16x16x64_bf16 v[52:55],v[40:43],v[72:79],v5
v_smfmac_f32_16x16x64_bf16 v[56:59],v[36:39],a[208:215],v5
v_add_f32 v48,v48,v50
v_smfmac_f32_16x16x64_bf16 v[56:59],v[40:43],a[216:223],v5
s_waitcnt lgkmcnt(0)
v_add_f32 v49,v49,v51
v_smfmac_f32_16x16x64_bf16 v[60:63],v[36:39],v[64:71],v5
v_cvt_pk_bf16_f32 v50,v48,v49
v_smfmac_f32_16x16x64_bf16 v[60:63],v[40:43],a[224:231],v5
v_add_f32 v52,v52,v54
v_add_f32 v53,v53,v55
v_cvt_pk_bf16_f32 v54,v52,v53
v_add_f32 v56,v56,v58
v_add_f32 v57,v57,v59
v_cvt_pk_bf16_f32 v51,v56,v57
v_add_f32 v60,v60,v62
v_add_f32 v61,v61,v63
v_cvt_pk_bf16_f32 v55,v60,v61
ds_write2st64_b64 v1,v[50:51],v[54:55] offset0:10 offset1:11
v_smfmac_f32_16x16x64_bf16 v[80:83],v[24:27],a[232:239],v5
v_mov_b32 v76,s18
v_smfmac_f32_16x16x64_bf16 v[84:87],v[24:27],a[240:247],v5
v_mov_b32 v77,s18
v_smfmac_f32_16x16x64_bf16 v[80:83],v[28:31],a[248:255],v5
v_mov_b32 v78,s18
v_smfmac_f32_16x16x64_bf16 v[84:87],v[28:31],v[88:95],v5
v_mov_b32 v79,s18
v_smfmac_f32_16x16x64_bf16 v[80:83],v[32:35],v[96:103],v5
v_mov_b32 v24,0
s_waitcnt lgkmcnt(0)
s_barrier
v_smfmac_f32_16x16x64_bf16 v[84:87],v[32:35],v[104:111],v5
ds_read_b64_tr_b16 v[48:49],v4 offset:4096
ds_read_b64_tr_b16 v[50:51],v4 offset:4608
v_smfmac_f32_16x16x64_bf16 v[80:83],v[36:39],v[112:119],v5
ds_read_b64_tr_b16 v[52:53],v4 offset:5120
ds_read_b64_tr_b16 v[54:55],v4 offset:5632
v_smfmac_f32_16x16x64_bf16 v[84:87],v[36:39],v[120:127],v5
ds_read_b64_tr_b16 v[56:57],v4 offset:6144
ds_read_b64_tr_b16 v[58:59],v4 offset:6656
v_smfmac_f32_16x16x64_bf16 v[80:83],v[40:43],v[128:135],v5
ds_read_b64_tr_b16 v[60:61],v4 offset:7168
ds_read_b64_tr_b16 v[62:63],v4 offset:7680
s_waitcnt lgkmcnt(6) vmcnt(4)
v_mfma_f32_16x16x32_bf16 v[64:67],v[44:47],v[48:51],0
s_waitcnt lgkmcnt(4)
v_mov_b32 v25,0
v_mfma_f32_16x16x32_bf16 v[68:71],v[44:47],v[52:55],0
s_waitcnt lgkmcnt(2)
v_mov_b32 v26,0
v_mfma_f32_16x16x32_bf16 v[64:67],v[12:15],v[56:59],v[64:67]
s_waitcnt lgkmcnt(0)
v_mov_b32 v27,0
v_mfma_f32_16x16x32_bf16 v[68:71],v[12:15],v[60:63],v[68:71]
v_mov_b32 v44,0
v_mfma_f32_16x16x32_bf16 v[72:75],v[48:51],v[48:51],0
v_mul_f32 v64,s42,v64
v_mul_f32 v65,s42,v65
v_mfma_f32_16x16x32_bf16 v[72:75],v[52:55],v[52:55],v[72:75]
v_fmac_f32 v64,s42,v70
v_fmac_f32 v65,s42,v71
v_exp_f32 v66,v64
v_exp_f32 v67,v65
s_mov_b64 exec,s[48:49]
v_cvt_pk_bf16_f32 v66,v66,v67
ds_write_b32 v9,v66 offset:516
s_mov_b64 exec,-1
v_mfma_f32_16x16x32_bf16 v[72:75],v[56:59],v[56:59],v[72:75]
v_mov_b32 v45,0
v_mov_b32 v46,0
v_mfma_f32_16x16x32_bf16 v[72:75],v[60:63],v[60:63],v[72:75]
v_mov_b32 v47,0
v_mov_b32 v12,0
v_mov_b32 v13,0
v_mov_b32 v14,0
v_mov_b32 v15,0
v_mfma_f32_16x16x32_bf16 v[48:51],v[76:79],v[76:79],0
s_waitcnt lgkmcnt(0)
s_barrier
ds_read_b128 v[56:59],v9 offset:512
v_smfmac_f32_16x16x64_bf16 v[84:87],v[40:43],v[136:143],v5
v_mul_f32 v74,s42,v74
v_mul_f32 v75,s42,v75
v_exp_f32 v72,v74
v_exp_f32 v73,v75
v_mov_b32 v61,0
v_cvt_pk_bf16_f32 v72,v72,v73
v_mov_b32 v62,0
s_nop 0
v_mov_b32_dpp v60,v72 quad_perm:[0,1,0,1] row_mask:0xf bank_mask:0xf
s_waitcnt vmcnt(2) lgkmcnt(0)
v_mfma_f32_16x16x32_bf16 v[48:51],v[76:79],v[56:59],0
ds_read_b128 v[28:31],v3 offset:30720
v_mov_b32_dpp v63,v72 quad_perm:[0,1,0,1] row_mask:0xf bank_mask:0xf
v_add_f32_e64 v80,v80,v82
v_mfma_f32_16x16x32_bf16 v[52:55],v[16:19],v[56:59],0
ds_read_b128 v[32:35],v3 offset:31744
v_add_f32_e64 v81,v81,v83
v_cvt_pk_bf16_f32 v82,v80,v81
v_mfma_f32_16x16x32_bf16 v[68:71],v[20:23],v[56:59],0
ds_read_b128 v[36:39],v3 offset:32768
v_add_f32 v84,v84,v86
v_add_f32 v85,v85,v87
v_mfma_f32_16x16x16_bf16 v[48:51],v[76:77],v[60:61],v[48:51]
ds_read_b128 v[40:43],v3 offset:33792
v_cvt_pk_bf16_f32 v83,v84,v85
s_nop 1
v_mfma_f32_16x16x16_bf16 v[52:55],v[82:83],v[60:61],v[52:55]
v_mov_b32 v84,0
v_mov_b32 v85,0
v_mfma_f32_16x16x16_bf16 v[68:71],v[82:83],v[62:63],v[68:71]
v_rcp_f32 v66,v48
v_subrev_u32_e64 v67,s58,v48
v_cndmask_b32 v48,0,v66,s[48:49]
v_cndmask_b32 v50,0,v66,s[46:47]
v_mul_f32 v52,v52,v48
v_mul_f32 v53,v53,v48
v_mul_f32 v54,v54,v48
v_mul_f32 v55,v55,v48
v_cmp_lt_u32 vcc,0x3c000000,v67
v_pk_fma_f32 v[52:53],v[68:69],v[50:51],v[52:53] op_sel_hi:[1,0,1]
v_pk_fma_f32 v[54:55],v[70:71],v[50:51],v[54:55] op_sel_hi:[1,0,1]
v_cvt_pk_bf16_f32 v58,v52,v53
v_cvt_pk_bf16_f32 v59,v54,v55
v_mfma_f32_16x16x32_bf16 v[68:71],v[76:79],v[76:79],0
ds_write_b64 v10,v[58:59] offset:2560
s_cbranch_vccnz ch1_slowsm
ch1_smdone:
v_mov_b32_dpp v60,v58 quad_perm:[0,1,0,1] row_mask:0xf bank_mask:0xf
v_mov_b32_dpp v61,v59 quad_perm:[0,1,0,1] row_mask:0xf bank_mask:0xf
v_mov_b32_dpp v62,v58 quad_perm:[2,3,2,3] row_mask:0xf bank_mask:0xf
v_mov_b32_dpp v63,v59 quad_perm:[2,3,2,3] row_mask:0xf bank_mask:0xf
s_waitcnt lgkmcnt(1)
s_nop 0
v_mfma_f32_16x16x32_bf16 v[16:19],v[60:63],v[244:247],0
v_mov_b32 v86,0
v_mov_b32_e64 v87,0
v_smfmac_f32_16x16x64_bf16 v[44:47],v[60:63],v[28:35],v5
s_waitcnt lgkmcnt(0)
s_barrier
ds_read_b128 v[48:51],v9 offset:2048
ds_read_b128 v[52:55],v9 offset:3072
ds_read_b128 v[56:59],v9 offset:3584
v_smfmac_f32_16x16x64_bf16 v[12:15],v[60:63],v[36:43],v5
v_smfmac_f32_16x16x64_bf16 v[24:27],v[60:63],v[144:151],v5
v_smfmac_f32_16x16x64_bf16 v[84:87],v[60:63],v[152:159],v5
ds_read_b128 v[64:67],v3 offset:34816
s_waitcnt lgkmcnt(3)
v_smfmac_f32_16x16x64_bf16 v[44:47],v[48:51],v[160:167],v5
ds_read_b128 v[68:71],v3 offset:35840
s_waitcnt lgkmcnt(3)
v_smfmac_f32_16x16x64_bf16 v[44:47],v[52:55],v[168:175],v5
ds_read_b128 v[72:75],v3 offset:36864
s_waitcnt lgkmcnt(3)
v_smfmac_f32_16x16x64_bf16 v[44:47],v[56:59],v[176:183],v5
ds_read_b128 v[76:79],v3 offset:37888
v_smfmac_f32_16x16x64_bf16 v[12:15],v[48:51],v[184:191],v5
ds_read_b128 v[80:83],v0 offset:1024
v_smfmac_f32_16x16x64_bf16 v[12:15],v[52:55],v[192:199],v5
v_cvt_pk_bf16_f32 v44,v44,v45
v_cvt_pk_bf16_f32 v45,v46,v47
v_and_or_b32 v44,v44,-2,s26
v_smfmac_f32_16x16x64_bf16 v[12:15],v[56:59],v[200:207],v5
buffer_store_dwordx2 v[44:45],v6,s[8:11],s34 offen
s_waitcnt lgkmcnt(3)
v_smfmac_f32_16x16x64_bf16 v[24:27],v[48:51],v[64:71],v5
v_smfmac_f32_16x16x64_bf16 v[24:27],v[52:55],v[208:215],v5
v_cvt_pk_bf16_f32 v12,v12,v13
v_cvt_pk_bf16_f32 v13,v14,v15
v_and_or_b32 v12,v12,-2,s26
v_smfmac_f32_16x16x64_bf16 v[24:27],v[56:59],v[216:223],v5
buffer_store_dwordx2 v[12:13],v6,s[8:11],s41 offen
s_waitcnt lgkmcnt(1)
v_smfmac_f32_16x16x64_bf16 v[84:87],v[48:51],v[72:79],v5
v_smfmac_f32_16x16x64_bf16 v[84:87],v[52:55],v[224:231],v5
v_cvt_pk_bf16_f32 v24,v24,v25
v_cvt_pk_bf16_f32 v25,v26,v27
v_and_or_b32 v24,v24,-2,s26
v_smfmac_f32_16x16x64_bf16 v[84:87],v[56:59],v[232:239],v5
buffer_store_dwordx2 v[24:25],v6,s[8:11],s35 offen
v_mfma_f32_16x16x32_bf16 v[16:19],v[48:51],v[240:243],v[16:19]
v_mfma_f32_16x16x32_bf16 v[16:19],v[52:55],v[248:251],v[16:19]
v_cvt_pk_bf16_f32 v26,v84,v85
v_cvt_pk_bf16_f32 v27,v86,v87
v_and_or_b32 v26,v26,-2,s26
v_mfma_f32_16x16x32_bf16 v[16:19],v[56:59],v[252:255],v[16:19]
buffer_store_dwordx2 v[26:27],v6,s[8:11],s44 offen
ds_read_b128 v[64:67],v3
ds_read_b128 v[68:71],v3 offset:1024
ds_read_b128 v[72:75],v3 offset:2048
ds_read_b128 v[76:79],v3 offset:3072
s_nop 2
v_cvt_pk_bf16_f32 v16,v16,v17
v_and_or_b32 v16,v16,-2,s26
buffer_store_dword v16,v2,s[8:11],s36 offen
v_mov_b32 v48,0
s_add_u32 s20,s20,2
v_mov_b32 v49,0
s_add_u32 s25,s25,1
v_mov_b32 v50,0
s_add_u32 s32,s32,16384
v_mov_b32 v51,0
s_add_u32 s56,s56,16384
v_mov_b32 v52,0
s_add_u32 s27,s27,0x4000
v_mov_b32 v53,0
s_add_u32 s28,s28,0x4000
v_mov_b32 v54,0
s_add_u32 s29,s29,0x4000
v_mov_b32 v20,s20
v_mov_b32 v55,0
s_add_u32 s30,s30,0x4000
v_mov_b32 v56,0
s_add_u32 s54,s54,0x4000
v_mov_b32 v57,0
s_add_u32 s31,s31,0x4000
v_mov_b32 v58,0
s_add_u32 s55,s55,0x4000
v_mov_b32 v59,0
s_nop 0
v_mov_b32 v60,0
s_nop 0
v_mov_b32 v61,0
s_nop 0
v_mov_b32 v62,0
s_nop 0
v_mov_b32 v63,0
s_nop 0
v_bfe_u32 v22,v0,6,2
v_lshl_add_u32 v22,v22,11,v7
v_mov_b32 v5,v5
s_nop 3
v_mov_b32 v5,v5
buffer_load_dwordx4 v[28:31],v0,s[8:11],s37 offen sc1
buffer_load_dwordx4 v[32:35],v0,s[8:11],s37 offen offset:1024 sc1
v_mov_b32 v5,v5
s_nop 3
v_mov_b32 v5,v5
s_nop 3
v_mov_b32 v5,v5
s_nop 3
v_mov_b32 v5,v5
s_nop 3
v_mov_b32 v5,v5
s_nop 3
v_mov_b32 v5,v5
s_nop 3
v_mov_b32 v5,v5
s_nop 3
v_mov_b32 v5,v5
s_nop 3
v_mov_b32_e64 v5,v5
s_nop 1
buffer_load_dwordx4 v[36:39],v0,s[8:11],s45 offen sc1
buffer_load_dwordx4 v[40:43],v0,s[8:11],s45 offen offset:1024 sc1
s_waitcnt vmcnt(3) lgkmcnt(0)
v_mfma_f32_16x16x32_bf16 v[84:87],v[80:83],v[28:31],0
v_xor_b32 v28,s26,v28
s_waitcnt vmcnt(2)
v_mfma_f32_16x16x32_bf16 v[84:87],v[80:83],v[32:35],v[84:87]
v_bitop3_b32 v28,v28,v32,s26 bitop3:0xf6
v_and_b32 v28,1,v28
v_cmp_ne_u32 vcc,0,v28
s_nop 3
v_add_f32_dpp v84,v84,v84 row_ror:4 row_mask:0xf bank_mask:0xf
v_add_f32_dpp v85,v85,v85 row_ror:4 row_mask:0xf bank_mask:0xf
s_nop 0
v_add_f32_dpp v84,v84,v84 row_ror:8 row_mask:0xf bank_mask:0xf
v_add_f32_dpp v85,v85,v85 row_ror:8 row_mask:0xf bank_mask:0xf
v_cvt_pk_bf16_f32 v8,v84,v85
s_cbranch_vccnz ch1_pollP0
ch1_okP0:
s_mov_b64 exec,3
buffer_store_dword v20,v4,s[8:11],s57 offen
s_mov_b64 exec,-1
buffer_store_dword v8,v22,s[8:11],s30 offen
s_waitcnt vmcnt(3) lgkmcnt(0)
v_mfma_f32_16x16x32_bf16 v[84:87],v[80:83],v[36:39],0
v_xor_b32_e64 v36,s26,v36
s_waitcnt vmcnt(2)
v_mfma_f32_16x16x32_bf16 v[84:87],v[80:83],v[40:43],v[84:87]
v_bitop3_b32 v36,v36,v40,s26 bitop3:0xf6
v_and_b32 v36,1,v36
v_cmp_ne_u32_e64 vcc,0,v36
s_nop 3
v_add_f32_dpp v84,v84,v84 row_ror:4 row_mask:0xf bank_mask:0xf
v_add_f32_dpp v85,v85,v85 row_ror:4 row_mask:0xf bank_mask:0xf
s_nop 0
v_add_f32_dpp v84,v84,v84 row_ror:8 row_mask:0xf bank_mask:0xf
v_add_f32_dpp v85,v85,v85 row_ror:8 row_mask:0xf bank_mask:0xf
v_cvt_pk_bf16_f32 v11,v84,v85
s_cbranch_vccnz ch1_pollP1
ch1_okP1:
buffer_store_dword v11,v7,s[8:11],s31 offen
ch1_nored:
s_barrier
buffer_load_dwordx4 v[44:47],v0,s[8:11],s27 offen
v_mov_b32 v80,0
s_nop 0
v_mov_b32 v81,0
s_nop 0
v_mov_b32 v82,0
buffer_load_dwordx4 v[12:15],v0,s[8:11],s27 offen offset:1024
s_nop 0
v_mov_b32 v83,0
s_nop 0
v_mov_b32 v84,0
s_nop 0
v_mov_b32 v85,0
s_nop 0
v_mov_b32 v86,0
s_nop 0
buffer_load_dwordx4 v[16:19],v0,s[8:11],s28 offen
v_mov_b32 v87,0
s_nop 0
v_mov_b32 v5,v5
s_nop 3
v_mov_b32 v5,v5
s_nop 0
buffer_load_dwordx4 v[20:23],v0,s[8:11],s28 offen offset:1024
s_xor_b32 s26,s26,1
s_cmp_eq_u32 s25,63
s_cbranch_scc1 ch1_done
s_branch ch1_top
ch1_pollP0:
buffer_load_dwordx4 v[28:31],v0,s[8:11],s37 offen sc1
buffer_load_dwordx4 v[32:35],v0,s[8:11],s37 offen offset:1024 sc1
s_add_u32 s38,s38,1
s_cmp_gt_u32 s38,2000000
s_cbranch_scc1 ch1_fail
s_waitcnt vmcnt(1) lgkmcnt(0)
v_mfma_f32_16x16x32_bf16 v[84:87],v[80:83],v[28:31],0
v_xor_b32 v28,s26,v28
s_waitcnt vmcnt(0)
v_mfma_f32_16x16x32_bf16 v[84:87],v[80:83],v[32:35],v[84:87]
v_bitop3_b32 v28,v28,v32,s26 bitop3:0xf6
v_and_b32 v28,1,v28
v_cmp_ne_u32 vcc,0,v28
s_nop 3
v_add_f32_dpp v84,v84,v84 row_ror:4 row_mask:0xf bank_mask:0xf
v_add_f32_dpp v85,v85,v85 row_ror:4 row_mask:0xf bank_mask:0xf
s_nop 0
v_add_f32_dpp v84,v84,v84 row_ror:8 row_mask:0xf bank_mask:0xf
v_add_f32_dpp v85,v85,v85 row_ror:8 row_mask:0xf bank_mask:0xf
v_cvt_pk_bf16_f32 v8,v84,v85
s_cbranch_vccnz ch1_pollP0
s_branch ch1_okP0
ch1_pollP1:
buffer_load_dwordx4 v[36:39],v0,s[8:11],s45 offen sc1
buffer_load_dwordx4 v[40:43],v0,s[8:11],s45 offen offset:1024 sc1
s_add_u32 s38,s38,1
s_cmp_gt_u32 s38,2000000
s_cbranch_scc1 ch1_fail
s_waitcnt vmcnt(1) lgkmcnt(0)
v_mfma_f32_16x16x32_bf16 v[84:87],v[80:83],v[36:39],0
v_xor_b32_e64 v36,s26,v36
s_waitcnt vmcnt(0)
v_mfma_f32_16x16x32_bf16 v[84:87],v[80:83],v[40:43],v[84:87]
v_bitop3_b32 v36,v36,v40,s26 bitop3:0xf6
v_and_b32 v36,1,v36
v_cmp_ne_u32_e64 vcc,0,v36
s_nop 3
v_add_f32_dpp v84,v84,v84 row_ror:4 row_mask:0xf bank_mask:0xf
v_add_f32_dpp v85,v85,v85 row_ror:4 row_mask:0xf bank_mask:0xf
s_nop 0
v_add_f32_dpp v84,v84,v84 row_ror:8 row_mask:0xf bank_mask:0xf
v_add_f32_dpp v85,v85,v85 row_ror:8 row_mask:0xf bank_mask:0xf
v_cvt_pk_bf16_f32 v11,v84,v85
s_cbranch_vccnz ch1_pollP1
s_branch ch1_okP1
ch1_slowsm:
s_mov_b64 exec,s[48:49]
ds_write_b64 v9,v[64:65] offset:4104
s_mov_b64 exec,-1
s_waitcnt lgkmcnt(0)
s_barrier
ds_read_b128 v[48:51],v9 offset:4096
ds_read_b128 v[52:55],v9 offset:4608
v_mov_b32_dpp v72,v74 quad_perm:[0,1,0,1] row_mask:0xf bank_mask:0xf
v_mov_b32_dpp v73,v75 quad_perm:[0,1,0,1] row_mask:0xf bank_mask:0xf
s_waitcnt lgkmcnt(0)
v_max_f32_e64 v68,v48,v49
v_max3_f32 v68,v68,v50,v51
v_max3_f32 v68,v68,v52,v53
v_max3_f32 v68,v68,v54,v55
v_max3_f32 v68,v68,v72,v73
v_mov_b32 v69,v68
s_nop 1
v_permlane16_swap_b32 v68,v69
v_max_f32 v68,v68,v69
v_mov_b32 v69,v68
s_nop 1
v_permlane32_swap_b32 v68,v69
v_max_f32 v68,v68,v69
v_sub_f32 v48,v48,v68
v_exp_f32 v48,v48
v_sub_f32 v49,v49,v68
v_exp_f32 v49,v49
v_sub_f32 v50,v50,v68
v_exp_f32 v50,v50
v_sub_f32 v51,v51,v68
v_exp_f32 v51,v51
v_sub_f32 v52,v52,v68
v_exp_f32 v52,v52
v_sub_f32 v53,v53,v68
v_exp_f32 v53,v53
v_sub_f32 v54,v54,v68
v_exp_f32 v54,v54
v_sub_f32 v55,v55,v68
v_exp_f32 v55,v55
v_sub_f32 v72,v72,v68
v_exp_f32 v72,v72
v_sub_f32 v73,v73,v68
v_exp_f32 v73,v73
v_cvt_pk_bf16_f32 v56,v48,v49
v_cvt_pk_bf16_f32 v57,v50,v51
v_cvt_pk_bf16_f32 v58,v52,v53
v_cvt_pk_bf16_f32 v59,v54,v55
v_cvt_pk_bf16_f32 v60,v72,v73
v_cvt_pk_bf16_f32 v63,v72,v73
v_mfma_f32_16x16x32_bf16 v[48:51],v[76:79],v[56:59],0
v_mfma_f32_16x16x32_bf16 v[52:55],v[16:19],v[56:59],0
v_mfma_f32_16x16x32_bf16 v[68:71],v[20:23],v[56:59],0
v_mfma_f32_16x16x16_bf16 v[48:51],v[76:77],v[60:61],v[48:51]
v_mfma_f32_16x16x16_bf16 v[52:55],v[82:83],v[60:61],v[52:55]
v_mfma_f32_16x16x16_bf16 v[68:71],v[82:83],v[62:63],v[68:71]
v_rcp_f32 v66,v48
s_nop 0
v_cndmask_b32 v48,0,v66,s[48:49]
v_cndmask_b32 v50,0,v66,s[46:47]
v_mul_f32 v52,v52,v48
v_mul_f32 v53,v53,v48
v_mul_f32 v54,v54,v48
v_mul_f32 v55,v55,v48
v_pk_fma_f32 v[52:53],v[68:69],v[50:51],v[52:53] op_sel_hi:[1,0,1]
v_pk_fma_f32 v[54:55],v[70:71],v[50:51],v[54:55] op_sel_hi:[1,0,1]
v_cvt_pk_bf16_f32 v58,v52,v53
v_cvt_pk_bf16_f32 v59,v54,v55
v_mfma_f32_16x16x32_bf16 v[68:71],v[76:79],v[76:79],0
ds_write_b64 v10,v[58:59] offset:2560
s_branch ch1_smdone
ch1_retry0:
buffer_load_dwordx4 v[44:47],v0,s[8:11],s27 offen sc1
buffer_load_dwordx4 v[12:15],v0,s[8:11],s27 offen offset:1024 sc1
buffer_load_dwordx4 v[16:19],v0,s[8:11],s28 offen sc1
buffer_load_dwordx4 v[20:23],v0,s[8:11],s28 offen offset:1024 sc1
s_add_u32 s38,s38,1
s_cmp_gt_u32 s38,2000000
s_cbranch_scc1 ch1_fail
s_waitcnt vmcnt(0)
v_cmp_eq_u32_e64 vcc,-1,v44
s_cbranch_vccnz ch1_retry0
s_branch ch1_ok0
ch1_retry1:
buffer_load_dwordx4 v[12:15],v0,s[8:11],s27 offen offset:1024 sc1
buffer_load_dwordx4 v[16:19],v0,s[8:11],s28 offen sc1
buffer_load_dwordx4 v[20:23],v0,s[8:11],s28 offen offset:1024 sc1
buffer_load_dwordx4 v[24:27],v0,s[8:11],s28 offen offset:2048 sc1
buffer_load_dwordx4 v[28:31],v0,s[8:11],s28 offen offset:3072 sc1
s_add_u32 s38,s38,1
s_cmp_gt_u32 s38,2000000
s_cbranch_scc1 ch1_fail
s_waitcnt vmcnt(0)
v_cmp_eq_u32 vcc,-1,v12
s_cbranch_vccnz ch1_retry1
s_branch ch1_ok1
ch1_retry2:
buffer_load_dwordx4 v[16:19],v0,s[8:11],s28 offen sc1
buffer_load_dwordx4 v[20:23],v0,s[8:11],s28 offen offset:1024 sc1
buffer_load_dwordx4 v[24:27],v0,s[8:11],s28 offen offset:2048 sc1
buffer_load_dwordx4 v[28:31],v0,s[8:11],s28 offen offset:3072 sc1
buffer_load_dwordx4 v[32:35],v0,s[8:11],s29 offen sc1
buffer_load_dwordx4 v[36:39],v0,s[8:11],s29 offen offset:1024 sc1
s_add_u32 s38,s38,1
s_cmp_gt_u32 s38,2000000
s_cbranch_scc1 ch1_fail
s_waitcnt vmcnt(0)
v_cmp_eq_u32 vcc,-1,v16
s_cbranch_vccnz ch1_retry2
s_branch ch1_ok2
ch1_retry3:
buffer_load_dwordx4 v[20:23],v0,s[8:11],s28 offen offset:1024 sc1
buffer_load_dwordx4 v[24:27],v0,s[8:11],s28 offen offset:2048 sc1
buffer_load_dwordx4 v[28:31],v0,s[8:11],s28 offen offset:3072 sc1
buffer_load_dwordx4 v[32:35],v0,s[8:11],s29 offen sc1
buffer_load_dwordx4 v[36:39],v0,s[8:11],s29 offen offset:1024 sc1
buffer_load_dwordx4 v[40:43],v0,s[8:11],s29 offen offset:2048 sc1
s_add_u32 s38,s38,1
s_cmp_gt_u32 s38,2000000
s_cbranch_scc1 ch1_fail
s_waitcnt vmcnt(0)
v_cmp_eq_u32 vcc,-1,v20
s_cbranch_vccnz ch1_retry3
s_branch ch1_ok3
ch1_retry4:
buffer_load_dwordx4 v[24:27],v0,s[8:11],s28 offen offset:2048 sc1
buffer_load_dwordx4 v[28:31],v0,s[8:11],s28 offen offset:3072 sc1
buffer_load_dwordx4 v[32:35],v0,s[8:11],s29 offen sc1
buffer_load_dwordx4 v[36:39],v0,s[8:11],s29 offen offset:1024 sc1
buffer_load_dwordx4 v[40:43],v0,s[8:11],s29 offen offset:2048 sc1
s_add_u32 s38,s38,1
s_cmp_gt_u32 s38,2000000
s_cbranch_scc1 ch1_fail
s_waitcnt vmcnt(0)
v_cmp_eq_u32 vcc,-1,v24
s_cbranch_vccnz ch1_retry4
s_branch ch1_ok4
ch1_retry5:
buffer_load_dwordx4 v[28:31],v0,s[8:11],s28 offen offset:3072 sc1
buffer_load_dwordx4 v[32:35],v0,s[8:11],s29 offen sc1
buffer_load_dwordx4 v[36:39],v0,s[8:11],s29 offen offset:1024 sc1
buffer_load_dwordx4 v[40:43],v0,s[8:11],s29 offen offset:2048 sc1
s_add_u32 s38,s38,1
s_cmp_gt_u32 s38,2000000
s_cbranch_scc1 ch1_fail
s_waitcnt vmcnt(0)
v_cmp_eq_u32 vcc,-1,v28
s_cbranch_vccnz ch1_retry5
s_branch ch1_ok5
ch1_retry6:
buffer_load_dwordx4 v[32:35],v0,s[8:11],s29 offen sc1
buffer_load_dwordx4 v[36:39],v0,s[8:11],s29 offen offset:1024 sc1
buffer_load_dwordx4 v[40:43],v0,s[8:11],s29 offen offset:2048 sc1
s_add_u32 s38,s38,1
s_cmp_gt_u32 s38,2000000
s_cbranch_scc1 ch1_fail
s_waitcnt vmcnt(0)
v_cmp_eq_u32 vcc,-1,v32
s_cbranch_vccnz ch1_retry6
s_branch ch1_ok6
ch1_retry7:
buffer_load_dwordx4 v[36:39],v0,s[8:11],s29 offen offset:1024 sc1
buffer_load_dwordx4 v[40:43],v0,s[8:11],s29 offen offset:2048 sc1
s_add_u32 s38,s38,1
s_cmp_gt_u32 s38,2000000
s_cbranch_scc1 ch1_fail
s_waitcnt vmcnt(0)
v_cmp_eq_u32 vcc,-1,v36
s_cbranch_vccnz ch1_retry7
s_branch ch1_ok7
ch1_retry8:
buffer_load_dwordx4 v[40:43],v0,s[8:11],s29 offen offset:2048 sc1
s_add_u32 s38,s38,1
s_cmp_gt_u32 s38,2000000
s_cbranch_scc1 ch1_fail
s_waitcnt vmcnt(0)
v_cmp_eq_u32 vcc,-1,v40
s_cbranch_vccnz ch1_retry8
s_branch ch1_ok8
ch1_done:
buffer_store_dword v8,v7,s[8:11],s54 offen sc1
buffer_store_dword v11,v7,s[8:11],s55 offen sc1
s_waitcnt vmcnt(0) lgkmcnt(0)
s_cmp_lg_u32 s52,0
s_cbranch_scc1 c_join
s_mov_b32 s52,16777216
s_mov_b32 s23,1
s_add_u32 s40,s30,0x8000
buffer_load_dword v21,v7,s[8:11],s40 offen sc1
s_add_u32 s40,s31,0x8000
buffer_load_dword v21,v7,s[8:11],s40 offen sc1
s_add_u32 s27,s27,0x4000
s_add_u32 s28,s28,0x4000
s_add_u32 s29,s29,0x4000
s_add_u32 s30,s30,0x4000
s_add_u32 s54,s54,0x4000
s_add_u32 s31,s31,0x4000
s_add_u32 s55,s55,0x4000
v_lshrrev_b32 v18,4,v0
v_and_b32 v28,3,v18
v_bfe_u32 v30,v18,4,1
v_lshrrev_b32_e64 v29,5,v18
v_mul_u32_u24 v29,1152,v29
v_lshl_add_u32 v28,v28,1,v30
v_lshl_add_u32 v29,v28,1,v29
s_and_b32 s39,s24,3
s_mul_i32 s39,s39,2304
s_lshr_b32 s40,s24,3
s_lshl_b32 s40,s40,6
s_add_u32 s39,s39,s40
s_bfe_u32 s40,s24,0x10002
s_lshl_b32 s40,s40,4
s_add_u32 s39,s39,s40
buffer_load_ushort v31,v29,s[12:15],s39 offen
buffer_load_ushort v32,v29,s[12:15],s39 offen offset:32
v_and_b32 v28,3,v18
v_bfe_u32 v30,v18,4,1
v_lshrrev_b32 v29,5,v18
v_mul_u32_u24 v29,1152,v29
v_lshl_add_u32 v28,v28,1,v30
v_lshl_add_u32 v29,v28,1,v29
s_and_b32 s39,s24,3
s_mul_i32 s39,s39,2304
s_lshr_b32 s40,s24,3
s_lshl_b32 s40,s40,6
s_add_u32 s39,s39,s40
s_bfe_u32 s40,s24,0x10002
s_lshl_b32 s40,s40,4
s_add_u32 s39,s39,s40
buffer_load_ushort v33,v29,s[12:15],s39 offen offset:768
buffer_load_ushort v34,v29,s[12:15],s39 offen offset:800
s_waitcnt vmcnt(0)
v_lshl_or_b32 v28,v32,16,v31
v_min_u32 v8,-2,v28
v_bfe_u32 v29,v0,6,2
v_lshl_add_u32 v29,v29,11,v7
buffer_store_dword v8,v29,s[8:11],s30 offen
v_lshl_or_b32 v28,v34,16,v33
v_min_u32_e64 v11,-2,v28
buffer_store_dword v11,v7,s[8:11],s31 offen
s_mov_b32 s63,6308092
v_mov_b32 v12,0
ch1_idle:
s_sleep 16
buffer_load_dword v13,v12,s[8:11],s63 offen sc1
s_add_u32 s38,s38,1
s_cmp_gt_u32 s38,2000000
s_cbranch_scc1 ch1_fail
s_waitcnt vmcnt(0)
v_cmp_eq_u32 vcc,0,v13
s_cbranch_vccnz ch1_idle
s_branch ch1_layer
ch1_fail:
s_waitcnt vmcnt(0) lgkmcnt(0)
s_endpgm
c_w2:
v_mov_b32 v10,v0
v_and_b32 v11,15,v10
v_lshrrev_b32 v12,4,v10
v_lshlrev_b32 v13,4,v10
v_add_u32 v3,86016,v13
v_add_u32 v0,0,v13
v_lshlrev_b32 v13,3,v10
v_lshrrev_b32 v14,5,v10
v_lshlrev_b32 v14,6,v14
v_xor_b32 v1,v14,v13
v_lshlrev_b32 v13,2,v11
v_lshl_add_u32 v2,v12,11,v13
v_and_b32 v13,3,v10
v_lshrrev_b32 v14,2,v10
v_lshlrev_b32 v15,7,v13
v_lshl_add_u32 v15,v14,3,v15
v_lshrrev_b32 v16,1,v13
v_lshlrev_b32 v16,6,v16
v_xor_b32 v4,v16,v15
v_and_b32 v15,1,v10
v_lshlrev_b32 v15,4,v15
v_lshl_add_u32 v9,v14,5,v15
s_mov_b32 s46,0xcccccccc
s_mov_b32 s47,0xcccccccc
s_mov_b32 s48,0x33333333
s_mov_b32 s49,0x33333333
v_mov_b32 v15,0x4444
v_mov_b32 v16,0xeeee
v_cndmask_b32 v5,v15,v16,s[46:47]
v_lshrrev_b32 v15,3,v11
v_lshl_add_u32 v15,v15,2,v12
v_lshlrev_b32 v15,11,v15
v_and_b32_e64 v17,7,v11
v_lshl_add_u32 v6,v17,3,v15
v_and_b32 v15,2,v11
v_lshrrev_b32 v16,1,v12
v_add_u32 v15,v15,v16
v_lshlrev_b32 v15,4,v15
v_and_b32 v16,1,v11
v_and_b32 v17,1,v12
v_lshl_add_u32 v16,v16,1,v17
v_lshl_add_u32 v7,v16,2,v15
v_lshrrev_b32 v17,4,v10
v_and_b32 v18,15,v10
v_lshlrev_b32 v16,1,v17
v_xor_b32 v16,v16,v18
v_lshlrev_b32 v16,4,v16
v_bfe_u32 v18,v10,2,3
v_lshlrev_b32 v18,1,v18
v_bfe_u32 v245,v10,1,1
v_add_u32 v245,8,v245
v_xor_b32 v245,v245,v18
v_lshlrev_b32 v245,4,v245
v_and_b32 v18,1,v10
v_lshl_add_u32 v245,v18,3,v245
v_bfe_u32 v18,v10,2,2
v_lshl_add_u32 v17,v17,3,v18
v_lshl_add_u32 v244,v17,8,v245
v_xor_b32 v245,32,v244
v_bfe_u32 v17,v10,4,1
v_lshrrev_b32 v18,5,v10
v_lshlrev_b32_e64 v19,2,v18
v_lshl_add_u32 v19,v17,4,v19
v_lshl_add_u32 v240,v19,13,v16
v_xor_b32 v241,0x80,v240
v_lshl_add_u32 v19,v18,3,v17
v_lshl_add_u32 v242,v19,13,v16
v_xor_b32 v243,0x80,v242
v_lshrrev_b32 v84,5,v10
v_and_b32 v85,31,v10
v_lshlrev_b32 v86,2,v84
v_xor_b32 v85,v85,v86
v_xor_b32 v85,8,v85
v_mul_u32_u24 v84,1152,v84
v_lshl_add_u32 v11,v85,4,v84
v_lshrrev_b32 v84,3,v10
v_mul_u32_u24 v84,1152,v84
v_and_b32_e64 v85,7,v10
v_lshl_add_u32 v12,v85,4,v84
v_bfe_u32 v84,v10,2,1
v_bfe_u32 v85,v10,4,1
v_lshl_add_u32 v86,v85,1,v84
v_xor_b32 v86,2,v86
v_lshlrev_b32 v86,6,v86
v_bfe_u32 v87,v10,3,1
v_lshl_add_u32 v86,v87,5,v86
v_and_b32 v87,3,v10
v_lshl_add_u32 v86,v87,3,v86
v_lshl_add_u32 v84,v85,4,v84
v_lshrrev_b32 v85,5,v10
v_lshl_add_u32 v84,v85,2,v84
v_lshl_add_u32 v13,v84,9,v86
v_lshrrev_b32 v84,2,v10
v_lshlrev_b32 v84,7,v84
v_lshl_add_u32 v84,v87,3,v84
v_add_u32 v14,64,v84
s_lshl_b32 s56,s24,8
s_mul_i32 s32,s24,147456
s_barrier
s_add_u32 s60,s56,262144
s_mov_b32 m0,38912
s_nop 0
buffer_load_dwordx4 v240,s[80:83],s60 offen lds
s_add_u32 s60,s56,270336
s_mov_b32 m0,39936
s_nop 0
buffer_load_dwordx4 v240,s[80:83],s60 offen lds
s_add_u32 s60,s56,278528
s_mov_b32 m0,40960
s_nop 0
buffer_load_dwordx4 v241,s[80:83],s60 offen lds
s_add_u32 s60,s56,286720
s_mov_b32 m0,41984
s_nop 0
buffer_load_dwordx4 v241,s[80:83],s60 offen lds
s_add_u32 s60,s56,786432
s_mov_b32 m0,77824
s_nop 0
buffer_load_dwordx4 v240,s[80:83],s60 offen lds
s_add_u32 s60,s56,794624
s_mov_b32 m0,78848
s_nop 0
buffer_load_dwordx4 v240,s[80:83],s60 offen lds
s_add_u32 s60,s56,802816
s_mov_b32 m0,79872
s_nop 0
buffer_load_dwordx4 v241,s[80:83],s60 offen lds
s_add_u32 s60,s56,811008
s_mov_b32 m0,80896
s_nop 0
buffer_load_dwordx4 v241,s[80:83],s60 offen lds
s_add_u32 s60,s56,1310720
s_mov_b32 m0,116736
s_nop 0
buffer_load_dwordx4 v240,s[80:83],s60 offen lds
s_add_u32 s60,s56,1318912
s_mov_b32 m0,117760
s_nop 0
buffer_load_dwordx4 v240,s[80:83],s60 offen lds
s_add_u32 s60,s56,1327104
s_mov_b32 m0,118784
s_nop 0
buffer_load_dwordx4 v241,s[80:83],s60 offen lds
s_add_u32 s60,s56,1335296
s_mov_b32 m0,119808
s_nop 0
buffer_load_dwordx4 v241,s[80:83],s60 offen lds
s_waitcnt vmcnt(8) lgkmcnt(0)
s_barrier
s_add_u32 s60,s56,1835008
s_mov_b32 m0,155648
s_nop 0
buffer_load_dwordx4 v240,s[80:83],s60 offen lds
s_add_u32 s60,s56,1843200
s_mov_b32 m0,156672
s_nop 0
buffer_load_dwordx4 v240,s[80:83],s60 offen lds
s_add_u32 s60,s56,1851392
s_mov_b32 m0,157696
s_nop 0
buffer_load_dwordx4 v241,s[80:83],s60 offen lds
s_add_u32 s60,s56,1859584
s_mov_b32 m0,158720
s_nop 0
buffer_load_dwordx4 v241,s[80:83],s60 offen lds
v_add_u32 v15,30720,v244
ds_read_b64_tr_b16 a[0:1],v15
ds_read_b64_tr_b16 a[2:3],v15 offset:1024
ds_read_b64_tr_b16 a[4:5],v15 offset:8192
ds_read_b64_tr_b16 a[6:7],v15 offset:9216
v_add_u32 v246,30720,v245
ds_read_b64_tr_b16 v[80:81],v246
ds_read_b64_tr_b16 v[82:83],v246 offset:1024
ds_read_b64_tr_b16 v[84:85],v246 offset:8192
ds_read_b64_tr_b16 v[86:87],v246 offset:9216
s_waitcnt lgkmcnt(0)
ds_write_b128 v3,v[80:83] offset:2048
ds_write_b128 v3,v[84:87] offset:3072
s_waitcnt vmcnt(8) lgkmcnt(0)
s_barrier
s_add_u32 s60,s56,2359296
s_mov_b32 m0,38912
s_nop 0
buffer_load_dwordx4 v240,s[80:83],s60 offen lds
s_add_u32 s60,s56,2367488
s_mov_b32 m0,39936
s_nop 0
buffer_load_dwordx4 v240,s[80:83],s60 offen lds
s_add_u32 s60,s56,2375680
s_mov_b32 m0,40960
s_nop 0
buffer_load_dwordx4 v241,s[80:83],s60 offen lds
s_add_u32 s60,s56,2383872
s_mov_b32 m0,41984
s_nop 0
buffer_load_dwordx4 v241,s[80:83],s60 offen lds
v_add_u32 v15,69632,v244
ds_read_b64_tr_b16 a[32:33],v15
ds_read_b64_tr_b16 a[34:35],v15 offset:1024
ds_read_b64_tr_b16 a[36:37],v15 offset:8192
ds_read_b64_tr_b16 a[38:39],v15 offset:9216
v_add_u32 v246,69632,v245
ds_read_b64_tr_b16 v[80:81],v246
ds_read_b64_tr_b16 v[82:83],v246 offset:1024
ds_read_b64_tr_b16 v[84:85],v246 offset:8192
ds_read_b64_tr_b16 v[86:87],v246 offset:9216
s_waitcnt lgkmcnt(0)
ds_write_b128 v3,v[80:83] offset:6144
ds_write_b128 v3,v[84:87] offset:7168
s_waitcnt vmcnt(8) lgkmcnt(0)
s_barrier
s_add_u32 s60,s56,2883584
s_mov_b32 m0,77824
s_nop 0
buffer_load_dwordx4 v240,s[80:83],s60 offen lds
s_add_u32 s60,s56,2891776
s_mov_b32 m0,78848
s_nop 0
buffer_load_dwordx4 v240,s[80:83],s60 offen lds
s_add_u32 s60,s56,2899968
s_mov_b32 m0,79872
s_nop 0
buffer_load_dwordx4 v241,s[80:83],s60 offen lds
s_add_u32 s60,s56,2908160
s_mov_b32 m0,80896
s_nop 0
buffer_load_dwordx4 v241,s[80:83],s60 offen lds
v_add_u32 v15,108544,v244
ds_read_b64_tr_b16 a[64:65],v15
ds_read_b64_tr_b16 a[66:67],v15 offset:1024
ds_read_b64_tr_b16 a[68:69],v15 offset:8192
ds_read_b64_tr_b16 a[70:71],v15 offset:9216
v_add_u32 v246,108544,v245
ds_read_b64_tr_b16 v[80:81],v246
ds_read_b64_tr_b16 v[82:83],v246 offset:1024
ds_read_b64_tr_b16 v[84:85],v246 offset:8192
ds_read_b64_tr_b16 v[86:87],v246 offset:9216
s_waitcnt lgkmcnt(0)
ds_write_b128 v3,v[80:83] offset:10240
ds_write_b128 v3,v[84:87] offset:11264
s_nop 0
s_barrier
s_cmp_eq_u32 s21,0
s_cbranch_scc0 ann_83
v_mov_b32 v40,s2
v_mov_b32 v41,s3
s_mov_b64 exec,1
global_store_byte v40,v41,s[4:5] sc1
s_mov_b64 exec,-1
ann_83:
s_waitcnt vmcnt(8) lgkmcnt(0)
s_barrier
s_add_u32 s60,s56,3407872
s_mov_b32 m0,116736
s_nop 0
buffer_load_dwordx4 v240,s[80:83],s60 offen lds
s_add_u32 s60,s56,3416064
s_mov_b32 m0,117760
s_nop 0
buffer_load_dwordx4 v240,s[80:83],s60 offen lds
s_add_u32 s60,s56,3424256
s_mov_b32 m0,118784
s_nop 0
buffer_load_dwordx4 v241,s[80:83],s60 offen lds
s_add_u32 s60,s56,3432448
s_mov_b32 m0,119808
s_nop 0
buffer_load_dwordx4 v241,s[80:83],s60 offen lds
v_add_u32 v15,147456,v244
ds_read_b64_tr_b16 a[96:97],v15
ds_read_b64_tr_b16 a[98:99],v15 offset:1024
ds_read_b64_tr_b16 a[100:101],v15 offset:8192
ds_read_b64_tr_b16 a[102:103],v15 offset:9216
v_add_u32 v246,147456,v245
ds_read_b64_tr_b16 v[80:81],v246
ds_read_b64_tr_b16 v[82:83],v246 offset:1024
ds_read_b64_tr_b16 v[84:85],v246 offset:8192
ds_read_b64_tr_b16 v[86:87],v246 offset:9216
s_waitcnt lgkmcnt(0)
ds_write_b128 v3,v[80:83] offset:14336
ds_write_b128 v3,v[84:87] offset:15360
s_waitcnt vmcnt(8) lgkmcnt(0)
s_barrier
s_add_u32 s60,s56,3932160
s_mov_b32 m0,155648
s_nop 0
buffer_load_dwordx4 v240,s[80:83],s60 offen lds
s_add_u32 s60,s56,3940352
s_mov_b32 m0,156672
s_nop 0
buffer_load_dwordx4 v240,s[80:83],s60 offen lds
s_add_u32 s60,s56,3948544
s_mov_b32 m0,157696
s_nop 0
buffer_load_dwordx4 v241,s[80:83],s60 offen lds
s_add_u32 s60,s56,3956736
s_mov_b32 m0,158720
s_nop 0
buffer_load_dwordx4 v241,s[80:83],s60 offen lds
v_add_u32 v15,30720,v244
ds_read_b64_tr_b16 a[128:129],v15
ds_read_b64_tr_b16 a[130:131],v15 offset:1024
ds_read_b64_tr_b16 a[132:133],v15 offset:8192
ds_read_b64_tr_b16 a[134:135],v15 offset:9216
v_add_u32 v246,30720,v245
ds_read_b64_tr_b16 v[80:81],v246
ds_read_b64_tr_b16 v[82:83],v246 offset:1024
ds_read_b64_tr_b16 v[84:85],v246 offset:8192
ds_read_b64_tr_b16 v[86:87],v246 offset:9216
s_waitcnt lgkmcnt(0)
ds_write_b128 v3,v[80:83] offset:18432
ds_write_b128 v3,v[84:87] offset:19456
s_waitcnt vmcnt(8) lgkmcnt(0)
s_barrier
s_add_u32 s60,s56,4456448
s_mov_b32 m0,38912
s_nop 0
buffer_load_dwordx4 v242,s[80:83],s60 offen lds
s_add_u32 s60,s56,4472832
s_mov_b32 m0,39936
s_nop 0
buffer_load_dwordx4 v242,s[80:83],s60 offen lds
s_add_u32 s60,s56,4489216
s_mov_b32 m0,40960
s_nop 0
buffer_load_dwordx4 v243,s[80:83],s60 offen lds
s_add_u32 s60,s56,4505600
s_mov_b32 m0,41984
s_nop 0
buffer_load_dwordx4 v243,s[80:83],s60 offen lds
v_add_u32 v15,69632,v244
ds_read_b64_tr_b16 a[152:153],v15
ds_read_b64_tr_b16 a[154:155],v15 offset:1024
ds_read_b64_tr_b16 a[156:157],v15 offset:8192
ds_read_b64_tr_b16 a[158:159],v15 offset:9216
v_add_u32 v246,69632,v245
ds_read_b64_tr_b16 a[160:161],v246
ds_read_b64_tr_b16 a[162:163],v246 offset:1024
ds_read_b64_tr_b16 a[164:165],v246 offset:8192
ds_read_b64_tr_b16 a[166:167],v246 offset:9216
s_waitcnt vmcnt(8) lgkmcnt(0)
s_barrier
s_add_u32 s60,s56,262144
s_mov_b32 m0,77824
s_nop 0
buffer_load_dwordx4 v240,s[76:79],s60 offen lds
s_add_u32 s60,s56,270336
s_mov_b32 m0,78848
s_nop 0
buffer_load_dwordx4 v240,s[76:79],s60 offen lds
s_add_u32 s60,s56,278528
s_mov_b32 m0,79872
s_nop 0
buffer_load_dwordx4 v241,s[76:79],s60 offen lds
s_add_u32 s60,s56,286720
s_mov_b32 m0,80896
s_nop 0
buffer_load_dwordx4 v241,s[76:79],s60 offen lds
v_add_u32 v15,108544,v244
ds_read_b64_tr_b16 v[64:65],v15
ds_read_b64_tr_b16 v[66:67],v15 offset:1024
ds_read_b64_tr_b16 v[68:69],v15 offset:8192
ds_read_b64_tr_b16 v[70:71],v15 offset:9216
v_add_u32 v246,108544,v245
ds_read_b64_tr_b16 a[184:185],v246
ds_read_b64_tr_b16 a[186:187],v246 offset:1024
ds_read_b64_tr_b16 a[188:189],v246 offset:8192
ds_read_b64_tr_b16 a[190:191],v246 offset:9216
v_lshlrev_b32 v40,2,v10
global_load_dword v41,v40,s[4:5] sc1
v_and_b32 v28,3,v10
v_bfe_u32 v30,v10,4,1
v_lshrrev_b32_e64 v29,5,v10
v_mul_u32_u24 v29,1152,v29
v_lshl_add_u32 v28,v28,1,v30
v_lshl_add_u32 v29,v28,1,v29
s_and_b32 s39,s24,3
s_mul_i32 s39,s39,2304
s_lshr_b32 s40,s24,3
s_lshl_b32 s40,s40,6
s_add_u32 s39,s39,s40
s_bfe_u32 s40,s24,0x10002
s_lshl_b32 s40,s40,4
s_add_u32 s39,s39,s40
buffer_load_ushort v31,v29,s[12:15],s39 offen offset:256
buffer_load_ushort v32,v29,s[12:15],s39 offen offset:288
v_and_b32 v28,3,v10
v_bfe_u32 v30,v10,4,1
v_lshrrev_b32 v29,5,v10
v_mul_u32_u24 v29,1152,v29
v_lshl_add_u32 v28,v28,1,v30
v_lshl_add_u32 v29,v28,2,v29
s_and_b32 s39,s24,3
s_mul_i32 s39,s39,2304
s_lshr_b32 s40,s24,2
s_lshl_b32 s40,s40,5
s_add_u32 s39,s39,s40
buffer_load_ushort v33,v29,s[12:15],s39 offen offset:1024
buffer_load_ushort v34,v29,s[12:15],s39 offen offset:1026
s_waitcnt vmcnt(8) lgkmcnt(0)
s_barrier
s_add_u32 s60,s56,786432
s_mov_b32 m0,116736
s_nop 0
buffer_load_dwordx4 v240,s[76:79],s60 offen lds
s_add_u32 s60,s56,794624
s_mov_b32 m0,117760
s_nop 0
buffer_load_dwordx4 v240,s[76:79],s60 offen lds
s_add_u32 s60,s56,802816
s_mov_b32 m0,118784
s_nop 0
buffer_load_dwordx4 v241,s[76:79],s60 offen lds
s_add_u32 s60,s56,811008
s_mov_b32 m0,119808
s_nop 0
buffer_load_dwordx4 v241,s[76:79],s60 offen lds
v_add_u32 v15,147456,v244
ds_read_b64_tr_b16 a[208:209],v15
ds_read_b64_tr_b16 a[210:211],v15 offset:1024
ds_read_b64_tr_b16 a[212:213],v15 offset:8192
ds_read_b64_tr_b16 a[214:215],v15 offset:9216
v_add_u32 v246,147456,v245
ds_read_b64_tr_b16 v[72:73],v246
ds_read_b64_tr_b16 v[74:75],v246 offset:1024
ds_read_b64_tr_b16 v[76:77],v246 offset:8192
ds_read_b64_tr_b16 v[78:79],v246 offset:9216
s_waitcnt vmcnt(8) lgkmcnt(0)
s_barrier
s_add_u32 s60,s56,1310720
s_mov_b32 m0,155648
s_nop 0
buffer_load_dwordx4 v240,s[76:79],s60 offen lds
s_add_u32 s60,s56,1318912
s_mov_b32 m0,156672
s_nop 0
buffer_load_dwordx4 v240,s[76:79],s60 offen lds
s_add_u32 s60,s56,1327104
s_mov_b32 m0,157696
s_nop 0
buffer_load_dwordx4 v241,s[76:79],s60 offen lds
s_add_u32 s60,s56,1335296
s_mov_b32 m0,158720
s_nop 0
buffer_load_dwordx4 v241,s[76:79],s60 offen lds
v_add_u32 v15,30720,v244
ds_read_b64_tr_b16 a[216:217],v15
ds_read_b64_tr_b16 a[218:219],v15 offset:1024
ds_read_b64_tr_b16 a[220:221],v15 offset:8192
ds_read_b64_tr_b16 a[222:223],v15 offset:9216
v_add_u32 v246,30720,v245
ds_read_b64_tr_b16 a[224:225],v246
ds_read_b64_tr_b16 a[226:227],v246 offset:1024
ds_read_b64_tr_b16 a[228:229],v246 offset:8192
ds_read_b64_tr_b16 a[230:231],v246 offset:9216
s_waitcnt vmcnt(8) lgkmcnt(0)
s_barrier
s_add_u32 s60,s56,1835008
s_mov_b32 m0,38912
s_nop 0
buffer_load_dwordx4 v240,s[76:79],s60 offen lds
s_add_u32 s60,s56,1843200
s_mov_b32 m0,39936
s_nop 0
buffer_load_dwordx4 v240,s[76:79],s60 offen lds
s_add_u32 s60,s56,1851392
s_mov_b32 m0,40960
s_nop 0
buffer_load_dwordx4 v241,s[76:79],s60 offen lds
s_add_u32 s60,s56,1859584
s_mov_b32 m0,41984
s_nop 0
buffer_load_dwordx4 v241,s[76:79],s60 offen lds
v_add_u32 v15,69632,v244
ds_read_b64_tr_b16 v[80:81],v15
ds_read_b64_tr_b16 v[82:83],v15 offset:1024
ds_read_b64_tr_b16 v[84:85],v15 offset:8192
ds_read_b64_tr_b16 v[86:87],v15 offset:9216
s_waitcnt lgkmcnt(0)
ds_write_b128 v3,v[80:83]
ds_write_b128 v3,v[84:87] offset:1024
v_add_u32 v246,69632,v245
ds_read_b64_tr_b16 a[8:9],v246
ds_read_b64_tr_b16 a[10:11],v246 offset:1024
ds_read_b64_tr_b16 a[12:13],v246 offset:8192
ds_read_b64_tr_b16 a[14:15],v246 offset:9216
s_waitcnt vmcnt(8) lgkmcnt(0)
s_barrier
s_add_u32 s60,s56,2359296
s_mov_b32 m0,77824
s_nop 0
buffer_load_dwordx4 v240,s[76:79],s60 offen lds
s_add_u32 s60,s56,2367488
s_mov_b32 m0,78848
s_nop 0
buffer_load_dwordx4 v240,s[76:79],s60 offen lds
s_add_u32 s60,s56,2375680
s_mov_b32 m0,79872
s_nop 0
buffer_load_dwordx4 v241,s[76:79],s60 offen lds
s_add_u32 s60,s56,2383872
s_mov_b32 m0,80896
s_nop 0
buffer_load_dwordx4 v241,s[76:79],s60 offen lds
v_add_u32 v15,108544,v244
ds_read_b64_tr_b16 v[80:81],v15
ds_read_b64_tr_b16 v[82:83],v15 offset:1024
ds_read_b64_tr_b16 v[84:85],v15 offset:8192
ds_read_b64_tr_b16 v[86:87],v15 offset:9216
s_waitcnt lgkmcnt(0)
ds_write_b128 v3,v[80:83] offset:4096
ds_write_b128 v3,v[84:87] offset:5120
v_add_u32 v246,108544,v245
ds_read_b64_tr_b16 a[40:41],v246
ds_read_b64_tr_b16 a[42:43],v246 offset:1024
ds_read_b64_tr_b16 a[44:45],v246 offset:8192
ds_read_b64_tr_b16 a[46:47],v246 offset:9216
s_cmp_lg_u32 s19,0
s_cbranch_scc1 ver_84
s_mov_b32 s19,1
v_mbcnt_lo_u32_b32 v46,-1,0
v_mbcnt_hi_u32_b32 v46,-1,v46
v_lshlrev_b32_e64 v40,2,v46
s_mov_b32 s63,0
s_branch el_85s
el_85:
global_load_dword v41,v40,s[4:5] sc1
s_add_u32 s63,s63,1
s_cmp_gt_u32 s63,4000000
s_cbranch_scc1 ch2_fail
s_waitcnt vmcnt(0)
el_85s:
v_bfe_u32 v42,v41,0,8
v_bfe_u32 v43,v41,8,8
v_bfe_u32 v44,v41,16,8
v_bfe_u32 v45,v41,24,8
v_min_u32 v41,v42,v43
v_min3_u32 v41,v41,v44,v45
v_cmp_eq_u32 vcc,0,v41
s_cbranch_vccnz el_85
s_mov_b32 s62,0
elw_86:
s_add_u32 s62,s62,1
s_mov_b32 s61,0
v_cmp_eq_u32 vcc,s62,v42
s_bcnt1_i32_b64 s60,vcc
s_add_u32 s61,s61,s60
v_cmp_eq_u32 vcc,s62,v43
s_bcnt1_i32_b64 s60,vcc
s_add_u32 s61,s61,s60
v_cmp_eq_u32 vcc,s62,v44
s_bcnt1_i32_b64 s60,vcc
s_add_u32 s61,s61,s60
v_cmp_eq_u32 vcc,s62,v45
s_bcnt1_i32_b64 s60,vcc
s_add_u32 s61,s61,s60
s_cmp_ge_u32 s62,16
s_cbranch_scc1 ch2_fail
s_cmp_lt_u32 s61,32
s_cbranch_scc1 elw_86
s_mov_b32 s61,0
s_mov_b32 s63,0
v_cmp_gt_u32 vcc,s3,v42
s_bcnt1_i32_b64 s60,vcc
s_add_u32 s63,s63,s60
v_add_u32 v41,0,v40
v_cmp_gt_u32 s[16:17],s2,v41
v_cmp_eq_u32 vcc,s3,v42
s_and_b64 vcc,vcc,s[16:17]
s_bcnt1_i32_b64 s60,vcc
s_add_u32 s61,s61,s60
v_cmp_gt_u32 vcc,s3,v43
s_bcnt1_i32_b64 s60,vcc
s_add_u32 s63,s63,s60
v_add_u32 v41,1,v40
v_cmp_gt_u32 s[16:17],s2,v41
v_cmp_eq_u32 vcc,s3,v43
s_and_b64 vcc,vcc,s[16:17]
s_bcnt1_i32_b64 s60,vcc
s_add_u32 s61,s61,s60
v_cmp_gt_u32 vcc,s3,v44
s_bcnt1_i32_b64 s60,vcc
s_add_u32 s63,s63,s60
v_add_u32 v41,2,v40
v_cmp_gt_u32 s[16:17],s2,v41
v_cmp_eq_u32 vcc,s3,v44
s_and_b64 vcc,vcc,s[16:17]
s_bcnt1_i32_b64 s60,vcc
s_add_u32 s61,s61,s60
v_cmp_gt_u32 vcc,s3,v45
s_bcnt1_i32_b64 s60,vcc
s_add_u32 s63,s63,s60
v_add_u32 v41,3,v40
v_cmp_gt_u32 s[16:17],s2,v41
v_cmp_eq_u32 vcc,s3,v45
s_and_b64 vcc,vcc,s[16:17]
s_bcnt1_i32_b64 s60,vcc
s_add_u32 s61,s61,s60
s_add_u32 s18,s61,s63
s_cmp_gt_u32 s62,s3
s_cselect_b32 s60,32,0
s_add_u32 s18,s18,s60
s_cmp_lg_u32 s62,s3
s_cbranch_scc1 eld_87
s_cmp_lt_u32 s61,32
s_cselect_b32 s18,s61,s18
eld_87:
s_add_u32 s60,s24,0
s_cmp_eq_u32 s60,s18
s_cbranch_scc1 ver_84
s_mov_b32 s24,s18
s_mov_b32 s10,268435456
s_waitcnt vmcnt(0) lgkmcnt(0)
s_branch k_role
ver_84:
s_lshl_b32 s39,s24,6
s_add_u32 s34,s39,32768
s_add_u32 s41,s34,65536
s_add_u32 s35,s34,131072
s_add_u32 s44,s34,196608
s_add_u32 s36,s39,278528
s_add_u32 s30,s39,2105344
s_add_u32 s31,s39,2111488
s_and_b32 s27,s24,3
s_lshl_b32 s27,s27,11
s_add_u32 s27,s27,2097152
s_mov_b32 s28,2105344
s_mov_b32 s29,2109440
s_lshl_b32 s39,s24,11
s_add_u32 s37,s39,65536
s_mov_b32 s26,0
s_mov_b32 s42,1040356334
s_mov_b32 s18,0x3f803f80
s_mov_b32 s58,562036736
v_mov_b32 v20,-1
v_mov_b32 v21,-1
v_mov_b32 v22,-1
v_mov_b32_e64 v23,-1
s_add_u32 s45,s37,196608
s_cmp_ge_u32 s24,16
s_cselect_b32 s45,0x40000000,s45
buffer_load_dwordx4 v[24:27],v0,s[8:11],s37 offen sc1
buffer_load_dwordx4 v[24:27],v0,s[8:11],s37 offen offset:1024 sc1
s_add_u32 s39,s30,0x4000
buffer_load_dword v24,v7,s[8:11],s39 offen sc1
buffer_load_dword v24,v7,s[8:11],s30 offen sc1
buffer_load_dwordx4 v[24:27],v0,s[8:11],s45 offen sc1
buffer_load_dwordx4 v[24:27],v0,s[8:11],s45 offen offset:1024 sc1
s_add_u32 s39,s31,0x4000
buffer_load_dword v24,v7,s[8:11],s39 offen sc1
buffer_load_dword v24,v7,s[8:11],s31 offen sc1
v_lshl_or_b32 v28,v32,16,v31
v_min_u32_e64 v8,-2,v28
buffer_store_dword v8,v7,s[8:11],s30 offen
v_lshl_or_b32 v28,v34,16,v33
v_min_u32 v10,-2,v28
buffer_store_dword v10,v7,s[8:11],s31 offen
s_waitcnt vmcnt(8) lgkmcnt(0)
s_barrier
s_add_u32 s60,s56,2883584
s_mov_b32 m0,116736
s_nop 0
buffer_load_dwordx4 v240,s[76:79],s60 offen lds
s_add_u32 s60,s56,2891776
s_mov_b32 m0,117760
s_nop 0
buffer_load_dwordx4 v240,s[76:79],s60 offen lds
s_add_u32 s60,s56,2899968
s_mov_b32 m0,118784
s_nop 0
buffer_load_dwordx4 v241,s[76:79],s60 offen lds
s_add_u32 s60,s56,2908160
s_mov_b32 m0,119808
s_nop 0
buffer_load_dwordx4 v241,s[76:79],s60 offen lds
v_add_u32 v15,147456,v244
ds_read_b64_tr_b16 v[80:81],v15
ds_read_b64_tr_b16 v[82:83],v15 offset:1024
ds_read_b64_tr_b16 v[84:85],v15 offset:8192
ds_read_b64_tr_b16 v[86:87],v15 offset:9216
s_waitcnt lgkmcnt(0)
ds_write_b128 v3,v[80:83] offset:8192
ds_write_b128 v3,v[84:87] offset:9216
v_add_u32 v246,147456,v245
ds_read_b64_tr_b16 a[72:73],v246
ds_read_b64_tr_b16 a[74:75],v246 offset:1024
ds_read_b64_tr_b16 a[76:77],v246 offset:8192
ds_read_b64_tr_b16 a[78:79],v246 offset:9216
s_waitcnt vmcnt(8) lgkmcnt(0)
s_barrier
s_add_u32 s60,s56,3407872
s_mov_b32 m0,155648
s_nop 0
buffer_load_dwordx4 v240,s[76:79],s60 offen lds
s_add_u32 s60,s56,3416064
s_mov_b32 m0,156672
s_nop 0
buffer_load_dwordx4 v240,s[76:79],s60 offen lds
s_add_u32 s60,s56,3424256
s_mov_b32 m0,157696
s_nop 0
buffer_load_dwordx4 v241,s[76:79],s60 offen lds
s_add_u32 s60,s56,3432448
s_mov_b32 m0,158720
s_nop 0
buffer_load_dwordx4 v241,s[76:79],s60 offen lds
v_add_u32 v15,30720,v244
ds_read_b64_tr_b16 v[80:81],v15
ds_read_b64_tr_b16 v[82:83],v15 offset:1024
ds_read_b64_tr_b16 v[84:85],v15 offset:8192
ds_read_b64_tr_b16 v[86:87],v15 offset:9216
s_waitcnt lgkmcnt(0)
ds_write_b128 v3,v[80:83] offset:12288
ds_write_b128 v3,v[84:87] offset:13312
v_add_u32 v246,30720,v245
ds_read_b64_tr_b16 a[104:105],v246
ds_read_b64_tr_b16 a[106:107],v246 offset:1024
ds_read_b64_tr_b16 a[108:109],v246 offset:8192
ds_read_b64_tr_b16 a[110:111],v246 offset:9216
s_waitcnt vmcnt(8) lgkmcnt(0)
s_barrier
s_add_u32 s60,s56,3932160
s_mov_b32 m0,38912
s_nop 0
buffer_load_dwordx4 v240,s[76:79],s60 offen lds
s_add_u32 s60,s56,3940352
s_mov_b32 m0,39936
s_nop 0
buffer_load_dwordx4 v240,s[76:79],s60 offen lds
s_add_u32 s60,s56,3948544
s_mov_b32 m0,40960
s_nop 0
buffer_load_dwordx4 v241,s[76:79],s60 offen lds
s_add_u32 s60,s56,3956736
s_mov_b32 m0,41984
s_nop 0
buffer_load_dwordx4 v241,s[76:79],s60 offen lds
v_add_u32 v15,69632,v244
ds_read_b64_tr_b16 v[80:81],v15
ds_read_b64_tr_b16 v[82:83],v15 offset:1024
ds_read_b64_tr_b16 v[84:85],v15 offset:8192
ds_read_b64_tr_b16 v[86:87],v15 offset:9216
s_waitcnt lgkmcnt(0)
ds_write_b128 v3,v[80:83] offset:16384
ds_write_b128 v3,v[84:87] offset:17408
v_add_u32 v246,69632,v245
ds_read_b64_tr_b16 a[136:137],v246
ds_read_b64_tr_b16 a[138:139],v246 offset:1024
ds_read_b64_tr_b16 a[140:141],v246 offset:8192
ds_read_b64_tr_b16 a[142:143],v246 offset:9216
s_waitcnt vmcnt(8) lgkmcnt(0)
s_barrier
s_add_u32 s60,s56,4456448
s_mov_b32 m0,77824
s_nop 0
buffer_load_dwordx4 v242,s[76:79],s60 offen lds
s_add_u32 s60,s56,4472832
s_mov_b32 m0,78848
s_nop 0
buffer_load_dwordx4 v242,s[76:79],s60 offen lds
s_add_u32 s60,s56,4489216
s_mov_b32 m0,79872
s_nop 0
buffer_load_dwordx4 v243,s[76:79],s60 offen lds
s_add_u32 s60,s56,4505600
s_mov_b32 m0,80896
s_nop 0
buffer_load_dwordx4 v243,s[76:79],s60 offen lds
v_add_u32 v15,108544,v244
ds_read_b64_tr_b16 a[144:145],v15
ds_read_b64_tr_b16 a[146:147],v15 offset:1024
ds_read_b64_tr_b16 a[148:149],v15 offset:8192
ds_read_b64_tr_b16 a[150:151],v15 offset:9216
v_add_u32 v246,108544,v245
ds_read_b64_tr_b16 v[80:81],v246
ds_read_b64_tr_b16 v[82:83],v246 offset:1024
ds_read_b64_tr_b16 v[84:85],v246 offset:8192
ds_read_b64_tr_b16 v[86:87],v246 offset:9216
s_waitcnt lgkmcnt(0)
ds_write_b128 v3,v[80:83] offset:20480
ds_write_b128 v3,v[84:87] offset:21504
s_waitcnt vmcnt(8) lgkmcnt(0)
s_barrier
s_add_u32 s60,s56,262144
s_mov_b32 m0,116736
s_nop 0
buffer_load_dwordx4 v240,s[84:87],s60 offen lds
s_add_u32 s60,s56,270336
s_mov_b32 m0,117760
s_nop 0
buffer_load_dwordx4 v240,s[84:87],s60 offen lds
s_add_u32 s60,s56,278528
s_mov_b32 m0,118784
s_nop 0
buffer_load_dwordx4 v241,s[84:87],s60 offen lds
s_add_u32 s60,s56,286720
s_mov_b32 m0,119808
s_nop 0
buffer_load_dwordx4 v241,s[84:87],s60 offen lds
v_add_u32 v15,147456,v244
ds_read_b64_tr_b16 a[168:169],v15
ds_read_b64_tr_b16 a[170:171],v15 offset:1024
ds_read_b64_tr_b16 a[172:173],v15 offset:8192
ds_read_b64_tr_b16 a[174:175],v15 offset:9216
v_add_u32 v246,147456,v245
ds_read_b64_tr_b16 a[176:177],v246
ds_read_b64_tr_b16 a[178:179],v246 offset:1024
ds_read_b64_tr_b16 a[180:181],v246 offset:8192
ds_read_b64_tr_b16 a[182:183],v246 offset:9216
s_waitcnt vmcnt(8) lgkmcnt(0)
s_barrier
s_add_u32 s60,s56,786432
s_mov_b32 m0,155648
s_nop 0
buffer_load_dwordx4 v240,s[84:87],s60 offen lds
s_add_u32 s60,s56,794624
s_mov_b32 m0,156672
s_nop 0
buffer_load_dwordx4 v240,s[84:87],s60 offen lds
s_add_u32 s60,s56,802816
s_mov_b32 m0,157696
s_nop 0
buffer_load_dwordx4 v241,s[84:87],s60 offen lds
s_add_u32 s60,s56,811008
s_mov_b32 m0,158720
s_nop 0
buffer_load_dwordx4 v241,s[84:87],s60 offen lds
v_add_u32 v15,30720,v244
ds_read_b64_tr_b16 v[48:49],v15
ds_read_b64_tr_b16 v[50:51],v15 offset:1024
ds_read_b64_tr_b16 v[52:53],v15 offset:8192
ds_read_b64_tr_b16 v[54:55],v15 offset:9216
v_add_u32 v246,30720,v245
ds_read_b64_tr_b16 a[192:193],v246
ds_read_b64_tr_b16 a[194:195],v246 offset:1024
ds_read_b64_tr_b16 a[196:197],v246 offset:8192
ds_read_b64_tr_b16 a[198:199],v246 offset:9216
s_waitcnt vmcnt(8) lgkmcnt(0)
s_barrier
s_add_u32 s60,s56,1310720
s_mov_b32 m0,38912
s_nop 0
buffer_load_dwordx4 v240,s[84:87],s60 offen lds
s_add_u32 s60,s56,1318912
s_mov_b32 m0,39936
s_nop 0
buffer_load_dwordx4 v240,s[84:87],s60 offen lds
s_add_u32 s60,s56,1327104
s_mov_b32 m0,40960
s_nop 0
buffer_load_dwordx4 v241,s[84:87],s60 offen lds
s_add_u32 s60,s56,1335296
s_mov_b32 m0,41984
s_nop 0
buffer_load_dwordx4 v241,s[84:87],s60 offen lds
v_add_u32 v15,69632,v244
ds_read_b64_tr_b16 a[200:201],v15
ds_read_b64_tr_b16 a[202:203],v15 offset:1024
ds_read_b64_tr_b16 a[204:205],v15 offset:8192
ds_read_b64_tr_b16 a[206:207],v15 offset:9216
v_add_u32 v246,69632,v245
ds_read_b64_tr_b16 v[56:57],v246
ds_read_b64_tr_b16 v[58:59],v246 offset:1024
ds_read_b64_tr_b16 v[60:61],v246 offset:8192
ds_read_b64_tr_b16 v[62:63],v246 offset:9216
s_waitcnt vmcnt(8) lgkmcnt(0)
s_barrier
s_add_u32 s60,s56,1835008
s_mov_b32 m0,77824
s_nop 0
buffer_load_dwordx4 v240,s[84:87],s60 offen lds
s_add_u32 s60,s56,1843200
s_mov_b32 m0,78848
s_nop 0
buffer_load_dwordx4 v240,s[84:87],s60 offen lds
s_add_u32 s60,s56,1851392
s_mov_b32 m0,79872
s_nop 0
buffer_load_dwordx4 v241,s[84:87],s60 offen lds
s_add_u32 s60,s56,1859584
s_mov_b32 m0,80896
s_nop 0
buffer_load_dwordx4 v241,s[84:87],s60 offen lds
v_add_u32 v15,108544,v244
ds_read_b64_tr_b16 a[16:17],v15
ds_read_b64_tr_b16 a[18:19],v15 offset:1024
ds_read_b64_tr_b16 a[20:21],v15 offset:8192
ds_read_b64_tr_b16 a[22:23],v15 offset:9216
v_add_u32 v246,108544,v245
ds_read_b64_tr_b16 a[24:25],v246
ds_read_b64_tr_b16 a[26:27],v246 offset:1024
ds_read_b64_tr_b16 a[28:29],v246 offset:8192
ds_read_b64_tr_b16 a[30:31],v246 offset:9216
s_waitcnt vmcnt(8) lgkmcnt(0)
s_barrier
s_add_u32 s60,s56,2359296
s_mov_b32 m0,116736
s_nop 0
buffer_load_dwordx4 v240,s[84:87],s60 offen lds
s_add_u32 s60,s56,2367488
s_mov_b32 m0,117760
s_nop 0
buffer_load_dwordx4 v240,s[84:87],s60 offen lds
s_add_u32 s60,s56,2375680
s_mov_b32 m0,118784
s_nop 0
buffer_load_dwordx4 v241,s[84:87],s60 offen lds
s_add_u32 s60,s56,2383872
s_mov_b32 m0,119808
s_nop 0
buffer_load_dwordx4 v241,s[84:87],s60 offen lds
v_add_u32 v15,147456,v244
ds_read_b64_tr_b16 a[48:49],v15
ds_read_b64_tr_b16 a[50:51],v15 offset:1024
ds_read_b64_tr_b16 a[52:53],v15 offset:8192
ds_read_b64_tr_b16 a[54:55],v15 offset:9216
v_add_u32 v246,147456,v245
ds_read_b64_tr_b16 a[56:57],v246
ds_read_b64_tr_b16 a[58:59],v246 offset:1024
ds_read_b64_tr_b16 a[60:61],v246 offset:8192
ds_read_b64_tr_b16 a[62:63],v246 offset:9216
s_waitcnt vmcnt(8) lgkmcnt(0)
s_barrier
s_add_u32 s60,s56,2883584
s_mov_b32 m0,155648
s_nop 0
buffer_load_dwordx4 v240,s[84:87],s60 offen lds
s_add_u32 s60,s56,2891776
s_mov_b32 m0,156672
s_nop 0
buffer_load_dwordx4 v240,s[84:87],s60 offen lds
s_add_u32 s60,s56,2899968
s_mov_b32 m0,157696
s_nop 0
buffer_load_dwordx4 v241,s[84:87],s60 offen lds
s_add_u32 s60,s56,2908160
s_mov_b32 m0,158720
s_nop 0
buffer_load_dwordx4 v241,s[84:87],s60 offen lds
v_add_u32 v15,30720,v244
ds_read_b64_tr_b16 a[80:81],v15
ds_read_b64_tr_b16 a[82:83],v15 offset:1024
ds_read_b64_tr_b16 a[84:85],v15 offset:8192
ds_read_b64_tr_b16 a[86:87],v15 offset:9216
v_add_u32 v246,30720,v245
ds_read_b64_tr_b16 a[88:89],v246
ds_read_b64_tr_b16 a[90:91],v246 offset:1024
ds_read_b64_tr_b16 a[92:93],v246 offset:8192
ds_read_b64_tr_b16 a[94:95],v246 offset:9216
s_waitcnt vmcnt(8) lgkmcnt(0)
s_barrier
s_add_u32 s60,s56,3407872
s_mov_b32 m0,38912
s_nop 0
buffer_load_dwordx4 v240,s[84:87],s60 offen lds
s_add_u32 s60,s56,3416064
s_mov_b32 m0,39936
s_nop 0
buffer_load_dwordx4 v240,s[84:87],s60 offen lds
s_add_u32 s60,s56,3424256
s_mov_b32 m0,40960
s_nop 0
buffer_load_dwordx4 v241,s[84:87],s60 offen lds
s_add_u32 s60,s56,3432448
s_mov_b32 m0,41984
s_nop 0
buffer_load_dwordx4 v241,s[84:87],s60 offen lds
v_add_u32 v15,69632,v244
ds_read_b64_tr_b16 a[112:113],v15
ds_read_b64_tr_b16 a[114:115],v15 offset:1024
ds_read_b64_tr_b16 a[116:117],v15 offset:8192
ds_read_b64_tr_b16 a[118:119],v15 offset:9216
v_add_u32 v246,69632,v245
ds_read_b64_tr_b16 a[120:121],v246
ds_read_b64_tr_b16 a[122:123],v246 offset:1024
ds_read_b64_tr_b16 a[124:125],v246 offset:8192
ds_read_b64_tr_b16 a[126:127],v246 offset:9216
s_waitcnt vmcnt(8) lgkmcnt(0)
s_barrier
s_add_u32 s60,s56,3932160
s_mov_b32 m0,77824
s_nop 0
buffer_load_dwordx4 v240,s[84:87],s60 offen lds
s_add_u32 s60,s56,3940352
s_mov_b32 m0,78848
s_nop 0
buffer_load_dwordx4 v240,s[84:87],s60 offen lds
s_add_u32 s60,s56,3948544
s_mov_b32 m0,79872
s_nop 0
buffer_load_dwordx4 v241,s[84:87],s60 offen lds
s_add_u32 s60,s56,3956736
s_mov_b32 m0,80896
s_nop 0
buffer_load_dwordx4 v241,s[84:87],s60 offen lds
v_add_u32 v15,108544,v244
ds_read_b64_tr_b16 a[232:233],v15
ds_read_b64_tr_b16 a[234:235],v15 offset:1024
ds_read_b64_tr_b16 a[236:237],v15 offset:8192
ds_read_b64_tr_b16 a[238:239],v15 offset:9216
v_add_u32 v246,108544,v245
ds_read_b64_tr_b16 a[240:241],v246
ds_read_b64_tr_b16 a[242:243],v246 offset:1024
ds_read_b64_tr_b16 a[244:245],v246 offset:8192
ds_read_b64_tr_b16 a[246:247],v246 offset:9216
s_waitcnt vmcnt(8) lgkmcnt(0)
s_barrier
s_add_u32 s60,s56,4456448
s_mov_b32 m0,116736
s_nop 0
buffer_load_dwordx4 v242,s[84:87],s60 offen lds
s_add_u32 s60,s56,4472832
s_mov_b32 m0,117760
s_nop 0
buffer_load_dwordx4 v242,s[84:87],s60 offen lds
s_add_u32 s60,s56,4489216
s_mov_b32 m0,118784
s_nop 0
buffer_load_dwordx4 v243,s[84:87],s60 offen lds
s_add_u32 s60,s56,4505600
s_mov_b32 m0,119808
s_nop 0
buffer_load_dwordx4 v243,s[84:87],s60 offen lds
v_add_u32 v15,147456,v244
ds_read_b64_tr_b16 a[248:249],v15
ds_read_b64_tr_b16 a[250:251],v15 offset:1024
ds_read_b64_tr_b16 a[252:253],v15 offset:8192
ds_read_b64_tr_b16 a[254:255],v15 offset:9216
v_add_u32 v246,147456,v245
ds_read_b64_tr_b16 v[88:89],v246
ds_read_b64_tr_b16 v[90:91],v246 offset:1024
ds_read_b64_tr_b16 v[92:93],v246 offset:8192
ds_read_b64_tr_b16 v[94:95],v246 offset:9216
s_waitcnt vmcnt(8) lgkmcnt(0)
s_barrier
s_add_u32 s60,s32,18432
s_mov_b32 m0,155648
s_nop 0
buffer_load_dwordx4 v11,s[88:91],s60 offen lds
s_add_u32 s60,s32,20736
s_mov_b32 m0,156672
s_nop 0
buffer_load_dwordx4 v11,s[88:91],s60 offen lds
s_add_u32 s60,s32,23040
s_mov_b32 m0,157696
s_nop 0
buffer_load_dwordx4 v11,s[88:91],s60 offen lds
s_add_u32 s60,s32,25344
s_mov_b32 m0,158720
s_nop 0
buffer_load_dwordx4 v11,s[88:91],s60 offen lds
v_add_u32 v15,30720,v244
ds_read_b64_tr_b16 v[96:97],v15
ds_read_b64_tr_b16 v[98:99],v15 offset:1024
ds_read_b64_tr_b16 v[100:101],v15 offset:8192
ds_read_b64_tr_b16 v[102:103],v15 offset:9216
v_add_u32 v246,30720,v245
ds_read_b64_tr_b16 v[104:105],v246
ds_read_b64_tr_b16 v[106:107],v246 offset:1024
ds_read_b64_tr_b16 v[108:109],v246 offset:8192
ds_read_b64_tr_b16 v[110:111],v246 offset:9216
s_waitcnt vmcnt(8) lgkmcnt(0)
s_barrier
s_add_u32 s60,s32,55296
s_mov_b32 m0,38912
s_nop 0
buffer_load_dwordx4 v11,s[88:91],s60 offen lds
s_add_u32 s60,s32,57600
s_mov_b32 m0,39936
s_nop 0
buffer_load_dwordx4 v11,s[88:91],s60 offen lds
s_add_u32 s60,s32,59904
s_mov_b32 m0,40960
s_nop 0
buffer_load_dwordx4 v11,s[88:91],s60 offen lds
s_add_u32 s60,s32,62208
s_mov_b32 m0,41984
s_nop 0
buffer_load_dwordx4 v11,s[88:91],s60 offen lds
v_add_u32 v15,69632,v244
ds_read_b64_tr_b16 v[112:113],v15
ds_read_b64_tr_b16 v[114:115],v15 offset:1024
ds_read_b64_tr_b16 v[116:117],v15 offset:8192
ds_read_b64_tr_b16 v[118:119],v15 offset:9216
v_add_u32 v246,69632,v245
ds_read_b64_tr_b16 v[120:121],v246
ds_read_b64_tr_b16 v[122:123],v246 offset:1024
ds_read_b64_tr_b16 v[124:125],v246 offset:8192
ds_read_b64_tr_b16 v[126:127],v246 offset:9216
s_waitcnt vmcnt(8) lgkmcnt(0)
s_barrier
s_add_u32 s60,s32,92160
s_mov_b32 m0,77824
s_nop 0
buffer_load_dwordx4 v11,s[88:91],s60 offen lds
s_add_u32 s60,s32,94464
s_mov_b32 m0,78848
s_nop 0
buffer_load_dwordx4 v11,s[88:91],s60 offen lds
s_add_u32 s60,s32,96768
s_mov_b32 m0,79872
s_nop 0
buffer_load_dwordx4 v11,s[88:91],s60 offen lds
s_add_u32 s60,s32,99072
s_mov_b32 m0,80896
s_nop 0
buffer_load_dwordx4 v11,s[88:91],s60 offen lds
v_add_u32 v15,108544,v244
ds_read_b64_tr_b16 v[128:129],v15
ds_read_b64_tr_b16 v[130:131],v15 offset:1024
ds_read_b64_tr_b16 v[132:133],v15 offset:8192
ds_read_b64_tr_b16 v[134:135],v15 offset:9216
v_add_u32 v246,108544,v245
ds_read_b64_tr_b16 v[136:137],v246
ds_read_b64_tr_b16 v[138:139],v246 offset:1024
ds_read_b64_tr_b16 v[140:141],v246 offset:8192
ds_read_b64_tr_b16 v[142:143],v246 offset:9216
s_waitcnt vmcnt(8) lgkmcnt(0)
s_barrier
s_add_u32 s60,s32,129024
s_mov_b32 m0,116736
s_nop 0
buffer_load_dwordx4 v11,s[88:91],s60 offen lds
s_add_u32 s60,s32,131328
s_mov_b32 m0,117760
s_nop 0
buffer_load_dwordx4 v11,s[88:91],s60 offen lds
s_add_u32 s60,s32,133632
s_mov_b32 m0,118784
s_nop 0
buffer_load_dwordx4 v11,s[88:91],s60 offen lds
s_add_u32 s60,s32,135936
s_mov_b32 m0,119808
s_nop 0
buffer_load_dwordx4 v11,s[88:91],s60 offen lds
v_add_u32 v15,147456,v13
ds_read_b64_tr_b16 v[160:161],v15
ds_read_b64_tr_b16 v[162:163],v15 offset:1024
ds_read_b64_tr_b16 v[164:165],v15 offset:4096
ds_read_b64_tr_b16 v[166:167],v15 offset:5120
ds_read_b64_tr_b16 v[184:185],v15 offset:256
ds_read_b64_tr_b16 v[186:187],v15 offset:1280
ds_read_b64_tr_b16 v[188:189],v15 offset:4352
ds_read_b64_tr_b16 v[190:191],v15 offset:5376
s_waitcnt vmcnt(8) lgkmcnt(0)
s_barrier
s_add_u32 s60,s32,18944
s_mov_b32 m0,155648
s_nop 0
buffer_load_dwordx4 v11,s[88:91],s60 offen lds
s_add_u32 s60,s32,21248
s_mov_b32 m0,156672
s_nop 0
buffer_load_dwordx4 v11,s[88:91],s60 offen lds
s_add_u32 s60,s32,23552
s_mov_b32 m0,157696
s_nop 0
buffer_load_dwordx4 v11,s[88:91],s60 offen lds
s_add_u32 s60,s32,25856
s_mov_b32 m0,158720
s_nop 0
buffer_load_dwordx4 v11,s[88:91],s60 offen lds
v_add_u32 v15,30720,v13
ds_read_b64_tr_b16 v[168:169],v15
ds_read_b64_tr_b16 v[170:171],v15 offset:1024
ds_read_b64_tr_b16 v[172:173],v15 offset:4096
ds_read_b64_tr_b16 v[174:175],v15 offset:5120
ds_read_b64_tr_b16 v[192:193],v15 offset:256
ds_read_b64_tr_b16 v[194:195],v15 offset:1280
ds_read_b64_tr_b16 v[196:197],v15 offset:4352
ds_read_b64_tr_b16 v[198:199],v15 offset:5376
s_waitcnt vmcnt(8) lgkmcnt(0)
s_barrier
s_add_u32 s60,s32,55808
s_mov_b32 m0,38912
s_nop 0
buffer_load_dwordx4 v11,s[88:91],s60 offen lds
s_add_u32 s60,s32,58112
s_mov_b32 m0,39936
s_nop 0
buffer_load_dwordx4 v11,s[88:91],s60 offen lds
s_add_u32 s60,s32,60416
s_mov_b32 m0,40960
s_nop 0
buffer_load_dwordx4 v11,s[88:91],s60 offen lds
s_add_u32 s60,s32,62720
s_mov_b32 m0,41984
s_nop 0
buffer_load_dwordx4 v11,s[88:91],s60 offen lds
v_add_u32 v15,69632,v13
ds_read_b64_tr_b16 v[16:17],v15
ds_read_b64_tr_b16 v[18:19],v15 offset:1024
ds_read_b64_tr_b16 v[20:21],v15 offset:4096
ds_read_b64_tr_b16 v[22:23],v15 offset:5120
ds_read_b64_tr_b16 v[24:25],v15 offset:256
ds_read_b64_tr_b16 v[26:27],v15 offset:1280
ds_read_b64_tr_b16 v[28:29],v15 offset:4352
ds_read_b64_tr_b16 v[30:31],v15 offset:5376
s_waitcnt vmcnt(8) lgkmcnt(0)
s_barrier
s_add_u32 s60,s32,92672
s_mov_b32 m0,77824
s_nop 0
buffer_load_dwordx4 v11,s[88:91],s60 offen lds
s_add_u32 s60,s32,94976
s_mov_b32 m0,78848
s_nop 0
buffer_load_dwordx4 v11,s[88:91],s60 offen lds
s_add_u32 s60,s32,97280
s_mov_b32 m0,79872
s_nop 0
buffer_load_dwordx4 v11,s[88:91],s60 offen lds
s_add_u32 s60,s32,99584
s_mov_b32 m0,80896
s_nop 0
buffer_load_dwordx4 v11,s[88:91],s60 offen lds
v_add_u32 v15,108544,v13
ds_read_b64_tr_b16 v[176:177],v15
ds_read_b64_tr_b16 v[178:179],v15 offset:1024
ds_read_b64_tr_b16 v[180:181],v15 offset:4096
ds_read_b64_tr_b16 v[182:183],v15 offset:5120
ds_read_b64_tr_b16 v[200:201],v15 offset:256
ds_read_b64_tr_b16 v[202:203],v15 offset:1280
ds_read_b64_tr_b16 v[204:205],v15 offset:4352
ds_read_b64_tr_b16 v[206:207],v15 offset:5376
s_waitcnt vmcnt(8) lgkmcnt(0)
s_barrier
s_add_u32 s60,s32,129536
s_mov_b32 m0,116736
s_nop 0
buffer_load_dwordx4 v11,s[88:91],s60 offen lds
s_add_u32 s60,s32,131840
s_mov_b32 m0,117760
s_nop 0
buffer_load_dwordx4 v11,s[88:91],s60 offen lds
s_add_u32 s60,s32,134144
s_mov_b32 m0,118784
s_nop 0
buffer_load_dwordx4 v11,s[88:91],s60 offen lds
s_add_u32 s60,s32,136448
s_mov_b32 m0,119808
s_nop 0
buffer_load_dwordx4 v11,s[88:91],s60 offen lds
v_add_u32 v15,147456,v13
ds_read_b64_tr_b16 v[32:33],v15
ds_read_b64_tr_b16 v[34:35],v15 offset:1024
ds_read_b64_tr_b16 v[36:37],v15 offset:4096
ds_read_b64_tr_b16 v[38:39],v15 offset:5120
ds_read_b64_tr_b16 v[40:41],v15 offset:256
ds_read_b64_tr_b16 v[42:43],v15 offset:1280
ds_read_b64_tr_b16 v[44:45],v15 offset:4352
ds_read_b64_tr_b16 v[46:47],v15 offset:5376
s_waitcnt vmcnt(8) lgkmcnt(0)
s_barrier
s_add_u32 s60,s32,74752
s_mov_b32 m0,155648
s_nop 0
buffer_load_dwordx4 v12,s[88:91],s60 offen lds
s_add_u32 s60,s32,83968
s_mov_b32 m0,156672
s_nop 0
buffer_load_dwordx4 v12,s[88:91],s60 offen lds
s_add_u32 s60,s32,93184
s_mov_b32 m0,157696
s_nop 0
buffer_load_dwordx4 v12,s[88:91],s60 offen lds
s_add_u32 s60,s32,102400
s_mov_b32 m0,158720
s_nop 0
buffer_load_dwordx4 v12,s[88:91],s60 offen lds
v_add_u32 v15,30720,v13
ds_read_b64_tr_b16 v[208:209],v15
ds_read_b64_tr_b16 v[210:211],v15 offset:1024
ds_read_b64_tr_b16 v[212:213],v15 offset:4096
ds_read_b64_tr_b16 v[214:215],v15 offset:5120
ds_read_b64_tr_b16 v[224:225],v15 offset:256
ds_read_b64_tr_b16 v[226:227],v15 offset:1280
ds_read_b64_tr_b16 v[228:229],v15 offset:4352
ds_read_b64_tr_b16 v[230:231],v15 offset:5376
s_waitcnt vmcnt(8) lgkmcnt(0)
s_barrier
v_add_u32 v15,69632,v13
ds_read_b64_tr_b16 v[144:145],v15
ds_read_b64_tr_b16 v[146:147],v15 offset:1024
ds_read_b64_tr_b16 v[148:149],v15 offset:4096
ds_read_b64_tr_b16 v[150:151],v15 offset:5120
ds_read_b64_tr_b16 v[152:153],v15 offset:256
ds_read_b64_tr_b16 v[154:155],v15 offset:1280
ds_read_b64_tr_b16 v[156:157],v15 offset:4352
ds_read_b64_tr_b16 v[158:159],v15 offset:5376
s_waitcnt vmcnt(4) lgkmcnt(0)
s_barrier
v_add_u32 v15,108544,v13
ds_read_b64_tr_b16 v[216:217],v15
ds_read_b64_tr_b16 v[218:219],v15 offset:1024
ds_read_b64_tr_b16 v[220:221],v15 offset:4096
ds_read_b64_tr_b16 v[222:223],v15 offset:5120
ds_read_b64_tr_b16 v[232:233],v15 offset:256
ds_read_b64_tr_b16 v[234:235],v15 offset:1280
ds_read_b64_tr_b16 v[236:237],v15 offset:4352
ds_read_b64_tr_b16 v[238:239],v15 offset:5376
s_waitcnt vmcnt(0) lgkmcnt(0)
s_barrier
v_add_u32 v15,147456,v14
ds_read_b64_tr_b16 v[240:241],v15
ds_read_b64_tr_b16 v[242:243],v15 offset:2048
ds_read_b64_tr_b16 v[244:245],v15 offset:4096
ds_read_b64_tr_b16 v[246:247],v15 offset:6144
ds_read_b64_tr_b16 v[248:249],v15 offset:8192
ds_read_b64_tr_b16 v[250:251],v15 offset:10240
ds_read_b64_tr_b16 v[252:253],v15 offset:12288
ds_read_b64_tr_b16 v[254:255],v15 offset:14336
s_waitcnt lgkmcnt(0)
s_barrier
ds_write_b128 v3,v[64:67] offset:22528
ds_write_b128 v3,v[68:71] offset:23552
ds_write_b128 v3,v[48:51] offset:24576
ds_write_b128 v3,v[52:55] offset:25600
ds_write_b128 v3,v[56:59] offset:26624
ds_write_b128 v3,v[60:63] offset:27648
ds_write_b128 v3,v[72:75] offset:28672
ds_write_b128 v3,v[76:79] offset:29696
ds_write_b128 v3,v[16:19] offset:30720
ds_write_b128 v3,v[20:23] offset:31744
ds_write_b128 v3,v[24:27] offset:32768
ds_write_b128 v3,v[28:31] offset:33792
ds_write_b128 v3,v[32:35] offset:34816
ds_write_b128 v3,v[36:39] offset:35840
ds_write_b128 v3,v[40:43] offset:36864
ds_write_b128 v3,v[44:47] offset:37888
s_waitcnt lgkmcnt(0)
v_mov_b32 v11,v10
ch2_layer:
s_mov_b32 s25,0
s_mul_i32 s39,s24,1064960
s_add_u32 s32,s39,41955328
s_add_u32 s56,s39,41947136
s_lshl_b32 s39,s24,6
s_add_u32 s39,s39,s52
s_add_u32 s54,s39,8390656
s_add_u32 s55,s39,8396800
s_mov_b32 s38,0
ch2_entry:
v_and_b32 v10,8,v2
v_add_u32 v10,v9,v10
v_mov_b32 v48,0
v_mov_b32 v49,0
v_mov_b32 v50,0
v_mov_b32 v51,0
v_mov_b32 v52,0
v_mov_b32 v53,0
v_mov_b32 v54,0
v_mov_b32 v55,0
v_mov_b32 v56,0
v_mov_b32 v57,0
v_mov_b32 v58,0
v_mov_b32 v59,0
v_mov_b32 v60,0
v_mov_b32 v61,0
v_mov_b32 v62,0
v_mov_b32_e64 v63,0
ds_read_b128 v[64:67],v3
ds_read_b128 v[68:71],v3 offset:1024
ds_read_b128 v[72:75],v3 offset:2048
ds_read_b128 v[76:79],v3 offset:3072
v_mov_b32 v80,0
v_mov_b32 v81,0
v_mov_b32 v82,0
v_mov_b32 v83,0
v_mov_b32 v84,0
v_mov_b32 v85,0
v_mov_b32 v86,0
v_mov_b32 v87,0
buffer_load_dwordx4 v[44:47],v0,s[8:11],s27 offen
buffer_load_dwordx4 v[12:15],v0,s[8:11],s27 offen offset:1024
buffer_load_dwordx4 v[16:19],v0,s[8:11],s28 offen
buffer_load_dwordx4 v[20:23],v0,s[8:11],s28 offen offset:1024
s_waitcnt vmcnt(0)
s_barrier
ch2_top:
s_waitcnt vmcnt(3) lgkmcnt(2)
v_cmp_eq_u32 vcc,-1,v44
s_cbranch_vccnz ch2_retry0
ch2_ok0:
v_smfmac_f32_16x16x64_bf16 v[48:51],v[44:47],v[64:71],v5
ds_read_b128 v[64:67],v3 offset:4096
v_smfmac_f32_16x16x64_bf16 v[56:59],v[44:47],a[0:7],v5
ds_read_b128 v[68:71],v3 offset:5120
buffer_load_dwordx4 v[24:27],v0,s[8:11],s28 offen offset:2048
v_smfmac_f32_16x16x64_bf16 v[52:55],v[44:47],a[8:15],v5
s_waitcnt vmcnt(3) lgkmcnt(2)
v_smfmac_f32_16x16x64_bf16 v[60:63],v[44:47],v[72:79],v5
ds_read_b128 v[72:75],v3 offset:6144
v_cmp_eq_u32_e64 vcc,-1,v12
v_smfmac_f32_16x16x64_bf16 v[80:83],v[44:47],a[16:23],v5
ds_read_b128 v[76:79],v3 offset:7168
buffer_load_dwordx4 v[28:31],v0,s[8:11],s28 offen offset:3072
v_smfmac_f32_16x16x64_bf16 v[84:87],v[44:47],a[24:31],v5
s_cbranch_vccnz ch2_retry1
ch2_ok1:
s_waitcnt lgkmcnt(2)
v_smfmac_f32_16x16x64_bf16 v[48:51],v[12:15],v[64:71],v5
ds_read_b128 v[64:67],v3 offset:8192
v_smfmac_f32_16x16x64_bf16 v[56:59],v[12:15],a[32:39],v5
ds_read_b128 v[68:71],v3 offset:9216
buffer_load_dwordx4 v[32:35],v0,s[8:11],s29 offen
v_smfmac_f32_16x16x64_bf16 v[52:55],v[12:15],a[40:47],v5
s_waitcnt vmcnt(4) lgkmcnt(2)
v_smfmac_f32_16x16x64_bf16 v[60:63],v[12:15],v[72:79],v5
ds_read_b128 v[72:75],v3 offset:10240
v_cmp_eq_u32 vcc,-1,v16
v_smfmac_f32_16x16x64_bf16 v[80:83],v[12:15],a[48:55],v5
ds_read_b128 v[76:79],v3 offset:11264
buffer_load_dwordx4 v[36:39],v0,s[8:11],s29 offen offset:1024
v_smfmac_f32_16x16x64_bf16 v[84:87],v[12:15],a[56:63],v5
s_cbranch_vccnz ch2_retry2
ch2_ok2:
s_waitcnt lgkmcnt(2)
v_smfmac_f32_16x16x64_bf16 v[48:51],v[16:19],v[64:71],v5
ds_read_b128 v[64:67],v3 offset:12288
v_smfmac_f32_16x16x64_bf16 v[56:59],v[16:19],a[64:71],v5
ds_read_b128 v[68:71],v3 offset:13312
buffer_load_dwordx4 v[40:43],v0,s[8:11],s29 offen offset:2048
v_and_b32 v12,32,v0
v_smfmac_f32_16x16x64_bf16 v[52:55],v[16:19],a[72:79],v5
s_waitcnt vmcnt(5) lgkmcnt(2)
v_lshl_add_u32 v12,v12,4,v9
v_smfmac_f32_16x16x64_bf16 v[60:63],v[16:19],v[72:79],v5
ds_read_b128 v[72:75],v3 offset:14336
v_cmp_eq_u32_e64 vcc,-1,v20
v_smfmac_f32_16x16x64_bf16 v[80:83],v[16:19],a[80:87],v5
ds_read_b128 v[76:79],v3 offset:15360
buffer_load_dwordx4 v[44:47],v12,s[8:11],s56 offen sc1
v_smfmac_f32_16x16x64_bf16 v[84:87],v[16:19],a[88:95],v5
s_cbranch_vccnz ch2_retry3
ch2_ok3:
s_waitcnt lgkmcnt(2)
v_smfmac_f32_16x16x64_bf16 v[48:51],v[20:23],v[64:71],v5
ds_read_b128 v[64:67],v3 offset:16384
v_smfmac_f32_16x16x64_bf16 v[56:59],v[20:23],a[96:103],v5
ds_read_b128 v[68:71],v3 offset:17408
buffer_load_dwordx4 v[12:15],v12,s[8:11],s56 offen offset:1024 sc1
v_smfmac_f32_16x16x64_bf16 v[52:55],v[20:23],a[104:111],v5
s_waitcnt vmcnt(6) lgkmcnt(2)
v_smfmac_f32_16x16x64_bf16 v[60:63],v[20:23],v[72:79],v5
ds_read_b128 v[72:75],v3 offset:18432
v_cmp_eq_u32 vcc,-1,v24
v_smfmac_f32_16x16x64_bf16 v[80:83],v[20:23],a[112:119],v5
ds_read_b128 v[76:79],v3 offset:19456
buffer_load_dwordx4 v[16:19],v0,s[8:11],s32 offen sc1
v_smfmac_f32_16x16x64_bf16 v[84:87],v[20:23],a[120:127],v5
s_cbranch_vccnz ch2_retry4
ch2_ok4:
s_waitcnt vmcnt(6) lgkmcnt(2)
v_smfmac_f32_16x16x64_bf16 v[48:51],v[24:27],v[64:71],v5
ds_read_b128 v[64:67],v3 offset:20480
v_cmp_eq_u32_e64 vcc,-1,v28
v_smfmac_f32_16x16x64_bf16 v[56:59],v[24:27],a[128:135],v5
ds_read_b128 v[68:71],v3 offset:21504
buffer_load_dwordx4 v[20:23],v0,s[8:11],s32 offen offset:1024 sc1
v_smfmac_f32_16x16x64_bf16 v[52:55],v[24:27],a[136:143],v5
s_cbranch_vccnz ch2_retry5
ch2_ok5:
s_waitcnt vmcnt(6) lgkmcnt(2)
v_smfmac_f32_16x16x64_bf16 v[60:63],v[24:27],v[72:79],v5
ds_read_b128 v[72:75],v3 offset:22528
v_cmp_eq_u32 vcc,-1,v32
v_smfmac_f32_16x16x64_bf16 v[48:51],v[28:31],a[144:151],v5
ds_read_b128 v[76:79],v3 offset:23552
s_barrier
v_smfmac_f32_16x16x64_bf16 v[56:59],v[28:31],a[152:159],v5
s_cbranch_vccnz ch2_retry6
ch2_ok6:
s_waitcnt vmcnt(5) lgkmcnt(2)
v_smfmac_f32_16x16x64_bf16 v[52:55],v[28:31],v[64:71],v5
ds_read_b128 v[64:67],v3 offset:24576
v_cmp_eq_u32 vcc,-1,v36
v_smfmac_f32_16x16x64_bf16 v[60:63],v[28:31],a[160:167],v5
ds_read_b128 v[68:71],v3 offset:25600
v_smfmac_f32_16x16x64_bf16 v[48:51],v[32:35],a[168:175],v5
s_cbranch_vccnz ch2_retry7
ch2_ok7:
s_waitcnt vmcnt(4) lgkmcnt(2)
v_smfmac_f32_16x16x64_bf16 v[56:59],v[32:35],v[72:79],v5
ds_read_b128 v[72:75],v3 offset:26624
v_cmp_eq_u32 vcc,-1,v40
v_smfmac_f32_16x16x64_bf16 v[52:55],v[32:35],a[176:183],v5
ds_read_b128 v[76:79],v3 offset:27648
buffer_store_dword v8,v7,s[8:11],s54 offen sc1
v_smfmac_f32_16x16x64_bf16 v[60:63],v[32:35],a[184:191],v5
s_cbranch_vccnz ch2_retry8
ch2_ok8:
s_waitcnt lgkmcnt(2)
v_smfmac_f32_16x16x64_bf16 v[48:51],v[36:39],v[64:71],v5
ds_read_b128 v[64:67],v3 offset:28672
v_smfmac_f32_16x16x64_bf16 v[52:55],v[36:39],a[192:199],v5
ds_read_b128 v[68:71],v3 offset:29696
buffer_store_dword v11,v7,s[8:11],s55 offen sc1
v_smfmac_f32_16x16x64_bf16 v[48:51],v[40:43],a[200:207],v5
s_waitcnt lgkmcnt(2)
v_smfmac_f32_16x16x64_bf16 v[52:55],v[40:43],v[72:79],v5
v_smfmac_f32_16x16x64_bf16 v[56:59],v[36:39],a[208:215],v5
v_add_f32 v48,v48,v50
v_smfmac_f32_16x16x64_bf16 v[56:59],v[40:43],a[216:223],v5
s_waitcnt lgkmcnt(0)
v_add_f32 v49,v49,v51
v_smfmac_f32_16x16x64_bf16 v[60:63],v[36:39],v[64:71],v5
v_cvt_pk_bf16_f32 v50,v48,v49
v_smfmac_f32_16x16x64_bf16 v[60:63],v[40:43],a[224:231],v5
v_add_f32 v52,v52,v54
v_add_f32 v53,v53,v55
v_cvt_pk_bf16_f32 v54,v52,v53
v_add_f32 v56,v56,v58
v_add_f32 v57,v57,v59
v_cvt_pk_bf16_f32 v51,v56,v57
v_add_f32 v60,v60,v62
v_add_f32 v61,v61,v63
v_cvt_pk_bf16_f32 v55,v60,v61
ds_write2st64_b64 v1,v[50:51],v[54:55] offset0:12 offset1:13
v_smfmac_f32_16x16x64_bf16 v[80:83],v[24:27],a[232:239],v5
v_mov_b32 v76,s18
v_smfmac_f32_16x16x64_bf16 v[84:87],v[24:27],a[240:247],v5
v_mov_b32 v77,s18
v_smfmac_f32_16x16x64_bf16 v[80:83],v[28:31],a[248:255],v5
v_mov_b32 v78,s18
v_smfmac_f32_16x16x64_bf16 v[84:87],v[28:31],v[88:95],v5
v_mov_b32 v79,s18
v_smfmac_f32_16x16x64_bf16 v[80:83],v[32:35],v[96:103],v5
v_mov_b32_e64 v24,0
s_waitcnt lgkmcnt(0)
s_barrier
v_smfmac_f32_16x16x64_bf16 v[84:87],v[32:35],v[104:111],v5
ds_read_b64_tr_b16 v[48:49],v4 offset:4096
ds_read_b64_tr_b16 v[50:51],v4 offset:4608
v_smfmac_f32_16x16x64_bf16 v[80:83],v[36:39],v[112:119],v5
ds_read_b64_tr_b16 v[52:53],v4 offset:5120
ds_read_b64_tr_b16 v[54:55],v4 offset:5632
v_smfmac_f32_16x16x64_bf16 v[84:87],v[36:39],v[120:127],v5
ds_read_b64_tr_b16 v[56:57],v4 offset:6144
ds_read_b64_tr_b16 v[58:59],v4 offset:6656
v_smfmac_f32_16x16x64_bf16 v[80:83],v[40:43],v[128:135],v5
ds_read_b64_tr_b16 v[60:61],v4 offset:7168
ds_read_b64_tr_b16 v[62:63],v4 offset:7680
s_waitcnt lgkmcnt(6) vmcnt(4)
v_mfma_f32_16x16x32_bf16 v[64:67],v[44:47],v[48:51],0
s_waitcnt lgkmcnt(4)
v_mov_b32 v25,0
v_mfma_f32_16x16x32_bf16 v[68:71],v[44:47],v[52:55],0
s_waitcnt lgkmcnt(2)
v_mov_b32 v26,0
v_mfma_f32_16x16x32_bf16 v[64:67],v[12:15],v[56:59],v[64:67]
s_waitcnt lgkmcnt(0)
v_mov_b32 v27,0
v_mfma_f32_16x16x32_bf16 v[68:71],v[12:15],v[60:63],v[68:71]
v_mov_b32 v44,0
v_mfma_f32_16x16x32_bf16 v[72:75],v[48:51],v[48:51],0
v_mul_f32 v64,s42,v64
v_mul_f32 v65,s42,v65
v_mfma_f32_16x16x32_bf16 v[72:75],v[52:55],v[52:55],v[72:75]
v_fmac_f32 v64,s42,v70
v_fmac_f32 v65,s42,v71
v_exp_f32 v66,v64
v_exp_f32_e64 v67,v65
s_mov_b64 exec,s[48:49]
v_cvt_pk_bf16_f32 v66,v66,v67
ds_write_b32 v9,v66 offset:520
s_mov_b64 exec,-1
v_mfma_f32_16x16x32_bf16 v[72:75],v[56:59],v[56:59],v[72:75]
v_mov_b32 v45,0
v_mov_b32 v46,0
v_mfma_f32_16x16x32_bf16 v[72:75],v[60:63],v[60:63],v[72:75]
v_mov_b32 v47,0
v_mov_b32 v12,0
v_mov_b32 v13,0
v_mov_b32 v14,0
v_mov_b32 v15,0
v_mfma_f32_16x16x32_bf16 v[48:51],v[76:79],v[76:79],0
s_waitcnt lgkmcnt(0)
s_barrier
ds_read_b128 v[56:59],v9 offset:512
v_smfmac_f32_16x16x64_bf16 v[84:87],v[40:43],v[136:143],v5
v_mul_f32 v74,s42,v74
v_mul_f32 v75,s42,v75
v_exp_f32 v72,v74
v_exp_f32 v73,v75
v_mov_b32 v61,0
v_cvt_pk_bf16_f32 v72,v72,v73
v_mov_b32 v62,0
s_nop 0
v_mov_b32_dpp v60,v72 quad_perm:[0,1,0,1] row_mask:0xf bank_mask:0xf
s_waitcnt vmcnt(2) lgkmcnt(0)
v_mfma_f32_16x16x32_bf16 v[48:51],v[76:79],v[56:59],0
ds_read_b128 v[28:31],v3 offset:30720
v_mov_b32_dpp v63,v72 quad_perm:[0,1,0,1] row_mask:0xf bank_mask:0xf
v_add_f32 v80,v80,v82
v_mfma_f32_16x16x32_bf16 v[52:55],v[16:19],v[56:59],0
ds_read_b128 v[32:35],v3 offset:31744
v_add_f32 v81,v81,v83
v_cvt_pk_bf16_f32 v82,v80,v81
v_mfma_f32_16x16x32_bf16 v[68:71],v[20:23],v[56:59],0
ds_read_b128 v[36:39],v3 offset:32768
v_add_f32 v84,v84,v86
v_add_f32 v85,v85,v87
v_mfma_f32_16x16x16_bf16 v[48:51],v[76:77],v[60:61],v[48:51]
ds_read_b128 v[40:43],v3 offset:33792
v_cvt_pk_bf16_f32 v83,v84,v85
s_nop 1
v_mfma_f32_16x16x16_bf16 v[52:55],v[82:83],v[60:61],v[52:55]
v_mov_b32 v84,0
v_mov_b32 v85,0
v_mfma_f32_16x16x16_bf16 v[68:71],v[82:83],v[62:63],v[68:71]
v_rcp_f32 v66,v48
v_subrev_u32_e64 v67,s58,v48
v_cndmask_b32 v48,0,v66,s[48:49]
v_cndmask_b32 v50,0,v66,s[46:47]
v_mul_f32 v52,v52,v48
v_mul_f32 v53,v53,v48
v_mul_f32 v54,v54,v48
v_mul_f32 v55,v55,v48
v_cmp_lt_u32 vcc,0x3c000000,v67
v_pk_fma_f32 v[52:53],v[68:69],v[50:51],v[52:53] op_sel_hi:[1,0,1]
v_pk_fma_f32 v[54:55],v[70:71],v[50:51],v[54:55] op_sel_hi:[1,0,1]
v_cvt_pk_bf16_f32 v58,v52,v53
v_cvt_pk_bf16_f32 v59,v54,v55
v_mfma_f32_16x16x32_bf16 v[68:71],v[76:79],v[76:79],0
ds_write_b64 v10,v[58:59] offset:3072
s_cbranch_vccnz ch2_slowsm
ch2_smdone:
v_mov_b32_dpp v60,v58 quad_perm:[0,1,0,1] row_mask:0xf bank_mask:0xf
v_mov_b32_dpp v61,v59 quad_perm:[0,1,0,1] row_mask:0xf bank_mask:0xf
v_mov_b32_dpp v62,v58 quad_perm:[2,3,2,3] row_mask:0xf bank_mask:0xf
v_mov_b32_dpp v63,v59 quad_perm:[2,3,2,3] row_mask:0xf bank_mask:0xf
s_waitcnt lgkmcnt(1)
s_nop 0
v_mfma_f32_16x16x32_bf16 v[16:19],v[60:63],v[248:251],0
v_mov_b32 v86,0
v_mov_b32 v87,0
v_smfmac_f32_16x16x64_bf16 v[44:47],v[60:63],v[28:35],v5
s_waitcnt lgkmcnt(0)
s_barrier
ds_read_b128 v[48:51],v9 offset:2048
ds_read_b128 v[52:55],v9 offset:2560
ds_read_b128 v[56:59],v9 offset:3584
v_smfmac_f32_16x16x64_bf16 v[12:15],v[60:63],v[36:43],v5
v_smfmac_f32_16x16x64_bf16 v[24:27],v[60:63],v[144:151],v5
v_smfmac_f32_16x16x64_bf16 v[84:87],v[60:63],v[152:159],v5
ds_read_b128 v[64:67],v3 offset:34816
s_waitcnt lgkmcnt(3)
v_smfmac_f32_16x16x64_bf16 v[44:47],v[48:51],v[160:167],v5
ds_read_b128 v[68:71],v3 offset:35840
s_waitcnt lgkmcnt(3)
v_smfmac_f32_16x16x64_bf16 v[44:47],v[52:55],v[168:175],v5
ds_read_b128 v[72:75],v3 offset:36864
s_waitcnt lgkmcnt(3)
v_smfmac_f32_16x16x64_bf16 v[44:47],v[56:59],v[176:183],v5
ds_read_b128 v[76:79],v3 offset:37888
v_smfmac_f32_16x16x64_bf16 v[12:15],v[48:51],v[184:191],v5
ds_read_b128 v[80:83],v0 offset:1024
v_smfmac_f32_16x16x64_bf16 v[12:15],v[52:55],v[192:199],v5
v_cvt_pk_bf16_f32 v44,v44,v45
v_cvt_pk_bf16_f32 v45,v46,v47
v_and_or_b32 v44,v44,-2,s26
v_smfmac_f32_16x16x64_bf16 v[12:15],v[56:59],v[200:207],v5
buffer_store_dwordx2 v[44:45],v6,s[8:11],s34 offen
s_waitcnt lgkmcnt(3)
v_smfmac_f32_16x16x64_bf16 v[24:27],v[48:51],v[64:71],v5
v_smfmac_f32_16x16x64_bf16 v[24:27],v[52:55],v[208:215],v5
v_cvt_pk_bf16_f32 v12,v12,v13
v_cvt_pk_bf16_f32 v13,v14,v15
v_and_or_b32 v12,v12,-2,s26
v_smfmac_f32_16x16x64_bf16 v[24:27],v[56:59],v[216:223],v5
buffer_store_dwordx2 v[12:13],v6,s[8:11],s41 offen
s_waitcnt lgkmcnt(1)
v_smfmac_f32_16x16x64_bf16 v[84:87],v[48:51],v[72:79],v5
v_smfmac_f32_16x16x64_bf16 v[84:87],v[52:55],v[224:231],v5
v_cvt_pk_bf16_f32 v24,v24,v25
v_cvt_pk_bf16_f32 v25,v26,v27
v_and_or_b32 v24,v24,-2,s26
v_smfmac_f32_16x16x64_bf16 v[84:87],v[56:59],v[232:239],v5
buffer_store_dwordx2 v[24:25],v6,s[8:11],s35 offen
v_mfma_f32_16x16x32_bf16 v[16:19],v[48:51],v[240:243],v[16:19]
v_mfma_f32_16x16x32_bf16 v[16:19],v[52:55],v[244:247],v[16:19]
v_cvt_pk_bf16_f32 v26,v84,v85
v_cvt_pk_bf16_f32 v27,v86,v87
v_and_or_b32 v26,v26,-2,s26
v_mfma_f32_16x16x32_bf16 v[16:19],v[56:59],v[252:255],v[16:19]
buffer_store_dwordx2 v[26:27],v6,s[8:11],s44 offen
ds_read_b128 v[64:67],v3
ds_read_b128 v[68:71],v3 offset:1024
ds_read_b128 v[72:75],v3 offset:2048
ds_read_b128 v[76:79],v3 offset:3072
s_nop 2
v_cvt_pk_bf16_f32 v16,v16,v17
v_and_or_b32 v16,v16,-2,s26
buffer_store_dword v16,v2,s[8:11],s36 offen
v_mov_b32 v48,0
s_add_u32 s25,s25,1
v_mov_b32 v49,0
s_add_u32 s32,s32,16384
v_mov_b32_e64 v50,0
s_add_u32 s56,s56,16384
v_mov_b32 v51,0
s_add_u32 s27,s27,0x4000
v_mov_b32 v52,0
s_add_u32 s28,s28,0x4000
v_mov_b32 v53,0
s_add_u32 s29,s29,0x4000
v_mov_b32 v54,0
s_add_u32 s30,s30,0x4000
v_mov_b32_e64 v55,0
s_add_u32 s54,s54,0x4000
v_mov_b32 v56,0
s_add_u32 s31,s31,0x4000
v_mov_b32 v57,0
s_add_u32 s55,s55,0x4000
v_mov_b32 v58,0
s_nop 0
v_mov_b32 v59,0
s_nop 0
v_mov_b32 v60,0
s_nop 0
v_mov_b32 v61,0
s_nop 0
v_mov_b32 v62,0
s_nop 0
v_mov_b32 v63,0
s_nop 0
v_mov_b32 v5,v5
s_nop 3
v_mov_b32 v5,v5
s_nop 3
v_mov_b32 v5,v5
s_nop 3
v_mov_b32 v5,v5
s_nop 2
buffer_load_dwordx4 v[28:31],v0,s[8:11],s37 offen sc1
buffer_load_dwordx4 v[32:35],v0,s[8:11],s37 offen offset:1024 sc1
v_mov_b32 v5,v5
s_nop 3
v_mov_b32 v5,v5
s_nop 3
v_mov_b32 v5,v5
s_nop 3
v_mov_b32 v5,v5
s_nop 3
v_mov_b32 v5,v5
s_nop 3
v_mov_b32 v5,v5
s_nop 3
v_mov_b32 v5,v5
s_nop 3
buffer_load_dwordx4 v[36:39],v0,s[8:11],s45 offen sc1
buffer_load_dwordx4 v[40:43],v0,s[8:11],s45 offen offset:1024 sc1
s_waitcnt vmcnt(3) lgkmcnt(0)
v_mfma_f32_16x16x32_bf16 v[84:87],v[80:83],v[28:31],0
v_xor_b32_e64 v28,s26,v28
s_waitcnt vmcnt(2)
v_mfma_f32_16x16x32_bf16 v[84:87],v[80:83],v[32:35],v[84:87]
v_bitop3_b32 v28,v28,v32,s26 bitop3:0xf6
v_and_b32 v28,1,v28
v_cmp_ne_u32_e64 vcc,0,v28
s_nop 3
v_add_f32_dpp v84,v84,v84 row_ror:4 row_mask:0xf bank_mask:0xf
v_add_f32_dpp v85,v85,v85 row_ror:4 row_mask:0xf bank_mask:0xf
s_nop 0
v_add_f32_dpp v84,v84,v84 row_ror:8 row_mask:0xf bank_mask:0xf
v_add_f32_dpp v85,v85,v85 row_ror:8 row_mask:0xf bank_mask:0xf
v_cvt_pk_bf16_f32 v8,v84,v85
s_cbranch_vccnz ch2_pollP0
ch2_okP0:
buffer_store_dword v8,v7,s[8:11],s30 offen
s_cmp_ge_u32 s24,16
s_cbranch_scc1 ch2_nored
s_waitcnt vmcnt(2) lgkmcnt(0)
v_mfma_f32_16x16x32_bf16 v[84:87],v[80:83],v[36:39],0
v_xor_b32_e64 v36,s26,v36
s_waitcnt vmcnt(1)
v_mfma_f32_16x16x32_bf16 v[84:87],v[80:83],v[40:43],v[84:87]
v_bitop3_b32 v36,v36,v40,s26 bitop3:0xf6
v_and_b32 v36,1,v36
v_cmp_ne_u32_e64 vcc,0,v36
s_nop 3
v_add_f32_dpp v84,v84,v84 row_ror:4 row_mask:0xf bank_mask:0xf
v_add_f32_dpp v85,v85,v85 row_ror:4 row_mask:0xf bank_mask:0xf
s_nop 0
v_add_f32_dpp v84,v84,v84 row_ror:8 row_mask:0xf bank_mask:0xf
v_add_f32_dpp v85,v85,v85 row_ror:8 row_mask:0xf bank_mask:0xf
v_cvt_pk_bf16_f32 v11,v84,v85
s_cbranch_vccnz ch2_pollP1
ch2_okP1:
buffer_store_dword v11,v7,s[8:11],s31 offen
ch2_nored:
s_barrier
buffer_load_dwordx4 v[44:47],v0,s[8:11],s27 offen
v_mov_b32 v80,0
s_nop 0
v_mov_b32 v81,0
s_nop 0
v_mov_b32 v82,0
buffer_load_dwordx4 v[12:15],v0,s[8:11],s27 offen offset:1024
s_nop 0
v_mov_b32 v83,0
s_nop 0
v_mov_b32 v84,0
s_nop 0
v_mov_b32 v85,0
s_nop 0
v_mov_b32_e64 v86,0
s_nop 0
buffer_load_dwordx4 v[16:19],v0,s[8:11],s28 offen
v_mov_b32 v87,0
s_nop 0
v_mov_b32 v5,v5
s_nop 3
v_mov_b32 v5,v5
s_nop 0
buffer_load_dwordx4 v[20:23],v0,s[8:11],s28 offen offset:1024
s_xor_b32 s26,s26,1
s_cmp_eq_u32 s25,63
s_cbranch_scc1 ch2_done
s_branch ch2_top
ch2_pollP0:
buffer_load_dwordx4 v[28:31],v0,s[8:11],s37 offen sc1
buffer_load_dwordx4 v[32:35],v0,s[8:11],s37 offen offset:1024 sc1
s_add_u32 s38,s38,1
s_cmp_gt_u32 s38,2000000
s_cbranch_scc1 ch2_fail
s_waitcnt vmcnt(1) lgkmcnt(0)
v_mfma_f32_16x16x32_bf16 v[84:87],v[80:83],v[28:31],0
v_xor_b32 v28,s26,v28
s_waitcnt vmcnt(0)
v_mfma_f32_16x16x32_bf16 v[84:87],v[80:83],v[32:35],v[84:87]
v_bitop3_b32 v28,v28,v32,s26 bitop3:0xf6
v_and_b32 v28,1,v28
v_cmp_ne_u32_e64 vcc,0,v28
s_nop 3
v_add_f32_dpp v84,v84,v84 row_ror:4 row_mask:0xf bank_mask:0xf
v_add_f32_dpp v85,v85,v85 row_ror:4 row_mask:0xf bank_mask:0xf
s_nop 0
v_add_f32_dpp v84,v84,v84 row_ror:8 row_mask:0xf bank_mask:0xf
v_add_f32_dpp v85,v85,v85 row_ror:8 row_mask:0xf bank_mask:0xf
v_cvt_pk_bf16_f32 v8,v84,v85
s_cbranch_vccnz ch2_pollP0
s_branch ch2_okP0
ch2_pollP1:
buffer_load_dwordx4 v[36:39],v0,s[8:11],s45 offen sc1
buffer_load_dwordx4 v[40:43],v0,s[8:11],s45 offen offset:1024 sc1
s_add_u32 s38,s38,1
s_cmp_gt_u32 s38,2000000
s_cbranch_scc1 ch2_fail
s_waitcnt vmcnt(1) lgkmcnt(0)
v_mfma_f32_16x16x32_bf16 v[84:87],v[80:83],v[36:39],0
v_xor_b32_e64 v36,s26,v36
s_waitcnt vmcnt(0)
v_mfma_f32_16x16x32_bf16 v[84:87],v[80:83],v[40:43],v[84:87]
v_bitop3_b32 v36,v36,v40,s26 bitop3:0xf6
v_and_b32 v36,1,v36
v_cmp_ne_u32_e64 vcc,0,v36
s_nop 3
v_add_f32_dpp v84,v84,v84 row_ror:4 row_mask:0xf bank_mask:0xf
v_add_f32_dpp v85,v85,v85 row_ror:4 row_mask:0xf bank_mask:0xf
s_nop 0
v_add_f32_dpp v84,v84,v84 row_ror:8 row_mask:0xf bank_mask:0xf
v_add_f32_dpp v85,v85,v85 row_ror:8 row_mask:0xf bank_mask:0xf
v_cvt_pk_bf16_f32 v11,v84,v85
s_cbranch_vccnz ch2_pollP1
s_branch ch2_okP1
ch2_slowsm:
s_mov_b64 exec,s[48:49]
ds_write_b64 v9,v[64:65] offset:4608
s_mov_b64 exec,-1
s_waitcnt lgkmcnt(0)
s_barrier
ds_read_b128 v[48:51],v9 offset:4096
ds_read_b128 v[52:55],v9 offset:4608
v_mov_b32_dpp v72,v74 quad_perm:[0,1,0,1] row_mask:0xf bank_mask:0xf
v_mov_b32_dpp v73,v75 quad_perm:[0,1,0,1] row_mask:0xf bank_mask:0xf
s_waitcnt lgkmcnt(0)
v_max_f32_e64 v68,v48,v49
v_max3_f32 v68,v68,v50,v51
v_max3_f32 v68,v68,v52,v53
v_max3_f32 v68,v68,v54,v55
v_max3_f32 v68,v68,v72,v73
v_mov_b32 v69,v68
s_nop 1
v_permlane16_swap_b32 v68,v69
v_max_f32 v68,v68,v69
v_mov_b32 v69,v68
s_nop 1
v_permlane32_swap_b32 v68,v69
v_max_f32 v68,v68,v69
v_sub_f32 v48,v48,v68
v_exp_f32 v48,v48
v_sub_f32 v49,v49,v68
v_exp_f32 v49,v49
v_sub_f32 v50,v50,v68
v_exp_f32 v50,v50
v_sub_f32 v51,v51,v68
v_exp_f32 v51,v51
v_sub_f32 v52,v52,v68
v_exp_f32 v52,v52
v_sub_f32 v53,v53,v68
v_exp_f32 v53,v53
v_sub_f32 v54,v54,v68
v_exp_f32 v54,v54
v_sub_f32 v55,v55,v68
v_exp_f32 v55,v55
v_sub_f32 v72,v72,v68
v_exp_f32 v72,v72
v_sub_f32 v73,v73,v68
v_exp_f32 v73,v73
v_cvt_pk_bf16_f32 v56,v48,v49
v_cvt_pk_bf16_f32 v57,v50,v51
v_cvt_pk_bf16_f32 v58,v52,v53
v_cvt_pk_bf16_f32 v59,v54,v55
v_cvt_pk_bf16_f32 v60,v72,v73
v_cvt_pk_bf16_f32 v63,v72,v73
v_mfma_f32_16x16x32_bf16 v[48:51],v[76:79],v[56:59],0
v_mfma_f32_16x16x32_bf16 v[52:55],v[16:19],v[56:59],0
v_mfma_f32_16x16x32_bf16 v[68:71],v[20:23],v[56:59],0
v_mfma_f32_16x16x16_bf16 v[48:51],v[76:77],v[60:61],v[48:51]
v_mfma_f32_16x16x16_bf16 v[52:55],v[82:83],v[60:61],v[52:55]
v_mfma_f32_16x16x16_bf16 v[68:71],v[82:83],v[62:63],v[68:71]
v_rcp_f32 v66,v48
s_nop 0
v_cndmask_b32 v48,0,v66,s[48:49]
v_cndmask_b32 v50,0,v66,s[46:47]
v_mul_f32 v52,v52,v48
v_mul_f32 v53,v53,v48
v_mul_f32 v54,v54,v48
v_mul_f32 v55,v55,v48
v_pk_fma_f32 v[52:53],v[68:69],v[50:51],v[52:53] op_sel_hi:[1,0,1]
v_pk_fma_f32 v[54:55],v[70:71],v[50:51],v[54:55] op_sel_hi:[1,0,1]
v_cvt_pk_bf16_f32 v58,v52,v53
v_cvt_pk_bf16_f32 v59,v54,v55
v_mfma_f32_16x16x32_bf16 v[68:71],v[76:79],v[76:79],0
ds_write_b64 v10,v[58:59] offset:3072
s_branch ch2_smdone
ch2_retry0:
buffer_load_dwordx4 v[44:47],v0,s[8:11],s27 offen sc1
buffer_load_dwordx4 v[12:15],v0,s[8:11],s27 offen offset:1024 sc1
buffer_load_dwordx4 v[16:19],v0,s[8:11],s28 offen sc1
buffer_load_dwordx4 v[20:23],v0,s[8:11],s28 offen offset:1024 sc1
s_add_u32 s38,s38,1
s_cmp_gt_u32 s38,2000000
s_cbranch_scc1 ch2_fail
s_waitcnt vmcnt(0)
v_cmp_eq_u32_e64 vcc,-1,v44
s_cbranch_vccnz ch2_retry0
s_branch ch2_ok0
ch2_retry1:
buffer_load_dwordx4 v[12:15],v0,s[8:11],s27 offen offset:1024 sc1
buffer_load_dwordx4 v[16:19],v0,s[8:11],s28 offen sc1
buffer_load_dwordx4 v[20:23],v0,s[8:11],s28 offen offset:1024 sc1
buffer_load_dwordx4 v[24:27],v0,s[8:11],s28 offen offset:2048 sc1
buffer_load_dwordx4 v[28:31],v0,s[8:11],s28 offen offset:3072 sc1
s_add_u32 s38,s38,1
s_cmp_gt_u32 s38,2000000
s_cbranch_scc1 ch2_fail
s_waitcnt vmcnt(0)
v_cmp_eq_u32 vcc,-1,v12
s_cbranch_vccnz ch2_retry1
s_branch ch2_ok1
ch2_retry2:
buffer_load_dwordx4 v[16:19],v0,s[8:11],s28 offen sc1
buffer_load_dwordx4 v[20:23],v0,s[8:11],s28 offen offset:1024 sc1
buffer_load_dwordx4 v[24:27],v0,s[8:11],s28 offen offset:2048 sc1
buffer_load_dwordx4 v[28:31],v0,s[8:11],s28 offen offset:3072 sc1
buffer_load_dwordx4 v[32:35],v0,s[8:11],s29 offen sc1
buffer_load_dwordx4 v[36:39],v0,s[8:11],s29 offen offset:1024 sc1
s_add_u32 s38,s38,1
s_cmp_gt_u32 s38,2000000
s_cbranch_scc1 ch2_fail
s_waitcnt vmcnt(0)
v_cmp_eq_u32 vcc,-1,v16
s_cbranch_vccnz ch2_retry2
s_branch ch2_ok2
ch2_retry3:
buffer_load_dwordx4 v[20:23],v0,s[8:11],s28 offen offset:1024 sc1
buffer_load_dwordx4 v[24:27],v0,s[8:11],s28 offen offset:2048 sc1
buffer_load_dwordx4 v[28:31],v0,s[8:11],s28 offen offset:3072 sc1
buffer_load_dwordx4 v[32:35],v0,s[8:11],s29 offen sc1
buffer_load_dwordx4 v[36:39],v0,s[8:11],s29 offen offset:1024 sc1
buffer_load_dwordx4 v[40:43],v0,s[8:11],s29 offen offset:2048 sc1
s_add_u32 s38,s38,1
s_cmp_gt_u32 s38,2000000
s_cbranch_scc1 ch2_fail
s_waitcnt vmcnt(0)
v_cmp_eq_u32 vcc,-1,v20
s_cbranch_vccnz ch2_retry3
s_branch ch2_ok3
ch2_retry4:
buffer_load_dwordx4 v[24:27],v0,s[8:11],s28 offen offset:2048 sc1
buffer_load_dwordx4 v[28:31],v0,s[8:11],s28 offen offset:3072 sc1
buffer_load_dwordx4 v[32:35],v0,s[8:11],s29 offen sc1
buffer_load_dwordx4 v[36:39],v0,s[8:11],s29 offen offset:1024 sc1
buffer_load_dwordx4 v[40:43],v0,s[8:11],s29 offen offset:2048 sc1
s_add_u32 s38,s38,1
s_cmp_gt_u32 s38,2000000
s_cbranch_scc1 ch2_fail
s_waitcnt vmcnt(0)
v_cmp_eq_u32 vcc,-1,v24
s_cbranch_vccnz ch2_retry4
s_branch ch2_ok4
ch2_retry5:
buffer_load_dwordx4 v[28:31],v0,s[8:11],s28 offen offset:3072 sc1
buffer_load_dwordx4 v[32:35],v0,s[8:11],s29 offen sc1
buffer_load_dwordx4 v[36:39],v0,s[8:11],s29 offen offset:1024 sc1
buffer_load_dwordx4 v[40:43],v0,s[8:11],s29 offen offset:2048 sc1
s_add_u32 s38,s38,1
s_cmp_gt_u32 s38,2000000
s_cbranch_scc1 ch2_fail
s_waitcnt vmcnt(0)
v_cmp_eq_u32 vcc,-1,v28
s_cbranch_vccnz ch2_retry5
s_branch ch2_ok5
ch2_retry6:
buffer_load_dwordx4 v[32:35],v0,s[8:11],s29 offen sc1
buffer_load_dwordx4 v[36:39],v0,s[8:11],s29 offen offset:1024 sc1
buffer_load_dwordx4 v[40:43],v0,s[8:11],s29 offen offset:2048 sc1
s_add_u32 s38,s38,1
s_cmp_gt_u32 s38,2000000
s_cbranch_scc1 ch2_fail
s_waitcnt vmcnt(0)
v_cmp_eq_u32 vcc,-1,v32
s_cbranch_vccnz ch2_retry6
s_branch ch2_ok6
ch2_retry7:
buffer_load_dwordx4 v[36:39],v0,s[8:11],s29 offen offset:1024 sc1
buffer_load_dwordx4 v[40:43],v0,s[8:11],s29 offen offset:2048 sc1
s_add_u32 s38,s38,1
s_cmp_gt_u32 s38,2000000
s_cbranch_scc1 ch2_fail
s_waitcnt vmcnt(0)
v_cmp_eq_u32 vcc,-1,v36
s_cbranch_vccnz ch2_retry7
s_branch ch2_ok7
ch2_retry8:
buffer_load_dwordx4 v[40:43],v0,s[8:11],s29 offen offset:2048 sc1
s_add_u32 s38,s38,1
s_cmp_gt_u32 s38,2000000
s_cbranch_scc1 ch2_fail
s_waitcnt vmcnt(0)
v_cmp_eq_u32 vcc,-1,v40
s_cbranch_vccnz ch2_retry8
s_branch ch2_ok8
ch2_done:
buffer_store_dword v8,v7,s[8:11],s54 offen sc1
buffer_store_dword v11,v7,s[8:11],s55 offen sc1
s_waitcnt vmcnt(0) lgkmcnt(0)
s_cmp_lg_u32 s52,0
s_cbranch_scc1 c_join
s_mov_b32 s52,16777216
s_mov_b32 s23,1
s_add_u32 s40,s30,0x8000
buffer_load_dword v21,v7,s[8:11],s40 offen sc1
s_add_u32 s40,s31,0x8000
buffer_load_dword v21,v7,s[8:11],s40 offen sc1
s_add_u32 s27,s27,0x4000
s_add_u32 s28,s28,0x4000
s_add_u32 s29,s29,0x4000
s_add_u32 s30,s30,0x4000
s_add_u32 s54,s54,0x4000
s_add_u32 s31,s31,0x4000
s_add_u32 s55,s55,0x4000
v_lshrrev_b32 v18,4,v0
v_and_b32 v28,3,v18
v_bfe_u32 v30,v18,4,1
v_lshrrev_b32_e64 v29,5,v18
v_mul_u32_u24 v29,1152,v29
v_lshl_add_u32 v28,v28,1,v30
v_lshl_add_u32 v29,v28,1,v29
s_and_b32 s39,s24,3
s_mul_i32 s39,s39,2304
s_lshr_b32 s40,s24,3
s_lshl_b32 s40,s40,6
s_add_u32 s39,s39,s40
s_bfe_u32 s40,s24,0x10002
s_lshl_b32 s40,s40,4
s_add_u32 s39,s39,s40
buffer_load_ushort v31,v29,s[12:15],s39 offen offset:256
buffer_load_ushort v32,v29,s[12:15],s39 offen offset:288
v_and_b32 v28,3,v18
v_bfe_u32 v30,v18,4,1
v_lshrrev_b32 v29,5,v18
v_mul_u32_u24 v29,1152,v29
v_lshl_add_u32 v28,v28,1,v30
v_lshl_add_u32 v29,v28,2,v29
s_and_b32 s39,s24,3
s_mul_i32 s39,s39,2304
s_lshr_b32 s40,s24,2
s_lshl_b32 s40,s40,5
s_add_u32 s39,s39,s40
buffer_load_ushort v33,v29,s[12:15],s39 offen offset:1024
buffer_load_ushort v34,v29,s[12:15],s39 offen offset:1026
s_waitcnt vmcnt(0)
v_lshl_or_b32 v28,v32,16,v31
v_min_u32 v8,-2,v28
buffer_store_dword v8,v7,s[8:11],s30 offen
v_lshl_or_b32 v28,v34,16,v33
v_min_u32_e64 v11,-2,v28
buffer_store_dword v11,v7,s[8:11],s31 offen
s_mov_b32 s63,6308092
v_mov_b32 v12,0
ch2_idle:
s_sleep 16
buffer_load_dword v13,v12,s[8:11],s63 offen sc1
s_add_u32 s38,s38,1
s_cmp_gt_u32 s38,2000000
s_cbranch_scc1 ch2_fail
s_waitcnt vmcnt(0)
v_cmp_eq_u32 vcc,0,v13
s_cbranch_vccnz ch2_idle
s_branch ch2_layer
ch2_fail:
s_waitcnt vmcnt(0) lgkmcnt(0)
s_endpgm
c_w3:
v_mov_b32 v10,v0
v_and_b32 v11,15,v10
v_lshrrev_b32 v12,4,v10
v_lshlrev_b32 v13,4,v10
v_add_u32 v3,124928,v13
v_add_u32 v0,0,v13
v_lshlrev_b32 v13,3,v10
v_lshrrev_b32 v14,5,v10
v_lshlrev_b32 v14,6,v14
v_xor_b32 v1,v14,v13
v_lshlrev_b32 v13,2,v11
v_lshl_add_u32 v2,v12,11,v13
v_and_b32 v13,3,v10
v_lshrrev_b32 v14,2,v10
v_lshlrev_b32 v15,7,v13
v_lshl_add_u32 v15,v14,3,v15
v_lshrrev_b32 v16,1,v13
v_lshlrev_b32 v16,6,v16
v_xor_b32 v4,v16,v15
v_and_b32 v15,1,v10
v_lshlrev_b32 v15,4,v15
v_lshl_add_u32 v9,v14,5,v15
s_mov_b32 s46,0xcccccccc
s_mov_b32 s47,0xcccccccc
s_mov_b32 s48,0x33333333
s_mov_b32 s49,0x33333333
v_mov_b32 v15,0x4444
v_mov_b32 v16,0xeeee
v_cndmask_b32 v5,v15,v16,s[46:47]
v_lshrrev_b32 v15,3,v11
v_lshl_add_u32 v15,v15,2,v12
v_lshlrev_b32 v15,11,v15
v_and_b32_e64 v17,7,v11
v_lshl_add_u32 v6,v17,3,v15
v_and_b32 v15,2,v11
v_lshrrev_b32 v16,1,v12
v_add_u32 v15,v15,v16
v_lshlrev_b32 v15,4,v15
v_and_b32 v16,1,v11
v_and_b32 v17,1,v12
v_lshl_add_u32 v16,v16,1,v17
v_lshl_add_u32 v7,v16,2,v15
v_lshrrev_b32 v17,4,v10
v_and_b32 v18,15,v10
v_lshlrev_b32 v16,1,v17
v_xor_b32 v16,v16,v18
v_lshlrev_b32 v16,4,v16
v_bfe_u32 v18,v10,2,3
v_lshlrev_b32 v18,1,v18
v_bfe_u32 v245,v10,1,1
v_add_u32 v245,12,v245
v_xor_b32 v245,v245,v18
v_lshlrev_b32 v245,4,v245
v_and_b32 v18,1,v10
v_lshl_add_u32 v245,v18,3,v245
v_bfe_u32 v18,v10,2,2
v_lshl_add_u32 v17,v17,3,v18
v_lshl_add_u32 v244,v17,8,v245
v_xor_b32 v245,32,v244
v_bfe_u32 v17,v10,4,1
v_lshrrev_b32 v18,5,v10
v_lshlrev_b32_e64 v19,2,v18
v_lshl_add_u32 v19,v17,4,v19
v_lshl_add_u32 v240,v19,13,v16
v_xor_b32 v241,0x80,v240
v_lshl_add_u32 v19,v18,3,v17
v_lshl_add_u32 v242,v19,13,v16
v_xor_b32 v243,0x80,v242
v_lshrrev_b32 v84,5,v10
v_and_b32 v85,31,v10
v_lshlrev_b32 v86,2,v84
v_xor_b32 v85,v85,v86
v_xor_b32 v85,8,v85
v_mul_u32_u24 v84,1152,v84
v_lshl_add_u32 v11,v85,4,v84
v_lshrrev_b32 v84,3,v10
v_mul_u32_u24 v84,1152,v84
v_and_b32_e64 v85,7,v10
v_lshl_add_u32 v12,v85,4,v84
v_bfe_u32 v84,v10,2,1
v_bfe_u32 v85,v10,4,1
v_lshl_add_u32 v86,v85,1,v84
v_xor_b32 v86,3,v86
v_lshlrev_b32 v86,6,v86
v_bfe_u32 v87,v10,3,1
v_lshl_add_u32 v86,v87,5,v86
v_and_b32 v87,3,v10
v_lshl_add_u32 v86,v87,3,v86
v_lshl_add_u32 v84,v85,4,v84
v_lshrrev_b32 v85,5,v10
v_lshl_add_u32 v84,v85,2,v84
v_lshl_add_u32 v13,v84,9,v86
v_lshrrev_b32 v84,2,v10
v_lshlrev_b32 v84,7,v84
v_lshl_add_u32 v84,v87,3,v84
v_add_u32 v14,96,v84
s_lshl_b32 s56,s24,8
s_mul_i32 s32,s24,147456
s_barrier
s_add_u32 s60,s56,327680
s_mov_b32 m0,43008
s_nop 0
buffer_load_dwordx4 v240,s[80:83],s60 offen lds
s_add_u32 s60,s56,335872
s_mov_b32 m0,44032
s_nop 0
buffer_load_dwordx4 v240,s[80:83],s60 offen lds
s_add_u32 s60,s56,344064
s_mov_b32 m0,45056
s_nop 0
buffer_load_dwordx4 v241,s[80:83],s60 offen lds
s_add_u32 s60,s56,352256
s_mov_b32 m0,46080
s_nop 0
buffer_load_dwordx4 v241,s[80:83],s60 offen lds
s_add_u32 s60,s56,851968
s_mov_b32 m0,81920
s_nop 0
buffer_load_dwordx4 v240,s[80:83],s60 offen lds
s_add_u32 s60,s56,860160
s_mov_b32 m0,82944
s_nop 0
buffer_load_dwordx4 v240,s[80:83],s60 offen lds
s_add_u32 s60,s56,868352
s_mov_b32 m0,83968
s_nop 0
buffer_load_dwordx4 v241,s[80:83],s60 offen lds
s_add_u32 s60,s56,876544
s_mov_b32 m0,84992
s_nop 0
buffer_load_dwordx4 v241,s[80:83],s60 offen lds
s_add_u32 s60,s56,1376256
s_mov_b32 m0,120832
s_nop 0
buffer_load_dwordx4 v240,s[80:83],s60 offen lds
s_add_u32 s60,s56,1384448
s_mov_b32 m0,121856
s_nop 0
buffer_load_dwordx4 v240,s[80:83],s60 offen lds
s_add_u32 s60,s56,1392640
s_mov_b32 m0,122880
s_nop 0
buffer_load_dwordx4 v241,s[80:83],s60 offen lds
s_add_u32 s60,s56,1400832
s_mov_b32 m0,123904
s_nop 0
buffer_load_dwordx4 v241,s[80:83],s60 offen lds
s_waitcnt vmcnt(8) lgkmcnt(0)
s_barrier
s_add_u32 s60,s56,1900544
s_mov_b32 m0,159744
s_nop 0
buffer_load_dwordx4 v240,s[80:83],s60 offen lds
s_add_u32 s60,s56,1908736
s_mov_b32 m0,160768
s_nop 0
buffer_load_dwordx4 v240,s[80:83],s60 offen lds
s_add_u32 s60,s56,1916928
s_mov_b32 m0,161792
s_nop 0
buffer_load_dwordx4 v241,s[80:83],s60 offen lds
s_add_u32 s60,s56,1925120
s_mov_b32 m0,162816
s_nop 0
buffer_load_dwordx4 v241,s[80:83],s60 offen lds
v_add_u32 v15,30720,v244
ds_read_b64_tr_b16 a[0:1],v15
ds_read_b64_tr_b16 a[2:3],v15 offset:1024
ds_read_b64_tr_b16 a[4:5],v15 offset:8192
ds_read_b64_tr_b16 a[6:7],v15 offset:9216
v_add_u32 v246,30720,v245
ds_read_b64_tr_b16 v[80:81],v246
ds_read_b64_tr_b16 v[82:83],v246 offset:1024
ds_read_b64_tr_b16 v[84:85],v246 offset:8192
ds_read_b64_tr_b16 v[86:87],v246 offset:9216
s_waitcnt lgkmcnt(0)
ds_write_b128 v3,v[80:83] offset:2048
ds_write_b128 v3,v[84:87] offset:3072
s_waitcnt vmcnt(8) lgkmcnt(0)
s_barrier
s_add_u32 s60,s56,2424832
s_mov_b32 m0,43008
s_nop 0
buffer_load_dwordx4 v240,s[80:83],s60 offen lds
s_add_u32 s60,s56,2433024
s_mov_b32 m0,44032
s_nop 0
buffer_load_dwordx4 v240,s[80:83],s60 offen lds
s_add_u32 s60,s56,2441216
s_mov_b32 m0,45056
s_nop 0
buffer_load_dwordx4 v241,s[80:83],s60 offen lds
s_add_u32 s60,s56,2449408
s_mov_b32 m0,46080
s_nop 0
buffer_load_dwordx4 v241,s[80:83],s60 offen lds
v_add_u32 v15,69632,v244
ds_read_b64_tr_b16 a[32:33],v15
ds_read_b64_tr_b16 a[34:35],v15 offset:1024
ds_read_b64_tr_b16 a[36:37],v15 offset:8192
ds_read_b64_tr_b16 a[38:39],v15 offset:9216
v_add_u32 v246,69632,v245
ds_read_b64_tr_b16 v[80:81],v246
ds_read_b64_tr_b16 v[82:83],v246 offset:1024
ds_read_b64_tr_b16 v[84:85],v246 offset:8192
ds_read_b64_tr_b16 v[86:87],v246 offset:9216
s_waitcnt lgkmcnt(0)
ds_write_b128 v3,v[80:83] offset:6144
ds_write_b128 v3,v[84:87] offset:7168
s_waitcnt vmcnt(8) lgkmcnt(0)
s_barrier
s_add_u32 s60,s56,2949120
s_mov_b32 m0,81920
s_nop 0
buffer_load_dwordx4 v240,s[80:83],s60 offen lds
s_add_u32 s60,s56,2957312
s_mov_b32 m0,82944
s_nop 0
buffer_load_dwordx4 v240,s[80:83],s60 offen lds
s_add_u32 s60,s56,2965504
s_mov_b32 m0,83968
s_nop 0
buffer_load_dwordx4 v241,s[80:83],s60 offen lds
s_add_u32 s60,s56,2973696
s_mov_b32 m0,84992
s_nop 0
buffer_load_dwordx4 v241,s[80:83],s60 offen lds
v_add_u32 v15,108544,v244
ds_read_b64_tr_b16 a[64:65],v15
ds_read_b64_tr_b16 a[66:67],v15 offset:1024
ds_read_b64_tr_b16 a[68:69],v15 offset:8192
ds_read_b64_tr_b16 a[70:71],v15 offset:9216
v_add_u32 v246,108544,v245
ds_read_b64_tr_b16 v[80:81],v246
ds_read_b64_tr_b16 v[82:83],v246 offset:1024
ds_read_b64_tr_b16 v[84:85],v246 offset:8192
ds_read_b64_tr_b16 v[86:87],v246 offset:9216
s_waitcnt lgkmcnt(0)
ds_write_b128 v3,v[80:83] offset:10240
ds_write_b128 v3,v[84:87] offset:11264
s_nop 0
s_barrier
s_cmp_eq_u32 s21,0
s_cbranch_scc0 ann_89
v_mov_b32 v40,s2
v_mov_b32 v41,s3
s_mov_b64 exec,1
global_store_byte v40,v41,s[4:5] sc1
s_mov_b64 exec,-1
ann_89:
s_waitcnt vmcnt(8) lgkmcnt(0)
s_barrier
s_add_u32 s60,s56,3473408
s_mov_b32 m0,120832
s_nop 0
buffer_load_dwordx4 v240,s[80:83],s60 offen lds
s_add_u32 s60,s56,3481600
s_mov_b32 m0,121856
s_nop 0
buffer_load_dwordx4 v240,s[80:83],s60 offen lds
s_add_u32 s60,s56,3489792
s_mov_b32 m0,122880
s_nop 0
buffer_load_dwordx4 v241,s[80:83],s60 offen lds
s_add_u32 s60,s56,3497984
s_mov_b32 m0,123904
s_nop 0
buffer_load_dwordx4 v241,s[80:83],s60 offen lds
v_add_u32 v15,147456,v244
ds_read_b64_tr_b16 a[96:97],v15
ds_read_b64_tr_b16 a[98:99],v15 offset:1024
ds_read_b64_tr_b16 a[100:101],v15 offset:8192
ds_read_b64_tr_b16 a[102:103],v15 offset:9216
v_add_u32 v246,147456,v245
ds_read_b64_tr_b16 v[80:81],v246
ds_read_b64_tr_b16 v[82:83],v246 offset:1024
ds_read_b64_tr_b16 v[84:85],v246 offset:8192
ds_read_b64_tr_b16 v[86:87],v246 offset:9216
s_waitcnt lgkmcnt(0)
ds_write_b128 v3,v[80:83] offset:14336
ds_write_b128 v3,v[84:87] offset:15360
s_waitcnt vmcnt(8) lgkmcnt(0)
s_barrier
s_add_u32 s60,s56,3997696
s_mov_b32 m0,159744
s_nop 0
buffer_load_dwordx4 v240,s[80:83],s60 offen lds
s_add_u32 s60,s56,4005888
s_mov_b32 m0,160768
s_nop 0
buffer_load_dwordx4 v240,s[80:83],s60 offen lds
s_add_u32 s60,s56,4014080
s_mov_b32 m0,161792
s_nop 0
buffer_load_dwordx4 v241,s[80:83],s60 offen lds
s_add_u32 s60,s56,4022272
s_mov_b32 m0,162816
s_nop 0
buffer_load_dwordx4 v241,s[80:83],s60 offen lds
v_add_u32 v15,30720,v244
ds_read_b64_tr_b16 a[128:129],v15
ds_read_b64_tr_b16 a[130:131],v15 offset:1024
ds_read_b64_tr_b16 a[132:133],v15 offset:8192
ds_read_b64_tr_b16 a[134:135],v15 offset:9216
v_add_u32 v246,30720,v245
ds_read_b64_tr_b16 v[80:81],v246
ds_read_b64_tr_b16 v[82:83],v246 offset:1024
ds_read_b64_tr_b16 v[84:85],v246 offset:8192
ds_read_b64_tr_b16 v[86:87],v246 offset:9216
s_waitcnt lgkmcnt(0)
ds_write_b128 v3,v[80:83] offset:18432
ds_write_b128 v3,v[84:87] offset:19456
s_waitcnt vmcnt(8) lgkmcnt(0)
s_barrier
s_add_u32 s60,s56,4587520
s_mov_b32 m0,43008
s_nop 0
buffer_load_dwordx4 v242,s[80:83],s60 offen lds
s_add_u32 s60,s56,4603904
s_mov_b32 m0,44032
s_nop 0
buffer_load_dwordx4 v242,s[80:83],s60 offen lds
s_add_u32 s60,s56,4620288
s_mov_b32 m0,45056
s_nop 0
buffer_load_dwordx4 v243,s[80:83],s60 offen lds
s_add_u32 s60,s56,4636672
s_mov_b32 m0,46080
s_nop 0
buffer_load_dwordx4 v243,s[80:83],s60 offen lds
v_add_u32 v15,69632,v244
ds_read_b64_tr_b16 a[152:153],v15
ds_read_b64_tr_b16 a[154:155],v15 offset:1024
ds_read_b64_tr_b16 a[156:157],v15 offset:8192
ds_read_b64_tr_b16 a[158:159],v15 offset:9216
v_add_u32 v246,69632,v245
ds_read_b64_tr_b16 a[160:161],v246
ds_read_b64_tr_b16 a[162:163],v246 offset:1024
ds_read_b64_tr_b16 a[164:165],v246 offset:8192
ds_read_b64_tr_b16 a[166:167],v246 offset:9216
s_waitcnt vmcnt(8) lgkmcnt(0)
s_barrier
s_add_u32 s60,s56,327680
s_mov_b32 m0,81920
s_nop 0
buffer_load_dwordx4 v240,s[76:79],s60 offen lds
s_add_u32 s60,s56,335872
s_mov_b32 m0,82944
s_nop 0
buffer_load_dwordx4 v240,s[76:79],s60 offen lds
s_add_u32 s60,s56,344064
s_mov_b32 m0,83968
s_nop 0
buffer_load_dwordx4 v241,s[76:79],s60 offen lds
s_add_u32 s60,s56,352256
s_mov_b32 m0,84992
s_nop 0
buffer_load_dwordx4 v241,s[76:79],s60 offen lds
v_add_u32 v15,108544,v244
ds_read_b64_tr_b16 v[64:65],v15
ds_read_b64_tr_b16 v[66:67],v15 offset:1024
ds_read_b64_tr_b16 v[68:69],v15 offset:8192
ds_read_b64_tr_b16 v[70:71],v15 offset:9216
v_add_u32 v246,108544,v245
ds_read_b64_tr_b16 a[184:185],v246
ds_read_b64_tr_b16 a[186:187],v246 offset:1024
ds_read_b64_tr_b16 a[188:189],v246 offset:8192
ds_read_b64_tr_b16 a[190:191],v246 offset:9216
v_lshlrev_b32 v40,2,v10
global_load_dword v41,v40,s[4:5] sc1
v_and_b32 v28,3,v10
v_bfe_u32 v30,v10,4,1
v_lshrrev_b32 v29,5,v10
v_mul_u32_u24 v29,1152,v29
v_lshl_add_u32 v28,v28,1,v30
v_lshl_add_u32 v29,v28,1,v29
s_and_b32 s39,s24,3
s_mul_i32 s39,s39,2304
s_lshr_b32 s40,s24,3
s_lshl_b32 s40,s40,6
s_add_u32 s39,s39,s40
s_bfe_u32 s40,s24,0x10002
s_lshl_b32 s40,s40,4
s_add_u32 s39,s39,s40
buffer_load_ushort v31,v29,s[12:15],s39 offen offset:512
buffer_load_ushort v32,v29,s[12:15],s39 offen offset:544
s_waitcnt vmcnt(8) lgkmcnt(0)
s_barrier
s_add_u32 s60,s56,851968
s_mov_b32 m0,120832
s_nop 0
buffer_load_dwordx4 v240,s[76:79],s60 offen lds
s_add_u32 s60,s56,860160
s_mov_b32 m0,121856
s_nop 0
buffer_load_dwordx4 v240,s[76:79],s60 offen lds
s_add_u32 s60,s56,868352
s_mov_b32 m0,122880
s_nop 0
buffer_load_dwordx4 v241,s[76:79],s60 offen lds
s_add_u32 s60,s56,876544
s_mov_b32 m0,123904
s_nop 0
buffer_load_dwordx4 v241,s[76:79],s60 offen lds
v_add_u32 v15,147456,v244
ds_read_b64_tr_b16 a[208:209],v15
ds_read_b64_tr_b16 a[210:211],v15 offset:1024
ds_read_b64_tr_b16 a[212:213],v15 offset:8192
ds_read_b64_tr_b16 a[214:215],v15 offset:9216
v_add_u32 v246,147456,v245
ds_read_b64_tr_b16 v[72:73],v246
ds_read_b64_tr_b16 v[74:75],v246 offset:1024
ds_read_b64_tr_b16 v[76:77],v246 offset:8192
ds_read_b64_tr_b16 v[78:79],v246 offset:9216
s_waitcnt vmcnt(8) lgkmcnt(0)
s_barrier
s_add_u32 s60,s56,1376256
s_mov_b32 m0,159744
s_nop 0
buffer_load_dwordx4 v240,s[76:79],s60 offen lds
s_add_u32 s60,s56,1384448
s_mov_b32 m0,160768
s_nop 0
buffer_load_dwordx4 v240,s[76:79],s60 offen lds
s_add_u32 s60,s56,1392640
s_mov_b32 m0,161792
s_nop 0
buffer_load_dwordx4 v241,s[76:79],s60 offen lds
s_add_u32 s60,s56,1400832
s_mov_b32 m0,162816
s_nop 0
buffer_load_dwordx4 v241,s[76:79],s60 offen lds
v_add_u32 v15,30720,v244
ds_read_b64_tr_b16 a[216:217],v15
ds_read_b64_tr_b16 a[218:219],v15 offset:1024
ds_read_b64_tr_b16 a[220:221],v15 offset:8192
ds_read_b64_tr_b16 a[222:223],v15 offset:9216
v_add_u32 v246,30720,v245
ds_read_b64_tr_b16 a[224:225],v246
ds_read_b64_tr_b16 a[226:227],v246 offset:1024
ds_read_b64_tr_b16 a[228:229],v246 offset:8192
ds_read_b64_tr_b16 a[230:231],v246 offset:9216
s_waitcnt vmcnt(8) lgkmcnt(0)
s_barrier
s_add_u32 s60,s56,1900544
s_mov_b32 m0,43008
s_nop 0
buffer_load_dwordx4 v240,s[76:79],s60 offen lds
s_add_u32 s60,s56,1908736
s_mov_b32 m0,44032
s_nop 0
buffer_load_dwordx4 v240,s[76:79],s60 offen lds
s_add_u32 s60,s56,1916928
s_mov_b32 m0,45056
s_nop 0
buffer_load_dwordx4 v241,s[76:79],s60 offen lds
s_add_u32 s60,s56,1925120
s_mov_b32 m0,46080
s_nop 0
buffer_load_dwordx4 v241,s[76:79],s60 offen lds
v_add_u32 v15,69632,v244
ds_read_b64_tr_b16 v[80:81],v15
ds_read_b64_tr_b16 v[82:83],v15 offset:1024
ds_read_b64_tr_b16 v[84:85],v15 offset:8192
ds_read_b64_tr_b16 v[86:87],v15 offset:9216
s_waitcnt lgkmcnt(0)
ds_write_b128 v3,v[80:83]
ds_write_b128 v3,v[84:87] offset:1024
v_add_u32 v246,69632,v245
ds_read_b64_tr_b16 a[8:9],v246
ds_read_b64_tr_b16 a[10:11],v246 offset:1024
ds_read_b64_tr_b16 a[12:13],v246 offset:8192
ds_read_b64_tr_b16 a[14:15],v246 offset:9216
s_waitcnt vmcnt(8) lgkmcnt(0)
s_barrier
s_add_u32 s60,s56,2424832
s_mov_b32 m0,81920
s_nop 0
buffer_load_dwordx4 v240,s[76:79],s60 offen lds
s_add_u32 s60,s56,2433024
s_mov_b32 m0,82944
s_nop 0
buffer_load_dwordx4 v240,s[76:79],s60 offen lds
s_add_u32 s60,s56,2441216
s_mov_b32 m0,83968
s_nop 0
buffer_load_dwordx4 v241,s[76:79],s60 offen lds
s_add_u32 s60,s56,2449408
s_mov_b32 m0,84992
s_nop 0
buffer_load_dwordx4 v241,s[76:79],s60 offen lds
v_add_u32 v15,108544,v244
ds_read_b64_tr_b16 v[80:81],v15
ds_read_b64_tr_b16 v[82:83],v15 offset:1024
ds_read_b64_tr_b16 v[84:85],v15 offset:8192
ds_read_b64_tr_b16 v[86:87],v15 offset:9216
s_waitcnt lgkmcnt(0)
ds_write_b128 v3,v[80:83] offset:4096
ds_write_b128 v3,v[84:87] offset:5120
v_add_u32 v246,108544,v245
ds_read_b64_tr_b16 a[40:41],v246
ds_read_b64_tr_b16 a[42:43],v246 offset:1024
ds_read_b64_tr_b16 a[44:45],v246 offset:8192
ds_read_b64_tr_b16 a[46:47],v246 offset:9216
s_cmp_lg_u32 s19,0
s_cbranch_scc1 ver_90
s_mov_b32 s19,1
v_mbcnt_lo_u32_b32 v46,-1,0
v_mbcnt_hi_u32_b32 v46,-1,v46
v_lshlrev_b32 v40,2,v46
s_mov_b32 s63,0
s_branch el_91s
el_91:
global_load_dword v41,v40,s[4:5] sc1
s_add_u32 s63,s63,1
s_cmp_gt_u32 s63,4000000
s_cbranch_scc1 ch3_fail
s_waitcnt vmcnt(0)
el_91s:
v_bfe_u32 v42,v41,0,8
v_bfe_u32 v43,v41,8,8
v_bfe_u32 v44,v41,16,8
v_bfe_u32 v45,v41,24,8
v_min_u32 v41,v42,v43
v_min3_u32 v41,v41,v44,v45
v_cmp_eq_u32 vcc,0,v41
s_cbranch_vccnz el_91
s_mov_b32 s62,0
elw_92:
s_add_u32 s62,s62,1
s_mov_b32 s61,0
v_cmp_eq_u32 vcc,s62,v42
s_bcnt1_i32_b64 s60,vcc
s_add_u32 s61,s61,s60
v_cmp_eq_u32 vcc,s62,v43
s_bcnt1_i32_b64 s60,vcc
s_add_u32 s61,s61,s60
v_cmp_eq_u32 vcc,s62,v44
s_bcnt1_i32_b64 s60,vcc
s_add_u32 s61,s61,s60
v_cmp_eq_u32 vcc,s62,v45
s_bcnt1_i32_b64 s60,vcc
s_add_u32 s61,s61,s60
s_cmp_ge_u32 s62,16
s_cbranch_scc1 ch3_fail
s_cmp_lt_u32 s61,32
s_cbranch_scc1 elw_92
s_mov_b32 s61,0
s_mov_b32 s63,0
v_cmp_gt_u32 vcc,s3,v42
s_bcnt1_i32_b64 s60,vcc
s_add_u32 s63,s63,s60
v_add_u32 v41,0,v40
v_cmp_gt_u32 s[16:17],s2,v41
v_cmp_eq_u32 vcc,s3,v42
s_and_b64 vcc,vcc,s[16:17]
s_bcnt1_i32_b64 s60,vcc
s_add_u32 s61,s61,s60
v_cmp_gt_u32 vcc,s3,v43
s_bcnt1_i32_b64 s60,vcc
s_add_u32 s63,s63,s60
v_add_u32_e64 v41,1,v40
v_cmp_gt_u32 s[16:17],s2,v41
v_cmp_eq_u32 vcc,s3,v43
s_and_b64 vcc,vcc,s[16:17]
s_bcnt1_i32_b64 s60,vcc
s_add_u32 s61,s61,s60
v_cmp_gt_u32 vcc,s3,v44
s_bcnt1_i32_b64 s60,vcc
s_add_u32 s63,s63,s60
v_add_u32 v41,2,v40
v_cmp_gt_u32 s[16:17],s2,v41
v_cmp_eq_u32 vcc,s3,v44
s_and_b64 vcc,vcc,s[16:17]
s_bcnt1_i32_b64 s60,vcc
s_add_u32 s61,s61,s60
v_cmp_gt_u32 vcc,s3,v45
s_bcnt1_i32_b64 s60,vcc
s_add_u32 s63,s63,s60
v_add_u32 v41,3,v40
v_cmp_gt_u32 s[16:17],s2,v41
v_cmp_eq_u32 vcc,s3,v45
s_and_b64 vcc,vcc,s[16:17]
s_bcnt1_i32_b64 s60,vcc
s_add_u32 s61,s61,s60
s_add_u32 s18,s61,s63
s_cmp_gt_u32 s62,s3
s_cselect_b32 s60,32,0
s_add_u32 s18,s18,s60
s_cmp_lg_u32 s62,s3
s_cbranch_scc1 eld_93
s_cmp_lt_u32 s61,32
s_cselect_b32 s18,s61,s18
eld_93:
s_add_u32 s60,s24,0
s_cmp_eq_u32 s60,s18
s_cbranch_scc1 ver_90
s_mov_b32 s24,s18
s_mov_b32 s10,268435456
s_waitcnt vmcnt(0) lgkmcnt(0)
s_branch k_role
ver_90:
s_lshl_b32 s39,s24,6
s_add_u32 s34,s39,49152
s_add_u32 s41,s34,65536
s_add_u32 s35,s34,131072
s_add_u32 s44,s34,196608
s_add_u32 s36,s39,286720
s_add_u32 s30,s39,2107392
s_add_u32 s31,s39,2097152
s_and_b32 s27,s24,3
s_lshl_b32 s27,s27,11
s_add_u32 s27,s27,2097152
s_mov_b32 s28,2105344
s_mov_b32 s29,2109440
s_lshl_b32 s39,s24,11
s_add_u32 s37,s39,131072
s_mov_b32 s26,0
s_mov_b32 s42,1040356334
s_mov_b32 s18,0x3f803f80
s_mov_b32 s58,562036736
v_mov_b32 v20,-1
v_mov_b32 v21,-1
v_mov_b32 v22,-1
v_mov_b32 v23,-1
s_lshl_b32 s45,s24,9
s_add_u32 s45,s45,2129920
buffer_load_dwordx4 v[24:27],v0,s[8:11],s37 offen sc1
buffer_load_dwordx4 v[24:27],v0,s[8:11],s37 offen offset:1024 sc1
s_add_u32 s39,s30,0x4000
buffer_load_dword v24,v7,s[8:11],s39 offen sc1
buffer_load_dword v24,v7,s[8:11],s30 offen sc1
v_lshl_or_b32 v28,v32,16,v31
v_min_u32_e64 v8,-2,v28
buffer_store_dword v8,v7,s[8:11],s30 offen
s_waitcnt vmcnt(8) lgkmcnt(0)
s_barrier
s_add_u32 s60,s56,2949120
s_mov_b32 m0,120832
s_nop 0
buffer_load_dwordx4 v240,s[76:79],s60 offen lds
s_add_u32 s60,s56,2957312
s_mov_b32 m0,121856
s_nop 0
buffer_load_dwordx4 v240,s[76:79],s60 offen lds
s_add_u32 s60,s56,2965504
s_mov_b32 m0,122880
s_nop 0
buffer_load_dwordx4 v241,s[76:79],s60 offen lds
s_add_u32 s60,s56,2973696
s_mov_b32 m0,123904
s_nop 0
buffer_load_dwordx4 v241,s[76:79],s60 offen lds
v_add_u32 v15,147456,v244
ds_read_b64_tr_b16 v[80:81],v15
ds_read_b64_tr_b16 v[82:83],v15 offset:1024
ds_read_b64_tr_b16 v[84:85],v15 offset:8192
ds_read_b64_tr_b16 v[86:87],v15 offset:9216
s_waitcnt lgkmcnt(0)
ds_write_b128 v3,v[80:83] offset:8192
ds_write_b128 v3,v[84:87] offset:9216
v_add_u32 v246,147456,v245
ds_read_b64_tr_b16 a[72:73],v246
ds_read_b64_tr_b16 a[74:75],v246 offset:1024
ds_read_b64_tr_b16 a[76:77],v246 offset:8192
ds_read_b64_tr_b16 a[78:79],v246 offset:9216
s_waitcnt vmcnt(8) lgkmcnt(0)
s_barrier
s_add_u32 s60,s56,3473408
s_mov_b32 m0,159744
s_nop 0
buffer_load_dwordx4 v240,s[76:79],s60 offen lds
s_add_u32 s60,s56,3481600
s_mov_b32 m0,160768
s_nop 0
buffer_load_dwordx4 v240,s[76:79],s60 offen lds
s_add_u32 s60,s56,3489792
s_mov_b32 m0,161792
s_nop 0
buffer_load_dwordx4 v241,s[76:79],s60 offen lds
s_add_u32 s60,s56,3497984
s_mov_b32 m0,162816
s_nop 0
buffer_load_dwordx4 v241,s[76:79],s60 offen lds
v_add_u32 v15,30720,v244
ds_read_b64_tr_b16 v[80:81],v15
ds_read_b64_tr_b16 v[82:83],v15 offset:1024
ds_read_b64_tr_b16 v[84:85],v15 offset:8192
ds_read_b64_tr_b16 v[86:87],v15 offset:9216
s_waitcnt lgkmcnt(0)
ds_write_b128 v3,v[80:83] offset:12288
ds_write_b128 v3,v[84:87] offset:13312
v_add_u32 v246,30720,v245
ds_read_b64_tr_b16 a[104:105],v246
ds_read_b64_tr_b16 a[106:107],v246 offset:1024
ds_read_b64_tr_b16 a[108:109],v246 offset:8192
ds_read_b64_tr_b16 a[110:111],v246 offset:9216
s_waitcnt vmcnt(8) lgkmcnt(0)
s_barrier
s_add_u32 s60,s56,3997696
s_mov_b32 m0,43008
s_nop 0
buffer_load_dwordx4 v240,s[76:79],s60 offen lds
s_add_u32 s60,s56,4005888
s_mov_b32 m0,44032
s_nop 0
buffer_load_dwordx4 v240,s[76:79],s60 offen lds
s_add_u32 s60,s56,4014080
s_mov_b32 m0,45056
s_nop 0
buffer_load_dwordx4 v241,s[76:79],s60 offen lds
s_add_u32 s60,s56,4022272
s_mov_b32 m0,46080
s_nop 0
buffer_load_dwordx4 v241,s[76:79],s60 offen lds
v_add_u32 v15,69632,v244
ds_read_b64_tr_b16 v[80:81],v15
ds_read_b64_tr_b16 v[82:83],v15 offset:1024
ds_read_b64_tr_b16 v[84:85],v15 offset:8192
ds_read_b64_tr_b16 v[86:87],v15 offset:9216
s_waitcnt lgkmcnt(0)
ds_write_b128 v3,v[80:83] offset:16384
ds_write_b128 v3,v[84:87] offset:17408
v_add_u32 v246,69632,v245
ds_read_b64_tr_b16 a[136:137],v246
ds_read_b64_tr_b16 a[138:139],v246 offset:1024
ds_read_b64_tr_b16 a[140:141],v246 offset:8192
ds_read_b64_tr_b16 a[142:143],v246 offset:9216
s_waitcnt vmcnt(8) lgkmcnt(0)
s_barrier
s_add_u32 s60,s56,4587520
s_mov_b32 m0,81920
s_nop 0
buffer_load_dwordx4 v242,s[76:79],s60 offen lds
s_add_u32 s60,s56,4603904
s_mov_b32 m0,82944
s_nop 0
buffer_load_dwordx4 v242,s[76:79],s60 offen lds
s_add_u32 s60,s56,4620288
s_mov_b32 m0,83968
s_nop 0
buffer_load_dwordx4 v243,s[76:79],s60 offen lds
s_add_u32 s60,s56,4636672
s_mov_b32 m0,84992
s_nop 0
buffer_load_dwordx4 v243,s[76:79],s60 offen lds
v_add_u32 v15,108544,v244
ds_read_b64_tr_b16 a[144:145],v15
ds_read_b64_tr_b16 a[146:147],v15 offset:1024
ds_read_b64_tr_b16 a[148:149],v15 offset:8192
ds_read_b64_tr_b16 a[150:151],v15 offset:9216
v_add_u32 v246,108544,v245
ds_read_b64_tr_b16 v[80:81],v246
ds_read_b64_tr_b16 v[82:83],v246 offset:1024
ds_read_b64_tr_b16 v[84:85],v246 offset:8192
ds_read_b64_tr_b16 v[86:87],v246 offset:9216
s_waitcnt lgkmcnt(0)
ds_write_b128 v3,v[80:83] offset:20480
ds_write_b128 v3,v[84:87] offset:21504
s_waitcnt vmcnt(8) lgkmcnt(0)
s_barrier
s_add_u32 s60,s56,327680
s_mov_b32 m0,120832
s_nop 0
buffer_load_dwordx4 v240,s[84:87],s60 offen lds
s_add_u32 s60,s56,335872
s_mov_b32 m0,121856
s_nop 0
buffer_load_dwordx4 v240,s[84:87],s60 offen lds
s_add_u32 s60,s56,344064
s_mov_b32 m0,122880
s_nop 0
buffer_load_dwordx4 v241,s[84:87],s60 offen lds
s_add_u32 s60,s56,352256
s_mov_b32 m0,123904
s_nop 0
buffer_load_dwordx4 v241,s[84:87],s60 offen lds
v_add_u32 v15,147456,v244
ds_read_b64_tr_b16 a[168:169],v15
ds_read_b64_tr_b16 a[170:171],v15 offset:1024
ds_read_b64_tr_b16 a[172:173],v15 offset:8192
ds_read_b64_tr_b16 a[174:175],v15 offset:9216
v_add_u32 v246,147456,v245
ds_read_b64_tr_b16 a[176:177],v246
ds_read_b64_tr_b16 a[178:179],v246 offset:1024
ds_read_b64_tr_b16 a[180:181],v246 offset:8192
ds_read_b64_tr_b16 a[182:183],v246 offset:9216
s_waitcnt vmcnt(8) lgkmcnt(0)
s_barrier
s_add_u32 s60,s56,851968
s_mov_b32 m0,159744
s_nop 0
buffer_load_dwordx4 v240,s[84:87],s60 offen lds
s_add_u32 s60,s56,860160
s_mov_b32 m0,160768
s_nop 0
buffer_load_dwordx4 v240,s[84:87],s60 offen lds
s_add_u32 s60,s56,868352
s_mov_b32 m0,161792
s_nop 0
buffer_load_dwordx4 v241,s[84:87],s60 offen lds
s_add_u32 s60,s56,876544
s_mov_b32 m0,162816
s_nop 0
buffer_load_dwordx4 v241,s[84:87],s60 offen lds
v_add_u32 v15,30720,v244
ds_read_b64_tr_b16 v[48:49],v15
ds_read_b64_tr_b16 v[50:51],v15 offset:1024
ds_read_b64_tr_b16 v[52:53],v15 offset:8192
ds_read_b64_tr_b16 v[54:55],v15 offset:9216
v_add_u32 v246,30720,v245
ds_read_b64_tr_b16 a[192:193],v246
ds_read_b64_tr_b16 a[194:195],v246 offset:1024
ds_read_b64_tr_b16 a[196:197],v246 offset:8192
ds_read_b64_tr_b16 a[198:199],v246 offset:9216
s_waitcnt vmcnt(8) lgkmcnt(0)
s_barrier
s_add_u32 s60,s56,1376256
s_mov_b32 m0,43008
s_nop 0
buffer_load_dwordx4 v240,s[84:87],s60 offen lds
s_add_u32 s60,s56,1384448
s_mov_b32 m0,44032
s_nop 0
buffer_load_dwordx4 v240,s[84:87],s60 offen lds
s_add_u32 s60,s56,1392640
s_mov_b32 m0,45056
s_nop 0
buffer_load_dwordx4 v241,s[84:87],s60 offen lds
s_add_u32 s60,s56,1400832
s_mov_b32 m0,46080
s_nop 0
buffer_load_dwordx4 v241,s[84:87],s60 offen lds
v_add_u32 v15,69632,v244
ds_read_b64_tr_b16 a[200:201],v15
ds_read_b64_tr_b16 a[202:203],v15 offset:1024
ds_read_b64_tr_b16 a[204:205],v15 offset:8192
ds_read_b64_tr_b16 a[206:207],v15 offset:9216
v_add_u32 v246,69632,v245
ds_read_b64_tr_b16 v[56:57],v246
ds_read_b64_tr_b16 v[58:59],v246 offset:1024
ds_read_b64_tr_b16 v[60:61],v246 offset:8192
ds_read_b64_tr_b16 v[62:63],v246 offset:9216
s_waitcnt vmcnt(8) lgkmcnt(0)
s_barrier
s_add_u32 s60,s56,1900544
s_mov_b32 m0,81920
s_nop 0
buffer_load_dwordx4 v240,s[84:87],s60 offen lds
s_add_u32 s60,s56,1908736
s_mov_b32 m0,82944
s_nop 0
buffer_load_dwordx4 v240,s[84:87],s60 offen lds
s_add_u32 s60,s56,1916928
s_mov_b32 m0,83968
s_nop 0
buffer_load_dwordx4 v241,s[84:87],s60 offen lds
s_add_u32 s60,s56,1925120
s_mov_b32 m0,84992
s_nop 0
buffer_load_dwordx4 v241,s[84:87],s60 offen lds
v_add_u32 v15,108544,v244
ds_read_b64_tr_b16 a[16:17],v15
ds_read_b64_tr_b16 a[18:19],v15 offset:1024
ds_read_b64_tr_b16 a[20:21],v15 offset:8192
ds_read_b64_tr_b16 a[22:23],v15 offset:9216
v_add_u32 v246,108544,v245
ds_read_b64_tr_b16 a[24:25],v246
ds_read_b64_tr_b16 a[26:27],v246 offset:1024
ds_read_b64_tr_b16 a[28:29],v246 offset:8192
ds_read_b64_tr_b16 a[30:31],v246 offset:9216
s_waitcnt vmcnt(8) lgkmcnt(0)
s_barrier
s_add_u32 s60,s56,2424832
s_mov_b32 m0,120832
s_nop 0
buffer_load_dwordx4 v240,s[84:87],s60 offen lds
s_add_u32 s60,s56,2433024
s_mov_b32 m0,121856
s_nop 0
buffer_load_dwordx4 v240,s[84:87],s60 offen lds
s_add_u32 s60,s56,2441216
s_mov_b32 m0,122880
s_nop 0
buffer_load_dwordx4 v241,s[84:87],s60 offen lds
s_add_u32 s60,s56,2449408
s_mov_b32 m0,123904
s_nop 0
buffer_load_dwordx4 v241,s[84:87],s60 offen lds
v_add_u32 v15,147456,v244
ds_read_b64_tr_b16 a[48:49],v15
ds_read_b64_tr_b16 a[50:51],v15 offset:1024
ds_read_b64_tr_b16 a[52:53],v15 offset:8192
ds_read_b64_tr_b16 a[54:55],v15 offset:9216
v_add_u32 v246,147456,v245
ds_read_b64_tr_b16 a[56:57],v246
ds_read_b64_tr_b16 a[58:59],v246 offset:1024
ds_read_b64_tr_b16 a[60:61],v246 offset:8192
ds_read_b64_tr_b16 a[62:63],v246 offset:9216
s_waitcnt vmcnt(8) lgkmcnt(0)
s_barrier
s_add_u32 s60,s56,2949120
s_mov_b32 m0,159744
s_nop 0
buffer_load_dwordx4 v240,s[84:87],s60 offen lds
s_add_u32 s60,s56,2957312
s_mov_b32 m0,160768
s_nop 0
buffer_load_dwordx4 v240,s[84:87],s60 offen lds
s_add_u32 s60,s56,2965504
s_mov_b32 m0,161792
s_nop 0
buffer_load_dwordx4 v241,s[84:87],s60 offen lds
s_add_u32 s60,s56,2973696
s_mov_b32 m0,162816
s_nop 0
buffer_load_dwordx4 v241,s[84:87],s60 offen lds
v_add_u32 v15,30720,v244
ds_read_b64_tr_b16 a[80:81],v15
ds_read_b64_tr_b16 a[82:83],v15 offset:1024
ds_read_b64_tr_b16 a[84:85],v15 offset:8192
ds_read_b64_tr_b16 a[86:87],v15 offset:9216
v_add_u32 v246,30720,v245
ds_read_b64_tr_b16 a[88:89],v246
ds_read_b64_tr_b16 a[90:91],v246 offset:1024
ds_read_b64_tr_b16 a[92:93],v246 offset:8192
ds_read_b64_tr_b16 a[94:95],v246 offset:9216
s_waitcnt vmcnt(8) lgkmcnt(0)
s_barrier
s_add_u32 s60,s56,3473408
s_mov_b32 m0,43008
s_nop 0
buffer_load_dwordx4 v240,s[84:87],s60 offen lds
s_add_u32 s60,s56,3481600
s_mov_b32 m0,44032
s_nop 0
buffer_load_dwordx4 v240,s[84:87],s60 offen lds
s_add_u32 s60,s56,3489792
s_mov_b32 m0,45056
s_nop 0
buffer_load_dwordx4 v241,s[84:87],s60 offen lds
s_add_u32 s60,s56,3497984
s_mov_b32 m0,46080
s_nop 0
buffer_load_dwordx4 v241,s[84:87],s60 offen lds
v_add_u32 v15,69632,v244
ds_read_b64_tr_b16 a[112:113],v15
ds_read_b64_tr_b16 a[114:115],v15 offset:1024
ds_read_b64_tr_b16 a[116:117],v15 offset:8192
ds_read_b64_tr_b16 a[118:119],v15 offset:9216
v_add_u32 v246,69632,v245
ds_read_b64_tr_b16 a[120:121],v246
ds_read_b64_tr_b16 a[122:123],v246 offset:1024
ds_read_b64_tr_b16 a[124:125],v246 offset:8192
ds_read_b64_tr_b16 a[126:127],v246 offset:9216
s_waitcnt vmcnt(8) lgkmcnt(0)
s_barrier
s_add_u32 s60,s56,3997696
s_mov_b32 m0,81920
s_nop 0
buffer_load_dwordx4 v240,s[84:87],s60 offen lds
s_add_u32 s60,s56,4005888
s_mov_b32 m0,82944
s_nop 0
buffer_load_dwordx4 v240,s[84:87],s60 offen lds
s_add_u32 s60,s56,4014080
s_mov_b32 m0,83968
s_nop 0
buffer_load_dwordx4 v241,s[84:87],s60 offen lds
s_add_u32 s60,s56,4022272
s_mov_b32 m0,84992
s_nop 0
buffer_load_dwordx4 v241,s[84:87],s60 offen lds
v_add_u32 v15,108544,v244
ds_read_b64_tr_b16 a[232:233],v15
ds_read_b64_tr_b16 a[234:235],v15 offset:1024
ds_read_b64_tr_b16 a[236:237],v15 offset:8192
ds_read_b64_tr_b16 a[238:239],v15 offset:9216
v_add_u32 v246,108544,v245
ds_read_b64_tr_b16 a[240:241],v246
ds_read_b64_tr_b16 a[242:243],v246 offset:1024
ds_read_b64_tr_b16 a[244:245],v246 offset:8192
ds_read_b64_tr_b16 a[246:247],v246 offset:9216
s_waitcnt vmcnt(8) lgkmcnt(0)
s_barrier
s_add_u32 s60,s56,4587520
s_mov_b32 m0,120832
s_nop 0
buffer_load_dwordx4 v242,s[84:87],s60 offen lds
s_add_u32 s60,s56,4603904
s_mov_b32 m0,121856
s_nop 0
buffer_load_dwordx4 v242,s[84:87],s60 offen lds
s_add_u32 s60,s56,4620288
s_mov_b32 m0,122880
s_nop 0
buffer_load_dwordx4 v243,s[84:87],s60 offen lds
s_add_u32 s60,s56,4636672
s_mov_b32 m0,123904
s_nop 0
buffer_load_dwordx4 v243,s[84:87],s60 offen lds
v_add_u32 v15,147456,v244
ds_read_b64_tr_b16 a[248:249],v15
ds_read_b64_tr_b16 a[250:251],v15 offset:1024
ds_read_b64_tr_b16 a[252:253],v15 offset:8192
ds_read_b64_tr_b16 a[254:255],v15 offset:9216
v_add_u32 v246,147456,v245
ds_read_b64_tr_b16 v[88:89],v246
ds_read_b64_tr_b16 v[90:91],v246 offset:1024
ds_read_b64_tr_b16 v[92:93],v246 offset:8192
ds_read_b64_tr_b16 v[94:95],v246 offset:9216
s_waitcnt vmcnt(8) lgkmcnt(0)
s_barrier
s_add_u32 s60,s32,27648
s_mov_b32 m0,159744
s_nop 0
buffer_load_dwordx4 v11,s[88:91],s60 offen lds
s_add_u32 s60,s32,29952
s_mov_b32 m0,160768
s_nop 0
buffer_load_dwordx4 v11,s[88:91],s60 offen lds
s_add_u32 s60,s32,32256
s_mov_b32 m0,161792
s_nop 0
buffer_load_dwordx4 v11,s[88:91],s60 offen lds
s_add_u32 s60,s32,34560
s_mov_b32 m0,162816
s_nop 0
buffer_load_dwordx4 v11,s[88:91],s60 offen lds
v_add_u32 v15,30720,v244
ds_read_b64_tr_b16 v[96:97],v15
ds_read_b64_tr_b16 v[98:99],v15 offset:1024
ds_read_b64_tr_b16 v[100:101],v15 offset:8192
ds_read_b64_tr_b16 v[102:103],v15 offset:9216
v_add_u32 v246,30720,v245
ds_read_b64_tr_b16 v[104:105],v246
ds_read_b64_tr_b16 v[106:107],v246 offset:1024
ds_read_b64_tr_b16 v[108:109],v246 offset:8192
ds_read_b64_tr_b16 v[110:111],v246 offset:9216
s_waitcnt vmcnt(8) lgkmcnt(0)
s_barrier
s_add_u32 s60,s32,64512
s_mov_b32 m0,43008
s_nop 0
buffer_load_dwordx4 v11,s[88:91],s60 offen lds
s_add_u32 s60,s32,66816
s_mov_b32 m0,44032
s_nop 0
buffer_load_dwordx4 v11,s[88:91],s60 offen lds
s_add_u32 s60,s32,69120
s_mov_b32 m0,45056
s_nop 0
buffer_load_dwordx4 v11,s[88:91],s60 offen lds
s_add_u32 s60,s32,71424
s_mov_b32 m0,46080
s_nop 0
buffer_load_dwordx4 v11,s[88:91],s60 offen lds
v_add_u32 v15,69632,v244
ds_read_b64_tr_b16 v[112:113],v15
ds_read_b64_tr_b16 v[114:115],v15 offset:1024
ds_read_b64_tr_b16 v[116:117],v15 offset:8192
ds_read_b64_tr_b16 v[118:119],v15 offset:9216
v_add_u32 v246,69632,v245
ds_read_b64_tr_b16 v[120:121],v246
ds_read_b64_tr_b16 v[122:123],v246 offset:1024
ds_read_b64_tr_b16 v[124:125],v246 offset:8192
ds_read_b64_tr_b16 v[126:127],v246 offset:9216
s_waitcnt vmcnt(8) lgkmcnt(0)
s_barrier
s_add_u32 s60,s32,101376
s_mov_b32 m0,81920
s_nop 0
buffer_load_dwordx4 v11,s[88:91],s60 offen lds
s_add_u32 s60,s32,103680
s_mov_b32 m0,82944
s_nop 0
buffer_load_dwordx4 v11,s[88:91],s60 offen lds
s_add_u32 s60,s32,105984
s_mov_b32 m0,83968
s_nop 0
buffer_load_dwordx4 v11,s[88:91],s60 offen lds
s_add_u32 s60,s32,108288
s_mov_b32 m0,84992
s_nop 0
buffer_load_dwordx4 v11,s[88:91],s60 offen lds
v_add_u32 v15,108544,v244
ds_read_b64_tr_b16 v[128:129],v15
ds_read_b64_tr_b16 v[130:131],v15 offset:1024
ds_read_b64_tr_b16 v[132:133],v15 offset:8192
ds_read_b64_tr_b16 v[134:135],v15 offset:9216
v_add_u32 v246,108544,v245
ds_read_b64_tr_b16 v[136:137],v246
ds_read_b64_tr_b16 v[138:139],v246 offset:1024
ds_read_b64_tr_b16 v[140:141],v246 offset:8192
ds_read_b64_tr_b16 v[142:143],v246 offset:9216
s_waitcnt vmcnt(8) lgkmcnt(0)
s_barrier
s_add_u32 s60,s32,138240
s_mov_b32 m0,120832
s_nop 0
buffer_load_dwordx4 v11,s[88:91],s60 offen lds
s_add_u32 s60,s32,140544
s_mov_b32 m0,121856
s_nop 0
buffer_load_dwordx4 v11,s[88:91],s60 offen lds
s_add_u32 s60,s32,142848
s_mov_b32 m0,122880
s_nop 0
buffer_load_dwordx4 v11,s[88:91],s60 offen lds
s_add_u32 s60,s32,145152
s_mov_b32 m0,123904
s_nop 0
buffer_load_dwordx4 v11,s[88:91],s60 offen lds
v_add_u32 v15,147456,v13
ds_read_b64_tr_b16 v[160:161],v15
ds_read_b64_tr_b16 v[162:163],v15 offset:1024
ds_read_b64_tr_b16 v[164:165],v15 offset:4096
ds_read_b64_tr_b16 v[166:167],v15 offset:5120
ds_read_b64_tr_b16 v[184:185],v15 offset:256
ds_read_b64_tr_b16 v[186:187],v15 offset:1280
ds_read_b64_tr_b16 v[188:189],v15 offset:4352
ds_read_b64_tr_b16 v[190:191],v15 offset:5376
s_waitcnt vmcnt(8) lgkmcnt(0)
s_barrier
s_add_u32 s60,s32,28160
s_mov_b32 m0,159744
s_nop 0
buffer_load_dwordx4 v11,s[88:91],s60 offen lds
s_add_u32 s60,s32,30464
s_mov_b32 m0,160768
s_nop 0
buffer_load_dwordx4 v11,s[88:91],s60 offen lds
s_add_u32 s60,s32,32768
s_mov_b32 m0,161792
s_nop 0
buffer_load_dwordx4 v11,s[88:91],s60 offen lds
s_add_u32 s60,s32,35072
s_mov_b32 m0,162816
s_nop 0
buffer_load_dwordx4 v11,s[88:91],s60 offen lds
v_add_u32 v15,30720,v13
ds_read_b64_tr_b16 v[168:169],v15
ds_read_b64_tr_b16 v[170:171],v15 offset:1024
ds_read_b64_tr_b16 v[172:173],v15 offset:4096
ds_read_b64_tr_b16 v[174:175],v15 offset:5120
ds_read_b64_tr_b16 v[192:193],v15 offset:256
ds_read_b64_tr_b16 v[194:195],v15 offset:1280
ds_read_b64_tr_b16 v[196:197],v15 offset:4352
ds_read_b64_tr_b16 v[198:199],v15 offset:5376
s_waitcnt vmcnt(8) lgkmcnt(0)
s_barrier
s_add_u32 s60,s32,65024
s_mov_b32 m0,43008
s_nop 0
buffer_load_dwordx4 v11,s[88:91],s60 offen lds
s_add_u32 s60,s32,67328
s_mov_b32 m0,44032
s_nop 0
buffer_load_dwordx4 v11,s[88:91],s60 offen lds
s_add_u32 s60,s32,69632
s_mov_b32 m0,45056
s_nop 0
buffer_load_dwordx4 v11,s[88:91],s60 offen lds
s_add_u32 s60,s32,71936
s_mov_b32 m0,46080
s_nop 0
buffer_load_dwordx4 v11,s[88:91],s60 offen lds
v_add_u32 v15,69632,v13
ds_read_b64_tr_b16 v[176:177],v15
ds_read_b64_tr_b16 v[178:179],v15 offset:1024
ds_read_b64_tr_b16 v[180:181],v15 offset:4096
ds_read_b64_tr_b16 v[182:183],v15 offset:5120
ds_read_b64_tr_b16 v[200:201],v15 offset:256
ds_read_b64_tr_b16 v[202:203],v15 offset:1280
ds_read_b64_tr_b16 v[204:205],v15 offset:4352
ds_read_b64_tr_b16 v[206:207],v15 offset:5376
s_waitcnt vmcnt(8) lgkmcnt(0)
s_barrier
s_add_u32 s60,s32,101888
s_mov_b32 m0,81920
s_nop 0
buffer_load_dwordx4 v11,s[88:91],s60 offen lds
s_add_u32 s60,s32,104192
s_mov_b32 m0,82944
s_nop 0
buffer_load_dwordx4 v11,s[88:91],s60 offen lds
s_add_u32 s60,s32,106496
s_mov_b32 m0,83968
s_nop 0
buffer_load_dwordx4 v11,s[88:91],s60 offen lds
s_add_u32 s60,s32,108800
s_mov_b32 m0,84992
s_nop 0
buffer_load_dwordx4 v11,s[88:91],s60 offen lds
v_add_u32 v15,108544,v13
ds_read_b64_tr_b16 v[16:17],v15
ds_read_b64_tr_b16 v[18:19],v15 offset:1024
ds_read_b64_tr_b16 v[20:21],v15 offset:4096
ds_read_b64_tr_b16 v[22:23],v15 offset:5120
ds_read_b64_tr_b16 v[24:25],v15 offset:256
ds_read_b64_tr_b16 v[26:27],v15 offset:1280
ds_read_b64_tr_b16 v[28:29],v15 offset:4352
ds_read_b64_tr_b16 v[30:31],v15 offset:5376
s_waitcnt vmcnt(8) lgkmcnt(0)
s_barrier
s_add_u32 s60,s32,138752
s_mov_b32 m0,120832
s_nop 0
buffer_load_dwordx4 v11,s[88:91],s60 offen lds
s_add_u32 s60,s32,141056
s_mov_b32 m0,121856
s_nop 0
buffer_load_dwordx4 v11,s[88:91],s60 offen lds
s_add_u32 s60,s32,143360
s_mov_b32 m0,122880
s_nop 0
buffer_load_dwordx4 v11,s[88:91],s60 offen lds
s_add_u32 s60,s32,145664
s_mov_b32 m0,123904
s_nop 0
buffer_load_dwordx4 v11,s[88:91],s60 offen lds
v_add_u32 v15,147456,v13
ds_read_b64_tr_b16 v[32:33],v15
ds_read_b64_tr_b16 v[34:35],v15 offset:1024
ds_read_b64_tr_b16 v[36:37],v15 offset:4096
ds_read_b64_tr_b16 v[38:39],v15 offset:5120
ds_read_b64_tr_b16 v[40:41],v15 offset:256
ds_read_b64_tr_b16 v[42:43],v15 offset:1280
ds_read_b64_tr_b16 v[44:45],v15 offset:4352
ds_read_b64_tr_b16 v[46:47],v15 offset:5376
s_waitcnt vmcnt(8) lgkmcnt(0)
s_barrier
s_add_u32 s60,s32,111616
s_mov_b32 m0,159744
s_nop 0
buffer_load_dwordx4 v12,s[88:91],s60 offen lds
s_add_u32 s60,s32,120832
s_mov_b32 m0,160768
s_nop 0
buffer_load_dwordx4 v12,s[88:91],s60 offen lds
s_add_u32 s60,s32,130048
s_mov_b32 m0,161792
s_nop 0
buffer_load_dwordx4 v12,s[88:91],s60 offen lds
s_add_u32 s60,s32,139264
s_mov_b32 m0,162816
s_nop 0
buffer_load_dwordx4 v12,s[88:91],s60 offen lds
v_add_u32 v15,30720,v13
ds_read_b64_tr_b16 v[208:209],v15
ds_read_b64_tr_b16 v[210:211],v15 offset:1024
ds_read_b64_tr_b16 v[212:213],v15 offset:4096
ds_read_b64_tr_b16 v[214:215],v15 offset:5120
ds_read_b64_tr_b16 v[224:225],v15 offset:256
ds_read_b64_tr_b16 v[226:227],v15 offset:1280
ds_read_b64_tr_b16 v[228:229],v15 offset:4352
ds_read_b64_tr_b16 v[230:231],v15 offset:5376
s_waitcnt vmcnt(8) lgkmcnt(0)
s_barrier
v_add_u32 v15,69632,v13
ds_read_b64_tr_b16 v[216:217],v15
ds_read_b64_tr_b16 v[218:219],v15 offset:1024
ds_read_b64_tr_b16 v[220:221],v15 offset:4096
ds_read_b64_tr_b16 v[222:223],v15 offset:5120
ds_read_b64_tr_b16 v[232:233],v15 offset:256
ds_read_b64_tr_b16 v[234:235],v15 offset:1280
ds_read_b64_tr_b16 v[236:237],v15 offset:4352
ds_read_b64_tr_b16 v[238:239],v15 offset:5376
s_waitcnt vmcnt(4) lgkmcnt(0)
s_barrier
v_add_u32 v15,108544,v13
ds_read_b64_tr_b16 v[144:145],v15
ds_read_b64_tr_b16 v[146:147],v15 offset:1024
ds_read_b64_tr_b16 v[148:149],v15 offset:4096
ds_read_b64_tr_b16 v[150:151],v15 offset:5120
ds_read_b64_tr_b16 v[152:153],v15 offset:256
ds_read_b64_tr_b16 v[154:155],v15 offset:1280
ds_read_b64_tr_b16 v[156:157],v15 offset:4352
ds_read_b64_tr_b16 v[158:159],v15 offset:5376
s_waitcnt vmcnt(0) lgkmcnt(0)
s_barrier
v_add_u32 v15,147456,v14
ds_read_b64_tr_b16 v[240:241],v15
ds_read_b64_tr_b16 v[242:243],v15 offset:2048
ds_read_b64_tr_b16 v[244:245],v15 offset:4096
ds_read_b64_tr_b16 v[246:247],v15 offset:6144
ds_read_b64_tr_b16 v[248:249],v15 offset:8192
ds_read_b64_tr_b16 v[250:251],v15 offset:10240
ds_read_b64_tr_b16 v[252:253],v15 offset:12288
ds_read_b64_tr_b16 v[254:255],v15 offset:14336
s_waitcnt lgkmcnt(0)
s_barrier
ds_write_b128 v3,v[64:67] offset:22528
ds_write_b128 v3,v[68:71] offset:23552
ds_write_b128 v3,v[48:51] offset:24576
ds_write_b128 v3,v[52:55] offset:25600
ds_write_b128 v3,v[56:59] offset:26624
ds_write_b128 v3,v[60:63] offset:27648
ds_write_b128 v3,v[72:75] offset:28672
ds_write_b128 v3,v[76:79] offset:29696
ds_write_b128 v3,v[16:19] offset:30720
ds_write_b128 v3,v[20:23] offset:31744
ds_write_b128 v3,v[24:27] offset:32768
ds_write_b128 v3,v[28:31] offset:33792
ds_write_b128 v3,v[32:35] offset:34816
ds_write_b128 v3,v[36:39] offset:35840
ds_write_b128 v3,v[40:43] offset:36864
ds_write_b128 v3,v[44:47] offset:37888
s_waitcnt lgkmcnt(0)
v_mov_b32_e64 v11,v10
ch3_layer:
s_mov_b32 s25,0
s_mul_i32 s39,s24,1064960
s_add_u32 s32,s39,41957376
s_add_u32 s56,s39,41949184
s_lshl_b32 s39,s24,6
s_add_u32 s39,s39,s52
s_add_u32 s54,s39,8392704
s_add_u32 s55,s39,8388608
s_mov_b32 s38,0
ch3_entry:
v_and_b32 v10,8,v2
v_add_u32 v10,v9,v10
v_mov_b32 v48,0
v_mov_b32 v49,0
v_mov_b32 v50,0
v_mov_b32 v51,0
v_mov_b32 v52,0
v_mov_b32 v53,0
v_mov_b32 v54,0
v_mov_b32 v55,0
v_mov_b32 v56,0
v_mov_b32 v57,0
v_mov_b32 v58,0
v_mov_b32 v59,0
v_mov_b32 v60,0
v_mov_b32 v61,0
v_mov_b32 v62,0
v_mov_b32_e64 v63,0
ds_read_b128 v[64:67],v3
ds_read_b128 v[68:71],v3 offset:1024
ds_read_b128 v[72:75],v3 offset:2048
ds_read_b128 v[76:79],v3 offset:3072
v_mov_b32 v80,0
v_mov_b32 v81,0
v_mov_b32 v82,0
v_mov_b32 v83,0
v_mov_b32 v84,0
v_mov_b32 v85,0
v_mov_b32 v86,0
v_mov_b32 v87,0
buffer_load_dwordx4 v[44:47],v0,s[8:11],s27 offen
buffer_load_dwordx4 v[12:15],v0,s[8:11],s27 offen offset:1024
buffer_load_dwordx4 v[16:19],v0,s[8:11],s28 offen
buffer_load_dwordx4 v[20:23],v0,s[8:11],s28 offen offset:1024
s_waitcnt vmcnt(0)
s_lshl_b32 s53,s24,10
s_add_u32 s53,s53,s52
s_add_u32 s53,s53,6422528
ch3_kv0:
buffer_load_dword v11,v0,s[8:11],s53 offen sc1
s_add_u32 s38,s38,1
s_cmp_gt_u32 s38,2000000
s_cbranch_scc1 ch3_fail
s_sleep 1
s_waitcnt vmcnt(0)
v_cmp_ne_u32 s[50:51],0,v11
s_nop 0
s_bitcmp1_b64 s[50:51],0
s_cbranch_scc0 ch3_kv0
s_barrier
ch3_top:
s_waitcnt vmcnt(3) lgkmcnt(2)
v_cmp_eq_u32 vcc,-1,v44
s_cbranch_vccnz ch3_retry0
ch3_ok0:
v_smfmac_f32_16x16x64_bf16 v[48:51],v[44:47],v[64:71],v5
ds_read_b128 v[64:67],v3 offset:4096
v_smfmac_f32_16x16x64_bf16 v[56:59],v[44:47],a[0:7],v5
ds_read_b128 v[68:71],v3 offset:5120
buffer_load_dwordx4 v[24:27],v0,s[8:11],s28 offen offset:2048
v_smfmac_f32_16x16x64_bf16 v[52:55],v[44:47],a[8:15],v5
s_add_u32 s40,s25,1
s_waitcnt vmcnt(3) lgkmcnt(2)
v_cmp_ne_u32 s[16:17],0,v11
v_smfmac_f32_16x16x64_bf16 v[60:63],v[44:47],v[72:79],v5
ds_read_b128 v[72:75],v3 offset:6144
v_cmp_eq_u32_e64 vcc,-1,v12
v_smfmac_f32_16x16x64_bf16 v[80:83],v[44:47],a[16:23],v5
ds_read_b128 v[76:79],v3 offset:7168
buffer_load_dwordx4 v[28:31],v0,s[8:11],s28 offen offset:3072
v_smfmac_f32_16x16x64_bf16 v[84:87],v[44:47],a[24:31],v5
s_cbranch_vccnz ch3_retry1
ch3_ok1:
s_waitcnt lgkmcnt(2)
v_smfmac_f32_16x16x64_bf16 v[48:51],v[12:15],v[64:71],v5
ds_read_b128 v[64:67],v3 offset:8192
v_smfmac_f32_16x16x64_bf16 v[56:59],v[12:15],a[32:39],v5
ds_read_b128 v[68:71],v3 offset:9216
buffer_load_dwordx4 v[32:35],v0,s[8:11],s29 offen
v_smfmac_f32_16x16x64_bf16 v[52:55],v[12:15],a[40:47],v5
s_or_b64 s[50:51],s[50:51],s[16:17]
s_add_u32 s33,s25,4
s_waitcnt vmcnt(4) lgkmcnt(2)
v_smfmac_f32_16x16x64_bf16 v[60:63],v[12:15],v[72:79],v5
ds_read_b128 v[72:75],v3 offset:10240
v_cmp_eq_u32 vcc,-1,v16
v_smfmac_f32_16x16x64_bf16 v[80:83],v[12:15],a[48:55],v5
ds_read_b128 v[76:79],v3 offset:11264
buffer_load_dwordx4 v[36:39],v0,s[8:11],s29 offen offset:1024
v_smfmac_f32_16x16x64_bf16 v[84:87],v[12:15],a[56:63],v5
s_cbranch_vccnz ch3_retry2
ch3_ok2:
s_waitcnt lgkmcnt(2)
v_smfmac_f32_16x16x64_bf16 v[48:51],v[16:19],v[64:71],v5
ds_read_b128 v[64:67],v3 offset:12288
s_min_u32 s33,s33,63
v_smfmac_f32_16x16x64_bf16 v[56:59],v[16:19],a[64:71],v5
ds_read_b128 v[68:71],v3 offset:13312
buffer_load_dwordx4 v[40:43],v0,s[8:11],s29 offen offset:2048
v_and_b32 v12,32,v0
v_smfmac_f32_16x16x64_bf16 v[52:55],v[16:19],a[72:79],v5
s_bitcmp1_b64 s[50:51],s33
s_cselect_b32 s33,0x40000000,s53
s_waitcnt vmcnt(5) lgkmcnt(2)
v_lshl_add_u32 v12,v12,4,v9
v_smfmac_f32_16x16x64_bf16 v[60:63],v[16:19],v[72:79],v5
ds_read_b128 v[72:75],v3 offset:14336
v_cmp_eq_u32 vcc,-1,v20
v_smfmac_f32_16x16x64_bf16 v[80:83],v[16:19],a[80:87],v5
ds_read_b128 v[76:79],v3 offset:15360
buffer_load_dwordx4 v[44:47],v12,s[8:11],s56 offen sc1
v_smfmac_f32_16x16x64_bf16 v[84:87],v[16:19],a[88:95],v5
s_cbranch_vccnz ch3_retry3
ch3_ok3:
s_waitcnt lgkmcnt(2)
v_smfmac_f32_16x16x64_bf16 v[48:51],v[20:23],v[64:71],v5
ds_read_b128 v[64:67],v3 offset:16384
s_bitcmp1_b64 s[50:51],s40
v_smfmac_f32_16x16x64_bf16 v[56:59],v[20:23],a[96:103],v5
ds_read_b128 v[68:71],v3 offset:17408
buffer_load_dwordx4 v[12:15],v12,s[8:11],s56 offen offset:1024 sc1
v_smfmac_f32_16x16x64_bf16 v[52:55],v[20:23],a[104:111],v5
s_cbranch_scc0 ch3_kvw
ch3_kvok:
s_waitcnt vmcnt(6) lgkmcnt(2)
v_smfmac_f32_16x16x64_bf16 v[60:63],v[20:23],v[72:79],v5
ds_read_b128 v[72:75],v3 offset:18432
v_cmp_eq_u32 vcc,-1,v24
v_smfmac_f32_16x16x64_bf16 v[80:83],v[20:23],a[112:119],v5
ds_read_b128 v[76:79],v3 offset:19456
buffer_load_dwordx4 v[16:19],v0,s[8:11],s32 offen sc1
v_smfmac_f32_16x16x64_bf16 v[84:87],v[20:23],a[120:127],v5
s_cbranch_vccnz ch3_retry4
ch3_ok4:
s_waitcnt vmcnt(6) lgkmcnt(2)
v_smfmac_f32_16x16x64_bf16 v[48:51],v[24:27],v[64:71],v5
ds_read_b128 v[64:67],v3 offset:20480
s_add_u32 s39,s56,10240
v_cmp_eq_u32_e64 vcc,-1,v28
v_smfmac_f32_16x16x64_bf16 v[56:59],v[24:27],a[128:135],v5
ds_read_b128 v[68:71],v3 offset:21504
buffer_load_dwordx4 v[20:23],v0,s[8:11],s32 offen offset:1024 sc1
v_lshlrev_b32_e64 v11,3,v0
v_smfmac_f32_16x16x64_bf16 v[52:55],v[24:27],a[136:143],v5
s_cbranch_vccnz ch3_retry5
ch3_ok5:
s_waitcnt vmcnt(6) lgkmcnt(2)
v_smfmac_f32_16x16x64_bf16 v[60:63],v[24:27],v[72:79],v5
ds_read_b128 v[72:75],v3 offset:22528
s_add_u32 s40,s39,8192
v_cmp_eq_u32_e64 vcc,-1,v32
v_smfmac_f32_16x16x64_bf16 v[48:51],v[28:31],a[144:151],v5
ds_read_b128 v[76:79],v3 offset:23552
s_barrier
buffer_load_dword v11,v11,s[8:11],s39 offen sc1
v_smfmac_f32_16x16x64_bf16 v[56:59],v[28:31],a[152:159],v5
s_cbranch_vccnz ch3_retry6
ch3_ok6:
s_waitcnt vmcnt(6) lgkmcnt(2)
v_smfmac_f32_16x16x64_bf16 v[52:55],v[28:31],v[64:71],v5
ds_read_b128 v[64:67],v3 offset:24576
v_cmp_eq_u32 vcc,-1,v36
v_smfmac_f32_16x16x64_bf16 v[60:63],v[28:31],a[160:167],v5
ds_read_b128 v[68:71],v3 offset:25600
v_smfmac_f32_16x16x64_bf16 v[48:51],v[32:35],a[168:175],v5
s_cbranch_vccnz ch3_retry7
ch3_ok7:
s_waitcnt vmcnt(5) lgkmcnt(2)
v_smfmac_f32_16x16x64_bf16 v[56:59],v[32:35],v[72:79],v5
ds_read_b128 v[72:75],v3 offset:26624
v_cmp_eq_u32_e64 vcc,-1,v40
v_smfmac_f32_16x16x64_bf16 v[52:55],v[32:35],a[176:183],v5
ds_read_b128 v[76:79],v3 offset:27648
buffer_store_dword v8,v7,s[8:11],s54 offen sc1
v_smfmac_f32_16x16x64_bf16 v[60:63],v[32:35],a[184:191],v5
s_cbranch_vccnz ch3_retry8
ch3_ok8:
s_waitcnt lgkmcnt(2)
v_smfmac_f32_16x16x64_bf16 v[48:51],v[36:39],v[64:71],v5
ds_read_b128 v[64:67],v3 offset:28672
v_smfmac_f32_16x16x64_bf16 v[52:55],v[36:39],a[192:199],v5
ds_read_b128 v[68:71],v3 offset:29696
v_smfmac_f32_16x16x64_bf16 v[48:51],v[40:43],a[200:207],v5
s_waitcnt lgkmcnt(2)
v_smfmac_f32_16x16x64_bf16 v[52:55],v[40:43],v[72:79],v5
v_smfmac_f32_16x16x64_bf16 v[56:59],v[36:39],a[208:215],v5
buffer_load_dword v11,v11,s[8:11],s40 offen sc1
v_add_f32 v48,v48,v50
v_smfmac_f32_16x16x64_bf16 v[56:59],v[40:43],a[216:223],v5
s_waitcnt lgkmcnt(0)
v_add_f32 v49,v49,v51
v_smfmac_f32_16x16x64_bf16 v[60:63],v[36:39],v[64:71],v5
s_mov_b64 exec,15
buffer_load_dword v11,v11,s[8:11],s45 offen sc1
s_mov_b64 exec,-1
v_cvt_pk_bf16_f32 v50,v48,v49
v_smfmac_f32_16x16x64_bf16 v[60:63],v[40:43],a[224:231],v5
buffer_load_dword v11,v0,s[8:11],s33 offen sc1
v_add_f32 v52,v52,v54
v_add_f32 v53,v53,v55
v_cvt_pk_bf16_f32 v54,v52,v53
v_add_f32 v56,v56,v58
v_add_f32 v57,v57,v59
v_cvt_pk_bf16_f32 v51,v56,v57
v_add_f32 v60,v60,v62
v_add_f32 v61,v61,v63
v_cvt_pk_bf16_f32 v55,v60,v61
ds_write2st64_b64 v1,v[50:51],v[54:55] offset0:14 offset1:15
v_smfmac_f32_16x16x64_bf16 v[80:83],v[24:27],a[232:239],v5
v_mov_b32 v76,s18
v_smfmac_f32_16x16x64_bf16 v[84:87],v[24:27],a[240:247],v5
v_mov_b32 v77,s18
v_smfmac_f32_16x16x64_bf16 v[80:83],v[28:31],a[248:255],v5
v_mov_b32 v78,s18
v_smfmac_f32_16x16x64_bf16 v[84:87],v[28:31],v[88:95],v5
v_mov_b32 v79,s18
v_smfmac_f32_16x16x64_bf16 v[80:83],v[32:35],v[96:103],v5
v_mov_b32 v24,0
s_waitcnt lgkmcnt(0)
s_barrier
v_smfmac_f32_16x16x64_bf16 v[84:87],v[32:35],v[104:111],v5
ds_read_b64_tr_b16 v[48:49],v4 offset:4096
ds_read_b64_tr_b16 v[50:51],v4 offset:4608
v_smfmac_f32_16x16x64_bf16 v[80:83],v[36:39],v[112:119],v5
ds_read_b64_tr_b16 v[52:53],v4 offset:5120
ds_read_b64_tr_b16 v[54:55],v4 offset:5632
v_smfmac_f32_16x16x64_bf16 v[84:87],v[36:39],v[120:127],v5
ds_read_b64_tr_b16 v[56:57],v4 offset:6144
ds_read_b64_tr_b16 v[58:59],v4 offset:6656
v_smfmac_f32_16x16x64_bf16 v[80:83],v[40:43],v[128:135],v5
ds_read_b64_tr_b16 v[60:61],v4 offset:7168
ds_read_b64_tr_b16 v[62:63],v4 offset:7680
s_waitcnt lgkmcnt(6) vmcnt(7)
v_mfma_f32_16x16x32_bf16 v[64:67],v[44:47],v[48:51],0
s_waitcnt lgkmcnt(4)
v_mov_b32 v25,0
v_mfma_f32_16x16x32_bf16 v[68:71],v[44:47],v[52:55],0
s_waitcnt lgkmcnt(2)
v_mov_b32 v26,0
v_mfma_f32_16x16x32_bf16 v[64:67],v[12:15],v[56:59],v[64:67]
s_waitcnt lgkmcnt(0)
v_mov_b32 v27,0
v_mfma_f32_16x16x32_bf16 v[68:71],v[12:15],v[60:63],v[68:71]
v_mov_b32 v44,0
v_mfma_f32_16x16x32_bf16 v[72:75],v[48:51],v[48:51],0
v_mul_f32 v64,s42,v64
v_mul_f32 v65,s42,v65
v_mfma_f32_16x16x32_bf16 v[72:75],v[52:55],v[52:55],v[72:75]
v_fmac_f32 v64,s42,v70
v_fmac_f32 v65,s42,v71
v_exp_f32 v66,v64
v_exp_f32 v67,v65
s_mov_b64 exec,s[48:49]
v_cvt_pk_bf16_f32 v66,v66,v67
ds_write_b32 v9,v66 offset:524
s_mov_b64 exec,-1
v_mfma_f32_16x16x32_bf16 v[72:75],v[56:59],v[56:59],v[72:75]
v_mov_b32 v45,0
v_mov_b32 v46,0
v_mfma_f32_16x16x32_bf16 v[72:75],v[60:63],v[60:63],v[72:75]
v_mov_b32 v47,0
v_mov_b32 v12,0
v_mov_b32 v13,0
v_mov_b32 v14,0
v_mov_b32 v15,0
v_mfma_f32_16x16x32_bf16 v[48:51],v[76:79],v[76:79],0
s_waitcnt lgkmcnt(0)
s_barrier
ds_read_b128 v[56:59],v9 offset:512
v_smfmac_f32_16x16x64_bf16 v[84:87],v[40:43],v[136:143],v5
v_mul_f32 v74,s42,v74
v_mul_f32 v75,s42,v75
v_exp_f32 v72,v74
v_exp_f32 v73,v75
v_mov_b32 v61,0
v_cvt_pk_bf16_f32 v72,v72,v73
v_mov_b32 v62,0
s_nop 0
v_mov_b32_dpp v60,v72 quad_perm:[0,1,0,1] row_mask:0xf bank_mask:0xf
s_waitcnt vmcnt(5) lgkmcnt(0)
v_mfma_f32_16x16x32_bf16 v[48:51],v[76:79],v[56:59],0
ds_read_b128 v[28:31],v3 offset:30720
v_mov_b32_dpp v63,v72 quad_perm:[0,1,0,1] row_mask:0xf bank_mask:0xf
v_add_f32_e64 v80,v80,v82
v_mfma_f32_16x16x32_bf16 v[52:55],v[16:19],v[56:59],0
ds_read_b128 v[32:35],v3 offset:31744
v_add_f32_e64 v81,v81,v83
v_cvt_pk_bf16_f32 v82,v80,v81
v_mfma_f32_16x16x32_bf16 v[68:71],v[20:23],v[56:59],0
ds_read_b128 v[36:39],v3 offset:32768
v_add_f32 v84,v84,v86
v_add_f32 v85,v85,v87
v_mfma_f32_16x16x16_bf16 v[48:51],v[76:77],v[60:61],v[48:51]
ds_read_b128 v[40:43],v3 offset:33792
v_cvt_pk_bf16_f32 v83,v84,v85
s_nop 1
v_mfma_f32_16x16x16_bf16 v[52:55],v[82:83],v[60:61],v[52:55]
v_mov_b32 v84,0
v_mov_b32 v85,0
v_mfma_f32_16x16x16_bf16 v[68:71],v[82:83],v[62:63],v[68:71]
v_rcp_f32 v66,v48
v_subrev_u32_e64 v67,s58,v48
v_cndmask_b32 v48,0,v66,s[48:49]
v_cndmask_b32 v50,0,v66,s[46:47]
v_mul_f32 v52,v52,v48
v_mul_f32 v53,v53,v48
v_mul_f32 v54,v54,v48
v_mul_f32 v55,v55,v48
v_cmp_lt_u32 vcc,0x3c000000,v67
v_pk_fma_f32 v[52:53],v[68:69],v[50:51],v[52:53] op_sel_hi:[1,0,1]
v_pk_fma_f32 v[54:55],v[70:71],v[50:51],v[54:55] op_sel_hi:[1,0,1]
v_cvt_pk_bf16_f32 v58,v52,v53
v_cvt_pk_bf16_f32 v59,v54,v55
v_mfma_f32_16x16x32_bf16 v[68:71],v[76:79],v[76:79],0
ds_write_b64 v10,v[58:59] offset:3584
s_cbranch_vccnz ch3_slowsm
ch3_smdone:
v_mov_b32_dpp v60,v58 quad_perm:[0,1,0,1] row_mask:0xf bank_mask:0xf
v_mov_b32_dpp v61,v59 quad_perm:[0,1,0,1] row_mask:0xf bank_mask:0xf
v_mov_b32_dpp v62,v58 quad_perm:[2,3,2,3] row_mask:0xf bank_mask:0xf
v_mov_b32_dpp v63,v59 quad_perm:[2,3,2,3] row_mask:0xf bank_mask:0xf
s_waitcnt lgkmcnt(1)
s_nop 0
v_mfma_f32_16x16x32_bf16 v[16:19],v[60:63],v[252:255],0
v_mov_b32 v86,0
v_mov_b32_e64 v87,0
v_smfmac_f32_16x16x64_bf16 v[44:47],v[60:63],v[28:35],v5
s_waitcnt lgkmcnt(0)
s_barrier
ds_read_b128 v[48:51],v9 offset:2048
ds_read_b128 v[52:55],v9 offset:2560
ds_read_b128 v[56:59],v9 offset:3072
v_smfmac_f32_16x16x64_bf16 v[12:15],v[60:63],v[36:43],v5
v_smfmac_f32_16x16x64_bf16 v[24:27],v[60:63],v[144:151],v5
v_smfmac_f32_16x16x64_bf16 v[84:87],v[60:63],v[152:159],v5
ds_read_b128 v[64:67],v3 offset:34816
s_waitcnt lgkmcnt(3)
v_smfmac_f32_16x16x64_bf16 v[44:47],v[48:51],v[160:167],v5
ds_read_b128 v[68:71],v3 offset:35840
s_waitcnt lgkmcnt(3)
v_smfmac_f32_16x16x64_bf16 v[44:47],v[52:55],v[168:175],v5
ds_read_b128 v[72:75],v3 offset:36864
s_waitcnt lgkmcnt(3)
v_smfmac_f32_16x16x64_bf16 v[44:47],v[56:59],v[176:183],v5
ds_read_b128 v[76:79],v3 offset:37888
v_smfmac_f32_16x16x64_bf16 v[12:15],v[48:51],v[184:191],v5
ds_read_b128 v[80:83],v0 offset:1024
v_smfmac_f32_16x16x64_bf16 v[12:15],v[52:55],v[192:199],v5
v_cvt_pk_bf16_f32 v44,v44,v45
v_cvt_pk_bf16_f32 v45,v46,v47
v_and_or_b32 v44,v44,-2,s26
v_smfmac_f32_16x16x64_bf16 v[12:15],v[56:59],v[200:207],v5
buffer_store_dwordx2 v[44:45],v6,s[8:11],s34 offen
s_waitcnt lgkmcnt(3)
v_smfmac_f32_16x16x64_bf16 v[24:27],v[48:51],v[64:71],v5
v_smfmac_f32_16x16x64_bf16 v[24:27],v[52:55],v[208:215],v5
v_cvt_pk_bf16_f32 v12,v12,v13
v_cvt_pk_bf16_f32 v13,v14,v15
v_and_or_b32 v12,v12,-2,s26
v_smfmac_f32_16x16x64_bf16 v[24:27],v[56:59],v[216:223],v5
buffer_store_dwordx2 v[12:13],v6,s[8:11],s41 offen
s_waitcnt lgkmcnt(1)
v_smfmac_f32_16x16x64_bf16 v[84:87],v[48:51],v[72:79],v5
v_smfmac_f32_16x16x64_bf16 v[84:87],v[52:55],v[224:231],v5
v_cvt_pk_bf16_f32 v24,v24,v25
v_cvt_pk_bf16_f32 v25,v26,v27
v_and_or_b32 v24,v24,-2,s26
v_smfmac_f32_16x16x64_bf16 v[84:87],v[56:59],v[232:239],v5
buffer_store_dwordx2 v[24:25],v6,s[8:11],s35 offen
v_mfma_f32_16x16x32_bf16 v[16:19],v[48:51],v[240:243],v[16:19]
v_mfma_f32_16x16x32_bf16 v[16:19],v[52:55],v[244:247],v[16:19]
v_cvt_pk_bf16_f32 v26,v84,v85
v_cvt_pk_bf16_f32 v27,v86,v87
v_and_or_b32 v26,v26,-2,s26
v_mfma_f32_16x16x32_bf16 v[16:19],v[56:59],v[248:251],v[16:19]
buffer_store_dwordx2 v[26:27],v6,s[8:11],s44 offen
ds_read_b128 v[64:67],v3
ds_read_b128 v[68:71],v3 offset:1024
ds_read_b128 v[72:75],v3 offset:2048
ds_read_b128 v[76:79],v3 offset:3072
s_nop 2
v_cvt_pk_bf16_f32 v16,v16,v17
v_and_or_b32 v16,v16,-2,s26
buffer_store_dword v16,v2,s[8:11],s36 offen
v_mov_b32 v48,0
s_add_u32 s25,s25,1
v_mov_b32 v49,0
s_add_u32 s32,s32,16384
v_mov_b32 v50,0
s_add_u32 s56,s56,16384
v_mov_b32 v51,0
s_add_u32 s27,s27,0x4000
v_mov_b32 v52,0
s_add_u32 s28,s28,0x4000
v_mov_b32_e64 v53,0
s_add_u32 s29,s29,0x4000
v_mov_b32 v54,0
s_add_u32 s30,s30,0x4000
v_mov_b32 v55,0
s_add_u32 s54,s54,0x4000
v_mov_b32 v56,0
s_add_u32 s45,s45,0x4000
v_mov_b32 v57,0
s_nop 0
v_mov_b32 v58,0
s_nop 0
v_mov_b32 v59,0
s_nop 0
v_mov_b32 v60,0
s_nop 0
v_mov_b32 v61,0
s_nop 0
v_mov_b32 v62,0
s_nop 0
v_mov_b32 v63,0
s_nop 0
v_mov_b32 v5,v5
s_nop 3
v_mov_b32 v5,v5
s_nop 3
v_mov_b32 v5,v5
s_nop 3
v_mov_b32 v5,v5
s_nop 3
v_mov_b32 v5,v5
s_nop 3
v_mov_b32 v5,v5
s_nop 3
v_mov_b32 v5,v5
s_nop 3
v_mov_b32 v5,v5
s_nop 3
v_mov_b32 v5,v5
s_nop 3
v_mov_b32_e64 v5,v5
s_nop 0
buffer_load_dwordx4 v[28:31],v0,s[8:11],s37 offen sc1
buffer_load_dwordx4 v[32:35],v0,s[8:11],s37 offen offset:1024 sc1
v_mov_b32 v5,v5
s_nop 3
v_mov_b32 v5,v5
s_nop 3
v_mov_b32 v5,v5
s_nop 3
v_mov_b32 v5,v5
s_nop 3
v_mov_b32 v5,v5
s_nop 3
v_mov_b32 v5,v5
s_nop 3
v_mov_b32 v5,v5
s_nop 3
v_mov_b32 v5,v5
s_nop 0
s_waitcnt vmcnt(1) lgkmcnt(0)
v_mfma_f32_16x16x32_bf16 v[84:87],v[80:83],v[28:31],0
v_xor_b32_e64 v28,s26,v28
s_waitcnt vmcnt(0)
v_mfma_f32_16x16x32_bf16 v[84:87],v[80:83],v[32:35],v[84:87]
v_bitop3_b32 v28,v28,v32,s26 bitop3:0xf6
v_and_b32 v28,1,v28
v_cmp_ne_u32_e64 vcc,0,v28
s_nop 3
v_add_f32_dpp v84,v84,v84 row_ror:4 row_mask:0xf bank_mask:0xf
v_add_f32_dpp v85,v85,v85 row_ror:4 row_mask:0xf bank_mask:0xf
s_nop 0
v_add_f32_dpp v84,v84,v84 row_ror:8 row_mask:0xf bank_mask:0xf
v_add_f32_dpp v85,v85,v85 row_ror:8 row_mask:0xf bank_mask:0xf
v_cvt_pk_bf16_f32 v8,v84,v85
s_cbranch_vccnz ch3_pollP0
ch3_okP0:
buffer_store_dword v8,v7,s[8:11],s30 offen
s_barrier
buffer_load_dwordx4 v[44:47],v0,s[8:11],s27 offen
v_mov_b32 v80,0
s_nop 0
v_mov_b32 v81,0
s_nop 0
v_mov_b32 v82,0
buffer_load_dwordx4 v[12:15],v0,s[8:11],s27 offen offset:1024
s_nop 0
v_mov_b32 v83,0
s_nop 0
v_mov_b32 v84,0
s_nop 0
v_mov_b32 v85,0
s_nop 0
v_mov_b32 v86,0
s_nop 0
buffer_load_dwordx4 v[16:19],v0,s[8:11],s28 offen
v_mov_b32 v87,0
s_nop 0
v_mov_b32 v5,v5
s_nop 3
v_mov_b32 v5,v5
s_nop 0
buffer_load_dwordx4 v[20:23],v0,s[8:11],s28 offen offset:1024
s_xor_b32 s26,s26,1
s_cmp_eq_u32 s25,63
s_cbranch_scc1 ch3_done
s_branch ch3_top
ch3_pollP0:
buffer_load_dwordx4 v[28:31],v0,s[8:11],s37 offen sc1
buffer_load_dwordx4 v[32:35],v0,s[8:11],s37 offen offset:1024 sc1
s_add_u32 s38,s38,1
s_cmp_gt_u32 s38,2000000
s_cbranch_scc1 ch3_fail
s_waitcnt vmcnt(1) lgkmcnt(0)
v_mfma_f32_16x16x32_bf16 v[84:87],v[80:83],v[28:31],0
v_xor_b32 v28,s26,v28
s_waitcnt vmcnt(0)
v_mfma_f32_16x16x32_bf16 v[84:87],v[80:83],v[32:35],v[84:87]
v_bitop3_b32 v28,v28,v32,s26 bitop3:0xf6
v_and_b32 v28,1,v28
v_cmp_ne_u32 vcc,0,v28
s_nop 3
v_add_f32_dpp v84,v84,v84 row_ror:4 row_mask:0xf bank_mask:0xf
v_add_f32_dpp v85,v85,v85 row_ror:4 row_mask:0xf bank_mask:0xf
s_nop 0
v_add_f32_dpp v84,v84,v84 row_ror:8 row_mask:0xf bank_mask:0xf
v_add_f32_dpp v85,v85,v85 row_ror:8 row_mask:0xf bank_mask:0xf
v_cvt_pk_bf16_f32 v8,v84,v85
s_cbranch_vccnz ch3_pollP0
s_branch ch3_okP0
ch3_slowsm:
s_mov_b64 exec,s[48:49]
ds_write_b64 v9,v[64:65] offset:4616
s_mov_b64 exec,-1
s_waitcnt lgkmcnt(0)
s_barrier
ds_read_b128 v[48:51],v9 offset:4096
ds_read_b128 v[52:55],v9 offset:4608
v_mov_b32_dpp v72,v74 quad_perm:[0,1,0,1] row_mask:0xf bank_mask:0xf
v_mov_b32_dpp v73,v75 quad_perm:[0,1,0,1] row_mask:0xf bank_mask:0xf
s_waitcnt lgkmcnt(0)
v_max_f32 v68,v48,v49
v_max3_f32 v68,v68,v50,v51
v_max3_f32 v68,v68,v52,v53
v_max3_f32 v68,v68,v54,v55
v_max3_f32 v68,v68,v72,v73
v_mov_b32 v69,v68
s_nop 1
v_permlane16_swap_b32 v68,v69
v_max_f32 v68,v68,v69
v_mov_b32 v69,v68
s_nop 1
v_permlane32_swap_b32 v68,v69
v_max_f32 v68,v68,v69
v_sub_f32 v48,v48,v68
v_exp_f32 v48,v48
v_sub_f32 v49,v49,v68
v_exp_f32 v49,v49
v_sub_f32 v50,v50,v68
v_exp_f32 v50,v50
v_sub_f32 v51,v51,v68
v_exp_f32 v51,v51
v_sub_f32 v52,v52,v68
v_exp_f32 v52,v52
v_sub_f32 v53,v53,v68
v_exp_f32 v53,v53
v_sub_f32 v54,v54,v68
v_exp_f32 v54,v54
v_sub_f32 v55,v55,v68
v_exp_f32 v55,v55
v_sub_f32 v72,v72,v68
v_exp_f32 v72,v72
v_sub_f32 v73,v73,v68
v_exp_f32 v73,v73
v_cvt_pk_bf16_f32 v56,v48,v49
v_cvt_pk_bf16_f32 v57,v50,v51
v_cvt_pk_bf16_f32 v58,v52,v53
v_cvt_pk_bf16_f32 v59,v54,v55
v_cvt_pk_bf16_f32 v60,v72,v73
v_cvt_pk_bf16_f32 v63,v72,v73
v_mfma_f32_16x16x32_bf16 v[48:51],v[76:79],v[56:59],0
v_mfma_f32_16x16x32_bf16 v[52:55],v[16:19],v[56:59],0
v_mfma_f32_16x16x32_bf16 v[68:71],v[20:23],v[56:59],0
v_mfma_f32_16x16x16_bf16 v[48:51],v[76:77],v[60:61],v[48:51]
v_mfma_f32_16x16x16_bf16 v[52:55],v[82:83],v[60:61],v[52:55]
v_mfma_f32_16x16x16_bf16 v[68:71],v[82:83],v[62:63],v[68:71]
v_rcp_f32 v66,v48
s_nop 0
v_cndmask_b32 v48,0,v66,s[48:49]
v_cndmask_b32 v50,0,v66,s[46:47]
v_mul_f32 v52,v52,v48
v_mul_f32 v53,v53,v48
v_mul_f32 v54,v54,v48
v_mul_f32 v55,v55,v48
v_pk_fma_f32 v[52:53],v[68:69],v[50:51],v[52:53] op_sel_hi:[1,0,1]
v_pk_fma_f32 v[54:55],v[70:71],v[50:51],v[54:55] op_sel_hi:[1,0,1]
v_cvt_pk_bf16_f32 v58,v52,v53
v_cvt_pk_bf16_f32 v59,v54,v55
v_mfma_f32_16x16x32_bf16 v[68:71],v[76:79],v[76:79],0
ds_write_b64 v10,v[58:59] offset:3584
s_branch ch3_smdone
ch3_retry0:
buffer_load_dwordx4 v[44:47],v0,s[8:11],s27 offen sc1
buffer_load_dwordx4 v[12:15],v0,s[8:11],s27 offen offset:1024 sc1
buffer_load_dwordx4 v[16:19],v0,s[8:11],s28 offen sc1
buffer_load_dwordx4 v[20:23],v0,s[8:11],s28 offen offset:1024 sc1
s_add_u32 s38,s38,1
s_cmp_gt_u32 s38,2000000
s_cbranch_scc1 ch3_fail
s_waitcnt vmcnt(0)
v_cmp_eq_u32_e64 vcc,-1,v44
s_cbranch_vccnz ch3_retry0
s_branch ch3_ok0
ch3_retry1:
buffer_load_dwordx4 v[12:15],v0,s[8:11],s27 offen offset:1024 sc1
buffer_load_dwordx4 v[16:19],v0,s[8:11],s28 offen sc1
buffer_load_dwordx4 v[20:23],v0,s[8:11],s28 offen offset:1024 sc1
buffer_load_dwordx4 v[24:27],v0,s[8:11],s28 offen offset:2048 sc1
buffer_load_dwordx4 v[28:31],v0,s[8:11],s28 offen offset:3072 sc1
s_add_u32 s38,s38,1
s_cmp_gt_u32 s38,2000000
s_cbranch_scc1 ch3_fail
s_waitcnt vmcnt(0)
v_cmp_eq_u32 vcc,-1,v12
s_cbranch_vccnz ch3_retry1
s_branch ch3_ok1
ch3_retry2:
buffer_load_dwordx4 v[16:19],v0,s[8:11],s28 offen sc1
buffer_load_dwordx4 v[20:23],v0,s[8:11],s28 offen offset:1024 sc1
buffer_load_dwordx4 v[24:27],v0,s[8:11],s28 offen offset:2048 sc1
buffer_load_dwordx4 v[28:31],v0,s[8:11],s28 offen offset:3072 sc1
buffer_load_dwordx4 v[32:35],v0,s[8:11],s29 offen sc1
buffer_load_dwordx4 v[36:39],v0,s[8:11],s29 offen offset:1024 sc1
s_add_u32 s38,s38,1
s_cmp_gt_u32 s38,2000000
s_cbranch_scc1 ch3_fail
s_waitcnt vmcnt(0)
v_cmp_eq_u32 vcc,-1,v16
s_cbranch_vccnz ch3_retry2
s_branch ch3_ok2
ch3_retry3:
buffer_load_dwordx4 v[20:23],v0,s[8:11],s28 offen offset:1024 sc1
buffer_load_dwordx4 v[24:27],v0,s[8:11],s28 offen offset:2048 sc1
buffer_load_dwordx4 v[28:31],v0,s[8:11],s28 offen offset:3072 sc1
buffer_load_dwordx4 v[32:35],v0,s[8:11],s29 offen sc1
buffer_load_dwordx4 v[36:39],v0,s[8:11],s29 offen offset:1024 sc1
buffer_load_dwordx4 v[40:43],v0,s[8:11],s29 offen offset:2048 sc1
s_add_u32 s38,s38,1
s_cmp_gt_u32 s38,2000000
s_cbranch_scc1 ch3_fail
s_waitcnt vmcnt(0)
v_cmp_eq_u32 vcc,-1,v20
s_cbranch_vccnz ch3_retry3
s_branch ch3_ok3
ch3_retry4:
buffer_load_dwordx4 v[24:27],v0,s[8:11],s28 offen offset:2048 sc1
buffer_load_dwordx4 v[28:31],v0,s[8:11],s28 offen offset:3072 sc1
buffer_load_dwordx4 v[32:35],v0,s[8:11],s29 offen sc1
buffer_load_dwordx4 v[36:39],v0,s[8:11],s29 offen offset:1024 sc1
buffer_load_dwordx4 v[40:43],v0,s[8:11],s29 offen offset:2048 sc1
s_add_u32 s38,s38,1
s_cmp_gt_u32 s38,2000000
s_cbranch_scc1 ch3_fail
s_waitcnt vmcnt(0)
v_cmp_eq_u32 vcc,-1,v24
s_cbranch_vccnz ch3_retry4
s_branch ch3_ok4
ch3_retry5:
buffer_load_dwordx4 v[28:31],v0,s[8:11],s28 offen offset:3072 sc1
buffer_load_dwordx4 v[32:35],v0,s[8:11],s29 offen sc1
buffer_load_dwordx4 v[36:39],v0,s[8:11],s29 offen offset:1024 sc1
buffer_load_dwordx4 v[40:43],v0,s[8:11],s29 offen offset:2048 sc1
s_add_u32 s38,s38,1
s_cmp_gt_u32 s38,2000000
s_cbranch_scc1 ch3_fail
s_waitcnt vmcnt(0)
v_cmp_eq_u32 vcc,-1,v28
s_cbranch_vccnz ch3_retry5
s_branch ch3_ok5
ch3_retry6:
buffer_load_dwordx4 v[32:35],v0,s[8:11],s29 offen sc1
buffer_load_dwordx4 v[36:39],v0,s[8:11],s29 offen offset:1024 sc1
buffer_load_dwordx4 v[40:43],v0,s[8:11],s29 offen offset:2048 sc1
s_add_u32 s38,s38,1
s_cmp_gt_u32 s38,2000000
s_cbranch_scc1 ch3_fail
s_waitcnt vmcnt(0)
v_cmp_eq_u32 vcc,-1,v32
s_cbranch_vccnz ch3_retry6
s_branch ch3_ok6
ch3_retry7:
buffer_load_dwordx4 v[36:39],v0,s[8:11],s29 offen offset:1024 sc1
buffer_load_dwordx4 v[40:43],v0,s[8:11],s29 offen offset:2048 sc1
s_add_u32 s38,s38,1
s_cmp_gt_u32 s38,2000000
s_cbranch_scc1 ch3_fail
s_waitcnt vmcnt(0)
v_cmp_eq_u32 vcc,-1,v36
s_cbranch_vccnz ch3_retry7
s_branch ch3_ok7
ch3_retry8:
buffer_load_dwordx4 v[40:43],v0,s[8:11],s29 offen offset:2048 sc1
s_add_u32 s38,s38,1
s_cmp_gt_u32 s38,2000000
s_cbranch_scc1 ch3_fail
s_waitcnt vmcnt(0)
v_cmp_eq_u32_e64 vcc,-1,v40
s_cbranch_vccnz ch3_retry8
s_branch ch3_ok8
ch3_kvw:
buffer_load_dword v11,v0,s[8:11],s53 offen sc1
s_add_u32 s38,s38,1
s_cmp_gt_u32 s38,2000000
s_cbranch_scc1 ch3_fail
s_waitcnt vmcnt(0)
v_cmp_ne_u32 s[50:51],0,v11
s_nop 0
s_bitcmp1_b64 s[50:51],s40
s_cbranch_scc0 ch3_kvw
s_branch ch3_kvok
ch3_done:
buffer_store_dword v8,v7,s[8:11],s54 offen sc1
s_waitcnt vmcnt(0) lgkmcnt(0)
s_cmp_lg_u32 s52,0
s_cbranch_scc1 c_join
s_mov_b32 s52,16777216
s_mov_b32 s23,1
s_add_u32 s40,s30,0x8000
buffer_load_dword v21,v7,s[8:11],s40 offen sc1
s_add_u32 s27,s27,0x4000
s_add_u32 s28,s28,0x4000
s_add_u32 s29,s29,0x4000
s_add_u32 s30,s30,0x4000
s_add_u32 s54,s54,0x4000
s_add_u32 s45,s45,0x4000
v_lshrrev_b32 v18,4,v0
v_and_b32 v28,3,v18
v_bfe_u32 v30,v18,4,1
v_lshrrev_b32_e64 v29,5,v18
v_mul_u32_u24 v29,1152,v29
v_lshl_add_u32 v28,v28,1,v30
v_lshl_add_u32 v29,v28,1,v29
s_and_b32 s39,s24,3
s_mul_i32 s39,s39,2304
s_lshr_b32 s40,s24,3
s_lshl_b32 s40,s40,6
s_add_u32 s39,s39,s40
s_bfe_u32 s40,s24,0x10002
s_lshl_b32 s40,s40,4
s_add_u32 s39,s39,s40
buffer_load_ushort v31,v29,s[12:15],s39 offen offset:512
buffer_load_ushort v32,v29,s[12:15],s39 offen offset:544
s_waitcnt vmcnt(0)
v_lshl_or_b32 v28,v32,16,v31
v_min_u32 v8,-2,v28
buffer_store_dword v8,v7,s[8:11],s30 offen
s_mov_b32 s63,6308092
v_mov_b32 v12,0
ch3_idle:
s_sleep 16
buffer_load_dword v13,v12,s[8:11],s63 offen sc1
s_add_u32 s38,s38,1
s_cmp_gt_u32 s38,2000000
s_cbranch_scc1 ch3_fail
s_waitcnt vmcnt(0)
v_cmp_eq_u32 vcc,0,v13
s_cbranch_vccnz ch3_idle
s_branch ch3_layer
ch3_fail:
s_waitcnt vmcnt(0) lgkmcnt(0)
s_endpgm
k_last:
s_endpgm

.section .rodata,"a"
.p2align 6
.amdhsa_kernel interleave_layers__memory_aug_recurrent_mem_tr__mha_block__prompt_kernel
  .amdhsa_next_free_vgpr 512
  .amdhsa_next_free_sgpr 102
  .amdhsa_accum_offset 256
  .amdhsa_group_segment_fixed_size 0
  .amdhsa_kernarg_size 104
  .amdhsa_user_sgpr_count 2
  .amdhsa_user_sgpr_kernarg_segment_ptr 1
  .amdhsa_system_sgpr_workgroup_id_x 1
.end_amdhsa_kernel
```
